```python
import torch

def _softmax(x, axis=-1):
    return torch.softmax(x, dim=axis)

def _gelu(x):
    return torch.nn.functional.gelu(x, approximate='tanh')

def _silu(x):
    return torch.nn.functional.silu(x)

def _sigmoid(x):
    return torch.sigmoid(x)

def _layernorm(x, axis=-1, eps=1e-05):
    m = x.mean(dim=axis, keepdim=True)
    v = x.var(dim=axis, keepdim=True, unbiased=False)
    return (x - m) / torch.sqrt(v + eps)

def _scatter_add(tgt, idx, src, axis=0):
    return tgt.clone().index_add_(axis, idx, src)

def _segment_sum(src, seg, n):
    out = torch.zeros((n,) + src.shape[1:], dtype=src.dtype)
    return out.index_add_(0, seg, src)

def _pad(x, pw):
    flat = tuple((v for pair in reversed(pw) for v in pair))
    return torch.nn.functional.pad(x, flat)
kernel_name = 'parallel_sum__memory_aug_recurrent_mem_tr__dense_activation_silu__prompt'

def setup_inputs():

    _w = lambda a: (lambda t: t.to(torch.bfloat16) if t.is_floating_point() else t)(torch.as_tensor(a))

    def _A_setup():
        B, S, Dm = (1, 2048, 576)
        H, Dh = (32, 128)
        M, seg = (8, 32)
        seg = min(seg, S)
        S = S // seg * seg
        return {'x': _w((lambda *s: torch.randn(*s, dtype=torch.bfloat16) * 0.05)(B, S, Dm)), 'mem0': _w((lambda *s: torch.randn(*s, dtype=torch.bfloat16) * 0.2)(B, M, Dm)), 'Wq': _w((lambda *s: torch.randn(*s, dtype=torch.bfloat16) * 1.6)(Dm, H, Dh) * Dm ** (-0.5)), 'Wk': _w((lambda *s: torch.randn(*s, dtype=torch.bfloat16) * 1.6)(Dm, H, Dh) * Dm ** (-0.5)), 'Wv': _w((lambda *s: torch.randn(*s, dtype=torch.bfloat16) * 0.2)(Dm, H, Dh) * Dm ** (-0.5)), 'Wo': _w((lambda *s: torch.randn(*s, dtype=torch.bfloat16) * 0.2)(H, Dh, Dm) * (H * Dh) ** (-0.5)), 'seg_len': seg}
    _A_in = _A_setup()

    def _B_setup():
        B, S, D, F = (1, 2048, 576, 4608)
        return {'x': _w((lambda *s: torch.randn(*s, dtype=torch.bfloat16) * 0.05)(B, S, D)), 'w1': _w((lambda *s: torch.randn(*s, dtype=torch.bfloat16) * 0.8)(D, F) * D ** (-0.5)), 'w2': _w((lambda *s: torch.randn(*s, dtype=torch.bfloat16) * 0.1)(F, D) * F ** (-0.5))}
    _B_in = _B_setup()
    return {'A_x': _A_in['x'], 'A_mem0': _A_in['mem0'], 'A_Wq': _A_in['Wq'], 'A_Wk': _A_in['Wk'], 'A_Wv': _A_in['Wv'], 'A_Wo': _A_in['Wo'], 'A_seg_len': _A_in['seg_len'], 'B_x': _B_in['x'], 'B_w1': _B_in['w1'], 'B_w2': _B_in['w2']}

def reference(A_x, A_mem0, A_Wq, A_Wk, A_Wv, A_Wo, A_seg_len, B_x, B_w1, B_w2):

    def _A_ref(x, mem0, Wq, Wk, Wv, Wo, seg_len):
        B, S, Dm = x.shape
        H, Dh = (Wq.shape[1], Wq.shape[2])
        M = mem0.shape[1]
        scale = Dh ** (-0.5)
        n_seg = S // seg_len
        L = M + seg_len
        idx = torch.arange(L)
        mask = (idx[:, None] < M) | (idx[:, None] >= idx[None, :])
        mem = mem0
        outs = []
        for s in range(n_seg):
            xs = x[:, s * seg_len:(s + 1) * seg_len, :].clone()
            h = torch.concatenate([mem, xs], axis=1)
            q = torch.einsum('btd,dhe->bhte', h, Wq)
            k = torch.einsum('btd,dhe->bhte', h, Wk)
            v = torch.einsum('btd,dhe->bhte', h, Wv)
            scores = torch.einsum('bhqe,bhke->bhqk', q, k) * scale
            scores = torch.where(mask[None, None], scores, -1000000000.0)
            p = _softmax(scores, axis=-1)
            o = torch.einsum('bhqk,bhke->bhqe', p, v)
            o = torch.einsum('bhte,hed->btd', o, Wo)
            mem = o[:, :M, :].clone()
            outs.append(o[:, M:, :])
        return torch.concatenate(outs, axis=1)

    def _B_ref(x, w1, w2):
        h = torch.einsum('bsd,df->bsf', x, w1)
        h = _silu(h)
        out = torch.einsum('bsf,fd->bsd', h, w2)
        return out
    x = A_x
    xn = _layernorm(x, axis=-1)
    return x + _A_ref(xn, A_mem0, A_Wq, A_Wk, A_Wv, A_Wo, A_seg_len) + _B_ref(xn, B_w1, B_w2)
```

```asm
; @launch grid=(256,1,1) block=(256,1,1) lds=163840
.amdgcn_target "amdgcn-amd-amdhsa--gfx950"
.text
.globl parallel_sum__memory_aug_recurrent_mem_tr__dense_activation_silu__prompt_kernel
.p2align 8
.type parallel_sum__memory_aug_recurrent_mem_tr__dense_activation_silu__prompt_kernel,@function
parallel_sum__memory_aug_recurrent_mem_tr__dense_activation_silu__prompt_kernel:
    s_cmp_ge_u32 s2, 256
    s_cbranch_scc1 L_exit
    s_load_dwordx16 s[64:79], s[0:1], 0
    s_load_dwordx8 s[80:87], s[0:1], 64
    s_load_dwordx2 s[88:89], s[0:1], 96
    v_lshrrev_b32_e64 v1, 6, v0
    s_getreg_b32 s90, hwreg(HW_REG_XCC_ID, 0, 4)
    v_readfirstlane_b32 s4, v1
    s_waitcnt lgkmcnt(0)
    s_mov_b32 s32, s86
    s_mov_b32 s33, s87
    s_mov_b32 s34, 256
    s_mov_b32 s35, 0x20000
    s_cmp_lg_u32 s4, 0
    s_cbranch_scc1 L_notick
    s_lshl_b32 s91, s90, 2
    s_add_u32 s91, s91, 128
    s_cmp_eq_u32 s90, 0
    s_cselect_b32 s91, 0, s91
    v_mov_b32_e64 v1, 1
    s_mov_b64 exec, 1
    buffer_atomic_add v1, off, s[32:35], s91 sc0
    s_mov_b64 exec, -1
L_notick:
    s_mov_b32 s8, s88
    s_mov_b32 s9, s89
    s_mov_b32 s10, 268435456
    s_mov_b32 s11, 0x20000
    s_mov_b32 s48, s64
    s_mov_b32 s49, s65
    s_mov_b32 s50, 2359296
    s_mov_b32 s51, 0x20000
    s_mov_b32 s28, s66
    s_mov_b32 s29, s67
    s_mov_b32 s30, 9216
    s_mov_b32 s31, 0x20000
    s_mov_b32 s12, s68
    s_mov_b32 s13, s69
    s_mov_b32 s14, 4718592
    s_mov_b32 s15, 0x20000
    s_mov_b32 s16, s70
    s_mov_b32 s17, s71
    s_mov_b32 s18, 4718592
    s_mov_b32 s19, 0x20000
    s_mov_b32 s20, s72
    s_mov_b32 s21, s73
    s_mov_b32 s22, 4718592
    s_mov_b32 s23, 0x20000
    s_mov_b32 s24, s74
    s_mov_b32 s25, s75
    s_mov_b32 s26, 4718592
    s_mov_b32 s27, 0x20000
    s_mov_b32 s40, s80
    s_mov_b32 s41, s81
    s_mov_b32 s42, 5308416
    s_mov_b32 s43, 0x20000
    s_mov_b32 s44, s82
    s_mov_b32 s45, s83
    s_mov_b32 s46, 5308416
    s_mov_b32 s47, 0x20000
    s_mov_b32 s36, s84
    s_mov_b32 s37, s85
    s_mov_b32 s38, 2359296
    s_mov_b32 s39, 0x20000
    v_bfe_u32 v220, v0, 3, 3
    v_and_b32 v221, 7, v0
    v_mul_u32_u24 v222, 1152, v220
    v_lshl_add_u32 v222, v221, 4, v222
    v_lshrrev_b32 v223, 1, v221
    v_lshlrev_b32 v223, 10, v223
    v_and_b32_e64 v221, 1, v221
    v_lshl_add_u32 v223, v221, 9, v223
    v_lshl_add_u32 v223, v220, 4, v223
    s_cmp_lg_u32 s4, 0
    s_cbranch_scc1 L_tick_wait
    s_waitcnt vmcnt(0)
    v_readfirstlane_b32 s5, v1
    s_cmp_ge_u32 s5, 32
    s_cbranch_scc1 L_tick_over
    s_cmp_ge_u32 s90, 8
    s_cbranch_scc1 L_tick_over
    s_lshl_b32 s91, s90, 5
    s_add_u32 s5, s5, s91
    s_add_u32 s92, s2, 1
L_tick_id:
    s_cmp_ge_u32 s5, 32
    s_cbranch_scc1 L_tick_put
    v_mov_b32 v1, s92
    s_lshl_b32 s91, s5, 1
    s_mov_b64 exec, 1
    buffer_store_short v1, off, s[32:35], s91 offset:64 sc1
    s_mov_b64 exec, -1
    s_branch L_tick_put
L_tick_over:
    v_mov_b32 v1, 1
    s_mov_b64 exec, 1
    buffer_atomic_add v1, off, s[32:35], 0 offset:8 sc0
    s_mov_b64 exec, -1
    s_mov_b32 s79, 524288
    v_lshlrev_b32 v2, 2, v0
L_tick_poll:
    buffer_load_dword v3, v2, s[32:35], 0 offen sc1
    s_waitcnt vmcnt(0)
    v_readlane_b32 s92, v3, 0
    v_readlane_b32 s94, v3, 33
    s_add_u32 s92, s92, s94
    v_readlane_b32 s94, v3, 34
    s_add_u32 s92, s92, s94
    v_readlane_b32 s94, v3, 35
    s_add_u32 s92, s92, s94
    v_readlane_b32 s94, v3, 36
    s_add_u32 s92, s92, s94
    v_readlane_b32 s94, v3, 37
    s_add_u32 s92, s92, s94
    v_readlane_b32 s94, v3, 38
    s_add_u32 s92, s92, s94
    v_readlane_b32 s94, v3, 39
    s_add_u32 s92, s92, s94
    v_readlane_b32 s94, v3, 40
    s_add_u32 s92, s92, s94
    v_readlane_b32 s94, v3, 41
    s_add_u32 s92, s92, s94
    v_readlane_b32 s94, v3, 42
    s_add_u32 s92, s92, s94
    v_readlane_b32 s94, v3, 43
    s_add_u32 s92, s92, s94
    v_readlane_b32 s94, v3, 44
    s_add_u32 s92, s92, s94
    v_readlane_b32 s94, v3, 45
    s_add_u32 s92, s92, s94
    v_readlane_b32 s94, v3, 46
    s_add_u32 s92, s92, s94
    v_readlane_b32 s94, v3, 47
    s_add_u32 s92, s92, s94
    s_cmp_ge_u32 s92, 256
    s_cbranch_scc1 L_tick_sum
    s_sleep 8
    s_sub_u32 s79, s79, 1
    s_cbranch_scc1 L_tick_fail
    s_branch L_tick_poll
L_tick_fail:
    s_mov_b32 s5, 4096
    s_branch L_tick_put
L_tick_sum:
    v_readfirstlane_b32 s93, v1
    s_mov_b32 s92, 0xffff
    v_readlane_b32 s94, v3, 0
    s_min_u32 s94, s94, 32
    s_add_u32 s5, s94, s93
    s_cmp_lt_u32 s5, 32
    s_cselect_b32 s91, 1, 0
    s_add_u32 s5, s5, 0
    s_cmp_lg_u32 s91, 0
    s_cbranch_scc1 L_tick_id
    s_add_u32 s93, s93, s94
    s_sub_u32 s93, s93, 32
    v_readlane_b32 s94, v3, 33
    s_min_u32 s94, s94, 32
    s_add_u32 s5, s94, s93
    s_cmp_lt_u32 s5, 32
    s_cselect_b32 s91, 1, 0
    s_add_u32 s5, s5, 32
    s_cmp_lg_u32 s91, 0
    s_cbranch_scc1 L_tick_id
    s_add_u32 s93, s93, s94
    s_sub_u32 s93, s93, 32
    v_readlane_b32 s94, v3, 34
    s_min_u32 s94, s94, 32
    s_add_u32 s5, s94, s93
    s_cmp_lt_u32 s5, 32
    s_cselect_b32 s91, 1, 0
    s_add_u32 s5, s5, 64
    s_cmp_lg_u32 s91, 0
    s_cbranch_scc1 L_tick_id
    s_add_u32 s93, s93, s94
    s_sub_u32 s93, s93, 32
    v_readlane_b32 s94, v3, 35
    s_min_u32 s94, s94, 32
    s_add_u32 s5, s94, s93
    s_cmp_lt_u32 s5, 32
    s_cselect_b32 s91, 1, 0
    s_add_u32 s5, s5, 96
    s_cmp_lg_u32 s91, 0
    s_cbranch_scc1 L_tick_id
    s_add_u32 s93, s93, s94
    s_sub_u32 s93, s93, 32
    v_readlane_b32 s94, v3, 36
    s_min_u32 s94, s94, 32
    s_add_u32 s5, s94, s93
    s_cmp_lt_u32 s5, 32
    s_cselect_b32 s91, 1, 0
    s_add_u32 s5, s5, 128
    s_cmp_lg_u32 s91, 0
    s_cbranch_scc1 L_tick_id
    s_add_u32 s93, s93, s94
    s_sub_u32 s93, s93, 32
    v_readlane_b32 s94, v3, 37
    s_min_u32 s94, s94, 32
    s_add_u32 s5, s94, s93
    s_cmp_lt_u32 s5, 32
    s_cselect_b32 s91, 1, 0
    s_add_u32 s5, s5, 160
    s_cmp_lg_u32 s91, 0
    s_cbranch_scc1 L_tick_id
    s_add_u32 s93, s93, s94
    s_sub_u32 s93, s93, 32
    v_readlane_b32 s94, v3, 38
    s_min_u32 s94, s94, 32
    s_add_u32 s5, s94, s93
    s_cmp_lt_u32 s5, 32
    s_cselect_b32 s91, 1, 0
    s_add_u32 s5, s5, 192
    s_cmp_lg_u32 s91, 0
    s_cbranch_scc1 L_tick_id
    s_add_u32 s93, s93, s94
    s_sub_u32 s93, s93, 32
    v_readlane_b32 s94, v3, 39
    s_min_u32 s94, s94, 32
    s_add_u32 s5, s94, s93
    s_cmp_lt_u32 s5, 32
    s_cselect_b32 s91, 1, 0
    s_add_u32 s5, s5, 224
    s_cmp_lg_u32 s91, 0
    s_cbranch_scc1 L_tick_id
    s_add_u32 s93, s93, s94
    s_sub_u32 s93, s93, 32
    s_mov_b32 s5, 4096
L_tick_put:
    v_mov_b32 v1, s5
    v_mov_b32 v2, 0
    ds_write_b32 v2, v1
    s_waitcnt lgkmcnt(0)
    s_branch L_role
L_tick_wait:
    s_cmp_eq_u32 s4, 3
    s_cbranch_scc1 L_ln
    s_cmp_lg_u32 s2, 1
    s_cbranch_scc1 L_noclear
    s_cmp_lg_u32 s4, 1
    s_cbranch_scc1 L_noclear
    v_and_b32 v2, 63, v0
    v_lshlrev_b32 v2, 4, v2
    v_mov_b32 v4, 0
    v_mov_b32 v5, 0
    v_mov_b32 v6, 0
    v_mov_b32_e64 v7, 0
    s_mov_b32 s91, 0
    buffer_store_dwordx4 v[4:7], v2, s[8:11], s91 offen offset:0 sc1
    buffer_store_dwordx4 v[4:7], v2, s[8:11], s91 offen offset:1024 sc1
    buffer_store_dwordx4 v[4:7], v2, s[8:11], s91 offen offset:2048 sc1
    buffer_store_dwordx4 v[4:7], v2, s[8:11], s91 offen offset:3072 sc1
    s_mov_b32 s91, 4096
    buffer_store_dwordx4 v[4:7], v2, s[8:11], s91 offen offset:0 sc1
    buffer_store_dwordx4 v[4:7], v2, s[8:11], s91 offen offset:1024 sc1
    buffer_store_dwordx4 v[4:7], v2, s[8:11], s91 offen offset:2048 sc1
    buffer_store_dwordx4 v[4:7], v2, s[8:11], s91 offen offset:3072 sc1
    s_mov_b32 s91, 8192
    buffer_store_dwordx4 v[4:7], v2, s[8:11], s91 offen offset:0 sc1
    buffer_store_dwordx4 v[4:7], v2, s[8:11], s91 offen offset:1024 sc1
    buffer_store_dwordx4 v[4:7], v2, s[8:11], s91 offen offset:2048 sc1
    buffer_store_dwordx4 v[4:7], v2, s[8:11], s91 offen offset:3072 sc1
    s_mov_b32 s91, 12288
    buffer_store_dwordx4 v[4:7], v2, s[8:11], s91 offen offset:0 sc1
    buffer_store_dwordx4 v[4:7], v2, s[8:11], s91 offen offset:1024 sc1
    buffer_store_dwordx4 v[4:7], v2, s[8:11], s91 offen offset:2048 sc1
    buffer_store_dwordx4 v[4:7], v2, s[8:11], s91 offen offset:3072 sc1
    s_mov_b32 s91, 16384
    buffer_store_dwordx4 v[4:7], v2, s[8:11], s91 offen offset:0 sc1
    buffer_store_dwordx4 v[4:7], v2, s[8:11], s91 offen offset:1024 sc1
    buffer_store_dwordx4 v[4:7], v2, s[8:11], s91 offen offset:2048 sc1
    buffer_store_dwordx4 v[4:7], v2, s[8:11], s91 offen offset:3072 sc1
    s_mov_b32 s91, 20480
    buffer_store_dwordx4 v[4:7], v2, s[8:11], s91 offen offset:0 sc1
    buffer_store_dwordx4 v[4:7], v2, s[8:11], s91 offen offset:1024 sc1
    buffer_store_dwordx4 v[4:7], v2, s[8:11], s91 offen offset:2048 sc1
    buffer_store_dwordx4 v[4:7], v2, s[8:11], s91 offen offset:3072 sc1
    s_mov_b32 s91, 24576
    buffer_store_dwordx4 v[4:7], v2, s[8:11], s91 offen offset:0 sc1
    buffer_store_dwordx4 v[4:7], v2, s[8:11], s91 offen offset:1024 sc1
    buffer_store_dwordx4 v[4:7], v2, s[8:11], s91 offen offset:2048 sc1
    buffer_store_dwordx4 v[4:7], v2, s[8:11], s91 offen offset:3072 sc1
    s_mov_b32 s91, 28672
    buffer_store_dwordx4 v[4:7], v2, s[8:11], s91 offen offset:0 sc1
    buffer_store_dwordx4 v[4:7], v2, s[8:11], s91 offen offset:1024 sc1
    buffer_store_dwordx4 v[4:7], v2, s[8:11], s91 offen offset:2048 sc1
    buffer_store_dwordx4 v[4:7], v2, s[8:11], s91 offen offset:3072 sc1
    s_mov_b32 s91, 32768
    buffer_store_dwordx4 v[4:7], v2, s[8:11], s91 offen offset:0 sc1
    buffer_store_dwordx4 v[4:7], v2, s[8:11], s91 offen offset:1024 sc1
    buffer_store_dwordx4 v[4:7], v2, s[8:11], s91 offen offset:2048 sc1
    buffer_store_dwordx4 v[4:7], v2, s[8:11], s91 offen offset:3072 sc1
    s_mov_b32 s91, 36864
    buffer_store_dwordx4 v[4:7], v2, s[8:11], s91 offen offset:0 sc1
    buffer_store_dwordx4 v[4:7], v2, s[8:11], s91 offen offset:1024 sc1
    buffer_store_dwordx4 v[4:7], v2, s[8:11], s91 offen offset:2048 sc1
    buffer_store_dwordx4 v[4:7], v2, s[8:11], s91 offen offset:3072 sc1
    s_mov_b32 s91, 40960
    buffer_store_dwordx4 v[4:7], v2, s[8:11], s91 offen offset:0 sc1
    buffer_store_dwordx4 v[4:7], v2, s[8:11], s91 offen offset:1024 sc1
    buffer_store_dwordx4 v[4:7], v2, s[8:11], s91 offen offset:2048 sc1
    buffer_store_dwordx4 v[4:7], v2, s[8:11], s91 offen offset:3072 sc1
    v_mov_b32_e64 v2, 1
    s_waitcnt vmcnt(0)
    s_mov_b64 exec, 1
    buffer_store_dword v2, off, s[32:35], 0 offset:192 sc1
    s_mov_b64 exec, -1
L_noclear:
    s_branch L_role
L_ln:
    s_cmp_eq_u32 s90, 0
    s_cbranch_scc1 L_role
    s_mov_b32 s95, s2
    s_mul_i32 s84, s95, 9216
    buffer_load_dwordx4 v[184:187], v222, s[48:51], s84 offen offset:0
    buffer_load_dwordx4 v[188:191], v222, s[48:51], s84 offen offset:128
    buffer_load_dwordx4 v[192:195], v222, s[48:51], s84 offen offset:256
    buffer_load_dwordx4 v[196:199], v222, s[48:51], s84 offen offset:384
    buffer_load_dwordx4 v[200:203], v222, s[48:51], s84 offen offset:512
    buffer_load_dwordx4 v[204:207], v222, s[48:51], s84 offen offset:640
    buffer_load_dwordx4 v[208:211], v222, s[48:51], s84 offen offset:768
    buffer_load_dwordx4 v[212:215], v222, s[48:51], s84 offen offset:896
    buffer_load_dwordx4 v[216:219], v222, s[48:51], s84 offen offset:1024
    s_lshr_b32 s84, s95, 2
    s_mul_i32 s85, s84, 36864
    s_and_b32 s86, s95, 3
    s_lshl_b32 s87, s86, 7
    s_add_u32 s85, s85, s87
    s_add_u32 s85, s85, 1048576
    v_mov_b32 v224, 0
    s_waitcnt vmcnt(8)
    v_lshlrev_b32 v112, 16, v184
    v_and_b32 v113, 0xffff0000, v184
    v_add_f32 v224, v224, v112
    v_add_f32 v224, v224, v113
    v_lshlrev_b32_e64 v114, 16, v185
    v_and_b32 v115, 0xffff0000, v185
    v_add_f32 v224, v224, v114
    v_add_f32 v224, v224, v115
    v_lshlrev_b32_e64 v116, 16, v186
    v_and_b32 v117, 0xffff0000, v186
    v_add_f32 v224, v224, v116
    v_add_f32 v224, v224, v117
    v_lshlrev_b32_e64 v118, 16, v187
    v_and_b32 v119, 0xffff0000, v187
    v_add_f32 v224, v224, v118
    v_add_f32 v224, v224, v119
    s_waitcnt vmcnt(7)
    v_lshlrev_b32 v120, 16, v188
    v_and_b32 v121, 0xffff0000, v188
    v_add_f32 v224, v224, v120
    v_add_f32 v224, v224, v121
    v_lshlrev_b32_e64 v122, 16, v189
    v_and_b32 v123, 0xffff0000, v189
    v_add_f32 v224, v224, v122
    v_add_f32 v224, v224, v123
    v_lshlrev_b32_e64 v124, 16, v190
    v_and_b32 v125, 0xffff0000, v190
    v_add_f32 v224, v224, v124
    v_add_f32 v224, v224, v125
    v_lshlrev_b32_e64 v126, 16, v191
    v_and_b32 v127, 0xffff0000, v191
    v_add_f32 v224, v224, v126
    v_add_f32 v224, v224, v127
    s_waitcnt vmcnt(6)
    v_lshlrev_b32 v128, 16, v192
    v_and_b32 v129, 0xffff0000, v192
    v_add_f32 v224, v224, v128
    v_add_f32 v224, v224, v129
    v_lshlrev_b32_e64 v130, 16, v193
    v_and_b32 v131, 0xffff0000, v193
    v_add_f32 v224, v224, v130
    v_add_f32 v224, v224, v131
    v_lshlrev_b32_e64 v132, 16, v194
    v_and_b32 v133, 0xffff0000, v194
    v_add_f32 v224, v224, v132
    v_add_f32 v224, v224, v133
    v_lshlrev_b32_e64 v134, 16, v195
    v_and_b32 v135, 0xffff0000, v195
    v_add_f32 v224, v224, v134
    v_add_f32 v224, v224, v135
    s_waitcnt vmcnt(5)
    v_lshlrev_b32 v136, 16, v196
    v_and_b32 v137, 0xffff0000, v196
    v_add_f32 v224, v224, v136
    v_add_f32 v224, v224, v137
    v_lshlrev_b32_e64 v138, 16, v197
    v_and_b32 v139, 0xffff0000, v197
    v_add_f32 v224, v224, v138
    v_add_f32 v224, v224, v139
    v_lshlrev_b32_e64 v140, 16, v198
    v_and_b32 v141, 0xffff0000, v198
    v_add_f32 v224, v224, v140
    v_add_f32 v224, v224, v141
    v_lshlrev_b32_e64 v142, 16, v199
    v_and_b32 v143, 0xffff0000, v199
    v_add_f32 v224, v224, v142
    v_add_f32 v224, v224, v143
    s_waitcnt vmcnt(4)
    v_lshlrev_b32 v144, 16, v200
    v_and_b32 v145, 0xffff0000, v200
    v_add_f32 v224, v224, v144
    v_add_f32 v224, v224, v145
    v_lshlrev_b32_e64 v146, 16, v201
    v_and_b32 v147, 0xffff0000, v201
    v_add_f32 v224, v224, v146
    v_add_f32 v224, v224, v147
    v_lshlrev_b32_e64 v148, 16, v202
    v_and_b32 v149, 0xffff0000, v202
    v_add_f32 v224, v224, v148
    v_add_f32 v224, v224, v149
    v_lshlrev_b32_e64 v150, 16, v203
    v_and_b32 v151, 0xffff0000, v203
    v_add_f32 v224, v224, v150
    v_add_f32 v224, v224, v151
    s_waitcnt vmcnt(3)
    v_lshlrev_b32 v152, 16, v204
    v_and_b32 v153, 0xffff0000, v204
    v_add_f32 v224, v224, v152
    v_add_f32 v224, v224, v153
    v_lshlrev_b32_e64 v154, 16, v205
    v_and_b32 v155, 0xffff0000, v205
    v_add_f32 v224, v224, v154
    v_add_f32 v224, v224, v155
    v_lshlrev_b32_e64 v156, 16, v206
    v_and_b32 v157, 0xffff0000, v206
    v_add_f32 v224, v224, v156
    v_add_f32 v224, v224, v157
    v_lshlrev_b32_e64 v158, 16, v207
    v_and_b32 v159, 0xffff0000, v207
    v_add_f32 v224, v224, v158
    v_add_f32 v224, v224, v159
    s_waitcnt vmcnt(2)
    v_lshlrev_b32 v160, 16, v208
    v_and_b32 v161, 0xffff0000, v208
    v_add_f32 v224, v224, v160
    v_add_f32 v224, v224, v161
    v_lshlrev_b32_e64 v162, 16, v209
    v_and_b32 v163, 0xffff0000, v209
    v_add_f32 v224, v224, v162
    v_add_f32 v224, v224, v163
    v_lshlrev_b32_e64 v164, 16, v210
    v_and_b32 v165, 0xffff0000, v210
    v_add_f32 v224, v224, v164
    v_add_f32 v224, v224, v165
    v_lshlrev_b32_e64 v166, 16, v211
    v_and_b32 v167, 0xffff0000, v211
    v_add_f32 v224, v224, v166
    v_add_f32 v224, v224, v167
    s_waitcnt vmcnt(1)
    v_lshlrev_b32 v168, 16, v212
    v_and_b32 v169, 0xffff0000, v212
    v_add_f32 v224, v224, v168
    v_add_f32 v224, v224, v169
    v_lshlrev_b32_e64 v170, 16, v213
    v_and_b32 v171, 0xffff0000, v213
    v_add_f32 v224, v224, v170
    v_add_f32 v224, v224, v171
    v_lshlrev_b32_e64 v172, 16, v214
    v_and_b32 v173, 0xffff0000, v214
    v_add_f32 v224, v224, v172
    v_add_f32 v224, v224, v173
    v_lshlrev_b32_e64 v174, 16, v215
    v_and_b32 v175, 0xffff0000, v215
    v_add_f32 v224, v224, v174
    v_add_f32 v224, v224, v175
    s_waitcnt vmcnt(0)
    v_lshlrev_b32 v176, 16, v216
    v_and_b32 v177, 0xffff0000, v216
    v_add_f32 v224, v224, v176
    v_add_f32 v224, v224, v177
    v_lshlrev_b32_e64 v178, 16, v217
    v_and_b32 v179, 0xffff0000, v217
    v_add_f32 v224, v224, v178
    v_add_f32 v224, v224, v179
    v_lshlrev_b32_e64 v180, 16, v218
    v_and_b32 v181, 0xffff0000, v218
    v_add_f32 v224, v224, v180
    v_add_f32 v224, v224, v181
    v_lshlrev_b32_e64 v182, 16, v219
    v_and_b32 v183, 0xffff0000, v219
    v_add_f32 v224, v224, v182
    v_add_f32_e64 v224, v224, v183
    s_nop 1
    v_add_f32_dpp v224, v224, v224 quad_perm:[1,0,3,2] row_mask:0xf bank_mask:0xf
    s_nop 1
    v_add_f32_dpp v224, v224, v224 quad_perm:[2,3,0,1] row_mask:0xf bank_mask:0xf
    s_nop 1
    v_add_f32_dpp v224, v224, v224 row_half_mirror row_mask:0xf bank_mask:0xf
    v_mul_f32 v224, 0x3ae38e39, v224
    v_mov_b32 v225, 0
    v_sub_f32 v226, v112, v224
    v_fmac_f32 v225, v226, v226
    v_sub_f32 v226, v113, v224
    v_fmac_f32 v225, v226, v226
    v_sub_f32 v226, v114, v224
    v_fmac_f32 v225, v226, v226
    v_sub_f32 v226, v115, v224
    v_fmac_f32 v225, v226, v226
    v_sub_f32 v226, v116, v224
    v_fmac_f32 v225, v226, v226
    v_sub_f32 v226, v117, v224
    v_fmac_f32 v225, v226, v226
    v_sub_f32 v226, v118, v224
    v_fmac_f32 v225, v226, v226
    v_sub_f32 v226, v119, v224
    v_fmac_f32 v225, v226, v226
    v_sub_f32 v226, v120, v224
    v_fmac_f32 v225, v226, v226
    v_sub_f32 v226, v121, v224
    v_fmac_f32 v225, v226, v226
    v_sub_f32 v226, v122, v224
    v_fmac_f32 v225, v226, v226
    v_sub_f32 v226, v123, v224
    v_fmac_f32 v225, v226, v226
    v_sub_f32 v226, v124, v224
    v_fmac_f32 v225, v226, v226
    v_sub_f32 v226, v125, v224
    v_fmac_f32 v225, v226, v226
    v_sub_f32 v226, v126, v224
    v_fmac_f32 v225, v226, v226
    v_sub_f32 v226, v127, v224
    v_fmac_f32 v225, v226, v226
    v_sub_f32 v226, v128, v224
    v_fmac_f32 v225, v226, v226
    v_sub_f32 v226, v129, v224
    v_fmac_f32 v225, v226, v226
    v_sub_f32 v226, v130, v224
    v_fmac_f32 v225, v226, v226
    v_sub_f32 v226, v131, v224
    v_fmac_f32 v225, v226, v226
    v_sub_f32 v226, v132, v224
    v_fmac_f32 v225, v226, v226
    v_sub_f32 v226, v133, v224
    v_fmac_f32 v225, v226, v226
    v_sub_f32 v226, v134, v224
    v_fmac_f32 v225, v226, v226
    v_sub_f32 v226, v135, v224
    v_fmac_f32 v225, v226, v226
    v_sub_f32 v226, v136, v224
    v_fmac_f32 v225, v226, v226
    v_sub_f32 v226, v137, v224
    v_fmac_f32 v225, v226, v226
    v_sub_f32 v226, v138, v224
    v_fmac_f32 v225, v226, v226
    v_sub_f32 v226, v139, v224
    v_fmac_f32 v225, v226, v226
    v_sub_f32 v226, v140, v224
    v_fmac_f32 v225, v226, v226
    v_sub_f32 v226, v141, v224
    v_fmac_f32 v225, v226, v226
    v_sub_f32 v226, v142, v224
    v_fmac_f32 v225, v226, v226
    v_sub_f32 v226, v143, v224
    v_fmac_f32 v225, v226, v226
    v_sub_f32 v226, v144, v224
    v_fmac_f32 v225, v226, v226
    v_sub_f32 v226, v145, v224
    v_fmac_f32 v225, v226, v226
    v_sub_f32 v226, v146, v224
    v_fmac_f32 v225, v226, v226
    v_sub_f32 v226, v147, v224
    v_fmac_f32 v225, v226, v226
    v_sub_f32 v226, v148, v224
    v_fmac_f32 v225, v226, v226
    v_sub_f32 v226, v149, v224
    v_fmac_f32 v225, v226, v226
    v_sub_f32 v226, v150, v224
    v_fmac_f32 v225, v226, v226
    v_sub_f32 v226, v151, v224
    v_fmac_f32 v225, v226, v226
    v_sub_f32 v226, v152, v224
    v_fmac_f32 v225, v226, v226
    v_sub_f32 v226, v153, v224
    v_fmac_f32 v225, v226, v226
    v_sub_f32 v226, v154, v224
    v_fmac_f32 v225, v226, v226
    v_sub_f32 v226, v155, v224
    v_fmac_f32 v225, v226, v226
    v_sub_f32 v226, v156, v224
    v_fmac_f32 v225, v226, v226
    v_sub_f32 v226, v157, v224
    v_fmac_f32 v225, v226, v226
    v_sub_f32 v226, v158, v224
    v_fmac_f32 v225, v226, v226
    v_sub_f32 v226, v159, v224
    v_fmac_f32 v225, v226, v226
    v_sub_f32 v226, v160, v224
    v_fmac_f32 v225, v226, v226
    v_sub_f32 v226, v161, v224
    v_fmac_f32 v225, v226, v226
    v_sub_f32 v226, v162, v224
    v_fmac_f32 v225, v226, v226
    v_sub_f32 v226, v163, v224
    v_fmac_f32 v225, v226, v226
    v_sub_f32 v226, v164, v224
    v_fmac_f32 v225, v226, v226
    v_sub_f32 v226, v165, v224
    v_fmac_f32 v225, v226, v226
    v_sub_f32 v226, v166, v224
    v_fmac_f32 v225, v226, v226
    v_sub_f32 v226, v167, v224
    v_fmac_f32 v225, v226, v226
    v_sub_f32 v226, v168, v224
    v_fmac_f32 v225, v226, v226
    v_sub_f32 v226, v169, v224
    v_fmac_f32 v225, v226, v226
    v_sub_f32 v226, v170, v224
    v_fmac_f32 v225, v226, v226
    v_sub_f32 v226, v171, v224
    v_fmac_f32 v225, v226, v226
    v_sub_f32 v226, v172, v224
    v_fmac_f32 v225, v226, v226
    v_sub_f32 v226, v173, v224
    v_fmac_f32 v225, v226, v226
    v_sub_f32 v226, v174, v224
    v_fmac_f32 v225, v226, v226
    v_sub_f32 v226, v175, v224
    v_fmac_f32 v225, v226, v226
    v_sub_f32 v226, v176, v224
    v_fmac_f32 v225, v226, v226
    v_sub_f32 v226, v177, v224
    v_fmac_f32 v225, v226, v226
    v_sub_f32 v226, v178, v224
    v_fmac_f32 v225, v226, v226
    v_sub_f32 v226, v179, v224
    v_fmac_f32 v225, v226, v226
    v_sub_f32 v226, v180, v224
    v_fmac_f32 v225, v226, v226
    v_sub_f32 v226, v181, v224
    v_fmac_f32 v225, v226, v226
    v_sub_f32 v226, v182, v224
    v_fmac_f32 v225, v226, v226
    v_sub_f32 v226, v183, v224
    v_fmac_f32 v225, v226, v226
    s_nop 1
    v_add_f32_dpp v225, v225, v225 quad_perm:[1,0,3,2] row_mask:0xf bank_mask:0xf
    s_nop 1
    v_add_f32_dpp v225, v225, v225 quad_perm:[2,3,0,1] row_mask:0xf bank_mask:0xf
    s_nop 1
    v_add_f32_dpp v225, v225, v225 row_half_mirror row_mask:0xf bank_mask:0xf
    v_mul_f32 v225, 0x3ae38e39, v225
    v_cvt_pk_bf16_f32 v224, v224, v224
    v_and_b32 v224, 0xffff0000, v224
    v_cvt_pk_bf16_f32 v225, v225, v225
    v_and_b32 v225, 0xffff0000, v225
    v_add_f32 v225, 0x3727c5ac, v225
    v_cvt_pk_bf16_f32 v225, v225, v225
    v_and_b32 v225, 0xffff0000, v225
    v_sqrt_f32 v225, v225
    s_nop 0
    v_cvt_pk_bf16_f32 v225, v225, v225
    v_and_b32 v225, 0xffff0000, v225
    v_rcp_f32 v225, v225
    v_sub_f32 v112, v112, v224
    v_sub_f32_e64 v113, v113, v224
    v_cvt_pk_bf16_f32 v226, v112, v113
    v_lshlrev_b32_e64 v112, 16, v226
    v_and_b32 v113, 0xffff0000, v226
    v_mul_f32 v112, v112, v225
    v_mul_f32 v113, v113, v225
    v_cvt_pk_bf16_f32 v184, v112, v113
    v_sub_f32 v114, v114, v224
    v_sub_f32 v115, v115, v224
    v_cvt_pk_bf16_f32 v226, v114, v115
    v_lshlrev_b32_e64 v114, 16, v226
    v_and_b32 v115, 0xffff0000, v226
    v_mul_f32 v114, v114, v225
    v_mul_f32 v115, v115, v225
    v_cvt_pk_bf16_f32 v185, v114, v115
    v_sub_f32 v116, v116, v224
    v_sub_f32 v117, v117, v224
    v_cvt_pk_bf16_f32 v226, v116, v117
    v_lshlrev_b32_e64 v116, 16, v226
    v_and_b32 v117, 0xffff0000, v226
    v_mul_f32 v116, v116, v225
    v_mul_f32 v117, v117, v225
    v_cvt_pk_bf16_f32 v186, v116, v117
    v_sub_f32 v118, v118, v224
    v_sub_f32 v119, v119, v224
    v_cvt_pk_bf16_f32 v226, v118, v119
    v_lshlrev_b32_e64 v118, 16, v226
    v_and_b32 v119, 0xffff0000, v226
    v_mul_f32 v118, v118, v225
    v_mul_f32 v119, v119, v225
    v_cvt_pk_bf16_f32 v187, v118, v119
    buffer_store_dwordx4 v[184:187], v223, s[8:11], s85 offen sc1
    s_add_u32 s85, s85, 4096
    v_sub_f32 v120, v120, v224
    v_sub_f32 v121, v121, v224
    v_cvt_pk_bf16_f32 v226, v120, v121
    v_lshlrev_b32_e64 v120, 16, v226
    v_and_b32 v121, 0xffff0000, v226
    v_mul_f32 v120, v120, v225
    v_mul_f32 v121, v121, v225
    v_cvt_pk_bf16_f32 v188, v120, v121
    v_sub_f32 v122, v122, v224
    v_sub_f32 v123, v123, v224
    v_cvt_pk_bf16_f32 v226, v122, v123
    v_lshlrev_b32_e64 v122, 16, v226
    v_and_b32 v123, 0xffff0000, v226
    v_mul_f32 v122, v122, v225
    v_mul_f32 v123, v123, v225
    v_cvt_pk_bf16_f32 v189, v122, v123
    v_sub_f32 v124, v124, v224
    v_sub_f32 v125, v125, v224
    v_cvt_pk_bf16_f32 v226, v124, v125
    v_lshlrev_b32_e64 v124, 16, v226
    v_and_b32 v125, 0xffff0000, v226
    v_mul_f32 v124, v124, v225
    v_mul_f32 v125, v125, v225
    v_cvt_pk_bf16_f32 v190, v124, v125
    v_sub_f32 v126, v126, v224
    v_sub_f32 v127, v127, v224
    v_cvt_pk_bf16_f32 v226, v126, v127
    v_lshlrev_b32_e64 v126, 16, v226
    v_and_b32 v127, 0xffff0000, v226
    v_mul_f32 v126, v126, v225
    v_mul_f32 v127, v127, v225
    v_cvt_pk_bf16_f32 v191, v126, v127
    buffer_store_dwordx4 v[188:191], v223, s[8:11], s85 offen sc1
    s_add_u32 s85, s85, 4096
    v_sub_f32 v128, v128, v224
    v_sub_f32 v129, v129, v224
    v_cvt_pk_bf16_f32 v226, v128, v129
    v_lshlrev_b32_e64 v128, 16, v226
    v_and_b32 v129, 0xffff0000, v226
    v_mul_f32 v128, v128, v225
    v_mul_f32 v129, v129, v225
    v_cvt_pk_bf16_f32 v192, v128, v129
    v_sub_f32 v130, v130, v224
    v_sub_f32 v131, v131, v224
    v_cvt_pk_bf16_f32 v226, v130, v131
    v_lshlrev_b32_e64 v130, 16, v226
    v_and_b32 v131, 0xffff0000, v226
    v_mul_f32 v130, v130, v225
    v_mul_f32 v131, v131, v225
    v_cvt_pk_bf16_f32 v193, v130, v131
    v_sub_f32 v132, v132, v224
    v_sub_f32 v133, v133, v224
    v_cvt_pk_bf16_f32 v226, v132, v133
    v_lshlrev_b32_e64 v132, 16, v226
    v_and_b32 v133, 0xffff0000, v226
    v_mul_f32 v132, v132, v225
    v_mul_f32 v133, v133, v225
    v_cvt_pk_bf16_f32 v194, v132, v133
    v_sub_f32 v134, v134, v224
    v_sub_f32 v135, v135, v224
    v_cvt_pk_bf16_f32 v226, v134, v135
    v_lshlrev_b32_e64 v134, 16, v226
    v_and_b32 v135, 0xffff0000, v226
    v_mul_f32 v134, v134, v225
    v_mul_f32 v135, v135, v225
    v_cvt_pk_bf16_f32 v195, v134, v135
    buffer_store_dwordx4 v[192:195], v223, s[8:11], s85 offen sc1
    s_add_u32 s85, s85, 4096
    v_sub_f32 v136, v136, v224
    v_sub_f32 v137, v137, v224
    v_cvt_pk_bf16_f32 v226, v136, v137
    v_lshlrev_b32_e64 v136, 16, v226
    v_and_b32 v137, 0xffff0000, v226
    v_mul_f32 v136, v136, v225
    v_mul_f32 v137, v137, v225
    v_cvt_pk_bf16_f32 v196, v136, v137
    v_sub_f32 v138, v138, v224
    v_sub_f32 v139, v139, v224
    v_cvt_pk_bf16_f32 v226, v138, v139
    v_lshlrev_b32_e64 v138, 16, v226
    v_and_b32 v139, 0xffff0000, v226
    v_mul_f32 v138, v138, v225
    v_mul_f32 v139, v139, v225
    v_cvt_pk_bf16_f32 v197, v138, v139
    v_sub_f32 v140, v140, v224
    v_sub_f32 v141, v141, v224
    v_cvt_pk_bf16_f32 v226, v140, v141
    v_lshlrev_b32_e64 v140, 16, v226
    v_and_b32 v141, 0xffff0000, v226
    v_mul_f32 v140, v140, v225
    v_mul_f32 v141, v141, v225
    v_cvt_pk_bf16_f32 v198, v140, v141
    v_sub_f32 v142, v142, v224
    v_sub_f32 v143, v143, v224
    v_cvt_pk_bf16_f32 v226, v142, v143
    v_lshlrev_b32_e64 v142, 16, v226
    v_and_b32 v143, 0xffff0000, v226
    v_mul_f32 v142, v142, v225
    v_mul_f32 v143, v143, v225
    v_cvt_pk_bf16_f32 v199, v142, v143
    buffer_store_dwordx4 v[196:199], v223, s[8:11], s85 offen sc1
    s_add_u32 s85, s85, 4096
    v_sub_f32 v144, v144, v224
    v_sub_f32 v145, v145, v224
    v_cvt_pk_bf16_f32 v226, v144, v145
    v_lshlrev_b32_e64 v144, 16, v226
    v_and_b32 v145, 0xffff0000, v226
    v_mul_f32 v144, v144, v225
    v_mul_f32 v145, v145, v225
    v_cvt_pk_bf16_f32 v200, v144, v145
    v_sub_f32 v146, v146, v224
    v_sub_f32 v147, v147, v224
    v_cvt_pk_bf16_f32 v226, v146, v147
    v_lshlrev_b32_e64 v146, 16, v226
    v_and_b32 v147, 0xffff0000, v226
    v_mul_f32 v146, v146, v225
    v_mul_f32 v147, v147, v225
    v_cvt_pk_bf16_f32 v201, v146, v147
    v_sub_f32 v148, v148, v224
    v_sub_f32 v149, v149, v224
    v_cvt_pk_bf16_f32 v226, v148, v149
    v_lshlrev_b32_e64 v148, 16, v226
    v_and_b32 v149, 0xffff0000, v226
    v_mul_f32 v148, v148, v225
    v_mul_f32 v149, v149, v225
    v_cvt_pk_bf16_f32 v202, v148, v149
    v_sub_f32 v150, v150, v224
    v_sub_f32 v151, v151, v224
    v_cvt_pk_bf16_f32 v226, v150, v151
    v_lshlrev_b32_e64 v150, 16, v226
    v_and_b32 v151, 0xffff0000, v226
    v_mul_f32 v150, v150, v225
    v_mul_f32 v151, v151, v225
    v_cvt_pk_bf16_f32 v203, v150, v151
    buffer_store_dwordx4 v[200:203], v223, s[8:11], s85 offen sc1
    s_add_u32 s85, s85, 4096
    v_sub_f32 v152, v152, v224
    v_sub_f32 v153, v153, v224
    v_cvt_pk_bf16_f32 v226, v152, v153
    v_lshlrev_b32_e64 v152, 16, v226
    v_and_b32 v153, 0xffff0000, v226
    v_mul_f32 v152, v152, v225
    v_mul_f32 v153, v153, v225
    v_cvt_pk_bf16_f32 v204, v152, v153
    v_sub_f32 v154, v154, v224
    v_sub_f32 v155, v155, v224
    v_cvt_pk_bf16_f32 v226, v154, v155
    v_lshlrev_b32_e64 v154, 16, v226
    v_and_b32 v155, 0xffff0000, v226
    v_mul_f32 v154, v154, v225
    v_mul_f32 v155, v155, v225
    v_cvt_pk_bf16_f32 v205, v154, v155
    v_sub_f32 v156, v156, v224
    v_sub_f32 v157, v157, v224
    v_cvt_pk_bf16_f32 v226, v156, v157
    v_lshlrev_b32_e64 v156, 16, v226
    v_and_b32 v157, 0xffff0000, v226
    v_mul_f32 v156, v156, v225
    v_mul_f32 v157, v157, v225
    v_cvt_pk_bf16_f32 v206, v156, v157
    v_sub_f32 v158, v158, v224
    v_sub_f32 v159, v159, v224
    v_cvt_pk_bf16_f32 v226, v158, v159
    v_lshlrev_b32_e64 v158, 16, v226
    v_and_b32 v159, 0xffff0000, v226
    v_mul_f32 v158, v158, v225
    v_mul_f32 v159, v159, v225
    v_cvt_pk_bf16_f32 v207, v158, v159
    buffer_store_dwordx4 v[204:207], v223, s[8:11], s85 offen sc1
    s_add_u32 s85, s85, 4096
    v_sub_f32 v160, v160, v224
    v_sub_f32 v161, v161, v224
    v_cvt_pk_bf16_f32 v226, v160, v161
    v_lshlrev_b32_e64 v160, 16, v226
    v_and_b32 v161, 0xffff0000, v226
    v_mul_f32 v160, v160, v225
    v_mul_f32 v161, v161, v225
    v_cvt_pk_bf16_f32 v208, v160, v161
    v_sub_f32 v162, v162, v224
    v_sub_f32 v163, v163, v224
    v_cvt_pk_bf16_f32 v226, v162, v163
    v_lshlrev_b32_e64 v162, 16, v226
    v_and_b32 v163, 0xffff0000, v226
    v_mul_f32 v162, v162, v225
    v_mul_f32 v163, v163, v225
    v_cvt_pk_bf16_f32 v209, v162, v163
    v_sub_f32 v164, v164, v224
    v_sub_f32 v165, v165, v224
    v_cvt_pk_bf16_f32 v226, v164, v165
    v_lshlrev_b32_e64 v164, 16, v226
    v_and_b32 v165, 0xffff0000, v226
    v_mul_f32 v164, v164, v225
    v_mul_f32 v165, v165, v225
    v_cvt_pk_bf16_f32 v210, v164, v165
    v_sub_f32 v166, v166, v224
    v_sub_f32 v167, v167, v224
    v_cvt_pk_bf16_f32 v226, v166, v167
    v_lshlrev_b32_e64 v166, 16, v226
    v_and_b32 v167, 0xffff0000, v226
    v_mul_f32 v166, v166, v225
    v_mul_f32 v167, v167, v225
    v_cvt_pk_bf16_f32 v211, v166, v167
    buffer_store_dwordx4 v[208:211], v223, s[8:11], s85 offen sc1
    s_add_u32 s85, s85, 4096
    v_sub_f32 v168, v168, v224
    v_sub_f32 v169, v169, v224
    v_cvt_pk_bf16_f32 v226, v168, v169
    v_lshlrev_b32_e64 v168, 16, v226
    v_and_b32 v169, 0xffff0000, v226
    v_mul_f32 v168, v168, v225
    v_mul_f32 v169, v169, v225
    v_cvt_pk_bf16_f32 v212, v168, v169
    v_sub_f32 v170, v170, v224
    v_sub_f32 v171, v171, v224
    v_cvt_pk_bf16_f32 v226, v170, v171
    v_lshlrev_b32_e64 v170, 16, v226
    v_and_b32 v171, 0xffff0000, v226
    v_mul_f32 v170, v170, v225
    v_mul_f32 v171, v171, v225
    v_cvt_pk_bf16_f32 v213, v170, v171
    v_sub_f32 v172, v172, v224
    v_sub_f32 v173, v173, v224
    v_cvt_pk_bf16_f32 v226, v172, v173
    v_lshlrev_b32_e64 v172, 16, v226
    v_and_b32 v173, 0xffff0000, v226
    v_mul_f32 v172, v172, v225
    v_mul_f32 v173, v173, v225
    v_cvt_pk_bf16_f32 v214, v172, v173
    v_sub_f32 v174, v174, v224
    v_sub_f32 v175, v175, v224
    v_cvt_pk_bf16_f32 v226, v174, v175
    v_lshlrev_b32_e64 v174, 16, v226
    v_and_b32 v175, 0xffff0000, v226
    v_mul_f32 v174, v174, v225
    v_mul_f32 v175, v175, v225
    v_cvt_pk_bf16_f32 v215, v174, v175
    buffer_store_dwordx4 v[212:215], v223, s[8:11], s85 offen sc1
    s_add_u32 s85, s85, 4096
    v_sub_f32 v176, v176, v224
    v_sub_f32 v177, v177, v224
    v_cvt_pk_bf16_f32 v226, v176, v177
    v_lshlrev_b32_e64 v176, 16, v226
    v_and_b32 v177, 0xffff0000, v226
    v_mul_f32 v176, v176, v225
    v_mul_f32 v177, v177, v225
    v_cvt_pk_bf16_f32 v216, v176, v177
    v_sub_f32 v178, v178, v224
    v_sub_f32 v179, v179, v224
    v_cvt_pk_bf16_f32 v226, v178, v179
    v_lshlrev_b32_e64 v178, 16, v226
    v_and_b32 v179, 0xffff0000, v226
    v_mul_f32 v178, v178, v225
    v_mul_f32 v179, v179, v225
    v_cvt_pk_bf16_f32 v217, v178, v179
    v_sub_f32 v180, v180, v224
    v_sub_f32 v181, v181, v224
    v_cvt_pk_bf16_f32 v226, v180, v181
    v_lshlrev_b32_e64 v180, 16, v226
    v_and_b32 v181, 0xffff0000, v226
    v_mul_f32 v180, v180, v225
    v_mul_f32 v181, v181, v225
    v_cvt_pk_bf16_f32 v218, v180, v181
    v_sub_f32 v182, v182, v224
    v_sub_f32 v183, v183, v224
    v_cvt_pk_bf16_f32 v226, v182, v183
    v_lshlrev_b32_e64 v182, 16, v226
    v_and_b32 v183, 0xffff0000, v226
    v_mul_f32 v182, v182, v225
    v_mul_f32 v183, v183, v225
    v_cvt_pk_bf16_f32 v219, v182, v183
    buffer_store_dwordx4 v[216:219], v223, s[8:11], s85 offen sc1
    s_add_u32 s85, s85, 4096
    s_mov_b32 s79, 524288
L_rdy_1:
    buffer_load_dword v2, off, s[32:35], 0 offset:192 sc1
    s_waitcnt vmcnt(0)
    v_readfirstlane_b32 s84, v2
    s_cmp_lg_u32 s84, 0
    s_cbranch_scc1 L_rdyok_2
    s_sub_u32 s79, s79, 1
    s_cbranch_scc1 L_fail
    s_branch L_rdy_1
L_rdyok_2:
    s_lshr_b32 s84, s95, 2
    s_lshl_b32 s84, s84, 7
    s_and_b32 s86, s95, 3
    s_lshl_b32 s86, s86, 2
    s_add_u32 s84, s84, s86
    s_add_u32 s84, s84, 16384
    v_mov_b32 v220, 1
    s_mov_b64 exec, 1
    buffer_store_dword v220, off, s[8:11], s84 sc1
    s_mov_b64 exec, -1
L_role:
    s_barrier
    v_mov_b32_e64 v2, 0
    ds_read_b32 v1, v2
    s_waitcnt lgkmcnt(0)
    v_readfirstlane_b32 s5, v1
    s_barrier
    s_cmp_lt_u32 s5, 32
    s_cbranch_scc1 L_chain
    s_cmp_lg_u32 s4, 3
    s_cbranch_scc1 L_lndone
    s_cmp_lg_u32 s90, 0
    s_cbranch_scc1 L_lnhelp
    s_mov_b32 s95, s2
    s_mul_i32 s84, s95, 9216
    buffer_load_dwordx4 v[184:187], v222, s[48:51], s84 offen offset:0
    buffer_load_dwordx4 v[188:191], v222, s[48:51], s84 offen offset:128
    buffer_load_dwordx4 v[192:195], v222, s[48:51], s84 offen offset:256
    buffer_load_dwordx4 v[196:199], v222, s[48:51], s84 offen offset:384
    buffer_load_dwordx4 v[200:203], v222, s[48:51], s84 offen offset:512
    buffer_load_dwordx4 v[204:207], v222, s[48:51], s84 offen offset:640
    buffer_load_dwordx4 v[208:211], v222, s[48:51], s84 offen offset:768
    buffer_load_dwordx4 v[212:215], v222, s[48:51], s84 offen offset:896
    buffer_load_dwordx4 v[216:219], v222, s[48:51], s84 offen offset:1024
    s_lshr_b32 s84, s95, 2
    s_mul_i32 s85, s84, 36864
    s_and_b32 s86, s95, 3
    s_lshl_b32 s87, s86, 7
    s_add_u32 s85, s85, s87
    s_add_u32 s85, s85, 1048576
    v_mov_b32 v224, 0
    s_waitcnt vmcnt(8)
    v_lshlrev_b32_e64 v112, 16, v184
    v_and_b32 v113, 0xffff0000, v184
    v_add_f32 v224, v224, v112
    v_add_f32 v224, v224, v113
    v_lshlrev_b32_e64 v114, 16, v185
    v_and_b32 v115, 0xffff0000, v185
    v_add_f32 v224, v224, v114
    v_add_f32 v224, v224, v115
    v_lshlrev_b32_e64 v116, 16, v186
    v_and_b32 v117, 0xffff0000, v186
    v_add_f32 v224, v224, v116
    v_add_f32 v224, v224, v117
    v_lshlrev_b32_e64 v118, 16, v187
    v_and_b32 v119, 0xffff0000, v187
    v_add_f32 v224, v224, v118
    v_add_f32 v224, v224, v119
    s_waitcnt vmcnt(7)
    v_lshlrev_b32 v120, 16, v188
    v_and_b32 v121, 0xffff0000, v188
    v_add_f32 v224, v224, v120
    v_add_f32 v224, v224, v121
    v_lshlrev_b32_e64 v122, 16, v189
    v_and_b32 v123, 0xffff0000, v189
    v_add_f32 v224, v224, v122
    v_add_f32 v224, v224, v123
    v_lshlrev_b32_e64 v124, 16, v190
    v_and_b32 v125, 0xffff0000, v190
    v_add_f32 v224, v224, v124
    v_add_f32 v224, v224, v125
    v_lshlrev_b32_e64 v126, 16, v191
    v_and_b32 v127, 0xffff0000, v191
    v_add_f32 v224, v224, v126
    v_add_f32 v224, v224, v127
    s_waitcnt vmcnt(6)
    v_lshlrev_b32 v128, 16, v192
    v_and_b32 v129, 0xffff0000, v192
    v_add_f32 v224, v224, v128
    v_add_f32 v224, v224, v129
    v_lshlrev_b32_e64 v130, 16, v193
    v_and_b32 v131, 0xffff0000, v193
    v_add_f32 v224, v224, v130
    v_add_f32 v224, v224, v131
    v_lshlrev_b32_e64 v132, 16, v194
    v_and_b32 v133, 0xffff0000, v194
    v_add_f32 v224, v224, v132
    v_add_f32 v224, v224, v133
    v_lshlrev_b32_e64 v134, 16, v195
    v_and_b32 v135, 0xffff0000, v195
    v_add_f32 v224, v224, v134
    v_add_f32 v224, v224, v135
    s_waitcnt vmcnt(5)
    v_lshlrev_b32 v136, 16, v196
    v_and_b32 v137, 0xffff0000, v196
    v_add_f32 v224, v224, v136
    v_add_f32 v224, v224, v137
    v_lshlrev_b32_e64 v138, 16, v197
    v_and_b32 v139, 0xffff0000, v197
    v_add_f32 v224, v224, v138
    v_add_f32 v224, v224, v139
    v_lshlrev_b32_e64 v140, 16, v198
    v_and_b32 v141, 0xffff0000, v198
    v_add_f32 v224, v224, v140
    v_add_f32 v224, v224, v141
    v_lshlrev_b32_e64 v142, 16, v199
    v_and_b32 v143, 0xffff0000, v199
    v_add_f32 v224, v224, v142
    v_add_f32 v224, v224, v143
    s_waitcnt vmcnt(4)
    v_lshlrev_b32 v144, 16, v200
    v_and_b32 v145, 0xffff0000, v200
    v_add_f32 v224, v224, v144
    v_add_f32 v224, v224, v145
    v_lshlrev_b32_e64 v146, 16, v201
    v_and_b32 v147, 0xffff0000, v201
    v_add_f32 v224, v224, v146
    v_add_f32 v224, v224, v147
    v_lshlrev_b32_e64 v148, 16, v202
    v_and_b32 v149, 0xffff0000, v202
    v_add_f32 v224, v224, v148
    v_add_f32 v224, v224, v149
    v_lshlrev_b32_e64 v150, 16, v203
    v_and_b32 v151, 0xffff0000, v203
    v_add_f32 v224, v224, v150
    v_add_f32 v224, v224, v151
    s_waitcnt vmcnt(3)
    v_lshlrev_b32 v152, 16, v204
    v_and_b32 v153, 0xffff0000, v204
    v_add_f32 v224, v224, v152
    v_add_f32 v224, v224, v153
    v_lshlrev_b32_e64 v154, 16, v205
    v_and_b32 v155, 0xffff0000, v205
    v_add_f32 v224, v224, v154
    v_add_f32 v224, v224, v155
    v_lshlrev_b32_e64 v156, 16, v206
    v_and_b32 v157, 0xffff0000, v206
    v_add_f32 v224, v224, v156
    v_add_f32 v224, v224, v157
    v_lshlrev_b32_e64 v158, 16, v207
    v_and_b32 v159, 0xffff0000, v207
    v_add_f32 v224, v224, v158
    v_add_f32 v224, v224, v159
    s_waitcnt vmcnt(2)
    v_lshlrev_b32 v160, 16, v208
    v_and_b32 v161, 0xffff0000, v208
    v_add_f32 v224, v224, v160
    v_add_f32 v224, v224, v161
    v_lshlrev_b32_e64 v162, 16, v209
    v_and_b32 v163, 0xffff0000, v209
    v_add_f32 v224, v224, v162
    v_add_f32 v224, v224, v163
    v_lshlrev_b32_e64 v164, 16, v210
    v_and_b32 v165, 0xffff0000, v210
    v_add_f32 v224, v224, v164
    v_add_f32 v224, v224, v165
    v_lshlrev_b32_e64 v166, 16, v211
    v_and_b32 v167, 0xffff0000, v211
    v_add_f32 v224, v224, v166
    v_add_f32 v224, v224, v167
    s_waitcnt vmcnt(1)
    v_lshlrev_b32 v168, 16, v212
    v_and_b32 v169, 0xffff0000, v212
    v_add_f32 v224, v224, v168
    v_add_f32 v224, v224, v169
    v_lshlrev_b32_e64 v170, 16, v213
    v_and_b32 v171, 0xffff0000, v213
    v_add_f32 v224, v224, v170
    v_add_f32 v224, v224, v171
    v_lshlrev_b32_e64 v172, 16, v214
    v_and_b32 v173, 0xffff0000, v214
    v_add_f32 v224, v224, v172
    v_add_f32 v224, v224, v173
    v_lshlrev_b32_e64 v174, 16, v215
    v_and_b32 v175, 0xffff0000, v215
    v_add_f32 v224, v224, v174
    v_add_f32 v224, v224, v175
    s_waitcnt vmcnt(0)
    v_lshlrev_b32 v176, 16, v216
    v_and_b32 v177, 0xffff0000, v216
    v_add_f32 v224, v224, v176
    v_add_f32 v224, v224, v177
    v_lshlrev_b32_e64 v178, 16, v217
    v_and_b32 v179, 0xffff0000, v217
    v_add_f32 v224, v224, v178
    v_add_f32 v224, v224, v179
    v_lshlrev_b32_e64 v180, 16, v218
    v_and_b32 v181, 0xffff0000, v218
    v_add_f32 v224, v224, v180
    v_add_f32 v224, v224, v181
    v_lshlrev_b32_e64 v182, 16, v219
    v_and_b32 v183, 0xffff0000, v219
    v_add_f32 v224, v224, v182
    v_add_f32_e64 v224, v224, v183
    s_nop 1
    v_add_f32_dpp v224, v224, v224 quad_perm:[1,0,3,2] row_mask:0xf bank_mask:0xf
    s_nop 1
    v_add_f32_dpp v224, v224, v224 quad_perm:[2,3,0,1] row_mask:0xf bank_mask:0xf
    s_nop 1
    v_add_f32_dpp v224, v224, v224 row_half_mirror row_mask:0xf bank_mask:0xf
    v_mul_f32 v224, 0x3ae38e39, v224
    v_mov_b32 v225, 0
    v_sub_f32 v226, v112, v224
    v_fmac_f32 v225, v226, v226
    v_sub_f32 v226, v113, v224
    v_fmac_f32 v225, v226, v226
    v_sub_f32 v226, v114, v224
    v_fmac_f32 v225, v226, v226
    v_sub_f32 v226, v115, v224
    v_fmac_f32 v225, v226, v226
    v_sub_f32 v226, v116, v224
    v_fmac_f32 v225, v226, v226
    v_sub_f32 v226, v117, v224
    v_fmac_f32 v225, v226, v226
    v_sub_f32 v226, v118, v224
    v_fmac_f32 v225, v226, v226
    v_sub_f32 v226, v119, v224
    v_fmac_f32 v225, v226, v226
    v_sub_f32 v226, v120, v224
    v_fmac_f32 v225, v226, v226
    v_sub_f32 v226, v121, v224
    v_fmac_f32 v225, v226, v226
    v_sub_f32 v226, v122, v224
    v_fmac_f32 v225, v226, v226
    v_sub_f32 v226, v123, v224
    v_fmac_f32 v225, v226, v226
    v_sub_f32 v226, v124, v224
    v_fmac_f32 v225, v226, v226
    v_sub_f32 v226, v125, v224
    v_fmac_f32 v225, v226, v226
    v_sub_f32 v226, v126, v224
    v_fmac_f32 v225, v226, v226
    v_sub_f32 v226, v127, v224
    v_fmac_f32 v225, v226, v226
    v_sub_f32 v226, v128, v224
    v_fmac_f32 v225, v226, v226
    v_sub_f32 v226, v129, v224
    v_fmac_f32 v225, v226, v226
    v_sub_f32 v226, v130, v224
    v_fmac_f32 v225, v226, v226
    v_sub_f32 v226, v131, v224
    v_fmac_f32 v225, v226, v226
    v_sub_f32 v226, v132, v224
    v_fmac_f32 v225, v226, v226
    v_sub_f32 v226, v133, v224
    v_fmac_f32 v225, v226, v226
    v_sub_f32 v226, v134, v224
    v_fmac_f32 v225, v226, v226
    v_sub_f32 v226, v135, v224
    v_fmac_f32 v225, v226, v226
    v_sub_f32 v226, v136, v224
    v_fmac_f32 v225, v226, v226
    v_sub_f32 v226, v137, v224
    v_fmac_f32 v225, v226, v226
    v_sub_f32 v226, v138, v224
    v_fmac_f32 v225, v226, v226
    v_sub_f32 v226, v139, v224
    v_fmac_f32 v225, v226, v226
    v_sub_f32 v226, v140, v224
    v_fmac_f32 v225, v226, v226
    v_sub_f32 v226, v141, v224
    v_fmac_f32 v225, v226, v226
    v_sub_f32 v226, v142, v224
    v_fmac_f32 v225, v226, v226
    v_sub_f32 v226, v143, v224
    v_fmac_f32 v225, v226, v226
    v_sub_f32 v226, v144, v224
    v_fmac_f32 v225, v226, v226
    v_sub_f32 v226, v145, v224
    v_fmac_f32 v225, v226, v226
    v_sub_f32 v226, v146, v224
    v_fmac_f32 v225, v226, v226
    v_sub_f32 v226, v147, v224
    v_fmac_f32 v225, v226, v226
    v_sub_f32 v226, v148, v224
    v_fmac_f32 v225, v226, v226
    v_sub_f32 v226, v149, v224
    v_fmac_f32 v225, v226, v226
    v_sub_f32 v226, v150, v224
    v_fmac_f32 v225, v226, v226
    v_sub_f32 v226, v151, v224
    v_fmac_f32 v225, v226, v226
    v_sub_f32 v226, v152, v224
    v_fmac_f32 v225, v226, v226
    v_sub_f32 v226, v153, v224
    v_fmac_f32 v225, v226, v226
    v_sub_f32 v226, v154, v224
    v_fmac_f32 v225, v226, v226
    v_sub_f32 v226, v155, v224
    v_fmac_f32 v225, v226, v226
    v_sub_f32 v226, v156, v224
    v_fmac_f32 v225, v226, v226
    v_sub_f32 v226, v157, v224
    v_fmac_f32 v225, v226, v226
    v_sub_f32 v226, v158, v224
    v_fmac_f32 v225, v226, v226
    v_sub_f32 v226, v159, v224
    v_fmac_f32 v225, v226, v226
    v_sub_f32 v226, v160, v224
    v_fmac_f32 v225, v226, v226
    v_sub_f32 v226, v161, v224
    v_fmac_f32 v225, v226, v226
    v_sub_f32 v226, v162, v224
    v_fmac_f32 v225, v226, v226
    v_sub_f32 v226, v163, v224
    v_fmac_f32 v225, v226, v226
    v_sub_f32 v226, v164, v224
    v_fmac_f32 v225, v226, v226
    v_sub_f32 v226, v165, v224
    v_fmac_f32 v225, v226, v226
    v_sub_f32 v226, v166, v224
    v_fmac_f32 v225, v226, v226
    v_sub_f32 v226, v167, v224
    v_fmac_f32 v225, v226, v226
    v_sub_f32 v226, v168, v224
    v_fmac_f32 v225, v226, v226
    v_sub_f32 v226, v169, v224
    v_fmac_f32 v225, v226, v226
    v_sub_f32 v226, v170, v224
    v_fmac_f32 v225, v226, v226
    v_sub_f32 v226, v171, v224
    v_fmac_f32 v225, v226, v226
    v_sub_f32 v226, v172, v224
    v_fmac_f32 v225, v226, v226
    v_sub_f32 v226, v173, v224
    v_fmac_f32 v225, v226, v226
    v_sub_f32 v226, v174, v224
    v_fmac_f32 v225, v226, v226
    v_sub_f32 v226, v175, v224
    v_fmac_f32 v225, v226, v226
    v_sub_f32 v226, v176, v224
    v_fmac_f32 v225, v226, v226
    v_sub_f32 v226, v177, v224
    v_fmac_f32 v225, v226, v226
    v_sub_f32 v226, v178, v224
    v_fmac_f32 v225, v226, v226
    v_sub_f32 v226, v179, v224
    v_fmac_f32 v225, v226, v226
    v_sub_f32 v226, v180, v224
    v_fmac_f32 v225, v226, v226
    v_sub_f32 v226, v181, v224
    v_fmac_f32 v225, v226, v226
    v_sub_f32 v226, v182, v224
    v_fmac_f32 v225, v226, v226
    v_sub_f32 v226, v183, v224
    v_fmac_f32 v225, v226, v226
    s_nop 1
    v_add_f32_dpp v225, v225, v225 quad_perm:[1,0,3,2] row_mask:0xf bank_mask:0xf
    s_nop 1
    v_add_f32_dpp v225, v225, v225 quad_perm:[2,3,0,1] row_mask:0xf bank_mask:0xf
    s_nop 1
    v_add_f32_dpp v225, v225, v225 row_half_mirror row_mask:0xf bank_mask:0xf
    v_mul_f32 v225, 0x3ae38e39, v225
    v_cvt_pk_bf16_f32 v224, v224, v224
    v_and_b32 v224, 0xffff0000, v224
    v_cvt_pk_bf16_f32 v225, v225, v225
    v_and_b32 v225, 0xffff0000, v225
    v_add_f32 v225, 0x3727c5ac, v225
    v_cvt_pk_bf16_f32 v225, v225, v225
    v_and_b32 v225, 0xffff0000, v225
    v_sqrt_f32 v225, v225
    s_nop 0
    v_cvt_pk_bf16_f32 v225, v225, v225
    v_and_b32 v225, 0xffff0000, v225
    v_rcp_f32 v225, v225
    v_sub_f32 v112, v112, v224
    v_sub_f32_e64 v113, v113, v224
    v_cvt_pk_bf16_f32 v226, v112, v113
    v_lshlrev_b32_e64 v112, 16, v226
    v_and_b32 v113, 0xffff0000, v226
    v_mul_f32 v112, v112, v225
    v_mul_f32 v113, v113, v225
    v_cvt_pk_bf16_f32 v184, v112, v113
    v_sub_f32 v114, v114, v224
    v_sub_f32 v115, v115, v224
    v_cvt_pk_bf16_f32 v226, v114, v115
    v_lshlrev_b32_e64 v114, 16, v226
    v_and_b32 v115, 0xffff0000, v226
    v_mul_f32 v114, v114, v225
    v_mul_f32 v115, v115, v225
    v_cvt_pk_bf16_f32 v185, v114, v115
    v_sub_f32 v116, v116, v224
    v_sub_f32 v117, v117, v224
    v_cvt_pk_bf16_f32 v226, v116, v117
    v_lshlrev_b32_e64 v116, 16, v226
    v_and_b32 v117, 0xffff0000, v226
    v_mul_f32 v116, v116, v225
    v_mul_f32 v117, v117, v225
    v_cvt_pk_bf16_f32 v186, v116, v117
    v_sub_f32 v118, v118, v224
    v_sub_f32 v119, v119, v224
    v_cvt_pk_bf16_f32 v226, v118, v119
    v_lshlrev_b32_e64 v118, 16, v226
    v_and_b32 v119, 0xffff0000, v226
    v_mul_f32 v118, v118, v225
    v_mul_f32 v119, v119, v225
    v_cvt_pk_bf16_f32 v187, v118, v119
    buffer_store_dwordx4 v[184:187], v223, s[8:11], s85 offen sc1
    s_add_u32 s85, s85, 4096
    v_sub_f32 v120, v120, v224
    v_sub_f32 v121, v121, v224
    v_cvt_pk_bf16_f32 v226, v120, v121
    v_lshlrev_b32_e64 v120, 16, v226
    v_and_b32 v121, 0xffff0000, v226
    v_mul_f32 v120, v120, v225
    v_mul_f32 v121, v121, v225
    v_cvt_pk_bf16_f32 v188, v120, v121
    v_sub_f32 v122, v122, v224
    v_sub_f32 v123, v123, v224
    v_cvt_pk_bf16_f32 v226, v122, v123
    v_lshlrev_b32_e64 v122, 16, v226
    v_and_b32 v123, 0xffff0000, v226
    v_mul_f32 v122, v122, v225
    v_mul_f32 v123, v123, v225
    v_cvt_pk_bf16_f32 v189, v122, v123
    v_sub_f32 v124, v124, v224
    v_sub_f32 v125, v125, v224
    v_cvt_pk_bf16_f32 v226, v124, v125
    v_lshlrev_b32_e64 v124, 16, v226
    v_and_b32 v125, 0xffff0000, v226
    v_mul_f32 v124, v124, v225
    v_mul_f32 v125, v125, v225
    v_cvt_pk_bf16_f32 v190, v124, v125
    v_sub_f32 v126, v126, v224
    v_sub_f32 v127, v127, v224
    v_cvt_pk_bf16_f32 v226, v126, v127
    v_lshlrev_b32_e64 v126, 16, v226
    v_and_b32 v127, 0xffff0000, v226
    v_mul_f32 v126, v126, v225
    v_mul_f32 v127, v127, v225
    v_cvt_pk_bf16_f32 v191, v126, v127
    buffer_store_dwordx4 v[188:191], v223, s[8:11], s85 offen sc1
    s_add_u32 s85, s85, 4096
    v_sub_f32 v128, v128, v224
    v_sub_f32 v129, v129, v224
    v_cvt_pk_bf16_f32 v226, v128, v129
    v_lshlrev_b32_e64 v128, 16, v226
    v_and_b32 v129, 0xffff0000, v226
    v_mul_f32 v128, v128, v225
    v_mul_f32 v129, v129, v225
    v_cvt_pk_bf16_f32 v192, v128, v129
    v_sub_f32 v130, v130, v224
    v_sub_f32 v131, v131, v224
    v_cvt_pk_bf16_f32 v226, v130, v131
    v_lshlrev_b32_e64 v130, 16, v226
    v_and_b32 v131, 0xffff0000, v226
    v_mul_f32 v130, v130, v225
    v_mul_f32 v131, v131, v225
    v_cvt_pk_bf16_f32 v193, v130, v131
    v_sub_f32 v132, v132, v224
    v_sub_f32 v133, v133, v224
    v_cvt_pk_bf16_f32 v226, v132, v133
    v_lshlrev_b32_e64 v132, 16, v226
    v_and_b32 v133, 0xffff0000, v226
    v_mul_f32 v132, v132, v225
    v_mul_f32 v133, v133, v225
    v_cvt_pk_bf16_f32 v194, v132, v133
    v_sub_f32 v134, v134, v224
    v_sub_f32 v135, v135, v224
    v_cvt_pk_bf16_f32 v226, v134, v135
    v_lshlrev_b32_e64 v134, 16, v226
    v_and_b32 v135, 0xffff0000, v226
    v_mul_f32 v134, v134, v225
    v_mul_f32 v135, v135, v225
    v_cvt_pk_bf16_f32 v195, v134, v135
    buffer_store_dwordx4 v[192:195], v223, s[8:11], s85 offen sc1
    s_add_u32 s85, s85, 4096
    v_sub_f32 v136, v136, v224
    v_sub_f32 v137, v137, v224
    v_cvt_pk_bf16_f32 v226, v136, v137
    v_lshlrev_b32_e64 v136, 16, v226
    v_and_b32 v137, 0xffff0000, v226
    v_mul_f32 v136, v136, v225
    v_mul_f32 v137, v137, v225
    v_cvt_pk_bf16_f32 v196, v136, v137
    v_sub_f32 v138, v138, v224
    v_sub_f32 v139, v139, v224
    v_cvt_pk_bf16_f32 v226, v138, v139
    v_lshlrev_b32_e64 v138, 16, v226
    v_and_b32 v139, 0xffff0000, v226
    v_mul_f32 v138, v138, v225
    v_mul_f32 v139, v139, v225
    v_cvt_pk_bf16_f32 v197, v138, v139
    v_sub_f32 v140, v140, v224
    v_sub_f32 v141, v141, v224
    v_cvt_pk_bf16_f32 v226, v140, v141
    v_lshlrev_b32_e64 v140, 16, v226
    v_and_b32 v141, 0xffff0000, v226
    v_mul_f32 v140, v140, v225
    v_mul_f32 v141, v141, v225
    v_cvt_pk_bf16_f32 v198, v140, v141
    v_sub_f32 v142, v142, v224
    v_sub_f32 v143, v143, v224
    v_cvt_pk_bf16_f32 v226, v142, v143
    v_lshlrev_b32_e64 v142, 16, v226
    v_and_b32 v143, 0xffff0000, v226
    v_mul_f32 v142, v142, v225
    v_mul_f32 v143, v143, v225
    v_cvt_pk_bf16_f32 v199, v142, v143
    buffer_store_dwordx4 v[196:199], v223, s[8:11], s85 offen sc1
    s_add_u32 s85, s85, 4096
    v_sub_f32 v144, v144, v224
    v_sub_f32 v145, v145, v224
    v_cvt_pk_bf16_f32 v226, v144, v145
    v_lshlrev_b32_e64 v144, 16, v226
    v_and_b32 v145, 0xffff0000, v226
    v_mul_f32 v144, v144, v225
    v_mul_f32 v145, v145, v225
    v_cvt_pk_bf16_f32 v200, v144, v145
    v_sub_f32 v146, v146, v224
    v_sub_f32 v147, v147, v224
    v_cvt_pk_bf16_f32 v226, v146, v147
    v_lshlrev_b32_e64 v146, 16, v226
    v_and_b32 v147, 0xffff0000, v226
    v_mul_f32 v146, v146, v225
    v_mul_f32 v147, v147, v225
    v_cvt_pk_bf16_f32 v201, v146, v147
    v_sub_f32 v148, v148, v224
    v_sub_f32 v149, v149, v224
    v_cvt_pk_bf16_f32 v226, v148, v149
    v_lshlrev_b32_e64 v148, 16, v226
    v_and_b32 v149, 0xffff0000, v226
    v_mul_f32 v148, v148, v225
    v_mul_f32 v149, v149, v225
    v_cvt_pk_bf16_f32 v202, v148, v149
    v_sub_f32 v150, v150, v224
    v_sub_f32 v151, v151, v224
    v_cvt_pk_bf16_f32 v226, v150, v151
    v_lshlrev_b32_e64 v150, 16, v226
    v_and_b32 v151, 0xffff0000, v226
    v_mul_f32 v150, v150, v225
    v_mul_f32 v151, v151, v225
    v_cvt_pk_bf16_f32 v203, v150, v151
    buffer_store_dwordx4 v[200:203], v223, s[8:11], s85 offen sc1
    s_add_u32 s85, s85, 4096
    v_sub_f32 v152, v152, v224
    v_sub_f32 v153, v153, v224
    v_cvt_pk_bf16_f32 v226, v152, v153
    v_lshlrev_b32_e64 v152, 16, v226
    v_and_b32 v153, 0xffff0000, v226
    v_mul_f32 v152, v152, v225
    v_mul_f32 v153, v153, v225
    v_cvt_pk_bf16_f32 v204, v152, v153
    v_sub_f32 v154, v154, v224
    v_sub_f32 v155, v155, v224
    v_cvt_pk_bf16_f32 v226, v154, v155
    v_lshlrev_b32_e64 v154, 16, v226
    v_and_b32 v155, 0xffff0000, v226
    v_mul_f32 v154, v154, v225
    v_mul_f32 v155, v155, v225
    v_cvt_pk_bf16_f32 v205, v154, v155
    v_sub_f32 v156, v156, v224
    v_sub_f32 v157, v157, v224
    v_cvt_pk_bf16_f32 v226, v156, v157
    v_lshlrev_b32_e64 v156, 16, v226
    v_and_b32 v157, 0xffff0000, v226
    v_mul_f32 v156, v156, v225
    v_mul_f32 v157, v157, v225
    v_cvt_pk_bf16_f32 v206, v156, v157
    v_sub_f32 v158, v158, v224
    v_sub_f32 v159, v159, v224
    v_cvt_pk_bf16_f32 v226, v158, v159
    v_lshlrev_b32_e64 v158, 16, v226
    v_and_b32 v159, 0xffff0000, v226
    v_mul_f32 v158, v158, v225
    v_mul_f32 v159, v159, v225
    v_cvt_pk_bf16_f32 v207, v158, v159
    buffer_store_dwordx4 v[204:207], v223, s[8:11], s85 offen sc1
    s_add_u32 s85, s85, 4096
    v_sub_f32 v160, v160, v224
    v_sub_f32 v161, v161, v224
    v_cvt_pk_bf16_f32 v226, v160, v161
    v_lshlrev_b32_e64 v160, 16, v226
    v_and_b32 v161, 0xffff0000, v226
    v_mul_f32 v160, v160, v225
    v_mul_f32 v161, v161, v225
    v_cvt_pk_bf16_f32 v208, v160, v161
    v_sub_f32 v162, v162, v224
    v_sub_f32 v163, v163, v224
    v_cvt_pk_bf16_f32 v226, v162, v163
    v_lshlrev_b32_e64 v162, 16, v226
    v_and_b32 v163, 0xffff0000, v226
    v_mul_f32 v162, v162, v225
    v_mul_f32 v163, v163, v225
    v_cvt_pk_bf16_f32 v209, v162, v163
    v_sub_f32 v164, v164, v224
    v_sub_f32 v165, v165, v224
    v_cvt_pk_bf16_f32 v226, v164, v165
    v_lshlrev_b32_e64 v164, 16, v226
    v_and_b32 v165, 0xffff0000, v226
    v_mul_f32 v164, v164, v225
    v_mul_f32 v165, v165, v225
    v_cvt_pk_bf16_f32 v210, v164, v165
    v_sub_f32 v166, v166, v224
    v_sub_f32 v167, v167, v224
    v_cvt_pk_bf16_f32 v226, v166, v167
    v_lshlrev_b32_e64 v166, 16, v226
    v_and_b32 v167, 0xffff0000, v226
    v_mul_f32 v166, v166, v225
    v_mul_f32 v167, v167, v225
    v_cvt_pk_bf16_f32 v211, v166, v167
    buffer_store_dwordx4 v[208:211], v223, s[8:11], s85 offen sc1
    s_add_u32 s85, s85, 4096
    v_sub_f32 v168, v168, v224
    v_sub_f32 v169, v169, v224
    v_cvt_pk_bf16_f32 v226, v168, v169
    v_lshlrev_b32_e64 v168, 16, v226
    v_and_b32 v169, 0xffff0000, v226
    v_mul_f32 v168, v168, v225
    v_mul_f32 v169, v169, v225
    v_cvt_pk_bf16_f32 v212, v168, v169
    v_sub_f32 v170, v170, v224
    v_sub_f32 v171, v171, v224
    v_cvt_pk_bf16_f32 v226, v170, v171
    v_lshlrev_b32_e64 v170, 16, v226
    v_and_b32 v171, 0xffff0000, v226
    v_mul_f32 v170, v170, v225
    v_mul_f32 v171, v171, v225
    v_cvt_pk_bf16_f32 v213, v170, v171
    v_sub_f32 v172, v172, v224
    v_sub_f32 v173, v173, v224
    v_cvt_pk_bf16_f32 v226, v172, v173
    v_lshlrev_b32_e64 v172, 16, v226
    v_and_b32 v173, 0xffff0000, v226
    v_mul_f32 v172, v172, v225
    v_mul_f32 v173, v173, v225
    v_cvt_pk_bf16_f32 v214, v172, v173
    v_sub_f32 v174, v174, v224
    v_sub_f32 v175, v175, v224
    v_cvt_pk_bf16_f32 v226, v174, v175
    v_lshlrev_b32_e64 v174, 16, v226
    v_and_b32 v175, 0xffff0000, v226
    v_mul_f32 v174, v174, v225
    v_mul_f32 v175, v175, v225
    v_cvt_pk_bf16_f32 v215, v174, v175
    buffer_store_dwordx4 v[212:215], v223, s[8:11], s85 offen sc1
    s_add_u32 s85, s85, 4096
    v_sub_f32 v176, v176, v224
    v_sub_f32 v177, v177, v224
    v_cvt_pk_bf16_f32 v226, v176, v177
    v_lshlrev_b32_e64 v176, 16, v226
    v_and_b32 v177, 0xffff0000, v226
    v_mul_f32 v176, v176, v225
    v_mul_f32 v177, v177, v225
    v_cvt_pk_bf16_f32 v216, v176, v177
    v_sub_f32 v178, v178, v224
    v_sub_f32 v179, v179, v224
    v_cvt_pk_bf16_f32 v226, v178, v179
    v_lshlrev_b32_e64 v178, 16, v226
    v_and_b32 v179, 0xffff0000, v226
    v_mul_f32 v178, v178, v225
    v_mul_f32 v179, v179, v225
    v_cvt_pk_bf16_f32 v217, v178, v179
    v_sub_f32 v180, v180, v224
    v_sub_f32 v181, v181, v224
    v_cvt_pk_bf16_f32 v226, v180, v181
    v_lshlrev_b32_e64 v180, 16, v226
    v_and_b32 v181, 0xffff0000, v226
    v_mul_f32 v180, v180, v225
    v_mul_f32 v181, v181, v225
    v_cvt_pk_bf16_f32 v218, v180, v181
    v_sub_f32 v182, v182, v224
    v_sub_f32 v183, v183, v224
    v_cvt_pk_bf16_f32 v226, v182, v183
    v_lshlrev_b32_e64 v182, 16, v226
    v_and_b32 v183, 0xffff0000, v226
    v_mul_f32 v182, v182, v225
    v_mul_f32 v183, v183, v225
    v_cvt_pk_bf16_f32 v219, v182, v183
    buffer_store_dwordx4 v[216:219], v223, s[8:11], s85 offen sc1
    s_add_u32 s85, s85, 4096
    s_mov_b32 s79, 524288
L_rdy_3:
    buffer_load_dword v2, off, s[32:35], 0 offset:192 sc1
    s_waitcnt vmcnt(0)
    v_readfirstlane_b32 s54, v2
    s_cmp_lg_u32 s54, 0
    s_cbranch_scc1 L_rdyok_4
    s_sub_u32 s79, s79, 1
    s_cbranch_scc1 L_fail
    s_branch L_rdy_3
L_rdyok_4:
    s_lshr_b32 s84, s95, 2
    s_lshl_b32 s84, s84, 7
    s_and_b32 s86, s95, 3
    s_lshl_b32 s86, s86, 2
    s_add_u32 s84, s84, s86
    s_add_u32 s84, s84, 16384
    v_mov_b32 v220, 1
    s_mov_b64 exec, 1
    buffer_store_dword v220, off, s[8:11], s84 sc1
    s_mov_b64 exec, -1
L_lnhelp:
    s_bitcmp1_b32 s5, 4
    s_cbranch_scc1 L_lndone
    s_sub_u32 s55, s5, 32
    s_lshr_b32 s56, s55, 5
    s_lshl_b32 s56, s56, 4
    s_sub_u32 s55, s55, s56
    s_cmp_ge_u32 s55, 32
    s_cbranch_scc1 L_lndone
    s_lshl_b32 s55, s55, 1
    s_mov_b32 s79, 524288
L_lnid_5:
    buffer_load_ushort v2, off, s[32:35], s55 offset:64 sc1
    s_waitcnt vmcnt(0)
    v_readfirstlane_b32 s95, v2
    s_cmp_lg_u32 s95, 0
    s_cbranch_scc1 L_lnid_5_ok
    s_sub_u32 s79, s79, 1
    s_cbranch_scc1 L_fail
    s_branch L_lnid_5
L_lnid_5_ok:
    s_cmp_eq_u32 s95, 0xffff
    s_cbranch_scc1 L_lndone
    s_sub_u32 s95, s95, 1
    s_mul_i32 s84, s95, 9216
    buffer_load_dwordx4 v[184:187], v222, s[48:51], s84 offen offset:0
    buffer_load_dwordx4 v[188:191], v222, s[48:51], s84 offen offset:128
    buffer_load_dwordx4 v[192:195], v222, s[48:51], s84 offen offset:256
    buffer_load_dwordx4 v[196:199], v222, s[48:51], s84 offen offset:384
    buffer_load_dwordx4 v[200:203], v222, s[48:51], s84 offen offset:512
    buffer_load_dwordx4 v[204:207], v222, s[48:51], s84 offen offset:640
    buffer_load_dwordx4 v[208:211], v222, s[48:51], s84 offen offset:768
    buffer_load_dwordx4 v[212:215], v222, s[48:51], s84 offen offset:896
    buffer_load_dwordx4 v[216:219], v222, s[48:51], s84 offen offset:1024
    s_lshr_b32 s84, s95, 2
    s_mul_i32 s85, s84, 36864
    s_and_b32 s86, s95, 3
    s_lshl_b32 s87, s86, 7
    s_add_u32 s85, s85, s87
    s_add_u32 s85, s85, 1048576
    v_mov_b32 v224, 0
    s_waitcnt vmcnt(8)
    v_lshlrev_b32 v112, 16, v184
    v_and_b32 v113, 0xffff0000, v184
    v_add_f32 v224, v224, v112
    v_add_f32 v224, v224, v113
    v_lshlrev_b32_e64 v114, 16, v185
    v_and_b32 v115, 0xffff0000, v185
    v_add_f32 v224, v224, v114
    v_add_f32 v224, v224, v115
    v_lshlrev_b32_e64 v116, 16, v186
    v_and_b32 v117, 0xffff0000, v186
    v_add_f32 v224, v224, v116
    v_add_f32 v224, v224, v117
    v_lshlrev_b32_e64 v118, 16, v187
    v_and_b32 v119, 0xffff0000, v187
    v_add_f32 v224, v224, v118
    v_add_f32 v224, v224, v119
    s_waitcnt vmcnt(7)
    v_lshlrev_b32 v120, 16, v188
    v_and_b32 v121, 0xffff0000, v188
    v_add_f32 v224, v224, v120
    v_add_f32 v224, v224, v121
    v_lshlrev_b32_e64 v122, 16, v189
    v_and_b32 v123, 0xffff0000, v189
    v_add_f32 v224, v224, v122
    v_add_f32 v224, v224, v123
    v_lshlrev_b32_e64 v124, 16, v190
    v_and_b32 v125, 0xffff0000, v190
    v_add_f32 v224, v224, v124
    v_add_f32 v224, v224, v125
    v_lshlrev_b32_e64 v126, 16, v191
    v_and_b32 v127, 0xffff0000, v191
    v_add_f32 v224, v224, v126
    v_add_f32 v224, v224, v127
    s_waitcnt vmcnt(6)
    v_lshlrev_b32 v128, 16, v192
    v_and_b32 v129, 0xffff0000, v192
    v_add_f32 v224, v224, v128
    v_add_f32 v224, v224, v129
    v_lshlrev_b32_e64 v130, 16, v193
    v_and_b32 v131, 0xffff0000, v193
    v_add_f32 v224, v224, v130
    v_add_f32 v224, v224, v131
    v_lshlrev_b32_e64 v132, 16, v194
    v_and_b32 v133, 0xffff0000, v194
    v_add_f32 v224, v224, v132
    v_add_f32 v224, v224, v133
    v_lshlrev_b32_e64 v134, 16, v195
    v_and_b32 v135, 0xffff0000, v195
    v_add_f32 v224, v224, v134
    v_add_f32 v224, v224, v135
    s_waitcnt vmcnt(5)
    v_lshlrev_b32 v136, 16, v196
    v_and_b32 v137, 0xffff0000, v196
    v_add_f32 v224, v224, v136
    v_add_f32 v224, v224, v137
    v_lshlrev_b32_e64 v138, 16, v197
    v_and_b32 v139, 0xffff0000, v197
    v_add_f32 v224, v224, v138
    v_add_f32 v224, v224, v139
    v_lshlrev_b32_e64 v140, 16, v198
    v_and_b32 v141, 0xffff0000, v198
    v_add_f32 v224, v224, v140
    v_add_f32 v224, v224, v141
    v_lshlrev_b32_e64 v142, 16, v199
    v_and_b32 v143, 0xffff0000, v199
    v_add_f32 v224, v224, v142
    v_add_f32 v224, v224, v143
    s_waitcnt vmcnt(4)
    v_lshlrev_b32 v144, 16, v200
    v_and_b32 v145, 0xffff0000, v200
    v_add_f32 v224, v224, v144
    v_add_f32 v224, v224, v145
    v_lshlrev_b32_e64 v146, 16, v201
    v_and_b32 v147, 0xffff0000, v201
    v_add_f32 v224, v224, v146
    v_add_f32 v224, v224, v147
    v_lshlrev_b32_e64 v148, 16, v202
    v_and_b32 v149, 0xffff0000, v202
    v_add_f32 v224, v224, v148
    v_add_f32 v224, v224, v149
    v_lshlrev_b32_e64 v150, 16, v203
    v_and_b32 v151, 0xffff0000, v203
    v_add_f32 v224, v224, v150
    v_add_f32 v224, v224, v151
    s_waitcnt vmcnt(3)
    v_lshlrev_b32 v152, 16, v204
    v_and_b32 v153, 0xffff0000, v204
    v_add_f32 v224, v224, v152
    v_add_f32 v224, v224, v153
    v_lshlrev_b32_e64 v154, 16, v205
    v_and_b32 v155, 0xffff0000, v205
    v_add_f32 v224, v224, v154
    v_add_f32 v224, v224, v155
    v_lshlrev_b32_e64 v156, 16, v206
    v_and_b32 v157, 0xffff0000, v206
    v_add_f32 v224, v224, v156
    v_add_f32 v224, v224, v157
    v_lshlrev_b32_e64 v158, 16, v207
    v_and_b32 v159, 0xffff0000, v207
    v_add_f32 v224, v224, v158
    v_add_f32 v224, v224, v159
    s_waitcnt vmcnt(2)
    v_lshlrev_b32 v160, 16, v208
    v_and_b32 v161, 0xffff0000, v208
    v_add_f32 v224, v224, v160
    v_add_f32 v224, v224, v161
    v_lshlrev_b32_e64 v162, 16, v209
    v_and_b32 v163, 0xffff0000, v209
    v_add_f32 v224, v224, v162
    v_add_f32 v224, v224, v163
    v_lshlrev_b32_e64 v164, 16, v210
    v_and_b32 v165, 0xffff0000, v210
    v_add_f32 v224, v224, v164
    v_add_f32 v224, v224, v165
    v_lshlrev_b32_e64 v166, 16, v211
    v_and_b32 v167, 0xffff0000, v211
    v_add_f32 v224, v224, v166
    v_add_f32 v224, v224, v167
    s_waitcnt vmcnt(1)
    v_lshlrev_b32 v168, 16, v212
    v_and_b32 v169, 0xffff0000, v212
    v_add_f32 v224, v224, v168
    v_add_f32 v224, v224, v169
    v_lshlrev_b32_e64 v170, 16, v213
    v_and_b32 v171, 0xffff0000, v213
    v_add_f32 v224, v224, v170
    v_add_f32 v224, v224, v171
    v_lshlrev_b32_e64 v172, 16, v214
    v_and_b32 v173, 0xffff0000, v214
    v_add_f32 v224, v224, v172
    v_add_f32 v224, v224, v173
    v_lshlrev_b32_e64 v174, 16, v215
    v_and_b32 v175, 0xffff0000, v215
    v_add_f32 v224, v224, v174
    v_add_f32 v224, v224, v175
    s_waitcnt vmcnt(0)
    v_lshlrev_b32 v176, 16, v216
    v_and_b32 v177, 0xffff0000, v216
    v_add_f32 v224, v224, v176
    v_add_f32 v224, v224, v177
    v_lshlrev_b32_e64 v178, 16, v217
    v_and_b32 v179, 0xffff0000, v217
    v_add_f32 v224, v224, v178
    v_add_f32 v224, v224, v179
    v_lshlrev_b32_e64 v180, 16, v218
    v_and_b32 v181, 0xffff0000, v218
    v_add_f32 v224, v224, v180
    v_add_f32 v224, v224, v181
    v_lshlrev_b32_e64 v182, 16, v219
    v_and_b32 v183, 0xffff0000, v219
    v_add_f32 v224, v224, v182
    v_add_f32_e64 v224, v224, v183
    s_nop 1
    v_add_f32_dpp v224, v224, v224 quad_perm:[1,0,3,2] row_mask:0xf bank_mask:0xf
    s_nop 1
    v_add_f32_dpp v224, v224, v224 quad_perm:[2,3,0,1] row_mask:0xf bank_mask:0xf
    s_nop 1
    v_add_f32_dpp v224, v224, v224 row_half_mirror row_mask:0xf bank_mask:0xf
    v_mul_f32 v224, 0x3ae38e39, v224
    v_mov_b32 v225, 0
    v_sub_f32 v226, v112, v224
    v_fmac_f32 v225, v226, v226
    v_sub_f32 v226, v113, v224
    v_fmac_f32 v225, v226, v226
    v_sub_f32 v226, v114, v224
    v_fmac_f32 v225, v226, v226
    v_sub_f32 v226, v115, v224
    v_fmac_f32 v225, v226, v226
    v_sub_f32 v226, v116, v224
    v_fmac_f32 v225, v226, v226
    v_sub_f32 v226, v117, v224
    v_fmac_f32 v225, v226, v226
    v_sub_f32 v226, v118, v224
    v_fmac_f32 v225, v226, v226
    v_sub_f32 v226, v119, v224
    v_fmac_f32 v225, v226, v226
    v_sub_f32 v226, v120, v224
    v_fmac_f32 v225, v226, v226
    v_sub_f32 v226, v121, v224
    v_fmac_f32 v225, v226, v226
    v_sub_f32 v226, v122, v224
    v_fmac_f32 v225, v226, v226
    v_sub_f32 v226, v123, v224
    v_fmac_f32 v225, v226, v226
    v_sub_f32 v226, v124, v224
    v_fmac_f32 v225, v226, v226
    v_sub_f32 v226, v125, v224
    v_fmac_f32 v225, v226, v226
    v_sub_f32 v226, v126, v224
    v_fmac_f32 v225, v226, v226
    v_sub_f32 v226, v127, v224
    v_fmac_f32 v225, v226, v226
    v_sub_f32 v226, v128, v224
    v_fmac_f32 v225, v226, v226
    v_sub_f32 v226, v129, v224
    v_fmac_f32 v225, v226, v226
    v_sub_f32 v226, v130, v224
    v_fmac_f32 v225, v226, v226
    v_sub_f32 v226, v131, v224
    v_fmac_f32 v225, v226, v226
    v_sub_f32 v226, v132, v224
    v_fmac_f32 v225, v226, v226
    v_sub_f32 v226, v133, v224
    v_fmac_f32 v225, v226, v226
    v_sub_f32 v226, v134, v224
    v_fmac_f32 v225, v226, v226
    v_sub_f32 v226, v135, v224
    v_fmac_f32 v225, v226, v226
    v_sub_f32 v226, v136, v224
    v_fmac_f32 v225, v226, v226
    v_sub_f32 v226, v137, v224
    v_fmac_f32 v225, v226, v226
    v_sub_f32 v226, v138, v224
    v_fmac_f32 v225, v226, v226
    v_sub_f32 v226, v139, v224
    v_fmac_f32 v225, v226, v226
    v_sub_f32 v226, v140, v224
    v_fmac_f32 v225, v226, v226
    v_sub_f32 v226, v141, v224
    v_fmac_f32 v225, v226, v226
    v_sub_f32 v226, v142, v224
    v_fmac_f32 v225, v226, v226
    v_sub_f32 v226, v143, v224
    v_fmac_f32 v225, v226, v226
    v_sub_f32 v226, v144, v224
    v_fmac_f32 v225, v226, v226
    v_sub_f32 v226, v145, v224
    v_fmac_f32 v225, v226, v226
    v_sub_f32 v226, v146, v224
    v_fmac_f32 v225, v226, v226
    v_sub_f32 v226, v147, v224
    v_fmac_f32 v225, v226, v226
    v_sub_f32 v226, v148, v224
    v_fmac_f32 v225, v226, v226
    v_sub_f32 v226, v149, v224
    v_fmac_f32 v225, v226, v226
    v_sub_f32 v226, v150, v224
    v_fmac_f32 v225, v226, v226
    v_sub_f32 v226, v151, v224
    v_fmac_f32 v225, v226, v226
    v_sub_f32 v226, v152, v224
    v_fmac_f32 v225, v226, v226
    v_sub_f32 v226, v153, v224
    v_fmac_f32 v225, v226, v226
    v_sub_f32 v226, v154, v224
    v_fmac_f32 v225, v226, v226
    v_sub_f32 v226, v155, v224
    v_fmac_f32 v225, v226, v226
    v_sub_f32 v226, v156, v224
    v_fmac_f32 v225, v226, v226
    v_sub_f32 v226, v157, v224
    v_fmac_f32 v225, v226, v226
    v_sub_f32 v226, v158, v224
    v_fmac_f32 v225, v226, v226
    v_sub_f32 v226, v159, v224
    v_fmac_f32 v225, v226, v226
    v_sub_f32 v226, v160, v224
    v_fmac_f32 v225, v226, v226
    v_sub_f32 v226, v161, v224
    v_fmac_f32 v225, v226, v226
    v_sub_f32 v226, v162, v224
    v_fmac_f32 v225, v226, v226
    v_sub_f32 v226, v163, v224
    v_fmac_f32 v225, v226, v226
    v_sub_f32 v226, v164, v224
    v_fmac_f32 v225, v226, v226
    v_sub_f32 v226, v165, v224
    v_fmac_f32 v225, v226, v226
    v_sub_f32 v226, v166, v224
    v_fmac_f32 v225, v226, v226
    v_sub_f32 v226, v167, v224
    v_fmac_f32 v225, v226, v226
    v_sub_f32 v226, v168, v224
    v_fmac_f32 v225, v226, v226
    v_sub_f32 v226, v169, v224
    v_fmac_f32 v225, v226, v226
    v_sub_f32 v226, v170, v224
    v_fmac_f32 v225, v226, v226
    v_sub_f32 v226, v171, v224
    v_fmac_f32 v225, v226, v226
    v_sub_f32 v226, v172, v224
    v_fmac_f32 v225, v226, v226
    v_sub_f32 v226, v173, v224
    v_fmac_f32 v225, v226, v226
    v_sub_f32 v226, v174, v224
    v_fmac_f32 v225, v226, v226
    v_sub_f32 v226, v175, v224
    v_fmac_f32 v225, v226, v226
    v_sub_f32 v226, v176, v224
    v_fmac_f32 v225, v226, v226
    v_sub_f32 v226, v177, v224
    v_fmac_f32 v225, v226, v226
    v_sub_f32 v226, v178, v224
    v_fmac_f32 v225, v226, v226
    v_sub_f32 v226, v179, v224
    v_fmac_f32 v225, v226, v226
    v_sub_f32 v226, v180, v224
    v_fmac_f32 v225, v226, v226
    v_sub_f32 v226, v181, v224
    v_fmac_f32 v225, v226, v226
    v_sub_f32 v226, v182, v224
    v_fmac_f32 v225, v226, v226
    v_sub_f32 v226, v183, v224
    v_fmac_f32 v225, v226, v226
    s_nop 1
    v_add_f32_dpp v225, v225, v225 quad_perm:[1,0,3,2] row_mask:0xf bank_mask:0xf
    s_nop 1
    v_add_f32_dpp v225, v225, v225 quad_perm:[2,3,0,1] row_mask:0xf bank_mask:0xf
    s_nop 1
    v_add_f32_dpp v225, v225, v225 row_half_mirror row_mask:0xf bank_mask:0xf
    v_mul_f32 v225, 0x3ae38e39, v225
    v_cvt_pk_bf16_f32 v224, v224, v224
    v_and_b32 v224, 0xffff0000, v224
    v_cvt_pk_bf16_f32 v225, v225, v225
    v_and_b32 v225, 0xffff0000, v225
    v_add_f32 v225, 0x3727c5ac, v225
    v_cvt_pk_bf16_f32 v225, v225, v225
    v_and_b32 v225, 0xffff0000, v225
    v_sqrt_f32 v225, v225
    s_nop 0
    v_cvt_pk_bf16_f32 v225, v225, v225
    v_and_b32 v225, 0xffff0000, v225
    v_rcp_f32 v225, v225
    v_sub_f32 v112, v112, v224
    v_sub_f32_e64 v113, v113, v224
    v_cvt_pk_bf16_f32 v226, v112, v113
    v_lshlrev_b32_e64 v112, 16, v226
    v_and_b32 v113, 0xffff0000, v226
    v_mul_f32 v112, v112, v225
    v_mul_f32 v113, v113, v225
    v_cvt_pk_bf16_f32 v184, v112, v113
    v_sub_f32 v114, v114, v224
    v_sub_f32 v115, v115, v224
    v_cvt_pk_bf16_f32 v226, v114, v115
    v_lshlrev_b32_e64 v114, 16, v226
    v_and_b32 v115, 0xffff0000, v226
    v_mul_f32 v114, v114, v225
    v_mul_f32 v115, v115, v225
    v_cvt_pk_bf16_f32 v185, v114, v115
    v_sub_f32 v116, v116, v224
    v_sub_f32 v117, v117, v224
    v_cvt_pk_bf16_f32 v226, v116, v117
    v_lshlrev_b32_e64 v116, 16, v226
    v_and_b32 v117, 0xffff0000, v226
    v_mul_f32 v116, v116, v225
    v_mul_f32 v117, v117, v225
    v_cvt_pk_bf16_f32 v186, v116, v117
    v_sub_f32 v118, v118, v224
    v_sub_f32 v119, v119, v224
    v_cvt_pk_bf16_f32 v226, v118, v119
    v_lshlrev_b32_e64 v118, 16, v226
    v_and_b32 v119, 0xffff0000, v226
    v_mul_f32 v118, v118, v225
    v_mul_f32 v119, v119, v225
    v_cvt_pk_bf16_f32 v187, v118, v119
    buffer_store_dwordx4 v[184:187], v223, s[8:11], s85 offen sc1
    s_add_u32 s85, s85, 4096
    v_sub_f32 v120, v120, v224
    v_sub_f32 v121, v121, v224
    v_cvt_pk_bf16_f32 v226, v120, v121
    v_lshlrev_b32_e64 v120, 16, v226
    v_and_b32 v121, 0xffff0000, v226
    v_mul_f32 v120, v120, v225
    v_mul_f32 v121, v121, v225
    v_cvt_pk_bf16_f32 v188, v120, v121
    v_sub_f32 v122, v122, v224
    v_sub_f32 v123, v123, v224
    v_cvt_pk_bf16_f32 v226, v122, v123
    v_lshlrev_b32_e64 v122, 16, v226
    v_and_b32 v123, 0xffff0000, v226
    v_mul_f32 v122, v122, v225
    v_mul_f32 v123, v123, v225
    v_cvt_pk_bf16_f32 v189, v122, v123
    v_sub_f32 v124, v124, v224
    v_sub_f32 v125, v125, v224
    v_cvt_pk_bf16_f32 v226, v124, v125
    v_lshlrev_b32_e64 v124, 16, v226
    v_and_b32 v125, 0xffff0000, v226
    v_mul_f32 v124, v124, v225
    v_mul_f32 v125, v125, v225
    v_cvt_pk_bf16_f32 v190, v124, v125
    v_sub_f32 v126, v126, v224
    v_sub_f32 v127, v127, v224
    v_cvt_pk_bf16_f32 v226, v126, v127
    v_lshlrev_b32_e64 v126, 16, v226
    v_and_b32 v127, 0xffff0000, v226
    v_mul_f32 v126, v126, v225
    v_mul_f32 v127, v127, v225
    v_cvt_pk_bf16_f32 v191, v126, v127
    buffer_store_dwordx4 v[188:191], v223, s[8:11], s85 offen sc1
    s_add_u32 s85, s85, 4096
    v_sub_f32 v128, v128, v224
    v_sub_f32 v129, v129, v224
    v_cvt_pk_bf16_f32 v226, v128, v129
    v_lshlrev_b32_e64 v128, 16, v226
    v_and_b32 v129, 0xffff0000, v226
    v_mul_f32 v128, v128, v225
    v_mul_f32 v129, v129, v225
    v_cvt_pk_bf16_f32 v192, v128, v129
    v_sub_f32 v130, v130, v224
    v_sub_f32 v131, v131, v224
    v_cvt_pk_bf16_f32 v226, v130, v131
    v_lshlrev_b32_e64 v130, 16, v226
    v_and_b32 v131, 0xffff0000, v226
    v_mul_f32 v130, v130, v225
    v_mul_f32 v131, v131, v225
    v_cvt_pk_bf16_f32 v193, v130, v131
    v_sub_f32 v132, v132, v224
    v_sub_f32 v133, v133, v224
    v_cvt_pk_bf16_f32 v226, v132, v133
    v_lshlrev_b32_e64 v132, 16, v226
    v_and_b32 v133, 0xffff0000, v226
    v_mul_f32 v132, v132, v225
    v_mul_f32 v133, v133, v225
    v_cvt_pk_bf16_f32 v194, v132, v133
    v_sub_f32 v134, v134, v224
    v_sub_f32 v135, v135, v224
    v_cvt_pk_bf16_f32 v226, v134, v135
    v_lshlrev_b32_e64 v134, 16, v226
    v_and_b32 v135, 0xffff0000, v226
    v_mul_f32 v134, v134, v225
    v_mul_f32 v135, v135, v225
    v_cvt_pk_bf16_f32 v195, v134, v135
    buffer_store_dwordx4 v[192:195], v223, s[8:11], s85 offen sc1
    s_add_u32 s85, s85, 4096
    v_sub_f32 v136, v136, v224
    v_sub_f32 v137, v137, v224
    v_cvt_pk_bf16_f32 v226, v136, v137
    v_lshlrev_b32_e64 v136, 16, v226
    v_and_b32 v137, 0xffff0000, v226
    v_mul_f32 v136, v136, v225
    v_mul_f32 v137, v137, v225
    v_cvt_pk_bf16_f32 v196, v136, v137
    v_sub_f32 v138, v138, v224
    v_sub_f32 v139, v139, v224
    v_cvt_pk_bf16_f32 v226, v138, v139
    v_lshlrev_b32_e64 v138, 16, v226
    v_and_b32 v139, 0xffff0000, v226
    v_mul_f32 v138, v138, v225
    v_mul_f32 v139, v139, v225
    v_cvt_pk_bf16_f32 v197, v138, v139
    v_sub_f32 v140, v140, v224
    v_sub_f32 v141, v141, v224
    v_cvt_pk_bf16_f32 v226, v140, v141
    v_lshlrev_b32_e64 v140, 16, v226
    v_and_b32 v141, 0xffff0000, v226
    v_mul_f32 v140, v140, v225
    v_mul_f32 v141, v141, v225
    v_cvt_pk_bf16_f32 v198, v140, v141
    v_sub_f32 v142, v142, v224
    v_sub_f32 v143, v143, v224
    v_cvt_pk_bf16_f32 v226, v142, v143
    v_lshlrev_b32_e64 v142, 16, v226
    v_and_b32 v143, 0xffff0000, v226
    v_mul_f32 v142, v142, v225
    v_mul_f32 v143, v143, v225
    v_cvt_pk_bf16_f32 v199, v142, v143
    buffer_store_dwordx4 v[196:199], v223, s[8:11], s85 offen sc1
    s_add_u32 s85, s85, 4096
    v_sub_f32 v144, v144, v224
    v_sub_f32 v145, v145, v224
    v_cvt_pk_bf16_f32 v226, v144, v145
    v_lshlrev_b32_e64 v144, 16, v226
    v_and_b32 v145, 0xffff0000, v226
    v_mul_f32 v144, v144, v225
    v_mul_f32 v145, v145, v225
    v_cvt_pk_bf16_f32 v200, v144, v145
    v_sub_f32 v146, v146, v224
    v_sub_f32 v147, v147, v224
    v_cvt_pk_bf16_f32 v226, v146, v147
    v_lshlrev_b32_e64 v146, 16, v226
    v_and_b32 v147, 0xffff0000, v226
    v_mul_f32 v146, v146, v225
    v_mul_f32 v147, v147, v225
    v_cvt_pk_bf16_f32 v201, v146, v147
    v_sub_f32 v148, v148, v224
    v_sub_f32 v149, v149, v224
    v_cvt_pk_bf16_f32 v226, v148, v149
    v_lshlrev_b32_e64 v148, 16, v226
    v_and_b32 v149, 0xffff0000, v226
    v_mul_f32 v148, v148, v225
    v_mul_f32 v149, v149, v225
    v_cvt_pk_bf16_f32 v202, v148, v149
    v_sub_f32 v150, v150, v224
    v_sub_f32 v151, v151, v224
    v_cvt_pk_bf16_f32 v226, v150, v151
    v_lshlrev_b32_e64 v150, 16, v226
    v_and_b32 v151, 0xffff0000, v226
    v_mul_f32 v150, v150, v225
    v_mul_f32 v151, v151, v225
    v_cvt_pk_bf16_f32 v203, v150, v151
    buffer_store_dwordx4 v[200:203], v223, s[8:11], s85 offen sc1
    s_add_u32 s85, s85, 4096
    v_sub_f32 v152, v152, v224
    v_sub_f32 v153, v153, v224
    v_cvt_pk_bf16_f32 v226, v152, v153
    v_lshlrev_b32_e64 v152, 16, v226
    v_and_b32 v153, 0xffff0000, v226
    v_mul_f32 v152, v152, v225
    v_mul_f32 v153, v153, v225
    v_cvt_pk_bf16_f32 v204, v152, v153
    v_sub_f32 v154, v154, v224
    v_sub_f32 v155, v155, v224
    v_cvt_pk_bf16_f32 v226, v154, v155
    v_lshlrev_b32_e64 v154, 16, v226
    v_and_b32 v155, 0xffff0000, v226
    v_mul_f32 v154, v154, v225
    v_mul_f32 v155, v155, v225
    v_cvt_pk_bf16_f32 v205, v154, v155
    v_sub_f32 v156, v156, v224
    v_sub_f32 v157, v157, v224
    v_cvt_pk_bf16_f32 v226, v156, v157
    v_lshlrev_b32_e64 v156, 16, v226
    v_and_b32 v157, 0xffff0000, v226
    v_mul_f32 v156, v156, v225
    v_mul_f32 v157, v157, v225
    v_cvt_pk_bf16_f32 v206, v156, v157
    v_sub_f32 v158, v158, v224
    v_sub_f32 v159, v159, v224
    v_cvt_pk_bf16_f32 v226, v158, v159
    v_lshlrev_b32_e64 v158, 16, v226
    v_and_b32 v159, 0xffff0000, v226
    v_mul_f32 v158, v158, v225
    v_mul_f32 v159, v159, v225
    v_cvt_pk_bf16_f32 v207, v158, v159
    buffer_store_dwordx4 v[204:207], v223, s[8:11], s85 offen sc1
    s_add_u32 s85, s85, 4096
    v_sub_f32 v160, v160, v224
    v_sub_f32 v161, v161, v224
    v_cvt_pk_bf16_f32 v226, v160, v161
    v_lshlrev_b32_e64 v160, 16, v226
    v_and_b32 v161, 0xffff0000, v226
    v_mul_f32 v160, v160, v225
    v_mul_f32 v161, v161, v225
    v_cvt_pk_bf16_f32 v208, v160, v161
    v_sub_f32 v162, v162, v224
    v_sub_f32 v163, v163, v224
    v_cvt_pk_bf16_f32 v226, v162, v163
    v_lshlrev_b32_e64 v162, 16, v226
    v_and_b32 v163, 0xffff0000, v226
    v_mul_f32 v162, v162, v225
    v_mul_f32 v163, v163, v225
    v_cvt_pk_bf16_f32 v209, v162, v163
    v_sub_f32 v164, v164, v224
    v_sub_f32 v165, v165, v224
    v_cvt_pk_bf16_f32 v226, v164, v165
    v_lshlrev_b32_e64 v164, 16, v226
    v_and_b32 v165, 0xffff0000, v226
    v_mul_f32 v164, v164, v225
    v_mul_f32 v165, v165, v225
    v_cvt_pk_bf16_f32 v210, v164, v165
    v_sub_f32 v166, v166, v224
    v_sub_f32 v167, v167, v224
    v_cvt_pk_bf16_f32 v226, v166, v167
    v_lshlrev_b32_e64 v166, 16, v226
    v_and_b32 v167, 0xffff0000, v226
    v_mul_f32 v166, v166, v225
    v_mul_f32 v167, v167, v225
    v_cvt_pk_bf16_f32 v211, v166, v167
    buffer_store_dwordx4 v[208:211], v223, s[8:11], s85 offen sc1
    s_add_u32 s85, s85, 4096
    v_sub_f32 v168, v168, v224
    v_sub_f32 v169, v169, v224
    v_cvt_pk_bf16_f32 v226, v168, v169
    v_lshlrev_b32_e64 v168, 16, v226
    v_and_b32 v169, 0xffff0000, v226
    v_mul_f32 v168, v168, v225
    v_mul_f32 v169, v169, v225
    v_cvt_pk_bf16_f32 v212, v168, v169
    v_sub_f32 v170, v170, v224
    v_sub_f32 v171, v171, v224
    v_cvt_pk_bf16_f32 v226, v170, v171
    v_lshlrev_b32_e64 v170, 16, v226
    v_and_b32 v171, 0xffff0000, v226
    v_mul_f32 v170, v170, v225
    v_mul_f32 v171, v171, v225
    v_cvt_pk_bf16_f32 v213, v170, v171
    v_sub_f32 v172, v172, v224
    v_sub_f32 v173, v173, v224
    v_cvt_pk_bf16_f32 v226, v172, v173
    v_lshlrev_b32_e64 v172, 16, v226
    v_and_b32 v173, 0xffff0000, v226
    v_mul_f32 v172, v172, v225
    v_mul_f32 v173, v173, v225
    v_cvt_pk_bf16_f32 v214, v172, v173
    v_sub_f32 v174, v174, v224
    v_sub_f32 v175, v175, v224
    v_cvt_pk_bf16_f32 v226, v174, v175
    v_lshlrev_b32_e64 v174, 16, v226
    v_and_b32 v175, 0xffff0000, v226
    v_mul_f32 v174, v174, v225
    v_mul_f32 v175, v175, v225
    v_cvt_pk_bf16_f32 v215, v174, v175
    buffer_store_dwordx4 v[212:215], v223, s[8:11], s85 offen sc1
    s_add_u32 s85, s85, 4096
    v_sub_f32 v176, v176, v224
    v_sub_f32 v177, v177, v224
    v_cvt_pk_bf16_f32 v226, v176, v177
    v_lshlrev_b32_e64 v176, 16, v226
    v_and_b32 v177, 0xffff0000, v226
    v_mul_f32 v176, v176, v225
    v_mul_f32 v177, v177, v225
    v_cvt_pk_bf16_f32 v216, v176, v177
    v_sub_f32 v178, v178, v224
    v_sub_f32 v179, v179, v224
    v_cvt_pk_bf16_f32 v226, v178, v179
    v_lshlrev_b32_e64 v178, 16, v226
    v_and_b32 v179, 0xffff0000, v226
    v_mul_f32 v178, v178, v225
    v_mul_f32 v179, v179, v225
    v_cvt_pk_bf16_f32 v217, v178, v179
    v_sub_f32 v180, v180, v224
    v_sub_f32 v181, v181, v224
    v_cvt_pk_bf16_f32 v226, v180, v181
    v_lshlrev_b32_e64 v180, 16, v226
    v_and_b32 v181, 0xffff0000, v226
    v_mul_f32 v180, v180, v225
    v_mul_f32 v181, v181, v225
    v_cvt_pk_bf16_f32 v218, v180, v181
    v_sub_f32 v182, v182, v224
    v_sub_f32 v183, v183, v224
    v_cvt_pk_bf16_f32 v226, v182, v183
    v_lshlrev_b32_e64 v182, 16, v226
    v_and_b32 v183, 0xffff0000, v226
    v_mul_f32 v182, v182, v225
    v_mul_f32 v183, v183, v225
    v_cvt_pk_bf16_f32 v219, v182, v183
    buffer_store_dwordx4 v[216:219], v223, s[8:11], s85 offen sc1
    s_add_u32 s85, s85, 4096
    s_waitcnt vmcnt(0)
    s_lshr_b32 s84, s95, 2
    s_lshl_b32 s84, s84, 7
    s_and_b32 s86, s95, 3
    s_lshl_b32 s86, s86, 2
    s_add_u32 s84, s84, s86
    s_add_u32 s84, s84, 16384
    v_mov_b32 v220, 1
    s_mov_b64 exec, 1
    buffer_store_dword v220, off, s[8:11], s84 sc1
    s_mov_b64 exec, -1
L_lndone:
    s_barrier
    v_and_b32 v0, 63, v0
    v_lshlrev_b32 v0, 4, v0
    s_cmp_ge_u32 s5, 256
    s_cbranch_scc1 L_exit
    s_lshr_b32 s54, s5, 5
    s_sub_u32 s54, s54, 1
    s_and_b32 s55, s5, 31
    s_sub_u32 s52, s5, 122
    s_cmp_ge_u32 s54, 5
    s_cbranch_scc1 L_proj
    s_mul_i32 s52, s54, 14
    s_add_u32 s52, s52, s55
    s_sub_u32 s52, s52, 18
    s_cmp_ge_u32 s55, 18
    s_cbranch_scc1 L_proj
    s_mov_b32 s64, s55
    s_mov_b32 s63, s54
    s_cmp_ge_u32 s63, 2
    s_cbranch_scc1 L_roleD
    s_mov_b32 s84, -1
L_roleC:
    s_cmp_lg_u32 s4, 0
    s_cbranch_scc1 L_gook_7
    s_mov_b32 s79, 524288
    s_mov_b32 s55, 39936
L_go_6:
    buffer_load_dword v2, off, s[8:11], s55 sc1
    s_waitcnt vmcnt(0)
    v_readfirstlane_b32 s54, v2
    s_cmp_lg_u32 s54, 0
    s_cbranch_scc1 L_gook_7
    s_sleep 4
    s_sub_u32 s79, s79, 1
    s_cbranch_scc1 L_fail
    s_branch L_go_6
L_gook_7:
    s_barrier
    v_lshrrev_b32 v1, 4, v0
    v_lshrrev_b32_e64 v2, 2, v1
    v_mul_u32_u24 v2, 1152, v2
    v_and_b32_e64 v3, 3, v1
    v_lshl_add_u32 v4, v3, 4, v2
    s_mul_i32 s54, s4, 1179648
    s_lshl_b32 s55, s64, 6
    s_add_u32 s70, s54, s55
    s_lshl_b32 s60, s4, 15
    s_add_u32 m0, s60, 0
    s_add_u32 s54, s70, 0
    buffer_load_dwordx4 v4, s[24:27], s54 offen lds
    s_add_u32 m0, s60, 1024
    s_add_u32 s54, s70, 18432
    buffer_load_dwordx4 v4, s[24:27], s54 offen lds
    s_add_u32 m0, s60, 2048
    s_add_u32 s54, s70, 36864
    buffer_load_dwordx4 v4, s[24:27], s54 offen lds
    s_add_u32 m0, s60, 3072
    s_add_u32 s54, s70, 55296
    buffer_load_dwordx4 v4, s[24:27], s54 offen lds
    s_add_u32 m0, s60, 4096
    s_add_u32 s54, s70, 73728
    buffer_load_dwordx4 v4, s[24:27], s54 offen lds
    s_add_u32 m0, s60, 5120
    s_add_u32 s54, s70, 92160
    buffer_load_dwordx4 v4, s[24:27], s54 offen lds
    s_add_u32 m0, s60, 6144
    s_add_u32 s54, s70, 110592
    buffer_load_dwordx4 v4, s[24:27], s54 offen lds
    s_add_u32 m0, s60, 7168
    s_add_u32 s54, s70, 129024
    buffer_load_dwordx4 v4, s[24:27], s54 offen lds
    s_add_u32 m0, s60, 8192
    s_add_u32 s54, s70, 147456
    buffer_load_dwordx4 v4, s[24:27], s54 offen lds
    s_add_u32 m0, s60, 9216
    s_add_u32 s54, s70, 165888
    buffer_load_dwordx4 v4, s[24:27], s54 offen lds
    s_add_u32 m0, s60, 10240
    s_add_u32 s54, s70, 184320
    buffer_load_dwordx4 v4, s[24:27], s54 offen lds
    s_add_u32 m0, s60, 11264
    s_add_u32 s54, s70, 202752
    buffer_load_dwordx4 v4, s[24:27], s54 offen lds
    s_add_u32 m0, s60, 12288
    s_add_u32 s54, s70, 221184
    buffer_load_dwordx4 v4, s[24:27], s54 offen lds
    s_add_u32 m0, s60, 13312
    s_add_u32 s54, s70, 239616
    buffer_load_dwordx4 v4, s[24:27], s54 offen lds
    s_add_u32 m0, s60, 14336
    s_add_u32 s54, s70, 258048
    buffer_load_dwordx4 v4, s[24:27], s54 offen lds
    s_add_u32 m0, s60, 15360
    s_add_u32 s54, s70, 276480
    buffer_load_dwordx4 v4, s[24:27], s54 offen lds
    s_add_u32 m0, s60, 16384
    s_add_u32 s54, s70, 294912
    buffer_load_dwordx4 v4, s[24:27], s54 offen lds
    s_add_u32 m0, s60, 17408
    s_add_u32 s54, s70, 313344
    buffer_load_dwordx4 v4, s[24:27], s54 offen lds
    s_add_u32 m0, s60, 18432
    s_add_u32 s54, s70, 331776
    buffer_load_dwordx4 v4, s[24:27], s54 offen lds
    s_add_u32 m0, s60, 19456
    s_add_u32 s54, s70, 350208
    buffer_load_dwordx4 v4, s[24:27], s54 offen lds
    s_add_u32 m0, s60, 20480
    s_add_u32 s54, s70, 368640
    buffer_load_dwordx4 v4, s[24:27], s54 offen lds
    s_add_u32 m0, s60, 21504
    s_add_u32 s54, s70, 387072
    buffer_load_dwordx4 v4, s[24:27], s54 offen lds
    s_add_u32 m0, s60, 22528
    s_add_u32 s54, s70, 405504
    buffer_load_dwordx4 v4, s[24:27], s54 offen lds
    s_add_u32 m0, s60, 23552
    s_add_u32 s54, s70, 423936
    buffer_load_dwordx4 v4, s[24:27], s54 offen lds
    s_add_u32 m0, s60, 24576
    s_add_u32 s54, s70, 442368
    buffer_load_dwordx4 v4, s[24:27], s54 offen lds
    s_add_u32 m0, s60, 25600
    s_add_u32 s54, s70, 460800
    buffer_load_dwordx4 v4, s[24:27], s54 offen lds
    s_add_u32 m0, s60, 26624
    s_add_u32 s54, s70, 479232
    buffer_load_dwordx4 v4, s[24:27], s54 offen lds
    s_add_u32 m0, s60, 27648
    s_add_u32 s54, s70, 497664
    buffer_load_dwordx4 v4, s[24:27], s54 offen lds
    s_add_u32 m0, s60, 28672
    s_add_u32 s54, s70, 516096
    buffer_load_dwordx4 v4, s[24:27], s54 offen lds
    s_add_u32 m0, s60, 29696
    s_add_u32 s54, s70, 534528
    buffer_load_dwordx4 v4, s[24:27], s54 offen lds
    s_add_u32 m0, s60, 30720
    s_add_u32 s54, s70, 552960
    buffer_load_dwordx4 v4, s[24:27], s54 offen lds
    s_add_u32 m0, s60, 31744
    s_add_u32 s54, s70, 571392
    buffer_load_dwordx4 v4, s[24:27], s54 offen lds
    v_lshrrev_b32 v5, 5, v1
    v_bfe_u32 v6, v1, 2, 2
    v_lshl_add_u32 v5, v5, 2, v6
    v_lshlrev_b32_e64 v5, 6, v5
    v_bfe_u32 v6, v1, 4, 1
    v_lshl_add_u32 v5, v6, 5, v5
    v_lshl_add_u32 v5, v3, 3, v5
    v_add_u32 v5, s60, v5
    s_waitcnt vmcnt(16)
    ds_read_b64_tr_b16 a[0:1], v5 offset:0
    ds_read_b64_tr_b16 a[2:3], v5 offset:1024
    ds_read_b64_tr_b16 a[4:5], v5 offset:512
    ds_read_b64_tr_b16 a[6:7], v5 offset:1536
    ds_read_b64_tr_b16 a[8:9], v5 offset:2048
    ds_read_b64_tr_b16 a[10:11], v5 offset:3072
    ds_read_b64_tr_b16 a[12:13], v5 offset:2560
    ds_read_b64_tr_b16 a[14:15], v5 offset:3584
    ds_read_b64_tr_b16 a[16:17], v5 offset:4096
    ds_read_b64_tr_b16 a[18:19], v5 offset:5120
    ds_read_b64_tr_b16 a[20:21], v5 offset:4608
    ds_read_b64_tr_b16 a[22:23], v5 offset:5632
    ds_read_b64_tr_b16 a[24:25], v5 offset:6144
    ds_read_b64_tr_b16 a[26:27], v5 offset:7168
    ds_read_b64_tr_b16 a[28:29], v5 offset:6656
    ds_read_b64_tr_b16 a[30:31], v5 offset:7680
    ds_read_b64_tr_b16 a[32:33], v5 offset:8192
    ds_read_b64_tr_b16 a[34:35], v5 offset:9216
    ds_read_b64_tr_b16 a[36:37], v5 offset:8704
    ds_read_b64_tr_b16 a[38:39], v5 offset:9728
    ds_read_b64_tr_b16 a[40:41], v5 offset:10240
    ds_read_b64_tr_b16 a[42:43], v5 offset:11264
    ds_read_b64_tr_b16 a[44:45], v5 offset:10752
    ds_read_b64_tr_b16 a[46:47], v5 offset:11776
    ds_read_b64_tr_b16 a[48:49], v5 offset:12288
    ds_read_b64_tr_b16 a[50:51], v5 offset:13312
    ds_read_b64_tr_b16 a[52:53], v5 offset:12800
    ds_read_b64_tr_b16 a[54:55], v5 offset:13824
    ds_read_b64_tr_b16 a[56:57], v5 offset:14336
    ds_read_b64_tr_b16 a[58:59], v5 offset:15360
    ds_read_b64_tr_b16 a[60:61], v5 offset:14848
    ds_read_b64_tr_b16 a[62:63], v5 offset:15872
    s_waitcnt lgkmcnt(0)
    s_add_u32 m0, s60, 0
    s_add_u32 s54, s70, 589824
    buffer_load_dwordx4 v4, s[24:27], s54 offen lds
    s_add_u32 m0, s60, 1024
    s_add_u32 s54, s70, 608256
    buffer_load_dwordx4 v4, s[24:27], s54 offen lds
    s_add_u32 m0, s60, 2048
    s_add_u32 s54, s70, 626688
    buffer_load_dwordx4 v4, s[24:27], s54 offen lds
    s_add_u32 m0, s60, 3072
    s_add_u32 s54, s70, 645120
    buffer_load_dwordx4 v4, s[24:27], s54 offen lds
    s_add_u32 m0, s60, 4096
    s_add_u32 s54, s70, 663552
    buffer_load_dwordx4 v4, s[24:27], s54 offen lds
    s_add_u32 m0, s60, 5120
    s_add_u32 s54, s70, 681984
    buffer_load_dwordx4 v4, s[24:27], s54 offen lds
    s_add_u32 m0, s60, 6144
    s_add_u32 s54, s70, 700416
    buffer_load_dwordx4 v4, s[24:27], s54 offen lds
    s_add_u32 m0, s60, 7168
    s_add_u32 s54, s70, 718848
    buffer_load_dwordx4 v4, s[24:27], s54 offen lds
    s_add_u32 m0, s60, 8192
    s_add_u32 s54, s70, 737280
    buffer_load_dwordx4 v4, s[24:27], s54 offen lds
    s_add_u32 m0, s60, 9216
    s_add_u32 s54, s70, 755712
    buffer_load_dwordx4 v4, s[24:27], s54 offen lds
    s_add_u32 m0, s60, 10240
    s_add_u32 s54, s70, 774144
    buffer_load_dwordx4 v4, s[24:27], s54 offen lds
    s_add_u32 m0, s60, 11264
    s_add_u32 s54, s70, 792576
    buffer_load_dwordx4 v4, s[24:27], s54 offen lds
    s_add_u32 m0, s60, 12288
    s_add_u32 s54, s70, 811008
    buffer_load_dwordx4 v4, s[24:27], s54 offen lds
    s_add_u32 m0, s60, 13312
    s_add_u32 s54, s70, 829440
    buffer_load_dwordx4 v4, s[24:27], s54 offen lds
    s_add_u32 m0, s60, 14336
    s_add_u32 s54, s70, 847872
    buffer_load_dwordx4 v4, s[24:27], s54 offen lds
    s_add_u32 m0, s60, 15360
    s_add_u32 s54, s70, 866304
    buffer_load_dwordx4 v4, s[24:27], s54 offen lds
    s_waitcnt vmcnt(16)
    ds_read_b64_tr_b16 a[64:65], v5 offset:16384
    ds_read_b64_tr_b16 a[66:67], v5 offset:17408
    ds_read_b64_tr_b16 a[68:69], v5 offset:16896
    ds_read_b64_tr_b16 a[70:71], v5 offset:17920
    ds_read_b64_tr_b16 a[72:73], v5 offset:18432
    ds_read_b64_tr_b16 a[74:75], v5 offset:19456
    ds_read_b64_tr_b16 a[76:77], v5 offset:18944
    ds_read_b64_tr_b16 a[78:79], v5 offset:19968
    ds_read_b64_tr_b16 a[80:81], v5 offset:20480
    ds_read_b64_tr_b16 a[82:83], v5 offset:21504
    ds_read_b64_tr_b16 a[84:85], v5 offset:20992
    ds_read_b64_tr_b16 a[86:87], v5 offset:22016
    ds_read_b64_tr_b16 a[88:89], v5 offset:22528
    ds_read_b64_tr_b16 a[90:91], v5 offset:23552
    ds_read_b64_tr_b16 a[92:93], v5 offset:23040
    ds_read_b64_tr_b16 a[94:95], v5 offset:24064
    ds_read_b64_tr_b16 a[96:97], v5 offset:24576
    ds_read_b64_tr_b16 a[98:99], v5 offset:25600
    ds_read_b64_tr_b16 a[100:101], v5 offset:25088
    ds_read_b64_tr_b16 a[102:103], v5 offset:26112
    ds_read_b64_tr_b16 a[104:105], v5 offset:26624
    ds_read_b64_tr_b16 a[106:107], v5 offset:27648
    ds_read_b64_tr_b16 a[108:109], v5 offset:27136
    ds_read_b64_tr_b16 a[110:111], v5 offset:28160
    ds_read_b64_tr_b16 a[112:113], v5 offset:28672
    ds_read_b64_tr_b16 a[114:115], v5 offset:29696
    ds_read_b64_tr_b16 a[116:117], v5 offset:29184
    ds_read_b64_tr_b16 a[118:119], v5 offset:30208
    ds_read_b64_tr_b16 a[120:121], v5 offset:30720
    ds_read_b64_tr_b16 a[122:123], v5 offset:31744
    ds_read_b64_tr_b16 a[124:125], v5 offset:31232
    ds_read_b64_tr_b16 a[126:127], v5 offset:32256
    s_waitcnt lgkmcnt(0)
    s_add_u32 m0, s60, 16384
    s_add_u32 s54, s70, 884736
    buffer_load_dwordx4 v4, s[24:27], s54 offen lds
    s_add_u32 m0, s60, 17408
    s_add_u32 s54, s70, 903168
    buffer_load_dwordx4 v4, s[24:27], s54 offen lds
    s_add_u32 m0, s60, 18432
    s_add_u32 s54, s70, 921600
    buffer_load_dwordx4 v4, s[24:27], s54 offen lds
    s_add_u32 m0, s60, 19456
    s_add_u32 s54, s70, 940032
    buffer_load_dwordx4 v4, s[24:27], s54 offen lds
    s_add_u32 m0, s60, 20480
    s_add_u32 s54, s70, 958464
    buffer_load_dwordx4 v4, s[24:27], s54 offen lds
    s_add_u32 m0, s60, 21504
    s_add_u32 s54, s70, 976896
    buffer_load_dwordx4 v4, s[24:27], s54 offen lds
    s_add_u32 m0, s60, 22528
    s_add_u32 s54, s70, 995328
    buffer_load_dwordx4 v4, s[24:27], s54 offen lds
    s_add_u32 m0, s60, 23552
    s_add_u32 s54, s70, 1013760
    buffer_load_dwordx4 v4, s[24:27], s54 offen lds
    s_add_u32 m0, s60, 24576
    s_add_u32 s54, s70, 1032192
    buffer_load_dwordx4 v4, s[24:27], s54 offen lds
    s_add_u32 m0, s60, 25600
    s_add_u32 s54, s70, 1050624
    buffer_load_dwordx4 v4, s[24:27], s54 offen lds
    s_add_u32 m0, s60, 26624
    s_add_u32 s54, s70, 1069056
    buffer_load_dwordx4 v4, s[24:27], s54 offen lds
    s_add_u32 m0, s60, 27648
    s_add_u32 s54, s70, 1087488
    buffer_load_dwordx4 v4, s[24:27], s54 offen lds
    s_add_u32 m0, s60, 28672
    s_add_u32 s54, s70, 1105920
    buffer_load_dwordx4 v4, s[24:27], s54 offen lds
    s_add_u32 m0, s60, 29696
    s_add_u32 s54, s70, 1124352
    buffer_load_dwordx4 v4, s[24:27], s54 offen lds
    s_add_u32 m0, s60, 30720
    s_add_u32 s54, s70, 1142784
    buffer_load_dwordx4 v4, s[24:27], s54 offen lds
    s_add_u32 m0, s60, 31744
    s_add_u32 s54, s70, 1161216
    buffer_load_dwordx4 v4, s[24:27], s54 offen lds
    s_waitcnt vmcnt(16)
    ds_read_b64_tr_b16 a[128:129], v5 offset:0
    ds_read_b64_tr_b16 a[130:131], v5 offset:1024
    ds_read_b64_tr_b16 a[132:133], v5 offset:512
    ds_read_b64_tr_b16 a[134:135], v5 offset:1536
    ds_read_b64_tr_b16 a[136:137], v5 offset:2048
    ds_read_b64_tr_b16 a[138:139], v5 offset:3072
    ds_read_b64_tr_b16 a[140:141], v5 offset:2560
    ds_read_b64_tr_b16 a[142:143], v5 offset:3584
    ds_read_b64_tr_b16 a[144:145], v5 offset:4096
    ds_read_b64_tr_b16 a[146:147], v5 offset:5120
    ds_read_b64_tr_b16 a[148:149], v5 offset:4608
    ds_read_b64_tr_b16 a[150:151], v5 offset:5632
    ds_read_b64_tr_b16 a[152:153], v5 offset:6144
    ds_read_b64_tr_b16 a[154:155], v5 offset:7168
    ds_read_b64_tr_b16 a[156:157], v5 offset:6656
    ds_read_b64_tr_b16 a[158:159], v5 offset:7680
    ds_read_b64_tr_b16 a[160:161], v5 offset:8192
    ds_read_b64_tr_b16 a[162:163], v5 offset:9216
    ds_read_b64_tr_b16 a[164:165], v5 offset:8704
    ds_read_b64_tr_b16 a[166:167], v5 offset:9728
    ds_read_b64_tr_b16 a[168:169], v5 offset:10240
    ds_read_b64_tr_b16 a[170:171], v5 offset:11264
    ds_read_b64_tr_b16 a[172:173], v5 offset:10752
    ds_read_b64_tr_b16 a[174:175], v5 offset:11776
    ds_read_b64_tr_b16 a[176:177], v5 offset:12288
    ds_read_b64_tr_b16 a[178:179], v5 offset:13312
    ds_read_b64_tr_b16 a[180:181], v5 offset:12800
    ds_read_b64_tr_b16 a[182:183], v5 offset:13824
    ds_read_b64_tr_b16 a[184:185], v5 offset:14336
    ds_read_b64_tr_b16 a[186:187], v5 offset:15360
    ds_read_b64_tr_b16 a[188:189], v5 offset:14848
    ds_read_b64_tr_b16 a[190:191], v5 offset:15872
    s_waitcnt lgkmcnt(0)
    s_waitcnt vmcnt(0)
    ds_read_b64_tr_b16 a[192:193], v5 offset:16384
    ds_read_b64_tr_b16 a[194:195], v5 offset:17408
    ds_read_b64_tr_b16 a[196:197], v5 offset:16896
    ds_read_b64_tr_b16 a[198:199], v5 offset:17920
    ds_read_b64_tr_b16 a[200:201], v5 offset:18432
    ds_read_b64_tr_b16 a[202:203], v5 offset:19456
    ds_read_b64_tr_b16 a[204:205], v5 offset:18944
    ds_read_b64_tr_b16 a[206:207], v5 offset:19968
    ds_read_b64_tr_b16 a[208:209], v5 offset:20480
    ds_read_b64_tr_b16 a[210:211], v5 offset:21504
    ds_read_b64_tr_b16 a[212:213], v5 offset:20992
    ds_read_b64_tr_b16 a[214:215], v5 offset:22016
    ds_read_b64_tr_b16 a[216:217], v5 offset:22528
    ds_read_b64_tr_b16 a[218:219], v5 offset:23552
    ds_read_b64_tr_b16 a[220:221], v5 offset:23040
    ds_read_b64_tr_b16 a[222:223], v5 offset:24064
    ds_read_b64_tr_b16 a[224:225], v5 offset:24576
    ds_read_b64_tr_b16 a[226:227], v5 offset:25600
    ds_read_b64_tr_b16 a[228:229], v5 offset:25088
    ds_read_b64_tr_b16 a[230:231], v5 offset:26112
    ds_read_b64_tr_b16 a[232:233], v5 offset:26624
    ds_read_b64_tr_b16 a[234:235], v5 offset:27648
    ds_read_b64_tr_b16 a[236:237], v5 offset:27136
    ds_read_b64_tr_b16 a[238:239], v5 offset:28160
    ds_read_b64_tr_b16 a[240:241], v5 offset:28672
    ds_read_b64_tr_b16 a[242:243], v5 offset:29696
    ds_read_b64_tr_b16 a[244:245], v5 offset:29184
    ds_read_b64_tr_b16 a[246:247], v5 offset:30208
    ds_read_b64_tr_b16 a[248:249], v5 offset:30720
    ds_read_b64_tr_b16 a[250:251], v5 offset:31744
    ds_read_b64_tr_b16 a[252:253], v5 offset:31232
    ds_read_b64_tr_b16 a[254:255], v5 offset:32256
    s_waitcnt lgkmcnt(0)
    s_barrier
    v_min_u32 v2, 31, v1
    v_lshrrev_b32 v3, 2, v2
    v_and_b32 v2, 3, v2
    v_lshlrev_b32_e64 v2, 2, v2
    v_lshl_add_u32 v6, v3, 7, v2
    s_mul_i32 s68, s4, 1024
    s_add_u32 s68, s68, 12288
    s_lshl_b32 s54, s64, 7
    s_lshl_b32 s55, s4, 2
    s_add_u32 s69, s54, s55
    s_add_u32 s69, s69, 32768
    v_mov_b32 v7, 0
    v_and_b32_e64 v2, 31, v1
    v_mul_u32_u24 v2, 1152, v2
    v_lshrrev_b32_e64 v3, 5, v1
    v_lshl_add_u32 v8, v3, 3, v2
    s_lshl_b32 s54, s4, 12
    v_add_u32 v9, s54, v0
    s_lshl_b32 s54, s4, 10
    v_add_u32 v10, s54, v0
    v_and_b32 v11, 0x1f0, v0
    v_lshlrev_b32_e64 v11, 3, v11
    s_mov_b32 s53, s63
    s_mov_b32 s61, 0
    s_mov_b32 s62, 0
    s_mov_b32 s80, 0
    s_mov_b32 s81, 0
    s_mov_b32 s82, 0
    s_mov_b32 s90, 0
    s_mov_b32 s60, 0
L_op_8:
    s_mul_i32 s73, s53, 73728
    s_lshl_b32 s54, s64, 12
    s_add_u32 s73, s73, s54
    s_add_u32 s73, s73, 88080384
    s_mul_i32 s74, s53, 36864
    s_lshl_b32 s54, s64, 6
    s_lshl_b32 s55, s4, 4
    s_add_u32 s74, s74, s54
    s_add_u32 s74, s74, s55
    s_add_u32 s75, s53, 1
    s_mul_hi_u32 s54, s53, 0x55555556
    s_mul_i32 s55, s54, 3
    s_sub_u32 s55, s53, s55
    s_add_u32 s66, s54, 1
    s_cmp_lg_u32 s55, 0
    s_cbranch_scc1 L_ffn_11
    s_add_u32 s65, s69, 0
    s_cmp_ge_u32 s80, s66
    s_cbranch_scc1 L_wd_13
    s_mov_b32 s79, 524288
L_w_12:
    buffer_load_dword v12, v7, s[8:11], s65 offen sc1
    s_waitcnt vmcnt(0)
    v_cmp_gt_u32 vcc, s66, v12
    s_cbranch_vccz L_wo_14
    s_sub_u32 s79, s79, 1
    s_cbranch_scc1 L_fail
    s_branch L_w_12
L_wo_14:
    s_nop 1
    v_min_u32_dpp v12, v12, v12 quad_perm:[1,0,3,2] row_mask:0xf bank_mask:0xf
    s_nop 1
    v_min_u32_dpp v12, v12, v12 quad_perm:[2,3,0,1] row_mask:0xf bank_mask:0xf
    s_nop 1
    v_min_u32_dpp v12, v12, v12 row_half_mirror row_mask:0xf bank_mask:0xf
    s_nop 1
    v_min_u32_dpp v12, v12, v12 row_mirror row_mask:0xf bank_mask:0xf
    s_nop 0
    v_readlane_b32 s80, v12, 0
    v_readlane_b32 s56, v12, 16
    s_min_u32 s80, s80, s56
    v_readlane_b32 s56, v12, 32
    s_min_u32 s80, s80, s56
    v_readlane_b32 s56, v12, 48
    s_min_u32 s80, s80, s56
L_wd_13:
    s_branch L_ffok_10
L_ffn_11:
    s_cmp_lg_u32 s55, 1
    s_cbranch_scc1 L_ffn_15
    s_add_u32 s65, s69, 2304
    s_cmp_ge_u32 s81, s66
    s_cbranch_scc1 L_wd_17
    s_mov_b32 s79, 524288
L_w_16:
    buffer_load_dword v12, v7, s[8:11], s65 offen sc1
    s_waitcnt vmcnt(0)
    v_cmp_gt_u32 vcc, s66, v12
    s_cbranch_vccz L_wo_18
    s_sub_u32 s79, s79, 1
    s_cbranch_scc1 L_fail
    s_branch L_w_16
L_wo_18:
    s_nop 1
    v_min_u32_dpp v12, v12, v12 quad_perm:[1,0,3,2] row_mask:0xf bank_mask:0xf
    s_nop 1
    v_min_u32_dpp v12, v12, v12 quad_perm:[2,3,0,1] row_mask:0xf bank_mask:0xf
    s_nop 1
    v_min_u32_dpp v12, v12, v12 row_half_mirror row_mask:0xf bank_mask:0xf
    s_nop 1
    v_min_u32_dpp v12, v12, v12 row_mirror row_mask:0xf bank_mask:0xf
    s_nop 0
    v_readlane_b32 s81, v12, 0
    v_readlane_b32 s56, v12, 16
    s_min_u32 s81, s81, s56
    v_readlane_b32 s56, v12, 32
    s_min_u32 s81, s81, s56
    v_readlane_b32 s56, v12, 48
    s_min_u32 s81, s81, s56
L_wd_17:
    s_branch L_ffok_10
L_ffn_15:
    s_add_u32 s65, s69, 4608
    s_cmp_ge_u32 s82, s66
    s_cbranch_scc1 L_wd_21
    s_mov_b32 s79, 524288
L_w_20:
    buffer_load_dword v12, v7, s[8:11], s65 offen sc1
    s_waitcnt vmcnt(0)
    v_cmp_gt_u32 vcc, s66, v12
    s_cbranch_vccz L_wo_22
    s_sub_u32 s79, s79, 1
    s_cbranch_scc1 L_fail
    s_branch L_w_20
L_wo_22:
    s_nop 1
    v_min_u32_dpp v12, v12, v12 quad_perm:[1,0,3,2] row_mask:0xf bank_mask:0xf
    s_nop 1
    v_min_u32_dpp v12, v12, v12 quad_perm:[2,3,0,1] row_mask:0xf bank_mask:0xf
    s_nop 1
    v_min_u32_dpp v12, v12, v12 row_half_mirror row_mask:0xf bank_mask:0xf
    s_nop 1
    v_min_u32_dpp v12, v12, v12 row_mirror row_mask:0xf bank_mask:0xf
    s_nop 0
    v_readlane_b32 s82, v12, 0
    v_readlane_b32 s56, v12, 16
    s_min_u32 s82, s82, s56
    v_readlane_b32 s56, v12, 32
    s_min_u32 s82, s82, s56
    v_readlane_b32 s56, v12, 48
    s_min_u32 s82, s82, s56
L_wd_21:
L_ffok_10:
    buffer_load_dwordx4 v[48:51], v10, s[8:11], s73 offen sc1
    s_cmp_lg_u32 s60, 0
    s_cbranch_scc1 L_go_9
    s_mul_i32 s70, s53, 262144
    s_mul_i32 s54, s4, 65536
    s_add_u32 s70, s70, s54
    s_add_u32 s70, s70, 50331648
    s_and_b32 s54, s53, 1
    s_cmp_gt_u32 s53, 24
    s_cselect_b32 s54, s54, 0
    s_mul_i32 s55, s54, 28672
    s_cmp_lg_u32 s55, 0
    s_cbranch_scc1 L_two_23
    s_cmp_ge_u32 s61, s75
    s_cbranch_scc1 L_wd_26
    s_mov_b32 s79, 524288
L_w_25:
    buffer_load_dword v12, v6, s[8:11], s68 offen sc1
    s_waitcnt vmcnt(0)
    v_cmp_gt_u32 vcc, s75, v12
    s_cbranch_vccz L_wo_27
    s_sub_u32 s79, s79, 1
    s_cbranch_scc1 L_fail
    s_branch L_w_25
L_wo_27:
    s_nop 1
    v_min_u32_dpp v12, v12, v12 quad_perm:[1,0,3,2] row_mask:0xf bank_mask:0xf
    s_nop 1
    v_min_u32_dpp v12, v12, v12 quad_perm:[2,3,0,1] row_mask:0xf bank_mask:0xf
    s_nop 1
    v_min_u32_dpp v12, v12, v12 row_half_mirror row_mask:0xf bank_mask:0xf
    s_nop 1
    v_min_u32_dpp v12, v12, v12 row_mirror row_mask:0xf bank_mask:0xf
    s_nop 0
    v_readlane_b32 s61, v12, 0
    v_readlane_b32 s56, v12, 16
    s_min_u32 s61, s61, s56
    v_readlane_b32 s56, v12, 32
    s_min_u32 s61, s61, s56
    v_readlane_b32 s56, v12, 48
    s_min_u32 s61, s61, s56
L_wd_26:
    s_branch L_ofin_24
L_two_23:
    s_add_u32 s55, s55, s68
    s_cmp_ge_u32 s62, s75
    s_cbranch_scc1 L_wd_29
    s_mov_b32 s79, 524288
L_w_28:
    buffer_load_dword v12, v6, s[8:11], s55 offen sc1
    s_waitcnt vmcnt(0)
    v_cmp_gt_u32 vcc, s75, v12
    s_cbranch_vccz L_wo_30
    s_sub_u32 s79, s79, 1
    s_cbranch_scc1 L_fail
    s_branch L_w_28
L_wo_30:
    s_nop 1
    v_min_u32_dpp v12, v12, v12 quad_perm:[1,0,3,2] row_mask:0xf bank_mask:0xf
    s_nop 1
    v_min_u32_dpp v12, v12, v12 quad_perm:[2,3,0,1] row_mask:0xf bank_mask:0xf
    s_nop 1
    v_min_u32_dpp v12, v12, v12 row_half_mirror row_mask:0xf bank_mask:0xf
    s_nop 1
    v_min_u32_dpp v12, v12, v12 row_mirror row_mask:0xf bank_mask:0xf
    s_nop 0
    v_readlane_b32 s62, v12, 0
    v_readlane_b32 s56, v12, 16
    s_min_u32 s62, s62, s56
    v_readlane_b32 s56, v12, 32
    s_min_u32 s62, s62, s56
    v_readlane_b32 s56, v12, 48
    s_min_u32 s62, s62, s56
L_wd_29:
L_ofin_24:
    s_cmp_lg_u32 s84, -1
    s_cbranch_scc1 L_half
    buffer_load_dwordx4 v[52:55], v0, s[8:11], s70 offen offset:0 sc1
    buffer_load_dwordx4 v[56:59], v0, s[8:11], s70 offen offset:1024 sc1
    buffer_load_dwordx4 v[60:63], v0, s[8:11], s70 offen offset:2048 sc1
    buffer_load_dwordx4 v[64:67], v0, s[8:11], s70 offen offset:3072 sc1
    s_add_u32 s70, s70, 4096
    buffer_load_dwordx4 v[68:71], v0, s[8:11], s70 offen offset:0 sc1
    buffer_load_dwordx4 v[72:75], v0, s[8:11], s70 offen offset:1024 sc1
    buffer_load_dwordx4 v[76:79], v0, s[8:11], s70 offen offset:2048 sc1
    buffer_load_dwordx4 v[80:83], v0, s[8:11], s70 offen offset:3072 sc1
    s_add_u32 s70, s70, 4096
    buffer_load_dwordx4 v[84:87], v0, s[8:11], s70 offen offset:0 sc1
    buffer_load_dwordx4 v[88:91], v0, s[8:11], s70 offen offset:1024 sc1
    buffer_load_dwordx4 v[92:95], v0, s[8:11], s70 offen offset:2048 sc1
    buffer_load_dwordx4 v[96:99], v0, s[8:11], s70 offen offset:3072 sc1
    s_add_u32 s70, s70, 4096
    buffer_load_dwordx4 v[100:103], v0, s[8:11], s70 offen offset:0 sc1
    buffer_load_dwordx4 v[104:107], v0, s[8:11], s70 offen offset:1024 sc1
    buffer_load_dwordx4 v[108:111], v0, s[8:11], s70 offen offset:2048 sc1
    buffer_load_dwordx4 v[112:115], v0, s[8:11], s70 offen offset:3072 sc1
    s_add_u32 s70, s70, 4096
    buffer_load_dwordx4 v[116:119], v0, s[8:11], s70 offen offset:0 sc1
    buffer_load_dwordx4 v[120:123], v0, s[8:11], s70 offen offset:1024 sc1
    buffer_load_dwordx4 v[124:127], v0, s[8:11], s70 offen offset:2048 sc1
    buffer_load_dwordx4 v[128:131], v0, s[8:11], s70 offen offset:3072 sc1
    s_add_u32 s70, s70, 4096
    buffer_load_dwordx4 v[132:135], v0, s[8:11], s70 offen offset:0 sc1
    buffer_load_dwordx4 v[136:139], v0, s[8:11], s70 offen offset:1024 sc1
    buffer_load_dwordx4 v[140:143], v0, s[8:11], s70 offen offset:2048 sc1
    buffer_load_dwordx4 v[144:147], v0, s[8:11], s70 offen offset:3072 sc1
L_go_9:
    s_cmp_ge_u32 s53, 30
    s_cselect_b32 s59, 3, 2
    s_add_u32 s59, s59, s53
    s_and_b32 s54, s59, 1
    s_cmp_gt_u32 s59, 24
    s_cselect_b32 s54, s54, 0
    s_mul_i32 s67, s54, 28672
    s_add_u32 s67, s67, s68
    s_waitcnt vmcnt(23)
    v_mfma_f32_32x32x16_bf16 v[16:31], a[0:3], v[52:55], 0
    s_add_u32 s70, s70, 4096
    buffer_load_dwordx4 v[52:55], v0, s[8:11], s70 offen offset:0 sc1
    s_waitcnt vmcnt(23)
    v_mfma_f32_32x32x16_bf16 v[32:47], a[4:7], v[56:59], 0
    buffer_load_dwordx4 v[56:59], v0, s[8:11], s70 offen offset:1024 sc1
    s_waitcnt vmcnt(23)
    v_mfma_f32_32x32x16_bf16 v[16:31], a[8:11], v[60:63], v[16:31]
    buffer_load_dwordx4 v[60:63], v0, s[8:11], s70 offen offset:2048 sc1
    s_waitcnt vmcnt(23)
    v_mfma_f32_32x32x16_bf16 v[32:47], a[12:15], v[64:67], v[32:47]
    buffer_load_dwordx4 v[64:67], v0, s[8:11], s70 offen offset:3072 sc1
    s_waitcnt vmcnt(23)
    v_mfma_f32_32x32x16_bf16 v[16:31], a[16:19], v[68:71], v[16:31]
    s_add_u32 s70, s70, 4096
    buffer_load_dwordx4 v[68:71], v0, s[8:11], s70 offen offset:0 sc1
    s_waitcnt vmcnt(23)
    v_mfma_f32_32x32x16_bf16 v[32:47], a[20:23], v[72:75], v[32:47]
    buffer_load_dwordx4 v[72:75], v0, s[8:11], s70 offen offset:1024 sc1
    s_waitcnt vmcnt(23)
    v_mfma_f32_32x32x16_bf16 v[16:31], a[24:27], v[76:79], v[16:31]
    buffer_load_dwordx4 v[76:79], v0, s[8:11], s70 offen offset:2048 sc1
    s_waitcnt vmcnt(23)
    v_mfma_f32_32x32x16_bf16 v[32:47], a[28:31], v[80:83], v[32:47]
    buffer_load_dwordx4 v[80:83], v0, s[8:11], s70 offen offset:3072 sc1
    s_waitcnt vmcnt(23)
    v_mfma_f32_32x32x16_bf16 v[16:31], a[32:35], v[84:87], v[16:31]
    s_add_u32 s70, s70, 4096
    buffer_load_dwordx4 v[84:87], v0, s[8:11], s70 offen offset:0 sc1
    s_waitcnt vmcnt(23)
    v_mfma_f32_32x32x16_bf16 v[32:47], a[36:39], v[88:91], v[32:47]
    buffer_load_dwordx4 v[88:91], v0, s[8:11], s70 offen offset:1024 sc1
    s_waitcnt vmcnt(23)
    v_mfma_f32_32x32x16_bf16 v[16:31], a[40:43], v[92:95], v[16:31]
    buffer_load_dwordx4 v[92:95], v0, s[8:11], s70 offen offset:2048 sc1
    s_waitcnt vmcnt(23)
    v_mfma_f32_32x32x16_bf16 v[32:47], a[44:47], v[96:99], v[32:47]
    buffer_load_dwordx4 v[96:99], v0, s[8:11], s70 offen offset:3072 sc1
    s_waitcnt vmcnt(23)
    v_mfma_f32_32x32x16_bf16 v[16:31], a[48:51], v[100:103], v[16:31]
    s_add_u32 s70, s70, 4096
    buffer_load_dwordx4 v[100:103], v0, s[8:11], s70 offen offset:0 sc1
    s_waitcnt vmcnt(23)
    v_mfma_f32_32x32x16_bf16 v[32:47], a[52:55], v[104:107], v[32:47]
    buffer_load_dwordx4 v[104:107], v0, s[8:11], s70 offen offset:1024 sc1
    s_waitcnt vmcnt(23)
    v_mfma_f32_32x32x16_bf16 v[16:31], a[56:59], v[108:111], v[16:31]
    buffer_load_dwordx4 v[108:111], v0, s[8:11], s70 offen offset:2048 sc1
    s_waitcnt vmcnt(23)
    v_mfma_f32_32x32x16_bf16 v[32:47], a[60:63], v[112:115], v[32:47]
    buffer_load_dwordx4 v[112:115], v0, s[8:11], s70 offen offset:3072 sc1
    s_waitcnt vmcnt(23)
    v_mfma_f32_32x32x16_bf16 v[16:31], a[64:67], v[116:119], v[16:31]
    s_add_u32 s70, s70, 4096
    buffer_load_dwordx4 v[116:119], v0, s[8:11], s70 offen offset:0 sc1
    s_waitcnt vmcnt(23)
    v_mfma_f32_32x32x16_bf16 v[32:47], a[68:71], v[120:123], v[32:47]
    buffer_load_dwordx4 v[120:123], v0, s[8:11], s70 offen offset:1024 sc1
    s_waitcnt vmcnt(23)
    v_mfma_f32_32x32x16_bf16 v[16:31], a[72:75], v[124:127], v[16:31]
    buffer_load_dwordx4 v[124:127], v0, s[8:11], s70 offen offset:2048 sc1
    s_waitcnt vmcnt(23)
    v_mfma_f32_32x32x16_bf16 v[32:47], a[76:79], v[128:131], v[32:47]
    buffer_load_dwordx4 v[128:131], v0, s[8:11], s70 offen offset:3072 sc1
    s_waitcnt vmcnt(23)
    v_mfma_f32_32x32x16_bf16 v[16:31], a[80:83], v[132:135], v[16:31]
    s_add_u32 s70, s70, 4096
    buffer_load_dwordx4 v[132:135], v0, s[8:11], s70 offen offset:0 sc1
    s_waitcnt vmcnt(23)
    v_mfma_f32_32x32x16_bf16 v[32:47], a[84:87], v[136:139], v[32:47]
    buffer_load_dwordx4 v[136:139], v0, s[8:11], s70 offen offset:1024 sc1
    s_waitcnt vmcnt(23)
    v_mfma_f32_32x32x16_bf16 v[16:31], a[88:91], v[140:143], v[16:31]
    buffer_load_dwordx4 v[140:143], v0, s[8:11], s70 offen offset:2048 sc1
    s_waitcnt vmcnt(23)
    v_mfma_f32_32x32x16_bf16 v[32:47], a[92:95], v[144:147], v[32:47]
    buffer_load_dwordx4 v[144:147], v0, s[8:11], s70 offen offset:3072 sc1
    s_waitcnt vmcnt(23)
    v_mfma_f32_32x32x16_bf16 v[16:31], a[96:99], v[52:55], v[16:31]
    s_add_u32 s70, s70, 4096
    buffer_load_dwordx4 v[52:55], v0, s[8:11], s70 offen offset:0 sc1
    s_waitcnt vmcnt(23)
    v_mfma_f32_32x32x16_bf16 v[32:47], a[100:103], v[56:59], v[32:47]
    buffer_load_dwordx4 v[56:59], v0, s[8:11], s70 offen offset:1024 sc1
    s_waitcnt vmcnt(23)
    v_mfma_f32_32x32x16_bf16 v[16:31], a[104:107], v[60:63], v[16:31]
    buffer_load_dwordx4 v[60:63], v0, s[8:11], s70 offen offset:2048 sc1
    s_waitcnt vmcnt(23)
    v_mfma_f32_32x32x16_bf16 v[32:47], a[108:111], v[64:67], v[32:47]
    buffer_load_dwordx4 v[64:67], v0, s[8:11], s70 offen offset:3072 sc1
    s_waitcnt vmcnt(23)
    v_mfma_f32_32x32x16_bf16 v[16:31], a[112:115], v[68:71], v[16:31]
    s_add_u32 s70, s70, 4096
    buffer_load_dwordx4 v[68:71], v0, s[8:11], s70 offen offset:0 sc1
    s_waitcnt vmcnt(23)
    v_mfma_f32_32x32x16_bf16 v[32:47], a[116:119], v[72:75], v[32:47]
    buffer_load_dwordx4 v[72:75], v0, s[8:11], s70 offen offset:1024 sc1
    s_waitcnt vmcnt(23)
    v_mfma_f32_32x32x16_bf16 v[16:31], a[120:123], v[76:79], v[16:31]
    buffer_load_dwordx4 v[76:79], v0, s[8:11], s70 offen offset:2048 sc1
    s_waitcnt vmcnt(23)
    v_mfma_f32_32x32x16_bf16 v[32:47], a[124:127], v[80:83], v[32:47]
    buffer_load_dwordx4 v[80:83], v0, s[8:11], s70 offen offset:3072 sc1
    s_waitcnt vmcnt(23)
    v_mfma_f32_32x32x16_bf16 v[16:31], a[128:131], v[84:87], v[16:31]
    s_add_u32 s70, s70, 4096
    buffer_load_dwordx4 v[84:87], v0, s[8:11], s70 offen offset:0 sc1
    s_waitcnt vmcnt(23)
    v_mfma_f32_32x32x16_bf16 v[32:47], a[132:135], v[88:91], v[32:47]
    buffer_load_dwordx4 v[88:91], v0, s[8:11], s70 offen offset:1024 sc1
    s_waitcnt vmcnt(23)
    v_mfma_f32_32x32x16_bf16 v[16:31], a[136:139], v[92:95], v[16:31]
    buffer_load_dwordx4 v[92:95], v0, s[8:11], s70 offen offset:2048 sc1
    s_waitcnt vmcnt(23)
    v_mfma_f32_32x32x16_bf16 v[32:47], a[140:143], v[96:99], v[32:47]
    buffer_load_dwordx4 v[96:99], v0, s[8:11], s70 offen offset:3072 sc1
    s_waitcnt vmcnt(23)
    v_mfma_f32_32x32x16_bf16 v[16:31], a[144:147], v[100:103], v[16:31]
    s_add_u32 s70, s70, 4096
    buffer_load_dwordx4 v[100:103], v0, s[8:11], s70 offen offset:0 sc1
    s_waitcnt vmcnt(23)
    v_mfma_f32_32x32x16_bf16 v[32:47], a[148:151], v[104:107], v[32:47]
    buffer_load_dwordx4 v[104:107], v0, s[8:11], s70 offen offset:1024 sc1
    s_waitcnt vmcnt(23)
    v_mfma_f32_32x32x16_bf16 v[16:31], a[152:155], v[108:111], v[16:31]
    buffer_load_dwordx4 v[108:111], v0, s[8:11], s70 offen offset:2048 sc1
    s_waitcnt vmcnt(23)
    v_mfma_f32_32x32x16_bf16 v[32:47], a[156:159], v[112:115], v[32:47]
    buffer_load_dwordx4 v[112:115], v0, s[8:11], s70 offen offset:3072 sc1
    s_waitcnt vmcnt(23)
    v_mfma_f32_32x32x16_bf16 v[16:31], a[160:163], v[116:119], v[16:31]
    s_waitcnt vmcnt(22)
    v_mfma_f32_32x32x16_bf16 v[32:47], a[164:167], v[120:123], v[32:47]
    s_waitcnt vmcnt(21)
    v_mfma_f32_32x32x16_bf16 v[16:31], a[168:171], v[124:127], v[16:31]
    s_waitcnt vmcnt(20)
    v_mfma_f32_32x32x16_bf16 v[32:47], a[172:175], v[128:131], v[32:47]
    s_waitcnt vmcnt(19)
    v_mfma_f32_32x32x16_bf16 v[16:31], a[176:179], v[132:135], v[16:31]
    s_waitcnt vmcnt(18)
    v_mfma_f32_32x32x16_bf16 v[32:47], a[180:183], v[136:139], v[32:47]
    s_waitcnt vmcnt(17)
    v_mfma_f32_32x32x16_bf16 v[16:31], a[184:187], v[140:143], v[16:31]
    s_waitcnt vmcnt(16)
    v_mfma_f32_32x32x16_bf16 v[32:47], a[188:191], v[144:147], v[32:47]
    s_waitcnt vmcnt(15)
    v_mfma_f32_32x32x16_bf16 v[16:31], a[192:195], v[52:55], v[16:31]
    s_waitcnt vmcnt(14)
    v_mfma_f32_32x32x16_bf16 v[32:47], a[196:199], v[56:59], v[32:47]
    s_waitcnt vmcnt(13)
    v_mfma_f32_32x32x16_bf16 v[16:31], a[200:203], v[60:63], v[16:31]
    s_waitcnt vmcnt(12)
    v_mfma_f32_32x32x16_bf16 v[32:47], a[204:207], v[64:67], v[32:47]
    s_waitcnt vmcnt(11)
    v_mfma_f32_32x32x16_bf16 v[16:31], a[208:211], v[68:71], v[16:31]
    s_waitcnt vmcnt(10)
    v_mfma_f32_32x32x16_bf16 v[32:47], a[212:215], v[72:75], v[32:47]
    s_waitcnt vmcnt(9)
    v_mfma_f32_32x32x16_bf16 v[16:31], a[216:219], v[76:79], v[16:31]
    buffer_load_dword v12, v6, s[8:11], s67 offen sc1
    s_waitcnt vmcnt(9)
    v_mfma_f32_32x32x16_bf16 v[32:47], a[220:223], v[80:83], v[32:47]
    s_waitcnt vmcnt(8)
    v_mfma_f32_32x32x16_bf16 v[16:31], a[224:227], v[84:87], v[16:31]
    s_waitcnt vmcnt(7)
    v_mfma_f32_32x32x16_bf16 v[32:47], a[228:231], v[88:91], v[32:47]
    s_waitcnt vmcnt(6)
    v_mfma_f32_32x32x16_bf16 v[16:31], a[232:235], v[92:95], v[16:31]
    s_waitcnt vmcnt(5)
    v_mfma_f32_32x32x16_bf16 v[32:47], a[236:239], v[96:99], v[32:47]
    s_waitcnt vmcnt(4)
    v_mfma_f32_32x32x16_bf16 v[16:31], a[240:243], v[100:103], v[16:31]
    s_waitcnt vmcnt(3)
    v_mfma_f32_32x32x16_bf16 v[32:47], a[244:247], v[104:107], v[32:47]
    s_waitcnt vmcnt(2)
    v_mfma_f32_32x32x16_bf16 v[16:31], a[248:251], v[108:111], v[16:31]
    s_waitcnt vmcnt(1)
    v_mfma_f32_32x32x16_bf16 v[32:47], a[252:255], v[112:115], v[32:47]
    s_waitcnt vmcnt(0)
    s_nop 1
    v_min_u32_dpp v12, v12, v12 quad_perm:[1,0,3,2] row_mask:0xf bank_mask:0xf
    s_nop 1
    v_min_u32_dpp v12, v12, v12 quad_perm:[2,3,0,1] row_mask:0xf bank_mask:0xf
    s_nop 1
    v_min_u32_dpp v12, v12, v12 row_half_mirror row_mask:0xf bank_mask:0xf
    s_nop 1
    v_min_u32_dpp v12, v12, v12 row_mirror row_mask:0xf bank_mask:0xf
    s_nop 0
    v_readlane_b32 s55, v12, 0
    v_readlane_b32 s56, v12, 16
    s_min_u32 s55, s55, s56
    v_readlane_b32 s56, v12, 32
    s_min_u32 s55, s55, s56
    v_readlane_b32 s56, v12, 48
    s_min_u32 s55, s55, s56
    s_cmp_gt_u32 s55, s59
    s_cselect_b32 s60, 1, 0
    s_cmp_lt_u32 s59, 62
    s_cselect_b32 s60, s60, 0
    s_cmp_eq_u32 s60, 0
    s_cbranch_scc1 L_nopre_31
    s_mul_i32 s70, s59, 262144
    s_mul_i32 s54, s4, 65536
    s_add_u32 s70, s70, s54
    s_add_u32 s70, s70, 50331648
    buffer_load_dwordx4 v[52:55], v0, s[8:11], s70 offen offset:0 sc1
    buffer_load_dwordx4 v[56:59], v0, s[8:11], s70 offen offset:1024 sc1
    buffer_load_dwordx4 v[60:63], v0, s[8:11], s70 offen offset:2048 sc1
    buffer_load_dwordx4 v[64:67], v0, s[8:11], s70 offen offset:3072 sc1
    s_add_u32 s70, s70, 4096
    buffer_load_dwordx4 v[68:71], v0, s[8:11], s70 offen offset:0 sc1
    buffer_load_dwordx4 v[72:75], v0, s[8:11], s70 offen offset:1024 sc1
    buffer_load_dwordx4 v[76:79], v0, s[8:11], s70 offen offset:2048 sc1
    buffer_load_dwordx4 v[80:83], v0, s[8:11], s70 offen offset:3072 sc1
    s_add_u32 s70, s70, 4096
    buffer_load_dwordx4 v[84:87], v0, s[8:11], s70 offen offset:0 sc1
    buffer_load_dwordx4 v[88:91], v0, s[8:11], s70 offen offset:1024 sc1
    buffer_load_dwordx4 v[92:95], v0, s[8:11], s70 offen offset:2048 sc1
    buffer_load_dwordx4 v[96:99], v0, s[8:11], s70 offen offset:3072 sc1
    s_add_u32 s70, s70, 4096
    buffer_load_dwordx4 v[100:103], v0, s[8:11], s70 offen offset:0 sc1
    buffer_load_dwordx4 v[104:107], v0, s[8:11], s70 offen offset:1024 sc1
    buffer_load_dwordx4 v[108:111], v0, s[8:11], s70 offen offset:2048 sc1
    buffer_load_dwordx4 v[112:115], v0, s[8:11], s70 offen offset:3072 sc1
    s_add_u32 s70, s70, 4096
    buffer_load_dwordx4 v[116:119], v0, s[8:11], s70 offen offset:0 sc1
    buffer_load_dwordx4 v[120:123], v0, s[8:11], s70 offen offset:1024 sc1
    buffer_load_dwordx4 v[124:127], v0, s[8:11], s70 offen offset:2048 sc1
    buffer_load_dwordx4 v[128:131], v0, s[8:11], s70 offen offset:3072 sc1
    s_add_u32 s70, s70, 4096
    buffer_load_dwordx4 v[132:135], v0, s[8:11], s70 offen offset:0 sc1
    buffer_load_dwordx4 v[136:139], v0, s[8:11], s70 offen offset:1024 sc1
    buffer_load_dwordx4 v[140:143], v0, s[8:11], s70 offen offset:2048 sc1
    buffer_load_dwordx4 v[144:147], v0, s[8:11], s70 offen offset:3072 sc1
L_nopre_31:
    s_nop 7
    s_nop 3
    v_pk_add_f32 v[16:17], v[16:17], v[32:33]
    v_pk_add_f32 v[18:19], v[18:19], v[34:35]
    v_pk_add_f32 v[20:21], v[20:21], v[36:37]
    v_pk_add_f32 v[22:23], v[22:23], v[38:39]
    v_pk_add_f32 v[24:25], v[24:25], v[40:41]
    v_pk_add_f32 v[26:27], v[26:27], v[42:43]
    v_pk_add_f32 v[28:29], v[28:29], v[44:45]
    v_pk_add_f32 v[30:31], v[30:31], v[46:47]
    s_barrier
    ds_write_b128 v9, v[16:19] offset:0
    ds_write_b128 v9, v[20:23] offset:1024
    ds_write_b128 v9, v[24:27] offset:2048
    ds_write_b128 v9, v[28:31] offset:3072
    s_waitcnt lgkmcnt(0)
    s_barrier
    ds_read_b128 v[16:19], v10 offset:0
    ds_read_b128 v[20:23], v10 offset:4096
    ds_read_b128 v[24:27], v10 offset:8192
    ds_read_b128 v[28:31], v10 offset:12288
    s_waitcnt lgkmcnt(3)
    v_pk_add_f32 v[48:49], v[48:49], v[16:17]
    v_pk_add_f32 v[50:51], v[50:51], v[18:19]
    s_waitcnt lgkmcnt(2)
    v_pk_add_f32 v[48:49], v[48:49], v[20:21]
    v_pk_add_f32 v[50:51], v[50:51], v[22:23]
    s_waitcnt lgkmcnt(1)
    v_pk_add_f32 v[48:49], v[48:49], v[24:25]
    v_pk_add_f32 v[50:51], v[50:51], v[26:27]
    s_waitcnt lgkmcnt(0)
    v_pk_add_f32 v[48:49], v[48:49], v[28:29]
    v_pk_add_f32 v[50:51], v[50:51], v[30:31]
    v_cvt_pk_bf16_f32 v48, v48, v49
    v_cvt_pk_bf16_f32 v49, v50, v51
    buffer_store_dwordx2 v[48:49], v8, s[36:39], s74 offen
    s_mov_b32 s53, s59
    s_cmp_lt_u32 s53, 62
    s_cbranch_scc1 L_op_8
    s_endpgm
L_half:
    v_and_b32 v2, 0x100, v0
    v_lshlrev_b32 v3, 2, v2
    v_sub_u32_e64 v2, v0, v2
    v_add3_u32 v2, v2, v3, s84
    v_add_u32_e64 v3, s84, v10
    buffer_load_dwordx4 v[48:51], v3, s[8:11], s73 offen sc1
    s_mul_i32 s54, s84, 72
    s_add_u32 s74, s74, s54
    buffer_load_dwordx4 v[52:55], v2, s[8:11], s70 offen offset:0 sc1
    buffer_load_dwordx4 v[56:59], v2, s[8:11], s70 offen offset:2048 sc1
    s_add_u32 s70, s70, 4096
    buffer_load_dwordx4 v[60:63], v2, s[8:11], s70 offen offset:0 sc1
    buffer_load_dwordx4 v[64:67], v2, s[8:11], s70 offen offset:2048 sc1
    s_add_u32 s70, s70, 4096
    buffer_load_dwordx4 v[68:71], v2, s[8:11], s70 offen offset:0 sc1
    buffer_load_dwordx4 v[72:75], v2, s[8:11], s70 offen offset:2048 sc1
    s_add_u32 s70, s70, 4096
    buffer_load_dwordx4 v[76:79], v2, s[8:11], s70 offen offset:0 sc1
    buffer_load_dwordx4 v[80:83], v2, s[8:11], s70 offen offset:2048 sc1
    s_add_u32 s70, s70, 4096
    buffer_load_dwordx4 v[84:87], v2, s[8:11], s70 offen offset:0 sc1
    buffer_load_dwordx4 v[88:91], v2, s[8:11], s70 offen offset:2048 sc1
    s_add_u32 s70, s70, 4096
    buffer_load_dwordx4 v[92:95], v2, s[8:11], s70 offen offset:0 sc1
    buffer_load_dwordx4 v[96:99], v2, s[8:11], s70 offen offset:2048 sc1
    s_waitcnt vmcnt(11)
    v_mfma_f32_32x32x16_bf16 v[16:31], a[0:3], v[52:55], 0
    s_add_u32 s70, s70, 4096
    buffer_load_dwordx4 v[100:103], v2, s[8:11], s70 offen offset:0 sc1
    v_mfma_f32_32x32x16_bf16 v[32:47], a[4:7], v[52:55], 0
    s_waitcnt vmcnt(11)
    v_mfma_f32_32x32x16_bf16 v[16:31], a[8:11], v[56:59], v[16:31]
    buffer_load_dwordx4 v[104:107], v2, s[8:11], s70 offen offset:2048 sc1
    v_mfma_f32_32x32x16_bf16 v[32:47], a[12:15], v[56:59], v[32:47]
    s_waitcnt vmcnt(11)
    v_mfma_f32_32x32x16_bf16 v[16:31], a[16:19], v[60:63], v[16:31]
    s_add_u32 s70, s70, 4096
    buffer_load_dwordx4 v[108:111], v2, s[8:11], s70 offen offset:0 sc1
    v_mfma_f32_32x32x16_bf16 v[32:47], a[20:23], v[60:63], v[32:47]
    s_waitcnt vmcnt(11)
    v_mfma_f32_32x32x16_bf16 v[16:31], a[24:27], v[64:67], v[16:31]
    buffer_load_dwordx4 v[112:115], v2, s[8:11], s70 offen offset:2048 sc1
    v_mfma_f32_32x32x16_bf16 v[32:47], a[28:31], v[64:67], v[32:47]
    s_waitcnt vmcnt(11)
    v_mfma_f32_32x32x16_bf16 v[16:31], a[32:35], v[68:71], v[16:31]
    s_add_u32 s70, s70, 4096
    buffer_load_dwordx4 v[116:119], v2, s[8:11], s70 offen offset:0 sc1
    v_mfma_f32_32x32x16_bf16 v[32:47], a[36:39], v[68:71], v[32:47]
    s_waitcnt vmcnt(11)
    v_mfma_f32_32x32x16_bf16 v[16:31], a[40:43], v[72:75], v[16:31]
    buffer_load_dwordx4 v[120:123], v2, s[8:11], s70 offen offset:2048 sc1
    v_mfma_f32_32x32x16_bf16 v[32:47], a[44:47], v[72:75], v[32:47]
    s_waitcnt vmcnt(11)
    v_mfma_f32_32x32x16_bf16 v[16:31], a[48:51], v[76:79], v[16:31]
    s_add_u32 s70, s70, 4096
    buffer_load_dwordx4 v[124:127], v2, s[8:11], s70 offen offset:0 sc1
    v_mfma_f32_32x32x16_bf16 v[32:47], a[52:55], v[76:79], v[32:47]
    s_waitcnt vmcnt(11)
    v_mfma_f32_32x32x16_bf16 v[16:31], a[56:59], v[80:83], v[16:31]
    buffer_load_dwordx4 v[128:131], v2, s[8:11], s70 offen offset:2048 sc1
    v_mfma_f32_32x32x16_bf16 v[32:47], a[60:63], v[80:83], v[32:47]
    s_waitcnt vmcnt(11)
    v_mfma_f32_32x32x16_bf16 v[16:31], a[64:67], v[84:87], v[16:31]
    s_add_u32 s70, s70, 4096
    buffer_load_dwordx4 v[132:135], v2, s[8:11], s70 offen offset:0 sc1
    v_mfma_f32_32x32x16_bf16 v[32:47], a[68:71], v[84:87], v[32:47]
    s_waitcnt vmcnt(11)
    v_mfma_f32_32x32x16_bf16 v[16:31], a[72:75], v[88:91], v[16:31]
    buffer_load_dwordx4 v[136:139], v2, s[8:11], s70 offen offset:2048 sc1
    v_mfma_f32_32x32x16_bf16 v[32:47], a[76:79], v[88:91], v[32:47]
    s_waitcnt vmcnt(11)
    v_mfma_f32_32x32x16_bf16 v[16:31], a[80:83], v[92:95], v[16:31]
    s_add_u32 s70, s70, 4096
    buffer_load_dwordx4 v[140:143], v2, s[8:11], s70 offen offset:0 sc1
    v_mfma_f32_32x32x16_bf16 v[32:47], a[84:87], v[92:95], v[32:47]
    s_waitcnt vmcnt(11)
    v_mfma_f32_32x32x16_bf16 v[16:31], a[88:91], v[96:99], v[16:31]
    buffer_load_dwordx4 v[144:147], v2, s[8:11], s70 offen offset:2048 sc1
    v_mfma_f32_32x32x16_bf16 v[32:47], a[92:95], v[96:99], v[32:47]
    s_waitcnt vmcnt(11)
    v_mfma_f32_32x32x16_bf16 v[16:31], a[96:99], v[100:103], v[16:31]
    s_add_u32 s70, s70, 4096
    buffer_load_dwordx4 v[148:151], v2, s[8:11], s70 offen offset:0 sc1
    v_mfma_f32_32x32x16_bf16 v[32:47], a[100:103], v[100:103], v[32:47]
    s_waitcnt vmcnt(11)
    v_mfma_f32_32x32x16_bf16 v[16:31], a[104:107], v[104:107], v[16:31]
    buffer_load_dwordx4 v[152:155], v2, s[8:11], s70 offen offset:2048 sc1
    v_mfma_f32_32x32x16_bf16 v[32:47], a[108:111], v[104:107], v[32:47]
    s_waitcnt vmcnt(11)
    v_mfma_f32_32x32x16_bf16 v[16:31], a[112:115], v[108:111], v[16:31]
    s_add_u32 s70, s70, 4096
    buffer_load_dwordx4 v[156:159], v2, s[8:11], s70 offen offset:0 sc1
    v_mfma_f32_32x32x16_bf16 v[32:47], a[116:119], v[108:111], v[32:47]
    s_waitcnt vmcnt(11)
    v_mfma_f32_32x32x16_bf16 v[16:31], a[120:123], v[112:115], v[16:31]
    buffer_load_dwordx4 v[160:163], v2, s[8:11], s70 offen offset:2048 sc1
    v_mfma_f32_32x32x16_bf16 v[32:47], a[124:127], v[112:115], v[32:47]
    s_waitcnt vmcnt(11)
    v_mfma_f32_32x32x16_bf16 v[16:31], a[128:131], v[116:119], v[16:31]
    s_add_u32 s70, s70, 4096
    buffer_load_dwordx4 v[164:167], v2, s[8:11], s70 offen offset:0 sc1
    v_mfma_f32_32x32x16_bf16 v[32:47], a[132:135], v[116:119], v[32:47]
    s_waitcnt vmcnt(11)
    v_mfma_f32_32x32x16_bf16 v[16:31], a[136:139], v[120:123], v[16:31]
    buffer_load_dwordx4 v[168:171], v2, s[8:11], s70 offen offset:2048 sc1
    v_mfma_f32_32x32x16_bf16 v[32:47], a[140:143], v[120:123], v[32:47]
    s_waitcnt vmcnt(11)
    v_mfma_f32_32x32x16_bf16 v[16:31], a[144:147], v[124:127], v[16:31]
    s_add_u32 s70, s70, 4096
    buffer_load_dwordx4 v[172:175], v2, s[8:11], s70 offen offset:0 sc1
    v_mfma_f32_32x32x16_bf16 v[32:47], a[148:151], v[124:127], v[32:47]
    s_waitcnt vmcnt(11)
    v_mfma_f32_32x32x16_bf16 v[16:31], a[152:155], v[128:131], v[16:31]
    buffer_load_dwordx4 v[176:179], v2, s[8:11], s70 offen offset:2048 sc1
    v_mfma_f32_32x32x16_bf16 v[32:47], a[156:159], v[128:131], v[32:47]
    s_waitcnt vmcnt(11)
    v_mfma_f32_32x32x16_bf16 v[16:31], a[160:163], v[132:135], v[16:31]
    v_mfma_f32_32x32x16_bf16 v[32:47], a[164:167], v[132:135], v[32:47]
    s_waitcnt vmcnt(10)
    v_mfma_f32_32x32x16_bf16 v[16:31], a[168:171], v[136:139], v[16:31]
    v_mfma_f32_32x32x16_bf16 v[32:47], a[172:175], v[136:139], v[32:47]
    s_waitcnt vmcnt(9)
    v_mfma_f32_32x32x16_bf16 v[16:31], a[176:179], v[140:143], v[16:31]
    v_mfma_f32_32x32x16_bf16 v[32:47], a[180:183], v[140:143], v[32:47]
    s_waitcnt vmcnt(8)
    v_mfma_f32_32x32x16_bf16 v[16:31], a[184:187], v[144:147], v[16:31]
    v_mfma_f32_32x32x16_bf16 v[32:47], a[188:191], v[144:147], v[32:47]
    s_waitcnt vmcnt(7)
    v_mfma_f32_32x32x16_bf16 v[16:31], a[192:195], v[148:151], v[16:31]
    v_mfma_f32_32x32x16_bf16 v[32:47], a[196:199], v[148:151], v[32:47]
    s_waitcnt vmcnt(6)
    v_mfma_f32_32x32x16_bf16 v[16:31], a[200:203], v[152:155], v[16:31]
    v_mfma_f32_32x32x16_bf16 v[32:47], a[204:207], v[152:155], v[32:47]
    s_waitcnt vmcnt(5)
    v_mfma_f32_32x32x16_bf16 v[16:31], a[208:211], v[156:159], v[16:31]
    v_mfma_f32_32x32x16_bf16 v[32:47], a[212:215], v[156:159], v[32:47]
    s_waitcnt vmcnt(4)
    v_mfma_f32_32x32x16_bf16 v[16:31], a[216:219], v[160:163], v[16:31]
    v_mfma_f32_32x32x16_bf16 v[32:47], a[220:223], v[160:163], v[32:47]
    s_waitcnt vmcnt(3)
    v_mfma_f32_32x32x16_bf16 v[16:31], a[224:227], v[164:167], v[16:31]
    v_mfma_f32_32x32x16_bf16 v[32:47], a[228:231], v[164:167], v[32:47]
    s_waitcnt vmcnt(2)
    v_mfma_f32_32x32x16_bf16 v[16:31], a[232:235], v[168:171], v[16:31]
    v_mfma_f32_32x32x16_bf16 v[32:47], a[236:239], v[168:171], v[32:47]
    s_waitcnt vmcnt(1)
    v_mfma_f32_32x32x16_bf16 v[16:31], a[240:243], v[172:175], v[16:31]
    v_mfma_f32_32x32x16_bf16 v[32:47], a[244:247], v[172:175], v[32:47]
    s_waitcnt vmcnt(0)
    v_mfma_f32_32x32x16_bf16 v[16:31], a[248:251], v[176:179], v[16:31]
    v_mfma_f32_32x32x16_bf16 v[32:47], a[252:255], v[176:179], v[32:47]
    s_nop 7
    s_nop 3
    v_mov_b64 v[52:53], v[32:33]
    v_mov_b64 v[54:55], v[34:35]
    v_mov_b64 v[56:57], v[36:37]
    v_mov_b64 v[58:59], v[38:39]
    v_mov_b64 v[60:61], v[40:41]
    v_mov_b64 v[62:63], v[42:43]
    v_mov_b64 v[64:65], v[44:45]
    v_mov_b64 v[66:67], v[46:47]
    v_permlane16_swap_b32 v52, v32
    v_permlane16_swap_b32 v53, v33
    v_permlane16_swap_b32 v54, v34
    v_permlane16_swap_b32 v55, v35
    v_permlane16_swap_b32 v56, v36
    v_permlane16_swap_b32 v57, v37
    v_permlane16_swap_b32 v58, v38
    v_permlane16_swap_b32 v59, v39
    v_permlane16_swap_b32 v60, v40
    v_permlane16_swap_b32 v61, v41
    v_permlane16_swap_b32 v62, v42
    v_permlane16_swap_b32 v63, v43
    v_permlane16_swap_b32 v64, v44
    v_permlane16_swap_b32 v65, v45
    v_permlane16_swap_b32 v66, v46
    v_permlane16_swap_b32_e64 v67, v47
    v_pk_add_f32 v[16:17], v[16:17], v[32:33]
    v_pk_add_f32 v[18:19], v[18:19], v[34:35]
    v_pk_add_f32 v[20:21], v[20:21], v[36:37]
    v_pk_add_f32 v[22:23], v[22:23], v[38:39]
    v_pk_add_f32 v[24:25], v[24:25], v[40:41]
    v_pk_add_f32 v[26:27], v[26:27], v[42:43]
    v_pk_add_f32 v[28:29], v[28:29], v[44:45]
    v_pk_add_f32 v[30:31], v[30:31], v[46:47]
    ds_write_b128 v9, v[16:19] offset:0
    ds_write_b128 v9, v[20:23] offset:1024
    ds_write_b128 v9, v[24:27] offset:2048
    ds_write_b128 v9, v[28:31] offset:3072
    s_waitcnt vmcnt(0) lgkmcnt(0)
    s_barrier
    ds_read_b128 v[16:19], v10 offset:0
    ds_read_b128 v[20:23], v10 offset:4096
    ds_read_b128 v[24:27], v10 offset:8192
    ds_read_b128 v[28:31], v10 offset:12288
    s_waitcnt lgkmcnt(3)
    v_pk_add_f32 v[48:49], v[48:49], v[16:17]
    v_pk_add_f32 v[50:51], v[50:51], v[18:19]
    s_waitcnt lgkmcnt(2)
    v_pk_add_f32 v[48:49], v[48:49], v[20:21]
    v_pk_add_f32 v[50:51], v[50:51], v[22:23]
    s_waitcnt lgkmcnt(1)
    v_pk_add_f32 v[48:49], v[48:49], v[24:25]
    v_pk_add_f32 v[50:51], v[50:51], v[26:27]
    s_waitcnt lgkmcnt(0)
    v_pk_add_f32 v[48:49], v[48:49], v[28:29]
    v_pk_add_f32 v[50:51], v[50:51], v[30:31]
    v_cvt_pk_bf16_f32 v48, v48, v49
    v_cvt_pk_bf16_f32 v49, v50, v51
    s_cmp_lt_u32 s53, 62
    s_cbranch_scc1 L_half_again
    s_mov_b32 exec_lo, 0xffff
    s_mov_b32 exec_hi, 0xffff
    buffer_store_dwordx2 v[48:49], v8, s[36:39], s74 offen
    s_endpgm
L_half_again:
    s_add_u32 s53, s53, 8
    s_barrier
    s_branch L_op_8
L_roleD:
    s_sub_u32 s63, s63, 2
    s_cmp_lg_u32 s4, 0
    s_cbranch_scc1 L_gook_33
    s_mov_b32 s79, 524288
    s_mov_b32 s55, 39936
L_go_32:
    buffer_load_dword v2, off, s[8:11], s55 sc1
    s_waitcnt vmcnt(0)
    v_readfirstlane_b32 s54, v2
    s_cmp_lg_u32 s54, 0
    s_cbranch_scc1 L_gook_33
    s_sleep 4
    s_sub_u32 s79, s79, 1
    s_cbranch_scc1 L_fail
    s_branch L_go_32
L_gook_33:
    s_barrier
    v_lshrrev_b32 v1, 4, v0
    v_lshrrev_b32 v2, 2, v1
    v_mul_u32_u24 v2, 1152, v2
    v_and_b32_e64 v3, 3, v1
    v_lshl_add_u32 v4, v3, 4, v2
    s_mul_i32 s54, s4, 1327104
    s_lshl_b32 s55, s64, 6
    s_add_u32 s70, s54, s55
    s_lshl_b32 s60, s4, 15
    s_add_u32 m0, s60, 0
    s_add_u32 s54, s70, 0
    buffer_load_dwordx4 v4, s[44:47], s54 offen lds
    s_add_u32 m0, s60, 1024
    s_add_u32 s54, s70, 18432
    buffer_load_dwordx4 v4, s[44:47], s54 offen lds
    s_add_u32 m0, s60, 2048
    s_add_u32 s54, s70, 36864
    buffer_load_dwordx4 v4, s[44:47], s54 offen lds
    s_add_u32 m0, s60, 3072
    s_add_u32 s54, s70, 55296
    buffer_load_dwordx4 v4, s[44:47], s54 offen lds
    s_add_u32 m0, s60, 4096
    s_add_u32 s54, s70, 73728
    buffer_load_dwordx4 v4, s[44:47], s54 offen lds
    s_add_u32 m0, s60, 5120
    s_add_u32 s54, s70, 92160
    buffer_load_dwordx4 v4, s[44:47], s54 offen lds
    s_add_u32 m0, s60, 6144
    s_add_u32 s54, s70, 110592
    buffer_load_dwordx4 v4, s[44:47], s54 offen lds
    s_add_u32 m0, s60, 7168
    s_add_u32 s54, s70, 129024
    buffer_load_dwordx4 v4, s[44:47], s54 offen lds
    s_add_u32 m0, s60, 8192
    s_add_u32 s54, s70, 147456
    buffer_load_dwordx4 v4, s[44:47], s54 offen lds
    s_add_u32 m0, s60, 9216
    s_add_u32 s54, s70, 165888
    buffer_load_dwordx4 v4, s[44:47], s54 offen lds
    s_add_u32 m0, s60, 10240
    s_add_u32 s54, s70, 184320
    buffer_load_dwordx4 v4, s[44:47], s54 offen lds
    s_add_u32 m0, s60, 11264
    s_add_u32 s54, s70, 202752
    buffer_load_dwordx4 v4, s[44:47], s54 offen lds
    s_add_u32 m0, s60, 12288
    s_add_u32 s54, s70, 221184
    buffer_load_dwordx4 v4, s[44:47], s54 offen lds
    s_add_u32 m0, s60, 13312
    s_add_u32 s54, s70, 239616
    buffer_load_dwordx4 v4, s[44:47], s54 offen lds
    s_add_u32 m0, s60, 14336
    s_add_u32 s54, s70, 258048
    buffer_load_dwordx4 v4, s[44:47], s54 offen lds
    s_add_u32 m0, s60, 15360
    s_add_u32 s54, s70, 276480
    buffer_load_dwordx4 v4, s[44:47], s54 offen lds
    s_add_u32 m0, s60, 16384
    s_add_u32 s54, s70, 294912
    buffer_load_dwordx4 v4, s[44:47], s54 offen lds
    s_add_u32 m0, s60, 17408
    s_add_u32 s54, s70, 313344
    buffer_load_dwordx4 v4, s[44:47], s54 offen lds
    s_add_u32 m0, s60, 18432
    s_add_u32 s54, s70, 331776
    buffer_load_dwordx4 v4, s[44:47], s54 offen lds
    s_add_u32 m0, s60, 19456
    s_add_u32 s54, s70, 350208
    buffer_load_dwordx4 v4, s[44:47], s54 offen lds
    s_add_u32 m0, s60, 20480
    s_add_u32 s54, s70, 368640
    buffer_load_dwordx4 v4, s[44:47], s54 offen lds
    s_add_u32 m0, s60, 21504
    s_add_u32 s54, s70, 387072
    buffer_load_dwordx4 v4, s[44:47], s54 offen lds
    s_add_u32 m0, s60, 22528
    s_add_u32 s54, s70, 405504
    buffer_load_dwordx4 v4, s[44:47], s54 offen lds
    s_add_u32 m0, s60, 23552
    s_add_u32 s54, s70, 423936
    buffer_load_dwordx4 v4, s[44:47], s54 offen lds
    s_add_u32 m0, s60, 24576
    s_add_u32 s54, s70, 442368
    buffer_load_dwordx4 v4, s[44:47], s54 offen lds
    s_add_u32 m0, s60, 25600
    s_add_u32 s54, s70, 460800
    buffer_load_dwordx4 v4, s[44:47], s54 offen lds
    s_add_u32 m0, s60, 26624
    s_add_u32 s54, s70, 479232
    buffer_load_dwordx4 v4, s[44:47], s54 offen lds
    s_add_u32 m0, s60, 27648
    s_add_u32 s54, s70, 497664
    buffer_load_dwordx4 v4, s[44:47], s54 offen lds
    s_add_u32 m0, s60, 28672
    s_add_u32 s54, s70, 516096
    buffer_load_dwordx4 v4, s[44:47], s54 offen lds
    s_add_u32 m0, s60, 29696
    s_add_u32 s54, s70, 534528
    buffer_load_dwordx4 v4, s[44:47], s54 offen lds
    s_add_u32 m0, s60, 30720
    s_add_u32 s54, s70, 552960
    buffer_load_dwordx4 v4, s[44:47], s54 offen lds
    s_add_u32 m0, s60, 31744
    s_add_u32 s54, s70, 571392
    buffer_load_dwordx4 v4, s[44:47], s54 offen lds
    v_lshrrev_b32 v5, 5, v1
    v_bfe_u32 v6, v1, 2, 2
    v_lshl_add_u32 v5, v5, 2, v6
    v_lshlrev_b32_e64 v5, 6, v5
    v_bfe_u32 v6, v1, 4, 1
    v_lshl_add_u32 v5, v6, 5, v5
    v_lshl_add_u32 v5, v3, 3, v5
    v_add_u32 v5, s60, v5
    s_waitcnt vmcnt(16)
    ds_read_b64_tr_b16 a[0:1], v5 offset:0
    ds_read_b64_tr_b16 a[2:3], v5 offset:512
    ds_read_b64_tr_b16 a[4:5], v5 offset:1024
    ds_read_b64_tr_b16 a[6:7], v5 offset:1536
    ds_read_b64_tr_b16 a[8:9], v5 offset:2048
    ds_read_b64_tr_b16 a[10:11], v5 offset:2560
    ds_read_b64_tr_b16 a[12:13], v5 offset:3072
    ds_read_b64_tr_b16 a[14:15], v5 offset:3584
    ds_read_b64_tr_b16 a[16:17], v5 offset:4096
    ds_read_b64_tr_b16 a[18:19], v5 offset:4608
    ds_read_b64_tr_b16 a[20:21], v5 offset:5120
    ds_read_b64_tr_b16 a[22:23], v5 offset:5632
    ds_read_b64_tr_b16 a[24:25], v5 offset:6144
    ds_read_b64_tr_b16 a[26:27], v5 offset:6656
    ds_read_b64_tr_b16 a[28:29], v5 offset:7168
    ds_read_b64_tr_b16 a[30:31], v5 offset:7680
    ds_read_b64_tr_b16 a[32:33], v5 offset:8192
    ds_read_b64_tr_b16 a[34:35], v5 offset:8704
    ds_read_b64_tr_b16 a[36:37], v5 offset:9216
    ds_read_b64_tr_b16 a[38:39], v5 offset:9728
    ds_read_b64_tr_b16 a[40:41], v5 offset:10240
    ds_read_b64_tr_b16 a[42:43], v5 offset:10752
    ds_read_b64_tr_b16 a[44:45], v5 offset:11264
    ds_read_b64_tr_b16 a[46:47], v5 offset:11776
    ds_read_b64_tr_b16 a[48:49], v5 offset:12288
    ds_read_b64_tr_b16 a[50:51], v5 offset:12800
    ds_read_b64_tr_b16 a[52:53], v5 offset:13312
    ds_read_b64_tr_b16 a[54:55], v5 offset:13824
    ds_read_b64_tr_b16 a[56:57], v5 offset:14336
    ds_read_b64_tr_b16 a[58:59], v5 offset:14848
    ds_read_b64_tr_b16 a[60:61], v5 offset:15360
    ds_read_b64_tr_b16 a[62:63], v5 offset:15872
    s_waitcnt lgkmcnt(0)
    s_add_u32 m0, s60, 0
    s_add_u32 s54, s70, 589824
    buffer_load_dwordx4 v4, s[44:47], s54 offen lds
    s_add_u32 m0, s60, 1024
    s_add_u32 s54, s70, 608256
    buffer_load_dwordx4 v4, s[44:47], s54 offen lds
    s_add_u32 m0, s60, 2048
    s_add_u32 s54, s70, 626688
    buffer_load_dwordx4 v4, s[44:47], s54 offen lds
    s_add_u32 m0, s60, 3072
    s_add_u32 s54, s70, 645120
    buffer_load_dwordx4 v4, s[44:47], s54 offen lds
    s_add_u32 m0, s60, 4096
    s_add_u32 s54, s70, 663552
    buffer_load_dwordx4 v4, s[44:47], s54 offen lds
    s_add_u32 m0, s60, 5120
    s_add_u32 s54, s70, 681984
    buffer_load_dwordx4 v4, s[44:47], s54 offen lds
    s_add_u32 m0, s60, 6144
    s_add_u32 s54, s70, 700416
    buffer_load_dwordx4 v4, s[44:47], s54 offen lds
    s_add_u32 m0, s60, 7168
    s_add_u32 s54, s70, 718848
    buffer_load_dwordx4 v4, s[44:47], s54 offen lds
    s_add_u32 m0, s60, 8192
    s_add_u32 s54, s70, 737280
    buffer_load_dwordx4 v4, s[44:47], s54 offen lds
    s_add_u32 m0, s60, 9216
    s_add_u32 s54, s70, 755712
    buffer_load_dwordx4 v4, s[44:47], s54 offen lds
    s_add_u32 m0, s60, 10240
    s_add_u32 s54, s70, 774144
    buffer_load_dwordx4 v4, s[44:47], s54 offen lds
    s_add_u32 m0, s60, 11264
    s_add_u32 s54, s70, 792576
    buffer_load_dwordx4 v4, s[44:47], s54 offen lds
    s_add_u32 m0, s60, 12288
    s_add_u32 s54, s70, 811008
    buffer_load_dwordx4 v4, s[44:47], s54 offen lds
    s_add_u32 m0, s60, 13312
    s_add_u32 s54, s70, 829440
    buffer_load_dwordx4 v4, s[44:47], s54 offen lds
    s_add_u32 m0, s60, 14336
    s_add_u32 s54, s70, 847872
    buffer_load_dwordx4 v4, s[44:47], s54 offen lds
    s_add_u32 m0, s60, 15360
    s_add_u32 s54, s70, 866304
    buffer_load_dwordx4 v4, s[44:47], s54 offen lds
    s_waitcnt vmcnt(16)
    ds_read_b64_tr_b16 a[64:65], v5 offset:16384
    ds_read_b64_tr_b16 a[66:67], v5 offset:16896
    ds_read_b64_tr_b16 a[68:69], v5 offset:17408
    ds_read_b64_tr_b16 a[70:71], v5 offset:17920
    ds_read_b64_tr_b16 a[72:73], v5 offset:18432
    ds_read_b64_tr_b16 a[74:75], v5 offset:18944
    ds_read_b64_tr_b16 a[76:77], v5 offset:19456
    ds_read_b64_tr_b16 a[78:79], v5 offset:19968
    ds_read_b64_tr_b16 a[80:81], v5 offset:20480
    ds_read_b64_tr_b16 a[82:83], v5 offset:20992
    ds_read_b64_tr_b16 a[84:85], v5 offset:21504
    ds_read_b64_tr_b16 a[86:87], v5 offset:22016
    ds_read_b64_tr_b16 a[88:89], v5 offset:22528
    ds_read_b64_tr_b16 a[90:91], v5 offset:23040
    ds_read_b64_tr_b16 a[92:93], v5 offset:23552
    ds_read_b64_tr_b16 a[94:95], v5 offset:24064
    ds_read_b64_tr_b16 a[96:97], v5 offset:24576
    ds_read_b64_tr_b16 a[98:99], v5 offset:25088
    ds_read_b64_tr_b16 a[100:101], v5 offset:25600
    ds_read_b64_tr_b16 a[102:103], v5 offset:26112
    ds_read_b64_tr_b16 a[104:105], v5 offset:26624
    ds_read_b64_tr_b16 a[106:107], v5 offset:27136
    ds_read_b64_tr_b16 a[108:109], v5 offset:27648
    ds_read_b64_tr_b16 a[110:111], v5 offset:28160
    ds_read_b64_tr_b16 a[112:113], v5 offset:28672
    ds_read_b64_tr_b16 a[114:115], v5 offset:29184
    ds_read_b64_tr_b16 a[116:117], v5 offset:29696
    ds_read_b64_tr_b16 a[118:119], v5 offset:30208
    ds_read_b64_tr_b16 a[120:121], v5 offset:30720
    ds_read_b64_tr_b16 a[122:123], v5 offset:31232
    ds_read_b64_tr_b16 a[124:125], v5 offset:31744
    ds_read_b64_tr_b16 a[126:127], v5 offset:32256
    s_waitcnt lgkmcnt(0)
    s_add_u32 m0, s60, 16384
    s_add_u32 s54, s70, 884736
    buffer_load_dwordx4 v4, s[44:47], s54 offen lds
    s_add_u32 m0, s60, 17408
    s_add_u32 s54, s70, 903168
    buffer_load_dwordx4 v4, s[44:47], s54 offen lds
    s_add_u32 m0, s60, 18432
    s_add_u32 s54, s70, 921600
    buffer_load_dwordx4 v4, s[44:47], s54 offen lds
    s_add_u32 m0, s60, 19456
    s_add_u32 s54, s70, 940032
    buffer_load_dwordx4 v4, s[44:47], s54 offen lds
    s_add_u32 m0, s60, 20480
    s_add_u32 s54, s70, 958464
    buffer_load_dwordx4 v4, s[44:47], s54 offen lds
    s_add_u32 m0, s60, 21504
    s_add_u32 s54, s70, 976896
    buffer_load_dwordx4 v4, s[44:47], s54 offen lds
    s_add_u32 m0, s60, 22528
    s_add_u32 s54, s70, 995328
    buffer_load_dwordx4 v4, s[44:47], s54 offen lds
    s_add_u32 m0, s60, 23552
    s_add_u32 s54, s70, 1013760
    buffer_load_dwordx4 v4, s[44:47], s54 offen lds
    s_add_u32 m0, s60, 24576
    s_add_u32 s54, s70, 1032192
    buffer_load_dwordx4 v4, s[44:47], s54 offen lds
    s_add_u32 m0, s60, 25600
    s_add_u32 s54, s70, 1050624
    buffer_load_dwordx4 v4, s[44:47], s54 offen lds
    s_add_u32 m0, s60, 26624
    s_add_u32 s54, s70, 1069056
    buffer_load_dwordx4 v4, s[44:47], s54 offen lds
    s_add_u32 m0, s60, 27648
    s_add_u32 s54, s70, 1087488
    buffer_load_dwordx4 v4, s[44:47], s54 offen lds
    s_add_u32 m0, s60, 28672
    s_add_u32 s54, s70, 1105920
    buffer_load_dwordx4 v4, s[44:47], s54 offen lds
    s_add_u32 m0, s60, 29696
    s_add_u32 s54, s70, 1124352
    buffer_load_dwordx4 v4, s[44:47], s54 offen lds
    s_add_u32 m0, s60, 30720
    s_add_u32 s54, s70, 1142784
    buffer_load_dwordx4 v4, s[44:47], s54 offen lds
    s_add_u32 m0, s60, 31744
    s_add_u32 s54, s70, 1161216
    buffer_load_dwordx4 v4, s[44:47], s54 offen lds
    s_waitcnt vmcnt(16)
    ds_read_b64_tr_b16 a[128:129], v5 offset:0
    ds_read_b64_tr_b16 a[130:131], v5 offset:512
    ds_read_b64_tr_b16 a[132:133], v5 offset:1024
    ds_read_b64_tr_b16 a[134:135], v5 offset:1536
    ds_read_b64_tr_b16 a[136:137], v5 offset:2048
    ds_read_b64_tr_b16 a[138:139], v5 offset:2560
    ds_read_b64_tr_b16 a[140:141], v5 offset:3072
    ds_read_b64_tr_b16 a[142:143], v5 offset:3584
    ds_read_b64_tr_b16 a[144:145], v5 offset:4096
    ds_read_b64_tr_b16 a[146:147], v5 offset:4608
    ds_read_b64_tr_b16 a[148:149], v5 offset:5120
    ds_read_b64_tr_b16 a[150:151], v5 offset:5632
    ds_read_b64_tr_b16 a[152:153], v5 offset:6144
    ds_read_b64_tr_b16 a[154:155], v5 offset:6656
    ds_read_b64_tr_b16 a[156:157], v5 offset:7168
    ds_read_b64_tr_b16 a[158:159], v5 offset:7680
    ds_read_b64_tr_b16 a[160:161], v5 offset:8192
    ds_read_b64_tr_b16 a[162:163], v5 offset:8704
    ds_read_b64_tr_b16 a[164:165], v5 offset:9216
    ds_read_b64_tr_b16 a[166:167], v5 offset:9728
    ds_read_b64_tr_b16 a[168:169], v5 offset:10240
    ds_read_b64_tr_b16 a[170:171], v5 offset:10752
    ds_read_b64_tr_b16 a[172:173], v5 offset:11264
    ds_read_b64_tr_b16 a[174:175], v5 offset:11776
    ds_read_b64_tr_b16 a[176:177], v5 offset:12288
    ds_read_b64_tr_b16 a[178:179], v5 offset:12800
    ds_read_b64_tr_b16 a[180:181], v5 offset:13312
    ds_read_b64_tr_b16 a[182:183], v5 offset:13824
    ds_read_b64_tr_b16 a[184:185], v5 offset:14336
    ds_read_b64_tr_b16 a[186:187], v5 offset:14848
    ds_read_b64_tr_b16 a[188:189], v5 offset:15360
    ds_read_b64_tr_b16 a[190:191], v5 offset:15872
    s_waitcnt lgkmcnt(0)
    s_add_u32 m0, s60, 0
    s_add_u32 s54, s70, 1179648
    buffer_load_dwordx4 v4, s[44:47], s54 offen lds
    s_add_u32 m0, s60, 1024
    s_add_u32 s54, s70, 1198080
    buffer_load_dwordx4 v4, s[44:47], s54 offen lds
    s_add_u32 m0, s60, 2048
    s_add_u32 s54, s70, 1216512
    buffer_load_dwordx4 v4, s[44:47], s54 offen lds
    s_add_u32 m0, s60, 3072
    s_add_u32 s54, s70, 1234944
    buffer_load_dwordx4 v4, s[44:47], s54 offen lds
    s_add_u32 m0, s60, 4096
    s_add_u32 s54, s70, 1253376
    buffer_load_dwordx4 v4, s[44:47], s54 offen lds
    s_add_u32 m0, s60, 5120
    s_add_u32 s54, s70, 1271808
    buffer_load_dwordx4 v4, s[44:47], s54 offen lds
    s_add_u32 m0, s60, 6144
    s_add_u32 s54, s70, 1290240
    buffer_load_dwordx4 v4, s[44:47], s54 offen lds
    s_add_u32 m0, s60, 7168
    s_add_u32 s54, s70, 1308672
    buffer_load_dwordx4 v4, s[44:47], s54 offen lds
    s_waitcnt vmcnt(8)
    ds_read_b64_tr_b16 a[192:193], v5 offset:16384
    ds_read_b64_tr_b16 a[194:195], v5 offset:16896
    ds_read_b64_tr_b16 a[196:197], v5 offset:17408
    ds_read_b64_tr_b16 a[198:199], v5 offset:17920
    ds_read_b64_tr_b16 a[200:201], v5 offset:18432
    ds_read_b64_tr_b16 a[202:203], v5 offset:18944
    ds_read_b64_tr_b16 a[204:205], v5 offset:19456
    ds_read_b64_tr_b16 a[206:207], v5 offset:19968
    ds_read_b64_tr_b16 a[208:209], v5 offset:20480
    ds_read_b64_tr_b16 a[210:211], v5 offset:20992
    ds_read_b64_tr_b16 a[212:213], v5 offset:21504
    ds_read_b64_tr_b16 a[214:215], v5 offset:22016
    ds_read_b64_tr_b16 a[216:217], v5 offset:22528
    ds_read_b64_tr_b16 a[218:219], v5 offset:23040
    ds_read_b64_tr_b16 a[220:221], v5 offset:23552
    ds_read_b64_tr_b16 a[222:223], v5 offset:24064
    ds_read_b64_tr_b16 a[224:225], v5 offset:24576
    ds_read_b64_tr_b16 a[226:227], v5 offset:25088
    ds_read_b64_tr_b16 a[228:229], v5 offset:25600
    ds_read_b64_tr_b16 a[230:231], v5 offset:26112
    ds_read_b64_tr_b16 a[232:233], v5 offset:26624
    ds_read_b64_tr_b16 a[234:235], v5 offset:27136
    ds_read_b64_tr_b16 a[236:237], v5 offset:27648
    ds_read_b64_tr_b16 a[238:239], v5 offset:28160
    ds_read_b64_tr_b16 a[240:241], v5 offset:28672
    ds_read_b64_tr_b16 a[242:243], v5 offset:29184
    ds_read_b64_tr_b16 a[244:245], v5 offset:29696
    ds_read_b64_tr_b16 a[246:247], v5 offset:30208
    ds_read_b64_tr_b16 a[248:249], v5 offset:30720
    ds_read_b64_tr_b16 a[250:251], v5 offset:31232
    ds_read_b64_tr_b16 a[252:253], v5 offset:31744
    ds_read_b64_tr_b16 a[254:255], v5 offset:32256
    s_waitcnt lgkmcnt(0)
    s_waitcnt vmcnt(0)
    ds_read_b64_tr_b16 v[224:225], v5 offset:0
    ds_read_b64_tr_b16 v[226:227], v5 offset:512
    ds_read_b64_tr_b16 v[228:229], v5 offset:1024
    ds_read_b64_tr_b16 v[230:231], v5 offset:1536
    ds_read_b64_tr_b16 v[232:233], v5 offset:2048
    ds_read_b64_tr_b16 v[234:235], v5 offset:2560
    ds_read_b64_tr_b16 v[236:237], v5 offset:3072
    ds_read_b64_tr_b16 v[238:239], v5 offset:3584
    ds_read_b64_tr_b16 v[240:241], v5 offset:4096
    ds_read_b64_tr_b16 v[242:243], v5 offset:4608
    ds_read_b64_tr_b16 v[244:245], v5 offset:5120
    ds_read_b64_tr_b16 v[246:247], v5 offset:5632
    ds_read_b64_tr_b16 v[248:249], v5 offset:6144
    ds_read_b64_tr_b16 v[250:251], v5 offset:6656
    ds_read_b64_tr_b16 v[252:253], v5 offset:7168
    ds_read_b64_tr_b16 v[254:255], v5 offset:7680
    s_waitcnt lgkmcnt(0)
    s_barrier
    v_min_u32 v2, 35, v1
    v_lshrrev_b32 v3, 2, v2
    v_and_b32 v2, 3, v2
    v_lshlrev_b32 v2, 2, v2
    v_lshl_add_u32 v6, v3, 7, v2
    s_mul_i32 s68, s4, 1152
    s_add_u32 s68, s68, 24576
    s_lshl_b32 s54, s64, 7
    s_lshl_b32 s55, s4, 2
    s_add_u32 s69, s54, s55
    s_add_u32 s69, s69, 32768
    s_mul_i32 s54, s63, 2304
    s_add_u32 s57, s69, s54
    v_mov_b32 v7, 0
    v_and_b32 v2, 31, v1
    v_mul_u32_u24 v2, 1152, v2
    v_lshrrev_b32_e64 v3, 5, v1
    v_lshl_add_u32 v8, v3, 3, v2
    s_lshl_b32 s54, s4, 12
    v_add_u32 v9, s54, v0
    s_lshl_b32 s54, s4, 10
    v_add_u32 v10, s54, v0
    v_and_b32 v11, 0x1f0, v0
    v_lshlrev_b32_e64 v11, 3, v11
    s_mov_b32 s53, s63
    s_mov_b32 s61, 0
    s_mov_b32 s62, 0
    s_mov_b32 s80, 0
    s_mov_b32 s81, 0
    s_mov_b32 s82, 0
    s_mov_b32 s90, 0
    s_mov_b32 s60, 0
L_op_34:
    s_mul_i32 s73, s53, 73728
    s_lshl_b32 s54, s64, 12
    s_add_u32 s73, s73, s54
    s_add_u32 s73, s73, 88080384
    s_mul_i32 s74, s53, 36864
    s_lshl_b32 s54, s64, 6
    s_lshl_b32 s55, s4, 4
    s_add_u32 s74, s74, s54
    s_add_u32 s74, s74, s55
    s_add_u32 s75, s53, 1
    buffer_load_dwordx2 v[48:49], v8, s[48:51], s74 offen
    s_cmp_lg_u32 s60, 0
    s_cbranch_scc1 L_go_35
    s_mul_i32 s70, s53, 294912
    s_mul_i32 s54, s4, 73728
    s_add_u32 s70, s70, s54
    s_add_u32 s70, s70, 67108864
    s_cmp_ge_u32 s61, s75
    s_cbranch_scc1 L_wd_37
    s_mov_b32 s79, 524288
L_w_36:
    buffer_load_dword v12, v6, s[8:11], s68 offen sc1
    s_waitcnt vmcnt(0)
    v_cmp_gt_u32 vcc, s75, v12
    s_cbranch_vccz L_wo_38
    s_sub_u32 s79, s79, 1
    s_cbranch_scc1 L_fail
    s_branch L_w_36
L_wo_38:
    s_nop 1
    v_min_u32_dpp v12, v12, v12 quad_perm:[1,0,3,2] row_mask:0xf bank_mask:0xf
    s_nop 1
    v_min_u32_dpp v12, v12, v12 quad_perm:[2,3,0,1] row_mask:0xf bank_mask:0xf
    s_nop 1
    v_min_u32_dpp v12, v12, v12 row_half_mirror row_mask:0xf bank_mask:0xf
    s_nop 1
    v_min_u32_dpp v12, v12, v12 row_mirror row_mask:0xf bank_mask:0xf
    s_nop 0
    v_readlane_b32 s61, v12, 0
    v_readlane_b32 s56, v12, 16
    s_min_u32 s61, s61, s56
    v_readlane_b32 s56, v12, 32
    s_min_u32 s61, s61, s56
    v_readlane_b32 s56, v12, 48
    s_min_u32 s61, s61, s56
L_wd_37:
    buffer_load_dwordx4 v[52:55], v0, s[8:11], s70 offen offset:0 sc1
    buffer_load_dwordx4 v[56:59], v0, s[8:11], s70 offen offset:1024 sc1
    buffer_load_dwordx4 v[60:63], v0, s[8:11], s70 offen offset:2048 sc1
    buffer_load_dwordx4 v[64:67], v0, s[8:11], s70 offen offset:3072 sc1
    s_add_u32 s70, s70, 4096
    buffer_load_dwordx4 v[68:71], v0, s[8:11], s70 offen offset:0 sc1
    buffer_load_dwordx4 v[72:75], v0, s[8:11], s70 offen offset:1024 sc1
    buffer_load_dwordx4 v[76:79], v0, s[8:11], s70 offen offset:2048 sc1
    buffer_load_dwordx4 v[80:83], v0, s[8:11], s70 offen offset:3072 sc1
    s_add_u32 s70, s70, 4096
    buffer_load_dwordx4 v[84:87], v0, s[8:11], s70 offen offset:0 sc1
    buffer_load_dwordx4 v[88:91], v0, s[8:11], s70 offen offset:1024 sc1
    buffer_load_dwordx4 v[92:95], v0, s[8:11], s70 offen offset:2048 sc1
    buffer_load_dwordx4 v[96:99], v0, s[8:11], s70 offen offset:3072 sc1
    s_add_u32 s70, s70, 4096
    buffer_load_dwordx4 v[100:103], v0, s[8:11], s70 offen offset:0 sc1
    buffer_load_dwordx4 v[104:107], v0, s[8:11], s70 offen offset:1024 sc1
    buffer_load_dwordx4 v[108:111], v0, s[8:11], s70 offen offset:2048 sc1
    buffer_load_dwordx4 v[112:115], v0, s[8:11], s70 offen offset:3072 sc1
    s_add_u32 s70, s70, 4096
    buffer_load_dwordx4 v[116:119], v0, s[8:11], s70 offen offset:0 sc1
    buffer_load_dwordx4 v[120:123], v0, s[8:11], s70 offen offset:1024 sc1
    buffer_load_dwordx4 v[124:127], v0, s[8:11], s70 offen offset:2048 sc1
    buffer_load_dwordx4 v[128:131], v0, s[8:11], s70 offen offset:3072 sc1
    s_add_u32 s70, s70, 4096
    buffer_load_dwordx4 v[132:135], v0, s[8:11], s70 offen offset:0 sc1
    buffer_load_dwordx4 v[136:139], v0, s[8:11], s70 offen offset:1024 sc1
    buffer_load_dwordx4 v[140:143], v0, s[8:11], s70 offen offset:2048 sc1
    buffer_load_dwordx4 v[144:147], v0, s[8:11], s70 offen offset:3072 sc1
L_go_35:
    s_add_u32 s59, s53, 3
    s_waitcnt vmcnt(23)
    v_mfma_f32_32x32x16_bf16 v[16:31], a[0:3], v[52:55], 0
    s_add_u32 s70, s70, 4096
    buffer_load_dwordx4 v[52:55], v0, s[8:11], s70 offen offset:0 sc1
    s_waitcnt vmcnt(23)
    v_mfma_f32_32x32x16_bf16 v[32:47], a[4:7], v[56:59], 0
    buffer_load_dwordx4 v[56:59], v0, s[8:11], s70 offen offset:1024 sc1
    s_waitcnt vmcnt(23)
    v_mfma_f32_32x32x16_bf16 v[16:31], a[8:11], v[60:63], v[16:31]
    buffer_load_dwordx4 v[60:63], v0, s[8:11], s70 offen offset:2048 sc1
    s_waitcnt vmcnt(23)
    v_mfma_f32_32x32x16_bf16 v[32:47], a[12:15], v[64:67], v[32:47]
    buffer_load_dwordx4 v[64:67], v0, s[8:11], s70 offen offset:3072 sc1
    s_waitcnt vmcnt(23)
    v_mfma_f32_32x32x16_bf16 v[16:31], a[16:19], v[68:71], v[16:31]
    s_add_u32 s70, s70, 4096
    buffer_load_dwordx4 v[68:71], v0, s[8:11], s70 offen offset:0 sc1
    s_waitcnt vmcnt(23)
    v_mfma_f32_32x32x16_bf16 v[32:47], a[20:23], v[72:75], v[32:47]
    buffer_load_dwordx4 v[72:75], v0, s[8:11], s70 offen offset:1024 sc1
    s_waitcnt vmcnt(23)
    v_mfma_f32_32x32x16_bf16 v[16:31], a[24:27], v[76:79], v[16:31]
    buffer_load_dwordx4 v[76:79], v0, s[8:11], s70 offen offset:2048 sc1
    s_waitcnt vmcnt(23)
    v_mfma_f32_32x32x16_bf16 v[32:47], a[28:31], v[80:83], v[32:47]
    buffer_load_dwordx4 v[80:83], v0, s[8:11], s70 offen offset:3072 sc1
    s_waitcnt vmcnt(23)
    v_mfma_f32_32x32x16_bf16 v[16:31], a[32:35], v[84:87], v[16:31]
    s_add_u32 s70, s70, 4096
    buffer_load_dwordx4 v[84:87], v0, s[8:11], s70 offen offset:0 sc1
    s_waitcnt vmcnt(23)
    v_mfma_f32_32x32x16_bf16 v[32:47], a[36:39], v[88:91], v[32:47]
    buffer_load_dwordx4 v[88:91], v0, s[8:11], s70 offen offset:1024 sc1
    s_waitcnt vmcnt(23)
    v_mfma_f32_32x32x16_bf16 v[16:31], a[40:43], v[92:95], v[16:31]
    buffer_load_dwordx4 v[92:95], v0, s[8:11], s70 offen offset:2048 sc1
    s_waitcnt vmcnt(23)
    v_mfma_f32_32x32x16_bf16 v[32:47], a[44:47], v[96:99], v[32:47]
    buffer_load_dwordx4 v[96:99], v0, s[8:11], s70 offen offset:3072 sc1
    s_waitcnt vmcnt(23)
    v_mfma_f32_32x32x16_bf16 v[16:31], a[48:51], v[100:103], v[16:31]
    s_add_u32 s70, s70, 4096
    buffer_load_dwordx4 v[100:103], v0, s[8:11], s70 offen offset:0 sc1
    s_waitcnt vmcnt(23)
    v_mfma_f32_32x32x16_bf16 v[32:47], a[52:55], v[104:107], v[32:47]
    buffer_load_dwordx4 v[104:107], v0, s[8:11], s70 offen offset:1024 sc1
    s_waitcnt vmcnt(23)
    v_mfma_f32_32x32x16_bf16 v[16:31], a[56:59], v[108:111], v[16:31]
    buffer_load_dwordx4 v[108:111], v0, s[8:11], s70 offen offset:2048 sc1
    s_waitcnt vmcnt(23)
    v_mfma_f32_32x32x16_bf16 v[32:47], a[60:63], v[112:115], v[32:47]
    buffer_load_dwordx4 v[112:115], v0, s[8:11], s70 offen offset:3072 sc1
    s_waitcnt vmcnt(23)
    v_mfma_f32_32x32x16_bf16 v[16:31], a[64:67], v[116:119], v[16:31]
    s_add_u32 s70, s70, 4096
    buffer_load_dwordx4 v[116:119], v0, s[8:11], s70 offen offset:0 sc1
    s_waitcnt vmcnt(23)
    v_mfma_f32_32x32x16_bf16 v[32:47], a[68:71], v[120:123], v[32:47]
    buffer_load_dwordx4 v[120:123], v0, s[8:11], s70 offen offset:1024 sc1
    s_waitcnt vmcnt(23)
    v_mfma_f32_32x32x16_bf16 v[16:31], a[72:75], v[124:127], v[16:31]
    buffer_load_dwordx4 v[124:127], v0, s[8:11], s70 offen offset:2048 sc1
    s_waitcnt vmcnt(23)
    v_mfma_f32_32x32x16_bf16 v[32:47], a[76:79], v[128:131], v[32:47]
    buffer_load_dwordx4 v[128:131], v0, s[8:11], s70 offen offset:3072 sc1
    s_waitcnt vmcnt(23)
    v_mfma_f32_32x32x16_bf16 v[16:31], a[80:83], v[132:135], v[16:31]
    s_add_u32 s70, s70, 4096
    buffer_load_dwordx4 v[132:135], v0, s[8:11], s70 offen offset:0 sc1
    s_waitcnt vmcnt(23)
    v_mfma_f32_32x32x16_bf16 v[32:47], a[84:87], v[136:139], v[32:47]
    buffer_load_dwordx4 v[136:139], v0, s[8:11], s70 offen offset:1024 sc1
    s_waitcnt vmcnt(23)
    v_mfma_f32_32x32x16_bf16 v[16:31], a[88:91], v[140:143], v[16:31]
    buffer_load_dwordx4 v[140:143], v0, s[8:11], s70 offen offset:2048 sc1
    s_waitcnt vmcnt(23)
    v_mfma_f32_32x32x16_bf16 v[32:47], a[92:95], v[144:147], v[32:47]
    buffer_load_dwordx4 v[144:147], v0, s[8:11], s70 offen offset:3072 sc1
    s_waitcnt vmcnt(23)
    v_mfma_f32_32x32x16_bf16 v[16:31], a[96:99], v[52:55], v[16:31]
    s_add_u32 s70, s70, 4096
    buffer_load_dwordx4 v[52:55], v0, s[8:11], s70 offen offset:0 sc1
    s_waitcnt vmcnt(23)
    v_mfma_f32_32x32x16_bf16 v[32:47], a[100:103], v[56:59], v[32:47]
    buffer_load_dwordx4 v[56:59], v0, s[8:11], s70 offen offset:1024 sc1
    s_waitcnt vmcnt(23)
    v_mfma_f32_32x32x16_bf16 v[16:31], a[104:107], v[60:63], v[16:31]
    buffer_load_dwordx4 v[60:63], v0, s[8:11], s70 offen offset:2048 sc1
    s_waitcnt vmcnt(23)
    v_mfma_f32_32x32x16_bf16 v[32:47], a[108:111], v[64:67], v[32:47]
    buffer_load_dwordx4 v[64:67], v0, s[8:11], s70 offen offset:3072 sc1
    s_waitcnt vmcnt(23)
    v_mfma_f32_32x32x16_bf16 v[16:31], a[112:115], v[68:71], v[16:31]
    s_add_u32 s70, s70, 4096
    buffer_load_dwordx4 v[68:71], v0, s[8:11], s70 offen offset:0 sc1
    s_waitcnt vmcnt(23)
    v_mfma_f32_32x32x16_bf16 v[32:47], a[116:119], v[72:75], v[32:47]
    buffer_load_dwordx4 v[72:75], v0, s[8:11], s70 offen offset:1024 sc1
    s_waitcnt vmcnt(23)
    v_mfma_f32_32x32x16_bf16 v[16:31], a[120:123], v[76:79], v[16:31]
    buffer_load_dwordx4 v[76:79], v0, s[8:11], s70 offen offset:2048 sc1
    s_waitcnt vmcnt(23)
    v_mfma_f32_32x32x16_bf16 v[32:47], a[124:127], v[80:83], v[32:47]
    buffer_load_dwordx4 v[80:83], v0, s[8:11], s70 offen offset:3072 sc1
    s_waitcnt vmcnt(23)
    v_mfma_f32_32x32x16_bf16 v[16:31], a[128:131], v[84:87], v[16:31]
    s_add_u32 s70, s70, 4096
    buffer_load_dwordx4 v[84:87], v0, s[8:11], s70 offen offset:0 sc1
    s_waitcnt vmcnt(23)
    v_mfma_f32_32x32x16_bf16 v[32:47], a[132:135], v[88:91], v[32:47]
    buffer_load_dwordx4 v[88:91], v0, s[8:11], s70 offen offset:1024 sc1
    s_waitcnt vmcnt(23)
    v_mfma_f32_32x32x16_bf16 v[16:31], a[136:139], v[92:95], v[16:31]
    buffer_load_dwordx4 v[92:95], v0, s[8:11], s70 offen offset:2048 sc1
    s_waitcnt vmcnt(23)
    v_mfma_f32_32x32x16_bf16 v[32:47], a[140:143], v[96:99], v[32:47]
    buffer_load_dwordx4 v[96:99], v0, s[8:11], s70 offen offset:3072 sc1
    s_waitcnt vmcnt(23)
    v_mfma_f32_32x32x16_bf16 v[16:31], a[144:147], v[100:103], v[16:31]
    s_add_u32 s70, s70, 4096
    buffer_load_dwordx4 v[100:103], v0, s[8:11], s70 offen offset:0 sc1
    s_waitcnt vmcnt(23)
    v_mfma_f32_32x32x16_bf16 v[32:47], a[148:151], v[104:107], v[32:47]
    buffer_load_dwordx4 v[104:107], v0, s[8:11], s70 offen offset:1024 sc1
    s_waitcnt vmcnt(23)
    v_mfma_f32_32x32x16_bf16 v[16:31], a[152:155], v[108:111], v[16:31]
    buffer_load_dwordx4 v[108:111], v0, s[8:11], s70 offen offset:2048 sc1
    s_waitcnt vmcnt(23)
    v_mfma_f32_32x32x16_bf16 v[32:47], a[156:159], v[112:115], v[32:47]
    buffer_load_dwordx4 v[112:115], v0, s[8:11], s70 offen offset:3072 sc1
    s_waitcnt vmcnt(23)
    v_mfma_f32_32x32x16_bf16 v[16:31], a[160:163], v[116:119], v[16:31]
    s_add_u32 s70, s70, 4096
    buffer_load_dwordx4 v[116:119], v0, s[8:11], s70 offen offset:0 sc1
    s_waitcnt vmcnt(23)
    v_mfma_f32_32x32x16_bf16 v[32:47], a[164:167], v[120:123], v[32:47]
    buffer_load_dwordx4 v[120:123], v0, s[8:11], s70 offen offset:1024 sc1
    s_waitcnt vmcnt(23)
    v_mfma_f32_32x32x16_bf16 v[16:31], a[168:171], v[124:127], v[16:31]
    buffer_load_dwordx4 v[124:127], v0, s[8:11], s70 offen offset:2048 sc1
    s_waitcnt vmcnt(23)
    v_mfma_f32_32x32x16_bf16 v[32:47], a[172:175], v[128:131], v[32:47]
    buffer_load_dwordx4 v[128:131], v0, s[8:11], s70 offen offset:3072 sc1
    s_waitcnt vmcnt(23)
    v_mfma_f32_32x32x16_bf16 v[16:31], a[176:179], v[132:135], v[16:31]
    s_add_u32 s70, s70, 4096
    buffer_load_dwordx4 v[132:135], v0, s[8:11], s70 offen offset:0 sc1
    s_waitcnt vmcnt(23)
    v_mfma_f32_32x32x16_bf16 v[32:47], a[180:183], v[136:139], v[32:47]
    buffer_load_dwordx4 v[136:139], v0, s[8:11], s70 offen offset:1024 sc1
    s_waitcnt vmcnt(23)
    v_mfma_f32_32x32x16_bf16 v[16:31], a[184:187], v[140:143], v[16:31]
    buffer_load_dwordx4 v[140:143], v0, s[8:11], s70 offen offset:2048 sc1
    s_waitcnt vmcnt(23)
    v_mfma_f32_32x32x16_bf16 v[32:47], a[188:191], v[144:147], v[32:47]
    buffer_load_dwordx4 v[144:147], v0, s[8:11], s70 offen offset:3072 sc1
    s_waitcnt vmcnt(23)
    v_mfma_f32_32x32x16_bf16 v[16:31], a[192:195], v[52:55], v[16:31]
    s_waitcnt vmcnt(22)
    v_mfma_f32_32x32x16_bf16 v[32:47], a[196:199], v[56:59], v[32:47]
    s_waitcnt vmcnt(21)
    v_mfma_f32_32x32x16_bf16 v[16:31], a[200:203], v[60:63], v[16:31]
    s_waitcnt vmcnt(20)
    v_mfma_f32_32x32x16_bf16 v[32:47], a[204:207], v[64:67], v[32:47]
    s_waitcnt vmcnt(19)
    v_mfma_f32_32x32x16_bf16 v[16:31], a[208:211], v[68:71], v[16:31]
    s_waitcnt vmcnt(18)
    v_mfma_f32_32x32x16_bf16 v[32:47], a[212:215], v[72:75], v[32:47]
    s_waitcnt vmcnt(17)
    v_mfma_f32_32x32x16_bf16 v[16:31], a[216:219], v[76:79], v[16:31]
    s_waitcnt vmcnt(16)
    v_mfma_f32_32x32x16_bf16 v[32:47], a[220:223], v[80:83], v[32:47]
    s_waitcnt vmcnt(15)
    v_mfma_f32_32x32x16_bf16 v[16:31], a[224:227], v[84:87], v[16:31]
    s_waitcnt vmcnt(14)
    v_mfma_f32_32x32x16_bf16 v[32:47], a[228:231], v[88:91], v[32:47]
    s_waitcnt vmcnt(13)
    v_mfma_f32_32x32x16_bf16 v[16:31], a[232:235], v[92:95], v[16:31]
    s_waitcnt vmcnt(12)
    v_mfma_f32_32x32x16_bf16 v[32:47], a[236:239], v[96:99], v[32:47]
    s_waitcnt vmcnt(11)
    v_mfma_f32_32x32x16_bf16 v[16:31], a[240:243], v[100:103], v[16:31]
    s_waitcnt vmcnt(10)
    v_mfma_f32_32x32x16_bf16 v[32:47], a[244:247], v[104:107], v[32:47]
    s_waitcnt vmcnt(9)
    v_mfma_f32_32x32x16_bf16 v[16:31], a[248:251], v[108:111], v[16:31]
    buffer_load_dword v12, v6, s[8:11], s68 offen sc1
    s_waitcnt vmcnt(9)
    v_mfma_f32_32x32x16_bf16 v[32:47], a[252:255], v[112:115], v[32:47]
    s_waitcnt vmcnt(8)
    v_mfma_f32_32x32x16_bf16 v[16:31], v[224:227], v[116:119], v[16:31]
    s_waitcnt vmcnt(7)
    v_mfma_f32_32x32x16_bf16 v[32:47], v[228:231], v[120:123], v[32:47]
    s_waitcnt vmcnt(6)
    v_mfma_f32_32x32x16_bf16 v[16:31], v[232:235], v[124:127], v[16:31]
    s_waitcnt vmcnt(5)
    v_mfma_f32_32x32x16_bf16 v[32:47], v[236:239], v[128:131], v[32:47]
    s_waitcnt vmcnt(4)
    v_mfma_f32_32x32x16_bf16 v[16:31], v[240:243], v[132:135], v[16:31]
    s_waitcnt vmcnt(3)
    v_mfma_f32_32x32x16_bf16 v[32:47], v[244:247], v[136:139], v[32:47]
    s_waitcnt vmcnt(2)
    v_mfma_f32_32x32x16_bf16 v[16:31], v[248:251], v[140:143], v[16:31]
    s_waitcnt vmcnt(1)
    v_mfma_f32_32x32x16_bf16 v[32:47], v[252:255], v[144:147], v[32:47]
    s_waitcnt vmcnt(0)
    s_nop 1
    v_min_u32_dpp v12, v12, v12 quad_perm:[1,0,3,2] row_mask:0xf bank_mask:0xf
    s_nop 1
    v_min_u32_dpp v12, v12, v12 quad_perm:[2,3,0,1] row_mask:0xf bank_mask:0xf
    s_nop 1
    v_min_u32_dpp v12, v12, v12 row_half_mirror row_mask:0xf bank_mask:0xf
    s_nop 1
    v_min_u32_dpp v12, v12, v12 row_mirror row_mask:0xf bank_mask:0xf
    s_nop 0
    v_readlane_b32 s55, v12, 0
    v_readlane_b32 s56, v12, 16
    s_min_u32 s55, s55, s56
    v_readlane_b32 s56, v12, 32
    s_min_u32 s55, s55, s56
    v_readlane_b32 s56, v12, 48
    s_min_u32 s55, s55, s56
    s_cmp_gt_u32 s55, s59
    s_cselect_b32 s60, 1, 0
    s_cmp_lt_u32 s59, 64
    s_cselect_b32 s60, s60, 0
    s_cmp_eq_u32 s60, 0
    s_cbranch_scc1 L_nopre_39
    s_mul_i32 s70, s59, 294912
    s_mul_i32 s54, s4, 73728
    s_add_u32 s70, s70, s54
    s_add_u32 s70, s70, 67108864
    buffer_load_dwordx4 v[52:55], v0, s[8:11], s70 offen offset:0 sc1
    buffer_load_dwordx4 v[56:59], v0, s[8:11], s70 offen offset:1024 sc1
    buffer_load_dwordx4 v[60:63], v0, s[8:11], s70 offen offset:2048 sc1
    buffer_load_dwordx4 v[64:67], v0, s[8:11], s70 offen offset:3072 sc1
    s_add_u32 s70, s70, 4096
    buffer_load_dwordx4 v[68:71], v0, s[8:11], s70 offen offset:0 sc1
    buffer_load_dwordx4 v[72:75], v0, s[8:11], s70 offen offset:1024 sc1
    buffer_load_dwordx4 v[76:79], v0, s[8:11], s70 offen offset:2048 sc1
    buffer_load_dwordx4 v[80:83], v0, s[8:11], s70 offen offset:3072 sc1
    s_add_u32 s70, s70, 4096
    buffer_load_dwordx4 v[84:87], v0, s[8:11], s70 offen offset:0 sc1
    buffer_load_dwordx4 v[88:91], v0, s[8:11], s70 offen offset:1024 sc1
    buffer_load_dwordx4 v[92:95], v0, s[8:11], s70 offen offset:2048 sc1
    buffer_load_dwordx4 v[96:99], v0, s[8:11], s70 offen offset:3072 sc1
    s_add_u32 s70, s70, 4096
    buffer_load_dwordx4 v[100:103], v0, s[8:11], s70 offen offset:0 sc1
    buffer_load_dwordx4 v[104:107], v0, s[8:11], s70 offen offset:1024 sc1
    buffer_load_dwordx4 v[108:111], v0, s[8:11], s70 offen offset:2048 sc1
    buffer_load_dwordx4 v[112:115], v0, s[8:11], s70 offen offset:3072 sc1
    s_add_u32 s70, s70, 4096
    buffer_load_dwordx4 v[116:119], v0, s[8:11], s70 offen offset:0 sc1
    buffer_load_dwordx4 v[120:123], v0, s[8:11], s70 offen offset:1024 sc1
    buffer_load_dwordx4 v[124:127], v0, s[8:11], s70 offen offset:2048 sc1
    buffer_load_dwordx4 v[128:131], v0, s[8:11], s70 offen offset:3072 sc1
    s_add_u32 s70, s70, 4096
    buffer_load_dwordx4 v[132:135], v0, s[8:11], s70 offen offset:0 sc1
    buffer_load_dwordx4 v[136:139], v0, s[8:11], s70 offen offset:1024 sc1
    buffer_load_dwordx4 v[140:143], v0, s[8:11], s70 offen offset:2048 sc1
    buffer_load_dwordx4 v[144:147], v0, s[8:11], s70 offen offset:3072 sc1
L_nopre_39:
    v_and_b32 v51, 0xffff0000, v49
    v_lshlrev_b32 v50, 16, v49
    v_and_b32 v49, 0xffff0000, v48
    v_lshlrev_b32_e64 v48, 16, v48
    s_nop 7
    s_nop 3
    v_pk_add_f32 v[16:17], v[16:17], v[32:33]
    v_pk_add_f32 v[18:19], v[18:19], v[34:35]
    v_pk_add_f32 v[20:21], v[20:21], v[36:37]
    v_pk_add_f32 v[22:23], v[22:23], v[38:39]
    v_pk_add_f32 v[24:25], v[24:25], v[40:41]
    v_pk_add_f32 v[26:27], v[26:27], v[42:43]
    v_pk_add_f32 v[28:29], v[28:29], v[44:45]
    v_pk_add_f32 v[30:31], v[30:31], v[46:47]
    s_barrier
    ds_write_b128 v9, v[16:19] offset:0
    ds_write_b128 v9, v[20:23] offset:1024
    ds_write_b128 v9, v[24:27] offset:2048
    ds_write_b128 v9, v[28:31] offset:3072
    s_waitcnt lgkmcnt(0)
    s_barrier
    ds_read_b128 v[16:19], v10 offset:0
    ds_read_b128 v[20:23], v10 offset:4096
    ds_read_b128 v[24:27], v10 offset:8192
    ds_read_b128 v[28:31], v10 offset:12288
    s_waitcnt lgkmcnt(3)
    v_pk_add_f32 v[48:49], v[48:49], v[16:17]
    v_pk_add_f32 v[50:51], v[50:51], v[18:19]
    s_waitcnt lgkmcnt(2)
    v_pk_add_f32 v[48:49], v[48:49], v[20:21]
    v_pk_add_f32 v[50:51], v[50:51], v[22:23]
    s_waitcnt lgkmcnt(1)
    v_pk_add_f32 v[48:49], v[48:49], v[24:25]
    v_pk_add_f32 v[50:51], v[50:51], v[26:27]
    s_waitcnt lgkmcnt(0)
    v_pk_add_f32 v[48:49], v[48:49], v[28:29]
    v_pk_add_f32 v[50:51], v[50:51], v[30:31]
    buffer_store_dwordx4 v[48:51], v10, s[8:11], s73 offen sc1
    s_add_u32 s90, s90, 1
    v_mov_b32_e64 v2, s90
    s_waitcnt vmcnt(0)
    s_mov_b64 exec, 1
    buffer_store_dword v2, off, s[8:11], s57 sc1
    s_mov_b64 exec, -1
    s_mov_b32 s53, s59
    s_cmp_lt_u32 s53, 64
    s_cbranch_scc1 L_op_34
    s_cmp_lt_u32 s63, 2
    s_cbranch_scc1 L_DtoC
    s_endpgm
L_DtoC:
    s_cmp_eq_u32 s63, 1
    s_cselect_b32 s84, 256, 0
    s_mov_b32 s63, 54
    s_waitcnt vmcnt(0)
    s_barrier
    s_branch L_roleC
L_proj:
    s_cmp_ge_u32 s52, 32
    s_cbranch_scc1 L_notK
    v_lshrrev_b32 v1, 4, v0
    v_lshrrev_b32 v2, 4, v1
    v_and_b32 v3, 15, v1
    v_lshlrev_b32 v4, 2, v2
    v_xor_b32_e64 v3, v3, v4
    v_mul_u32_u24 v2, 8192, v2
    v_lshl_add_u32 v4, v3, 4, v2
    s_mul_i32 s54, s4, 1179648
    s_lshl_b32 s55, s52, 8
    s_add_u32 s54, s54, s55
    s_mul_i32 s55, s4, 36864
    s_mov_b32 m0, s55
    s_add_u32 s55, s55, 1024
    buffer_load_dwordx4 v4, s[16:19], s54 offen lds
    s_add_u32 s54, s54, 32768
    s_mov_b32 m0, s55
    s_add_u32 s55, s55, 1024
    buffer_load_dwordx4 v4, s[16:19], s54 offen lds
    s_add_u32 s54, s54, 32768
    s_mov_b32 m0, s55
    s_add_u32 s55, s55, 1024
    buffer_load_dwordx4 v4, s[16:19], s54 offen lds
    s_add_u32 s54, s54, 32768
    s_mov_b32 m0, s55
    s_add_u32 s55, s55, 1024
    buffer_load_dwordx4 v4, s[16:19], s54 offen lds
    s_add_u32 s54, s54, 32768
    s_mov_b32 m0, s55
    s_add_u32 s55, s55, 1024
    buffer_load_dwordx4 v4, s[16:19], s54 offen lds
    s_add_u32 s54, s54, 32768
    s_mov_b32 m0, s55
    s_add_u32 s55, s55, 1024
    buffer_load_dwordx4 v4, s[16:19], s54 offen lds
    s_add_u32 s54, s54, 32768
    s_mov_b32 m0, s55
    s_add_u32 s55, s55, 1024
    buffer_load_dwordx4 v4, s[16:19], s54 offen lds
    s_add_u32 s54, s54, 32768
    s_mov_b32 m0, s55
    s_add_u32 s55, s55, 1024
    buffer_load_dwordx4 v4, s[16:19], s54 offen lds
    s_add_u32 s54, s54, 32768
    s_mov_b32 m0, s55
    s_add_u32 s55, s55, 1024
    buffer_load_dwordx4 v4, s[16:19], s54 offen lds
    s_add_u32 s54, s54, 32768
    s_mov_b32 m0, s55
    s_add_u32 s55, s55, 1024
    buffer_load_dwordx4 v4, s[16:19], s54 offen lds
    s_add_u32 s54, s54, 32768
    s_mov_b32 m0, s55
    s_add_u32 s55, s55, 1024
    buffer_load_dwordx4 v4, s[16:19], s54 offen lds
    s_add_u32 s54, s54, 32768
    s_mov_b32 m0, s55
    s_add_u32 s55, s55, 1024
    buffer_load_dwordx4 v4, s[16:19], s54 offen lds
    s_add_u32 s54, s54, 32768
    s_mov_b32 m0, s55
    s_add_u32 s55, s55, 1024
    buffer_load_dwordx4 v4, s[16:19], s54 offen lds
    s_add_u32 s54, s54, 32768
    s_mov_b32 m0, s55
    s_add_u32 s55, s55, 1024
    buffer_load_dwordx4 v4, s[16:19], s54 offen lds
    s_add_u32 s54, s54, 32768
    s_mov_b32 m0, s55
    s_add_u32 s55, s55, 1024
    buffer_load_dwordx4 v4, s[16:19], s54 offen lds
    s_add_u32 s54, s54, 32768
    s_mov_b32 m0, s55
    s_add_u32 s55, s55, 1024
    buffer_load_dwordx4 v4, s[16:19], s54 offen lds
    s_add_u32 s54, s54, 32768
    s_mov_b32 m0, s55
    s_add_u32 s55, s55, 1024
    buffer_load_dwordx4 v4, s[16:19], s54 offen lds
    s_add_u32 s54, s54, 32768
    s_mov_b32 m0, s55
    s_add_u32 s55, s55, 1024
    buffer_load_dwordx4 v4, s[16:19], s54 offen lds
    s_add_u32 s54, s54, 32768
    s_mov_b32 m0, s55
    s_add_u32 s55, s55, 1024
    buffer_load_dwordx4 v4, s[16:19], s54 offen lds
    s_add_u32 s54, s54, 32768
    s_mov_b32 m0, s55
    s_add_u32 s55, s55, 1024
    buffer_load_dwordx4 v4, s[16:19], s54 offen lds
    s_add_u32 s54, s54, 32768
    s_mov_b32 m0, s55
    s_add_u32 s55, s55, 1024
    buffer_load_dwordx4 v4, s[16:19], s54 offen lds
    s_add_u32 s54, s54, 32768
    s_mov_b32 m0, s55
    s_add_u32 s55, s55, 1024
    buffer_load_dwordx4 v4, s[16:19], s54 offen lds
    s_add_u32 s54, s54, 32768
    s_mov_b32 m0, s55
    s_add_u32 s55, s55, 1024
    buffer_load_dwordx4 v4, s[16:19], s54 offen lds
    s_add_u32 s54, s54, 32768
    s_mov_b32 m0, s55
    s_add_u32 s55, s55, 1024
    buffer_load_dwordx4 v4, s[16:19], s54 offen lds
    s_add_u32 s54, s54, 32768
    s_mov_b32 m0, s55
    s_add_u32 s55, s55, 1024
    buffer_load_dwordx4 v4, s[16:19], s54 offen lds
    s_add_u32 s54, s54, 32768
    s_mov_b32 m0, s55
    s_add_u32 s55, s55, 1024
    buffer_load_dwordx4 v4, s[16:19], s54 offen lds
    s_add_u32 s54, s54, 32768
    s_mov_b32 m0, s55
    s_add_u32 s55, s55, 1024
    buffer_load_dwordx4 v4, s[16:19], s54 offen lds
    s_add_u32 s54, s54, 32768
    s_mov_b32 m0, s55
    s_add_u32 s55, s55, 1024
    buffer_load_dwordx4 v4, s[16:19], s54 offen lds
    s_add_u32 s54, s54, 32768
    s_mov_b32 m0, s55
    s_add_u32 s55, s55, 1024
    buffer_load_dwordx4 v4, s[16:19], s54 offen lds
    s_add_u32 s54, s54, 32768
    s_mov_b32 m0, s55
    s_add_u32 s55, s55, 1024
    buffer_load_dwordx4 v4, s[16:19], s54 offen lds
    s_add_u32 s54, s54, 32768
    s_mov_b32 m0, s55
    s_add_u32 s55, s55, 1024
    buffer_load_dwordx4 v4, s[16:19], s54 offen lds
    s_add_u32 s54, s54, 32768
    s_mov_b32 m0, s55
    s_add_u32 s55, s55, 1024
    buffer_load_dwordx4 v4, s[16:19], s54 offen lds
    s_add_u32 s54, s54, 32768
    s_mov_b32 m0, s55
    s_add_u32 s55, s55, 1024
    buffer_load_dwordx4 v4, s[16:19], s54 offen lds
    s_add_u32 s54, s54, 32768
    s_mov_b32 m0, s55
    s_add_u32 s55, s55, 1024
    buffer_load_dwordx4 v4, s[16:19], s54 offen lds
    s_add_u32 s54, s54, 32768
    s_mov_b32 m0, s55
    s_add_u32 s55, s55, 1024
    buffer_load_dwordx4 v4, s[16:19], s54 offen lds
    s_add_u32 s54, s54, 32768
    s_mov_b32 m0, s55
    s_add_u32 s55, s55, 1024
    buffer_load_dwordx4 v4, s[16:19], s54 offen lds
    s_add_u32 s54, s54, 32768
    v_lshrrev_b32_e64 v5, 5, v1
    v_bfe_u32 v6, v1, 2, 2
    v_bfe_u32 v7, v1, 4, 1
    v_and_b32_e64 v8, 3, v1
    v_lshl_add_u32 v7, v7, 2, v8
    v_and_b32_e64 v8, 1, v7
    v_bfe_u32 v9, v7, 1, 1
    v_lshl_add_u32 v8, v9, 2, v8
    v_lshrrev_b32_e64 v9, 2, v7
    v_lshl_add_u32 v7, v9, 1, v8
    v_lshrrev_b32 v8, 1, v7
    s_lshl_b32 s54, s4, 2
    v_add_u32 v8, s54, v8
    v_lshlrev_b32 v9, 2, v6
    v_xor_b32 v8, v8, v9
    v_and_b32 v7, 1, v7
    v_lshlrev_b32_e64 v7, 3, v7
    v_lshl_add_u32 v7, v8, 4, v7
    v_lshl_add_u32 v5, v5, 3, v6
    v_lshl_add_u32 v5, v5, 8, v7
    s_waitcnt vmcnt(0)
    s_barrier
    ds_read_b64_tr_b16 a[0:1], v5 offset:0
    ds_read_b64_tr_b16 a[2:3], v5 offset:1024
    ds_read_b64_tr_b16 a[4:5], v5 offset:4096
    ds_read_b64_tr_b16 a[6:7], v5 offset:5120
    ds_read_b64_tr_b16 a[8:9], v5 offset:8192
    ds_read_b64_tr_b16 a[10:11], v5 offset:9216
    ds_read_b64_tr_b16 a[12:13], v5 offset:12288
    ds_read_b64_tr_b16 a[14:15], v5 offset:13312
    ds_read_b64_tr_b16 a[16:17], v5 offset:16384
    ds_read_b64_tr_b16 a[18:19], v5 offset:17408
    ds_read_b64_tr_b16 a[20:21], v5 offset:20480
    ds_read_b64_tr_b16 a[22:23], v5 offset:21504
    ds_read_b64_tr_b16 a[24:25], v5 offset:24576
    ds_read_b64_tr_b16 a[26:27], v5 offset:25600
    ds_read_b64_tr_b16 a[28:29], v5 offset:28672
    ds_read_b64_tr_b16 a[30:31], v5 offset:29696
    ds_read_b64_tr_b16 a[32:33], v5 offset:32768
    ds_read_b64_tr_b16 a[34:35], v5 offset:33792
    ds_read_b64_tr_b16 a[36:37], v5 offset:36864
    ds_read_b64_tr_b16 a[38:39], v5 offset:37888
    ds_read_b64_tr_b16 a[40:41], v5 offset:40960
    ds_read_b64_tr_b16 a[42:43], v5 offset:41984
    ds_read_b64_tr_b16 a[44:45], v5 offset:45056
    ds_read_b64_tr_b16 a[46:47], v5 offset:46080
    ds_read_b64_tr_b16 a[48:49], v5 offset:49152
    ds_read_b64_tr_b16 a[50:51], v5 offset:50176
    ds_read_b64_tr_b16 a[52:53], v5 offset:53248
    ds_read_b64_tr_b16 a[54:55], v5 offset:54272
    ds_read_b64_tr_b16 a[56:57], v5 offset:57344
    ds_read_b64_tr_b16 a[58:59], v5 offset:58368
    ds_read_b64_tr_b16 a[60:61], v5 offset:61440
    ds_read_b64_tr_b16 a[62:63], v5 offset:62464
    v_add_u32 v5, 0x10000, v5
    ds_read_b64_tr_b16 a[64:65], v5 offset:0
    ds_read_b64_tr_b16 a[66:67], v5 offset:1024
    ds_read_b64_tr_b16 a[68:69], v5 offset:4096
    ds_read_b64_tr_b16 a[70:71], v5 offset:5120
    ds_read_b64_tr_b16 a[72:73], v5 offset:8192
    ds_read_b64_tr_b16 a[74:75], v5 offset:9216
    ds_read_b64_tr_b16 a[76:77], v5 offset:12288
    ds_read_b64_tr_b16 a[78:79], v5 offset:13312
    ds_read_b64_tr_b16 a[80:81], v5 offset:16384
    ds_read_b64_tr_b16 a[82:83], v5 offset:17408
    ds_read_b64_tr_b16 a[84:85], v5 offset:20480
    ds_read_b64_tr_b16 a[86:87], v5 offset:21504
    ds_read_b64_tr_b16 a[88:89], v5 offset:24576
    ds_read_b64_tr_b16 a[90:91], v5 offset:25600
    ds_read_b64_tr_b16 a[92:93], v5 offset:28672
    ds_read_b64_tr_b16 a[94:95], v5 offset:29696
    ds_read_b64_tr_b16 a[96:97], v5 offset:32768
    ds_read_b64_tr_b16 a[98:99], v5 offset:33792
    ds_read_b64_tr_b16 a[100:101], v5 offset:36864
    ds_read_b64_tr_b16 a[102:103], v5 offset:37888
    ds_read_b64_tr_b16 a[104:105], v5 offset:40960
    ds_read_b64_tr_b16 a[106:107], v5 offset:41984
    ds_read_b64_tr_b16 a[108:109], v5 offset:45056
    ds_read_b64_tr_b16 a[110:111], v5 offset:46080
    ds_read_b64_tr_b16 a[112:113], v5 offset:49152
    ds_read_b64_tr_b16 a[114:115], v5 offset:50176
    ds_read_b64_tr_b16 a[116:117], v5 offset:53248
    ds_read_b64_tr_b16 a[118:119], v5 offset:54272
    ds_read_b64_tr_b16 a[120:121], v5 offset:57344
    ds_read_b64_tr_b16 a[122:123], v5 offset:58368
    ds_read_b64_tr_b16 a[124:125], v5 offset:61440
    ds_read_b64_tr_b16 a[126:127], v5 offset:62464
    v_add_u32 v5, 0x10000, v5
    ds_read_b64_tr_b16 a[128:129], v5 offset:0
    ds_read_b64_tr_b16 a[130:131], v5 offset:1024
    ds_read_b64_tr_b16 a[132:133], v5 offset:4096
    ds_read_b64_tr_b16 a[134:135], v5 offset:5120
    ds_read_b64_tr_b16 a[136:137], v5 offset:8192
    ds_read_b64_tr_b16 a[138:139], v5 offset:9216
    ds_read_b64_tr_b16 a[140:141], v5 offset:12288
    ds_read_b64_tr_b16 a[142:143], v5 offset:13312
    v_lshlrev_b32_e64 v6, 3, v0
    s_mov_b32 s61, 0
    s_mov_b32 s54, 1
    s_mov_b32 s55, 16384
    s_cmp_ge_u32 s61, s54
    s_cbranch_scc1 L_wd_41
    s_mov_b32 s79, 524288
L_w_40:
    buffer_load_dwordx4 v[8:11], v6, s[8:11], s55 offen sc1
    s_waitcnt vmcnt(0)
    v_min3_u32 v8, v8, v9, v10
    v_min_u32 v8, v8, v11
    v_cmp_gt_u32 vcc, s54, v8
    s_cbranch_vccz L_wo_42
    s_sub_u32 s79, s79, 1
    s_cbranch_scc1 L_fail
    s_branch L_w_40
L_wo_42:
    s_nop 1
    v_min_u32_dpp v8, v8, v8 quad_perm:[1,0,3,2] row_mask:0xf bank_mask:0xf
    s_nop 1
    v_min_u32_dpp v8, v8, v8 quad_perm:[2,3,0,1] row_mask:0xf bank_mask:0xf
    s_nop 1
    v_min_u32_dpp v8, v8, v8 row_half_mirror row_mask:0xf bank_mask:0xf
    s_nop 1
    v_min_u32_dpp v8, v8, v8 row_mirror row_mask:0xf bank_mask:0xf
    s_nop 0
    v_readlane_b32 s61, v8, 0
    v_readlane_b32 s56, v8, 16
    s_min_u32 s61, s61, s56
    v_readlane_b32 s56, v8, 32
    s_min_u32 s61, s61, s56
    v_readlane_b32 s56, v8, 48
    s_min_u32 s61, s61, s56
L_wd_41:
    s_waitcnt lgkmcnt(0)
    s_barrier
    v_bfe_u32 v2, v1, 4, 1
    v_lshlrev_b32 v2, 10, v2
    v_lshrrev_b32_e64 v3, 5, v1
    v_lshl_add_u32 v2, v3, 8, v2
    v_and_b32 v3, 0xf0, v0
    v_add_u32_e64 v2, v2, v3
    s_mul_i32 s60, s4, 9216
    s_add_u32 s59, s60, 1048576
    s_lshl_b32 s54, s52, 7
    s_lshl_b32 s55, s4, 2
    s_add_u32 s57, s54, s55
    s_add_u32 s57, s57, 0
    s_lshl_b32 s54, s52, 2
    s_add_u32 s54, s54, s4
    s_lshl_b32 s58, s54, 12
    s_add_u32 s58, s58, 4194304
    v_mov_b32 v3, v0
    v_mov_b32_e64 v6, 0
    s_mov_b32 s62, 0
    s_lshl_b32 s69, s52, 7
    s_add_u32 s69, s69, 8204
    s_add_u32 m0, s60, 0
    s_add_u32 s54, s59, 0
    buffer_load_dwordx4 v0, s[8:11], s54 offen sc1 lds
    s_add_u32 m0, s60, 1024
    s_add_u32 s54, s59, 1024
    buffer_load_dwordx4 v0, s[8:11], s54 offen sc1 lds
    s_add_u32 m0, s60, 2048
    s_add_u32 s54, s59, 2048
    buffer_load_dwordx4 v0, s[8:11], s54 offen sc1 lds
    s_add_u32 m0, s60, 3072
    s_add_u32 s54, s59, 3072
    buffer_load_dwordx4 v0, s[8:11], s54 offen sc1 lds
    s_add_u32 m0, s60, 4096
    s_add_u32 s54, s59, 4096
    buffer_load_dwordx4 v0, s[8:11], s54 offen sc1 lds
    s_add_u32 m0, s60, 5120
    s_add_u32 s54, s59, 5120
    buffer_load_dwordx4 v0, s[8:11], s54 offen sc1 lds
    s_add_u32 m0, s60, 6144
    s_add_u32 s54, s59, 6144
    buffer_load_dwordx4 v0, s[8:11], s54 offen sc1 lds
    s_add_u32 m0, s60, 7168
    s_add_u32 s54, s59, 7168
    buffer_load_dwordx4 v0, s[8:11], s54 offen sc1 lds
    s_add_u32 m0, s60, 8192
    s_add_u32 s54, s59, 8192
    buffer_load_dwordx4 v0, s[8:11], s54 offen sc1 lds
    s_add_u32 s59, s59, 36864
    s_add_u32 s60, s60, 36864
    s_cmp_ge_u32 s60, 147456
    s_cselect_b32 s54, 147456, 0
    s_sub_u32 s60, s60, s54
    s_add_u32 m0, s60, 0
    s_add_u32 s54, s59, 0
    buffer_load_dwordx4 v0, s[8:11], s54 offen sc1 lds
    s_add_u32 m0, s60, 1024
    s_add_u32 s54, s59, 1024
    buffer_load_dwordx4 v0, s[8:11], s54 offen sc1 lds
    s_add_u32 m0, s60, 2048
    s_add_u32 s54, s59, 2048
    buffer_load_dwordx4 v0, s[8:11], s54 offen sc1 lds
    s_add_u32 m0, s60, 3072
    s_add_u32 s54, s59, 3072
    buffer_load_dwordx4 v0, s[8:11], s54 offen sc1 lds
    s_add_u32 m0, s60, 4096
    s_add_u32 s54, s59, 4096
    buffer_load_dwordx4 v0, s[8:11], s54 offen sc1 lds
    s_add_u32 m0, s60, 5120
    s_add_u32 s54, s59, 5120
    buffer_load_dwordx4 v0, s[8:11], s54 offen sc1 lds
    s_add_u32 m0, s60, 6144
    s_add_u32 s54, s59, 6144
    buffer_load_dwordx4 v0, s[8:11], s54 offen sc1 lds
    s_add_u32 m0, s60, 7168
    s_add_u32 s54, s59, 7168
    buffer_load_dwordx4 v0, s[8:11], s54 offen sc1 lds
    s_add_u32 m0, s60, 8192
    s_add_u32 s54, s59, 8192
    buffer_load_dwordx4 v0, s[8:11], s54 offen sc1 lds
    s_add_u32 s59, s59, 36864
    s_add_u32 s60, s60, 36864
    s_cmp_ge_u32 s60, 147456
    s_cselect_b32 s54, 147456, 0
    s_sub_u32 s60, s60, s54
    s_add_u32 m0, s60, 0
    s_add_u32 s54, s59, 0
    buffer_load_dwordx4 v0, s[8:11], s54 offen sc1 lds
    s_add_u32 m0, s60, 1024
    s_add_u32 s54, s59, 1024
    buffer_load_dwordx4 v0, s[8:11], s54 offen sc1 lds
    s_add_u32 m0, s60, 2048
    s_add_u32 s54, s59, 2048
    buffer_load_dwordx4 v0, s[8:11], s54 offen sc1 lds
    s_add_u32 m0, s60, 3072
    s_add_u32 s54, s59, 3072
    buffer_load_dwordx4 v0, s[8:11], s54 offen sc1 lds
    s_add_u32 m0, s60, 4096
    s_add_u32 s54, s59, 4096
    buffer_load_dwordx4 v0, s[8:11], s54 offen sc1 lds
    s_add_u32 m0, s60, 5120
    s_add_u32 s54, s59, 5120
    buffer_load_dwordx4 v0, s[8:11], s54 offen sc1 lds
    s_add_u32 m0, s60, 6144
    s_add_u32 s54, s59, 6144
    buffer_load_dwordx4 v0, s[8:11], s54 offen sc1 lds
    s_add_u32 m0, s60, 7168
    s_add_u32 s54, s59, 7168
    buffer_load_dwordx4 v0, s[8:11], s54 offen sc1 lds
    s_add_u32 m0, s60, 8192
    s_add_u32 s54, s59, 8192
    buffer_load_dwordx4 v0, s[8:11], s54 offen sc1 lds
    s_add_u32 s59, s59, 36864
    s_add_u32 s60, s60, 36864
    s_cmp_ge_u32 s60, 147456
    s_cselect_b32 s54, 147456, 0
    s_sub_u32 s60, s60, s54
    s_mov_b32 s53, 0
    s_waitcnt vmcnt(18)
    s_barrier
    ds_read_b128 v[48:51], v3 offset:0
    ds_read_b128 v[52:55], v3 offset:1024
    ds_read_b128 v[56:59], v3 offset:2048
    ds_read_b128 v[60:63], v3 offset:3072
    s_waitcnt lgkmcnt(3)
    v_mfma_f32_32x32x16_bf16 v[16:31], a[0:3], v[48:51], 0
    ds_read_b128 v[48:51], v3 offset:4096
    s_waitcnt lgkmcnt(3)
    v_mfma_f32_32x32x16_bf16 v[16:31], a[4:7], v[52:55], v[16:31]
    ds_read_b128 v[52:55], v3 offset:5120
    s_waitcnt lgkmcnt(3)
    v_mfma_f32_32x32x16_bf16 v[16:31], a[8:11], v[56:59], v[16:31]
    ds_read_b128 v[56:59], v3 offset:6144
    s_add_u32 m0, s60, 0
    s_add_u32 s54, s59, 0
    buffer_load_dwordx4 v0, s[8:11], s54 offen sc1 lds
    s_waitcnt lgkmcnt(3)
    v_mfma_f32_32x32x16_bf16 v[16:31], a[12:15], v[60:63], v[16:31]
    ds_read_b128 v[60:63], v3 offset:7168
    s_waitcnt lgkmcnt(3)
    v_mfma_f32_32x32x16_bf16 v[16:31], a[16:19], v[48:51], v[16:31]
    ds_read_b128 v[48:51], v3 offset:8192
    s_waitcnt lgkmcnt(3)
    v_mfma_f32_32x32x16_bf16 v[16:31], a[20:23], v[52:55], v[16:31]
    ds_read_b128 v[52:55], v3 offset:9216
    s_add_u32 m0, s60, 1024
    s_add_u32 s54, s59, 1024
    buffer_load_dwordx4 v0, s[8:11], s54 offen sc1 lds
    s_waitcnt lgkmcnt(3)
    v_mfma_f32_32x32x16_bf16 v[16:31], a[24:27], v[56:59], v[16:31]
    ds_read_b128 v[56:59], v3 offset:10240
    s_waitcnt lgkmcnt(3)
    v_mfma_f32_32x32x16_bf16 v[16:31], a[28:31], v[60:63], v[16:31]
    ds_read_b128 v[60:63], v3 offset:11264
    s_waitcnt lgkmcnt(3)
    v_mfma_f32_32x32x16_bf16 v[16:31], a[32:35], v[48:51], v[16:31]
    ds_read_b128 v[48:51], v3 offset:12288
    s_add_u32 m0, s60, 2048
    s_add_u32 s54, s59, 2048
    buffer_load_dwordx4 v0, s[8:11], s54 offen sc1 lds
    s_waitcnt lgkmcnt(3)
    v_mfma_f32_32x32x16_bf16 v[16:31], a[36:39], v[52:55], v[16:31]
    ds_read_b128 v[52:55], v3 offset:13312
    s_waitcnt lgkmcnt(3)
    v_mfma_f32_32x32x16_bf16 v[16:31], a[40:43], v[56:59], v[16:31]
    ds_read_b128 v[56:59], v3 offset:14336
    s_waitcnt lgkmcnt(3)
    v_mfma_f32_32x32x16_bf16 v[16:31], a[44:47], v[60:63], v[16:31]
    ds_read_b128 v[60:63], v3 offset:15360
    s_add_u32 m0, s60, 3072
    s_add_u32 s54, s59, 3072
    buffer_load_dwordx4 v0, s[8:11], s54 offen sc1 lds
    s_waitcnt lgkmcnt(3)
    v_mfma_f32_32x32x16_bf16 v[16:31], a[48:51], v[48:51], v[16:31]
    ds_read_b128 v[48:51], v3 offset:16384
    s_waitcnt lgkmcnt(3)
    v_mfma_f32_32x32x16_bf16 v[16:31], a[52:55], v[52:55], v[16:31]
    ds_read_b128 v[52:55], v3 offset:17408
    s_waitcnt lgkmcnt(3)
    v_mfma_f32_32x32x16_bf16 v[16:31], a[56:59], v[56:59], v[16:31]
    ds_read_b128 v[56:59], v3 offset:18432
    s_add_u32 m0, s60, 4096
    s_add_u32 s54, s59, 4096
    buffer_load_dwordx4 v0, s[8:11], s54 offen sc1 lds
    s_waitcnt lgkmcnt(3)
    v_mfma_f32_32x32x16_bf16 v[16:31], a[60:63], v[60:63], v[16:31]
    ds_read_b128 v[60:63], v3 offset:19456
    s_waitcnt lgkmcnt(3)
    v_mfma_f32_32x32x16_bf16 v[16:31], a[64:67], v[48:51], v[16:31]
    ds_read_b128 v[48:51], v3 offset:20480
    s_waitcnt lgkmcnt(3)
    v_mfma_f32_32x32x16_bf16 v[16:31], a[68:71], v[52:55], v[16:31]
    ds_read_b128 v[52:55], v3 offset:21504
    s_add_u32 m0, s60, 5120
    s_add_u32 s54, s59, 5120
    buffer_load_dwordx4 v0, s[8:11], s54 offen sc1 lds
    s_waitcnt lgkmcnt(3)
    v_mfma_f32_32x32x16_bf16 v[16:31], a[72:75], v[56:59], v[16:31]
    ds_read_b128 v[56:59], v3 offset:22528
    s_waitcnt lgkmcnt(3)
    v_mfma_f32_32x32x16_bf16 v[16:31], a[76:79], v[60:63], v[16:31]
    ds_read_b128 v[60:63], v3 offset:23552
    s_waitcnt lgkmcnt(3)
    v_mfma_f32_32x32x16_bf16 v[16:31], a[80:83], v[48:51], v[16:31]
    ds_read_b128 v[48:51], v3 offset:24576
    s_add_u32 m0, s60, 6144
    s_add_u32 s54, s59, 6144
    buffer_load_dwordx4 v0, s[8:11], s54 offen sc1 lds
    s_waitcnt lgkmcnt(3)
    v_mfma_f32_32x32x16_bf16 v[16:31], a[84:87], v[52:55], v[16:31]
    ds_read_b128 v[52:55], v3 offset:25600
    s_waitcnt lgkmcnt(3)
    v_mfma_f32_32x32x16_bf16 v[16:31], a[88:91], v[56:59], v[16:31]
    ds_read_b128 v[56:59], v3 offset:26624
    s_waitcnt lgkmcnt(3)
    v_mfma_f32_32x32x16_bf16 v[16:31], a[92:95], v[60:63], v[16:31]
    ds_read_b128 v[60:63], v3 offset:27648
    s_add_u32 m0, s60, 7168
    s_add_u32 s54, s59, 7168
    buffer_load_dwordx4 v0, s[8:11], s54 offen sc1 lds
    s_waitcnt lgkmcnt(3)
    v_mfma_f32_32x32x16_bf16 v[16:31], a[96:99], v[48:51], v[16:31]
    ds_read_b128 v[48:51], v3 offset:28672
    s_waitcnt lgkmcnt(3)
    v_mfma_f32_32x32x16_bf16 v[16:31], a[100:103], v[52:55], v[16:31]
    ds_read_b128 v[52:55], v3 offset:29696
    s_waitcnt lgkmcnt(3)
    v_mfma_f32_32x32x16_bf16 v[16:31], a[104:107], v[56:59], v[16:31]
    ds_read_b128 v[56:59], v3 offset:30720
    s_add_u32 m0, s60, 8192
    s_add_u32 s54, s59, 8192
    buffer_load_dwordx4 v0, s[8:11], s54 offen sc1 lds
    s_add_u32 s59, s59, 36864
    s_add_u32 s60, s60, 36864
    s_cmp_ge_u32 s60, 147456
    s_cselect_b32 s54, 147456, 0
    s_sub_u32 s60, s60, s54
    s_waitcnt lgkmcnt(3)
    v_mfma_f32_32x32x16_bf16 v[16:31], a[108:111], v[60:63], v[16:31]
    ds_read_b128 v[60:63], v3 offset:31744
    s_waitcnt lgkmcnt(3)
    v_mfma_f32_32x32x16_bf16 v[16:31], a[112:115], v[48:51], v[16:31]
    ds_read_b128 v[48:51], v3 offset:32768
    s_waitcnt lgkmcnt(3)
    v_mfma_f32_32x32x16_bf16 v[16:31], a[116:119], v[52:55], v[16:31]
    ds_read_b128 v[52:55], v3 offset:33792
    s_waitcnt lgkmcnt(3)
    v_mfma_f32_32x32x16_bf16 v[16:31], a[120:123], v[56:59], v[16:31]
    ds_read_b128 v[56:59], v3 offset:34816
    s_waitcnt lgkmcnt(3)
    v_mfma_f32_32x32x16_bf16 v[16:31], a[124:127], v[60:63], v[16:31]
    ds_read_b128 v[60:63], v3 offset:35840
    s_waitcnt lgkmcnt(3)
    v_mfma_f32_32x32x16_bf16 v[16:31], a[128:131], v[48:51], v[16:31]
    s_waitcnt lgkmcnt(2)
    v_mfma_f32_32x32x16_bf16 v[16:31], a[132:135], v[52:55], v[16:31]
    s_waitcnt lgkmcnt(1)
    v_mfma_f32_32x32x16_bf16 v[16:31], a[136:139], v[56:59], v[16:31]
    s_waitcnt lgkmcnt(0)
    v_mfma_f32_32x32x16_bf16 v[16:31], a[140:143], v[60:63], v[16:31]
    v_add_u32 v3, 36864, v3
    v_subrev_u32 v4, 147456, v3
    v_min_u32 v3, v3, v4
    s_waitcnt vmcnt(18)
    s_branch L_pj_in_43
L_pj_44:
    s_waitcnt vmcnt(12)
L_pj_in_43:
    s_barrier
    s_max_u32 s54, s53, 1
    s_sub_u32 s54, s54, 1
    v_mov_b32 v5, s54
    s_mov_b64 exec, 1
    buffer_store_dword v5, off, s[8:11], s57 sc1
    s_mov_b64 exec, -1
    ds_read_b128 v[48:51], v3 offset:0
    ds_read_b128 v[52:55], v3 offset:1024
    ds_read_b128 v[56:59], v3 offset:2048
    ds_read_b128 v[60:63], v3 offset:3072
    s_waitcnt lgkmcnt(3)
    v_mfma_f32_32x32x16_bf16 v[32:47], a[0:3], v[48:51], 0
    ds_read_b128 v[48:51], v3 offset:4096
    s_add_u32 m0, s60, 0
    s_add_u32 s54, s59, 0
    buffer_load_dwordx4 v0, s[8:11], s54 offen sc1 lds
    s_waitcnt lgkmcnt(3)
    v_mfma_f32_32x32x16_bf16 v[32:47], a[4:7], v[52:55], v[32:47]
    ds_read_b128 v[52:55], v3 offset:5120
    s_add_u32 m0, s60, 1024
    s_add_u32 s54, s59, 1024
    buffer_load_dwordx4 v0, s[8:11], s54 offen sc1 lds
    s_waitcnt lgkmcnt(3)
    v_mfma_f32_32x32x16_bf16 v[32:47], a[8:11], v[56:59], v[32:47]
    ds_read_b128 v[56:59], v3 offset:6144
    s_add_u32 m0, s60, 2048
    s_add_u32 s54, s59, 2048
    buffer_load_dwordx4 v0, s[8:11], s54 offen sc1 lds
    s_waitcnt lgkmcnt(3)
    v_mfma_f32_32x32x16_bf16 v[32:47], a[12:15], v[60:63], v[32:47]
    ds_read_b128 v[60:63], v3 offset:7168
    s_add_u32 m0, s60, 3072
    s_add_u32 s54, s59, 3072
    buffer_load_dwordx4 v0, s[8:11], s54 offen sc1 lds
    s_waitcnt lgkmcnt(3)
    v_mfma_f32_32x32x16_bf16 v[32:47], a[16:19], v[48:51], v[32:47]
    ds_read_b128 v[48:51], v3 offset:8192
    s_add_u32 m0, s60, 4096
    s_add_u32 s54, s59, 4096
    buffer_load_dwordx4 v0, s[8:11], s54 offen sc1 lds
    s_waitcnt lgkmcnt(3)
    v_mfma_f32_32x32x16_bf16 v[32:47], a[20:23], v[52:55], v[32:47]
    ds_read_b128 v[52:55], v3 offset:9216
    s_add_u32 m0, s60, 5120
    s_add_u32 s54, s59, 5120
    buffer_load_dwordx4 v0, s[8:11], s54 offen sc1 lds
    s_waitcnt lgkmcnt(3)
    v_mfma_f32_32x32x16_bf16 v[32:47], a[24:27], v[56:59], v[32:47]
    ds_read_b128 v[56:59], v3 offset:10240
    s_add_u32 m0, s60, 6144
    s_add_u32 s54, s59, 6144
    buffer_load_dwordx4 v0, s[8:11], s54 offen sc1 lds
    s_waitcnt lgkmcnt(3)
    v_mfma_f32_32x32x16_bf16 v[32:47], a[28:31], v[60:63], v[32:47]
    ds_read_b128 v[60:63], v3 offset:11264
    s_add_u32 m0, s60, 7168
    s_add_u32 s54, s59, 7168
    buffer_load_dwordx4 v0, s[8:11], s54 offen sc1 lds
    s_waitcnt lgkmcnt(3)
    v_mfma_f32_32x32x16_bf16 v[32:47], a[32:35], v[48:51], v[32:47]
    ds_read_b128 v[48:51], v3 offset:12288
    s_add_u32 m0, s60, 8192
    s_add_u32 s54, s59, 8192
    buffer_load_dwordx4 v0, s[8:11], s54 offen sc1 lds
    s_add_u32 s59, s59, 36864
    s_add_u32 s60, s60, 36864
    s_cmp_ge_u32 s60, 147456
    s_cselect_b32 s54, 147456, 0
    s_sub_u32 s60, s60, s54
    s_waitcnt lgkmcnt(3)
    v_mfma_f32_32x32x16_bf16 v[32:47], a[36:39], v[52:55], v[32:47]
    ds_read_b128 v[52:55], v3 offset:13312
    v_cvt_pk_bf16_f32 v64, v16, v17
    s_waitcnt lgkmcnt(3)
    v_mfma_f32_32x32x16_bf16 v[32:47], a[40:43], v[56:59], v[32:47]
    ds_read_b128 v[56:59], v3 offset:14336
    v_cvt_pk_bf16_f32 v65, v18, v19
    s_waitcnt lgkmcnt(3)
    v_mfma_f32_32x32x16_bf16 v[32:47], a[44:47], v[60:63], v[32:47]
    ds_read_b128 v[60:63], v3 offset:15360
    v_cvt_pk_bf16_f32 v66, v20, v21
    s_waitcnt lgkmcnt(3)
    v_mfma_f32_32x32x16_bf16 v[32:47], a[48:51], v[48:51], v[32:47]
    ds_read_b128 v[48:51], v3 offset:16384
    v_cvt_pk_bf16_f32 v67, v22, v23
    s_waitcnt lgkmcnt(3)
    v_mfma_f32_32x32x16_bf16 v[32:47], a[52:55], v[52:55], v[32:47]
    ds_read_b128 v[52:55], v3 offset:17408
    buffer_store_dwordx4 v[64:67], v2, s[8:11], s58 offen offset:0 sc1
    s_waitcnt lgkmcnt(3)
    v_mfma_f32_32x32x16_bf16 v[32:47], a[56:59], v[56:59], v[32:47]
    ds_read_b128 v[56:59], v3 offset:18432
    v_cvt_pk_bf16_f32 v68, v24, v25
    s_waitcnt lgkmcnt(3)
    v_mfma_f32_32x32x16_bf16 v[32:47], a[60:63], v[60:63], v[32:47]
    ds_read_b128 v[60:63], v3 offset:19456
    v_cvt_pk_bf16_f32 v69, v26, v27
    s_waitcnt lgkmcnt(3)
    v_mfma_f32_32x32x16_bf16 v[32:47], a[64:67], v[48:51], v[32:47]
    ds_read_b128 v[48:51], v3 offset:20480
    v_cvt_pk_bf16_f32 v70, v28, v29
    s_waitcnt lgkmcnt(3)
    v_mfma_f32_32x32x16_bf16 v[32:47], a[68:71], v[52:55], v[32:47]
    ds_read_b128 v[52:55], v3 offset:21504
    v_cvt_pk_bf16_f32 v71, v30, v31
    s_waitcnt lgkmcnt(3)
    v_mfma_f32_32x32x16_bf16 v[32:47], a[72:75], v[56:59], v[32:47]
    ds_read_b128 v[56:59], v3 offset:22528
    buffer_store_dwordx4 v[68:71], v2, s[8:11], s58 offen offset:512 sc1
    s_waitcnt lgkmcnt(3)
    v_mfma_f32_32x32x16_bf16 v[32:47], a[76:79], v[60:63], v[32:47]
    ds_read_b128 v[60:63], v3 offset:23552
    s_add_u32 s58, s58, 524288
    s_waitcnt lgkmcnt(3)
    v_mfma_f32_32x32x16_bf16 v[32:47], a[80:83], v[48:51], v[32:47]
    ds_read_b128 v[48:51], v3 offset:24576
    s_waitcnt lgkmcnt(3)
    v_mfma_f32_32x32x16_bf16 v[32:47], a[84:87], v[52:55], v[32:47]
    ds_read_b128 v[52:55], v3 offset:25600
    s_waitcnt lgkmcnt(3)
    v_mfma_f32_32x32x16_bf16 v[32:47], a[88:91], v[56:59], v[32:47]
    ds_read_b128 v[56:59], v3 offset:26624
    s_waitcnt lgkmcnt(3)
    v_mfma_f32_32x32x16_bf16 v[32:47], a[92:95], v[60:63], v[32:47]
    ds_read_b128 v[60:63], v3 offset:27648
    s_waitcnt lgkmcnt(3)
    v_mfma_f32_32x32x16_bf16 v[32:47], a[96:99], v[48:51], v[32:47]
    ds_read_b128 v[48:51], v3 offset:28672
    s_waitcnt lgkmcnt(3)
    v_mfma_f32_32x32x16_bf16 v[32:47], a[100:103], v[52:55], v[32:47]
    ds_read_b128 v[52:55], v3 offset:29696
    s_waitcnt lgkmcnt(3)
    v_mfma_f32_32x32x16_bf16 v[32:47], a[104:107], v[56:59], v[32:47]
    ds_read_b128 v[56:59], v3 offset:30720
    s_waitcnt lgkmcnt(3)
    v_mfma_f32_32x32x16_bf16 v[32:47], a[108:111], v[60:63], v[32:47]
    ds_read_b128 v[60:63], v3 offset:31744
    s_waitcnt lgkmcnt(3)
    v_mfma_f32_32x32x16_bf16 v[32:47], a[112:115], v[48:51], v[32:47]
    ds_read_b128 v[48:51], v3 offset:32768
    s_waitcnt lgkmcnt(3)
    v_mfma_f32_32x32x16_bf16 v[32:47], a[116:119], v[52:55], v[32:47]
    ds_read_b128 v[52:55], v3 offset:33792
    s_waitcnt lgkmcnt(3)
    v_mfma_f32_32x32x16_bf16 v[32:47], a[120:123], v[56:59], v[32:47]
    ds_read_b128 v[56:59], v3 offset:34816
    s_waitcnt lgkmcnt(3)
    v_mfma_f32_32x32x16_bf16 v[32:47], a[124:127], v[60:63], v[32:47]
    ds_read_b128 v[60:63], v3 offset:35840
    s_waitcnt lgkmcnt(3)
    v_mfma_f32_32x32x16_bf16 v[32:47], a[128:131], v[48:51], v[32:47]
    s_waitcnt lgkmcnt(2)
    v_mfma_f32_32x32x16_bf16 v[32:47], a[132:135], v[52:55], v[32:47]
    s_waitcnt lgkmcnt(1)
    v_mfma_f32_32x32x16_bf16 v[32:47], a[136:139], v[56:59], v[32:47]
    s_waitcnt lgkmcnt(0)
    v_mfma_f32_32x32x16_bf16 v[32:47], a[140:143], v[60:63], v[32:47]
    v_add_u32 v3, 36864, v3
    v_subrev_u32 v4, 147456, v3
    v_min_u32 v3, v3, v4
    s_add_u32 s53, s53, 1
    s_cmp_ge_u32 s53, 63
    s_cbranch_scc1 L_pj_44_end
    s_waitcnt vmcnt(12)
    s_barrier
    s_max_u32 s54, s53, 1
    s_sub_u32 s54, s54, 1
    v_mov_b32 v5, s54
    s_mov_b64 exec, 1
    buffer_store_dword v5, off, s[8:11], s57 sc1
    s_mov_b64 exec, -1
    ds_read_b128 v[48:51], v3 offset:0
    ds_read_b128 v[52:55], v3 offset:1024
    ds_read_b128 v[56:59], v3 offset:2048
    ds_read_b128 v[60:63], v3 offset:3072
    s_waitcnt lgkmcnt(3)
    v_mfma_f32_32x32x16_bf16 v[16:31], a[0:3], v[48:51], 0
    ds_read_b128 v[48:51], v3 offset:4096
    s_add_u32 m0, s60, 0
    s_add_u32 s54, s59, 0
    buffer_load_dwordx4 v0, s[8:11], s54 offen sc1 lds
    s_waitcnt lgkmcnt(3)
    v_mfma_f32_32x32x16_bf16 v[16:31], a[4:7], v[52:55], v[16:31]
    ds_read_b128 v[52:55], v3 offset:5120
    s_add_u32 m0, s60, 1024
    s_add_u32 s54, s59, 1024
    buffer_load_dwordx4 v0, s[8:11], s54 offen sc1 lds
    s_waitcnt lgkmcnt(3)
    v_mfma_f32_32x32x16_bf16 v[16:31], a[8:11], v[56:59], v[16:31]
    ds_read_b128 v[56:59], v3 offset:6144
    s_add_u32 m0, s60, 2048
    s_add_u32 s54, s59, 2048
    buffer_load_dwordx4 v0, s[8:11], s54 offen sc1 lds
    s_waitcnt lgkmcnt(3)
    v_mfma_f32_32x32x16_bf16 v[16:31], a[12:15], v[60:63], v[16:31]
    ds_read_b128 v[60:63], v3 offset:7168
    s_add_u32 m0, s60, 3072
    s_add_u32 s54, s59, 3072
    buffer_load_dwordx4 v0, s[8:11], s54 offen sc1 lds
    s_waitcnt lgkmcnt(3)
    v_mfma_f32_32x32x16_bf16 v[16:31], a[16:19], v[48:51], v[16:31]
    ds_read_b128 v[48:51], v3 offset:8192
    s_add_u32 m0, s60, 4096
    s_add_u32 s54, s59, 4096
    buffer_load_dwordx4 v0, s[8:11], s54 offen sc1 lds
    s_waitcnt lgkmcnt(3)
    v_mfma_f32_32x32x16_bf16 v[16:31], a[20:23], v[52:55], v[16:31]
    ds_read_b128 v[52:55], v3 offset:9216
    s_add_u32 m0, s60, 5120
    s_add_u32 s54, s59, 5120
    buffer_load_dwordx4 v0, s[8:11], s54 offen sc1 lds
    s_waitcnt lgkmcnt(3)
    v_mfma_f32_32x32x16_bf16 v[16:31], a[24:27], v[56:59], v[16:31]
    ds_read_b128 v[56:59], v3 offset:10240
    s_add_u32 m0, s60, 6144
    s_add_u32 s54, s59, 6144
    buffer_load_dwordx4 v0, s[8:11], s54 offen sc1 lds
    s_waitcnt lgkmcnt(3)
    v_mfma_f32_32x32x16_bf16 v[16:31], a[28:31], v[60:63], v[16:31]
    ds_read_b128 v[60:63], v3 offset:11264
    s_add_u32 m0, s60, 7168
    s_add_u32 s54, s59, 7168
    buffer_load_dwordx4 v0, s[8:11], s54 offen sc1 lds
    s_waitcnt lgkmcnt(3)
    v_mfma_f32_32x32x16_bf16 v[16:31], a[32:35], v[48:51], v[16:31]
    ds_read_b128 v[48:51], v3 offset:12288
    s_add_u32 m0, s60, 8192
    s_add_u32 s54, s59, 8192
    buffer_load_dwordx4 v0, s[8:11], s54 offen sc1 lds
    s_add_u32 s59, s59, 36864
    s_add_u32 s60, s60, 36864
    s_cmp_ge_u32 s60, 147456
    s_cselect_b32 s54, 147456, 0
    s_sub_u32 s60, s60, s54
    s_waitcnt lgkmcnt(3)
    v_mfma_f32_32x32x16_bf16 v[16:31], a[36:39], v[52:55], v[16:31]
    ds_read_b128 v[52:55], v3 offset:13312
    v_cvt_pk_bf16_f32 v64, v32, v33
    s_waitcnt lgkmcnt(3)
    v_mfma_f32_32x32x16_bf16 v[16:31], a[40:43], v[56:59], v[16:31]
    ds_read_b128 v[56:59], v3 offset:14336
    v_cvt_pk_bf16_f32 v65, v34, v35
    s_waitcnt lgkmcnt(3)
    v_mfma_f32_32x32x16_bf16 v[16:31], a[44:47], v[60:63], v[16:31]
    ds_read_b128 v[60:63], v3 offset:15360
    v_cvt_pk_bf16_f32 v66, v36, v37
    s_waitcnt lgkmcnt(3)
    v_mfma_f32_32x32x16_bf16 v[16:31], a[48:51], v[48:51], v[16:31]
    ds_read_b128 v[48:51], v3 offset:16384
    v_cvt_pk_bf16_f32 v67, v38, v39
    s_waitcnt lgkmcnt(3)
    v_mfma_f32_32x32x16_bf16 v[16:31], a[52:55], v[52:55], v[16:31]
    ds_read_b128 v[52:55], v3 offset:17408
    buffer_store_dwordx4 v[64:67], v2, s[8:11], s58 offen offset:0 sc1
    s_waitcnt lgkmcnt(3)
    v_mfma_f32_32x32x16_bf16 v[16:31], a[56:59], v[56:59], v[16:31]
    ds_read_b128 v[56:59], v3 offset:18432
    v_cvt_pk_bf16_f32 v68, v40, v41
    s_waitcnt lgkmcnt(3)
    v_mfma_f32_32x32x16_bf16 v[16:31], a[60:63], v[60:63], v[16:31]
    ds_read_b128 v[60:63], v3 offset:19456
    v_cvt_pk_bf16_f32 v69, v42, v43
    s_waitcnt lgkmcnt(3)
    v_mfma_f32_32x32x16_bf16 v[16:31], a[64:67], v[48:51], v[16:31]
    ds_read_b128 v[48:51], v3 offset:20480
    v_cvt_pk_bf16_f32 v70, v44, v45
    s_waitcnt lgkmcnt(3)
    v_mfma_f32_32x32x16_bf16 v[16:31], a[68:71], v[52:55], v[16:31]
    ds_read_b128 v[52:55], v3 offset:21504
    v_cvt_pk_bf16_f32 v71, v46, v47
    s_waitcnt lgkmcnt(3)
    v_mfma_f32_32x32x16_bf16 v[16:31], a[72:75], v[56:59], v[16:31]
    ds_read_b128 v[56:59], v3 offset:22528
    buffer_store_dwordx4 v[68:71], v2, s[8:11], s58 offen offset:512 sc1
    s_waitcnt lgkmcnt(3)
    v_mfma_f32_32x32x16_bf16 v[16:31], a[76:79], v[60:63], v[16:31]
    ds_read_b128 v[60:63], v3 offset:23552
    s_add_u32 s58, s58, 524288
    s_waitcnt lgkmcnt(3)
    v_mfma_f32_32x32x16_bf16 v[16:31], a[80:83], v[48:51], v[16:31]
    ds_read_b128 v[48:51], v3 offset:24576
    s_waitcnt lgkmcnt(3)
    v_mfma_f32_32x32x16_bf16 v[16:31], a[84:87], v[52:55], v[16:31]
    ds_read_b128 v[52:55], v3 offset:25600
    s_waitcnt lgkmcnt(3)
    v_mfma_f32_32x32x16_bf16 v[16:31], a[88:91], v[56:59], v[16:31]
    ds_read_b128 v[56:59], v3 offset:26624
    s_waitcnt lgkmcnt(3)
    v_mfma_f32_32x32x16_bf16 v[16:31], a[92:95], v[60:63], v[16:31]
    ds_read_b128 v[60:63], v3 offset:27648
    s_waitcnt lgkmcnt(3)
    v_mfma_f32_32x32x16_bf16 v[16:31], a[96:99], v[48:51], v[16:31]
    ds_read_b128 v[48:51], v3 offset:28672
    s_waitcnt lgkmcnt(3)
    v_mfma_f32_32x32x16_bf16 v[16:31], a[100:103], v[52:55], v[16:31]
    ds_read_b128 v[52:55], v3 offset:29696
    s_waitcnt lgkmcnt(3)
    v_mfma_f32_32x32x16_bf16 v[16:31], a[104:107], v[56:59], v[16:31]
    ds_read_b128 v[56:59], v3 offset:30720
    s_waitcnt lgkmcnt(3)
    v_mfma_f32_32x32x16_bf16 v[16:31], a[108:111], v[60:63], v[16:31]
    ds_read_b128 v[60:63], v3 offset:31744
    s_waitcnt lgkmcnt(3)
    v_mfma_f32_32x32x16_bf16 v[16:31], a[112:115], v[48:51], v[16:31]
    ds_read_b128 v[48:51], v3 offset:32768
    s_waitcnt lgkmcnt(3)
    v_mfma_f32_32x32x16_bf16 v[16:31], a[116:119], v[52:55], v[16:31]
    ds_read_b128 v[52:55], v3 offset:33792
    s_waitcnt lgkmcnt(3)
    v_mfma_f32_32x32x16_bf16 v[16:31], a[120:123], v[56:59], v[16:31]
    ds_read_b128 v[56:59], v3 offset:34816
    s_waitcnt lgkmcnt(3)
    v_mfma_f32_32x32x16_bf16 v[16:31], a[124:127], v[60:63], v[16:31]
    ds_read_b128 v[60:63], v3 offset:35840
    s_waitcnt lgkmcnt(3)
    v_mfma_f32_32x32x16_bf16 v[16:31], a[128:131], v[48:51], v[16:31]
    s_waitcnt lgkmcnt(2)
    v_mfma_f32_32x32x16_bf16 v[16:31], a[132:135], v[52:55], v[16:31]
    s_waitcnt lgkmcnt(1)
    v_mfma_f32_32x32x16_bf16 v[16:31], a[136:139], v[56:59], v[16:31]
    s_waitcnt lgkmcnt(0)
    v_mfma_f32_32x32x16_bf16 v[16:31], a[140:143], v[60:63], v[16:31]
    v_add_u32 v3, 36864, v3
    v_subrev_u32 v4, 147456, v3
    v_min_u32_e64 v3, v3, v4
    s_add_u32 s53, s53, 1
    s_branch L_pj_44
L_pj_44_end:
    s_nop 7
    s_nop 3
    v_cvt_pk_bf16_f32 v64, v32, v33
    v_cvt_pk_bf16_f32 v65, v34, v35
    v_cvt_pk_bf16_f32 v66, v36, v37
    v_cvt_pk_bf16_f32 v67, v38, v39
    buffer_store_dwordx4 v[64:67], v2, s[8:11], s58 offen offset:0 sc1
    v_cvt_pk_bf16_f32 v68, v40, v41
    v_cvt_pk_bf16_f32 v69, v42, v43
    v_cvt_pk_bf16_f32 v70, v44, v45
    v_cvt_pk_bf16_f32 v71, v46, v47
    buffer_store_dwordx4 v[68:71], v2, s[8:11], s58 offen offset:512 sc1
    s_add_u32 s58, s58, 524288
    s_waitcnt vmcnt(0)
    v_mov_b32_e64 v5, 64
    s_mov_b64 exec, 1
    buffer_store_dword v5, off, s[8:11], s57 sc1
    s_mov_b64 exec, -1
    s_mov_b32 s76, 25
    s_barrier
    s_branch L_roleQ
L_notK:
    s_sub_u32 s52, s52, 32
    s_cmp_ge_u32 s52, 32
    s_cbranch_scc1 L_notV
    v_lshrrev_b32 v1, 4, v0
    v_lshrrev_b32 v2, 4, v1
    v_and_b32 v3, 15, v1
    v_lshlrev_b32 v4, 2, v2
    v_xor_b32 v3, v3, v4
    v_mul_u32_u24 v2, 8192, v2
    v_lshl_add_u32 v4, v3, 4, v2
    s_mul_i32 s54, s4, 1179648
    s_lshl_b32 s55, s52, 8
    s_add_u32 s54, s54, s55
    s_mul_i32 s55, s4, 36864
    s_mov_b32 m0, s55
    s_add_u32 s55, s55, 1024
    buffer_load_dwordx4 v4, s[20:23], s54 offen lds
    s_add_u32 s54, s54, 32768
    s_mov_b32 m0, s55
    s_add_u32 s55, s55, 1024
    buffer_load_dwordx4 v4, s[20:23], s54 offen lds
    s_add_u32 s54, s54, 32768
    s_mov_b32 m0, s55
    s_add_u32 s55, s55, 1024
    buffer_load_dwordx4 v4, s[20:23], s54 offen lds
    s_add_u32 s54, s54, 32768
    s_mov_b32 m0, s55
    s_add_u32 s55, s55, 1024
    buffer_load_dwordx4 v4, s[20:23], s54 offen lds
    s_add_u32 s54, s54, 32768
    s_mov_b32 m0, s55
    s_add_u32 s55, s55, 1024
    buffer_load_dwordx4 v4, s[20:23], s54 offen lds
    s_add_u32 s54, s54, 32768
    s_mov_b32 m0, s55
    s_add_u32 s55, s55, 1024
    buffer_load_dwordx4 v4, s[20:23], s54 offen lds
    s_add_u32 s54, s54, 32768
    s_mov_b32 m0, s55
    s_add_u32 s55, s55, 1024
    buffer_load_dwordx4 v4, s[20:23], s54 offen lds
    s_add_u32 s54, s54, 32768
    s_mov_b32 m0, s55
    s_add_u32 s55, s55, 1024
    buffer_load_dwordx4 v4, s[20:23], s54 offen lds
    s_add_u32 s54, s54, 32768
    s_mov_b32 m0, s55
    s_add_u32 s55, s55, 1024
    buffer_load_dwordx4 v4, s[20:23], s54 offen lds
    s_add_u32 s54, s54, 32768
    s_mov_b32 m0, s55
    s_add_u32 s55, s55, 1024
    buffer_load_dwordx4 v4, s[20:23], s54 offen lds
    s_add_u32 s54, s54, 32768
    s_mov_b32 m0, s55
    s_add_u32 s55, s55, 1024
    buffer_load_dwordx4 v4, s[20:23], s54 offen lds
    s_add_u32 s54, s54, 32768
    s_mov_b32 m0, s55
    s_add_u32 s55, s55, 1024
    buffer_load_dwordx4 v4, s[20:23], s54 offen lds
    s_add_u32 s54, s54, 32768
    s_mov_b32 m0, s55
    s_add_u32 s55, s55, 1024
    buffer_load_dwordx4 v4, s[20:23], s54 offen lds
    s_add_u32 s54, s54, 32768
    s_mov_b32 m0, s55
    s_add_u32 s55, s55, 1024
    buffer_load_dwordx4 v4, s[20:23], s54 offen lds
    s_add_u32 s54, s54, 32768
    s_mov_b32 m0, s55
    s_add_u32 s55, s55, 1024
    buffer_load_dwordx4 v4, s[20:23], s54 offen lds
    s_add_u32 s54, s54, 32768
    s_mov_b32 m0, s55
    s_add_u32 s55, s55, 1024
    buffer_load_dwordx4 v4, s[20:23], s54 offen lds
    s_add_u32 s54, s54, 32768
    s_mov_b32 m0, s55
    s_add_u32 s55, s55, 1024
    buffer_load_dwordx4 v4, s[20:23], s54 offen lds
    s_add_u32 s54, s54, 32768
    s_mov_b32 m0, s55
    s_add_u32 s55, s55, 1024
    buffer_load_dwordx4 v4, s[20:23], s54 offen lds
    s_add_u32 s54, s54, 32768
    s_mov_b32 m0, s55
    s_add_u32 s55, s55, 1024
    buffer_load_dwordx4 v4, s[20:23], s54 offen lds
    s_add_u32 s54, s54, 32768
    s_mov_b32 m0, s55
    s_add_u32 s55, s55, 1024
    buffer_load_dwordx4 v4, s[20:23], s54 offen lds
    s_add_u32 s54, s54, 32768
    s_mov_b32 m0, s55
    s_add_u32 s55, s55, 1024
    buffer_load_dwordx4 v4, s[20:23], s54 offen lds
    s_add_u32 s54, s54, 32768
    s_mov_b32 m0, s55
    s_add_u32 s55, s55, 1024
    buffer_load_dwordx4 v4, s[20:23], s54 offen lds
    s_add_u32 s54, s54, 32768
    s_mov_b32 m0, s55
    s_add_u32 s55, s55, 1024
    buffer_load_dwordx4 v4, s[20:23], s54 offen lds
    s_add_u32 s54, s54, 32768
    s_mov_b32 m0, s55
    s_add_u32 s55, s55, 1024
    buffer_load_dwordx4 v4, s[20:23], s54 offen lds
    s_add_u32 s54, s54, 32768
    s_mov_b32 m0, s55
    s_add_u32 s55, s55, 1024
    buffer_load_dwordx4 v4, s[20:23], s54 offen lds
    s_add_u32 s54, s54, 32768
    s_mov_b32 m0, s55
    s_add_u32 s55, s55, 1024
    buffer_load_dwordx4 v4, s[20:23], s54 offen lds
    s_add_u32 s54, s54, 32768
    s_mov_b32 m0, s55
    s_add_u32 s55, s55, 1024
    buffer_load_dwordx4 v4, s[20:23], s54 offen lds
    s_add_u32 s54, s54, 32768
    s_mov_b32 m0, s55
    s_add_u32 s55, s55, 1024
    buffer_load_dwordx4 v4, s[20:23], s54 offen lds
    s_add_u32 s54, s54, 32768
    s_mov_b32 m0, s55
    s_add_u32 s55, s55, 1024
    buffer_load_dwordx4 v4, s[20:23], s54 offen lds
    s_add_u32 s54, s54, 32768
    s_mov_b32 m0, s55
    s_add_u32 s55, s55, 1024
    buffer_load_dwordx4 v4, s[20:23], s54 offen lds
    s_add_u32 s54, s54, 32768
    s_mov_b32 m0, s55
    s_add_u32 s55, s55, 1024
    buffer_load_dwordx4 v4, s[20:23], s54 offen lds
    s_add_u32 s54, s54, 32768
    s_mov_b32 m0, s55
    s_add_u32 s55, s55, 1024
    buffer_load_dwordx4 v4, s[20:23], s54 offen lds
    s_add_u32 s54, s54, 32768
    s_mov_b32 m0, s55
    s_add_u32 s55, s55, 1024
    buffer_load_dwordx4 v4, s[20:23], s54 offen lds
    s_add_u32 s54, s54, 32768
    s_mov_b32 m0, s55
    s_add_u32 s55, s55, 1024
    buffer_load_dwordx4 v4, s[20:23], s54 offen lds
    s_add_u32 s54, s54, 32768
    s_mov_b32 m0, s55
    s_add_u32 s55, s55, 1024
    buffer_load_dwordx4 v4, s[20:23], s54 offen lds
    s_add_u32 s54, s54, 32768
    s_mov_b32 m0, s55
    s_add_u32 s55, s55, 1024
    buffer_load_dwordx4 v4, s[20:23], s54 offen lds
    s_add_u32 s54, s54, 32768
    v_lshrrev_b32_e64 v5, 5, v1
    v_bfe_u32 v6, v1, 2, 2
    v_bfe_u32 v7, v1, 4, 1
    v_and_b32_e64 v8, 3, v1
    v_lshl_add_u32 v7, v7, 2, v8
    v_lshrrev_b32 v8, 1, v7
    s_lshl_b32 s54, s4, 2
    v_add_u32 v8, s54, v8
    v_lshlrev_b32 v9, 2, v6
    v_xor_b32 v8, v8, v9
    v_and_b32 v7, 1, v7
    v_lshlrev_b32_e64 v7, 3, v7
    v_lshl_add_u32 v7, v8, 4, v7
    v_lshl_add_u32 v5, v5, 3, v6
    v_lshl_add_u32 v5, v5, 8, v7
    s_waitcnt vmcnt(0)
    s_barrier
    ds_read_b64_tr_b16 a[0:1], v5 offset:0
    ds_read_b64_tr_b16 a[2:3], v5 offset:1024
    ds_read_b64_tr_b16 a[4:5], v5 offset:4096
    ds_read_b64_tr_b16 a[6:7], v5 offset:5120
    ds_read_b64_tr_b16 a[8:9], v5 offset:8192
    ds_read_b64_tr_b16 a[10:11], v5 offset:9216
    ds_read_b64_tr_b16 a[12:13], v5 offset:12288
    ds_read_b64_tr_b16 a[14:15], v5 offset:13312
    ds_read_b64_tr_b16 a[16:17], v5 offset:16384
    ds_read_b64_tr_b16 a[18:19], v5 offset:17408
    ds_read_b64_tr_b16 a[20:21], v5 offset:20480
    ds_read_b64_tr_b16 a[22:23], v5 offset:21504
    ds_read_b64_tr_b16 a[24:25], v5 offset:24576
    ds_read_b64_tr_b16 a[26:27], v5 offset:25600
    ds_read_b64_tr_b16 a[28:29], v5 offset:28672
    ds_read_b64_tr_b16 a[30:31], v5 offset:29696
    ds_read_b64_tr_b16 a[32:33], v5 offset:32768
    ds_read_b64_tr_b16 a[34:35], v5 offset:33792
    ds_read_b64_tr_b16 a[36:37], v5 offset:36864
    ds_read_b64_tr_b16 a[38:39], v5 offset:37888
    ds_read_b64_tr_b16 a[40:41], v5 offset:40960
    ds_read_b64_tr_b16 a[42:43], v5 offset:41984
    ds_read_b64_tr_b16 a[44:45], v5 offset:45056
    ds_read_b64_tr_b16 a[46:47], v5 offset:46080
    ds_read_b64_tr_b16 a[48:49], v5 offset:49152
    ds_read_b64_tr_b16 a[50:51], v5 offset:50176
    ds_read_b64_tr_b16 a[52:53], v5 offset:53248
    ds_read_b64_tr_b16 a[54:55], v5 offset:54272
    ds_read_b64_tr_b16 a[56:57], v5 offset:57344
    ds_read_b64_tr_b16 a[58:59], v5 offset:58368
    ds_read_b64_tr_b16 a[60:61], v5 offset:61440
    ds_read_b64_tr_b16 a[62:63], v5 offset:62464
    v_add_u32 v5, 0x10000, v5
    ds_read_b64_tr_b16 a[64:65], v5 offset:0
    ds_read_b64_tr_b16 a[66:67], v5 offset:1024
    ds_read_b64_tr_b16 a[68:69], v5 offset:4096
    ds_read_b64_tr_b16 a[70:71], v5 offset:5120
    ds_read_b64_tr_b16 a[72:73], v5 offset:8192
    ds_read_b64_tr_b16 a[74:75], v5 offset:9216
    ds_read_b64_tr_b16 a[76:77], v5 offset:12288
    ds_read_b64_tr_b16 a[78:79], v5 offset:13312
    ds_read_b64_tr_b16 a[80:81], v5 offset:16384
    ds_read_b64_tr_b16 a[82:83], v5 offset:17408
    ds_read_b64_tr_b16 a[84:85], v5 offset:20480
    ds_read_b64_tr_b16 a[86:87], v5 offset:21504
    ds_read_b64_tr_b16 a[88:89], v5 offset:24576
    ds_read_b64_tr_b16 a[90:91], v5 offset:25600
    ds_read_b64_tr_b16 a[92:93], v5 offset:28672
    ds_read_b64_tr_b16 a[94:95], v5 offset:29696
    ds_read_b64_tr_b16 a[96:97], v5 offset:32768
    ds_read_b64_tr_b16 a[98:99], v5 offset:33792
    ds_read_b64_tr_b16 a[100:101], v5 offset:36864
    ds_read_b64_tr_b16 a[102:103], v5 offset:37888
    ds_read_b64_tr_b16 a[104:105], v5 offset:40960
    ds_read_b64_tr_b16 a[106:107], v5 offset:41984
    ds_read_b64_tr_b16 a[108:109], v5 offset:45056
    ds_read_b64_tr_b16 a[110:111], v5 offset:46080
    ds_read_b64_tr_b16 a[112:113], v5 offset:49152
    ds_read_b64_tr_b16 a[114:115], v5 offset:50176
    ds_read_b64_tr_b16 a[116:117], v5 offset:53248
    ds_read_b64_tr_b16 a[118:119], v5 offset:54272
    ds_read_b64_tr_b16 a[120:121], v5 offset:57344
    ds_read_b64_tr_b16 a[122:123], v5 offset:58368
    ds_read_b64_tr_b16 a[124:125], v5 offset:61440
    ds_read_b64_tr_b16 a[126:127], v5 offset:62464
    v_add_u32 v5, 0x10000, v5
    ds_read_b64_tr_b16 a[128:129], v5 offset:0
    ds_read_b64_tr_b16 a[130:131], v5 offset:1024
    ds_read_b64_tr_b16 a[132:133], v5 offset:4096
    ds_read_b64_tr_b16 a[134:135], v5 offset:5120
    ds_read_b64_tr_b16 a[136:137], v5 offset:8192
    ds_read_b64_tr_b16 a[138:139], v5 offset:9216
    ds_read_b64_tr_b16 a[140:141], v5 offset:12288
    ds_read_b64_tr_b16 a[142:143], v5 offset:13312
    v_lshlrev_b32_e64 v6, 3, v0
    s_mov_b32 s61, 0
    s_mov_b32 s54, 1
    s_mov_b32 s55, 16384
    s_cmp_ge_u32 s61, s54
    s_cbranch_scc1 L_wd_46
    s_mov_b32 s79, 524288
L_w_45:
    buffer_load_dwordx4 v[8:11], v6, s[8:11], s55 offen sc1
    s_waitcnt vmcnt(0)
    v_min3_u32 v8, v8, v9, v10
    v_min_u32 v8, v8, v11
    v_cmp_gt_u32 vcc, s54, v8
    s_cbranch_vccz L_wo_47
    s_sub_u32 s79, s79, 1
    s_cbranch_scc1 L_fail
    s_branch L_w_45
L_wo_47:
    s_nop 1
    v_min_u32_dpp v8, v8, v8 quad_perm:[1,0,3,2] row_mask:0xf bank_mask:0xf
    s_nop 1
    v_min_u32_dpp v8, v8, v8 quad_perm:[2,3,0,1] row_mask:0xf bank_mask:0xf
    s_nop 1
    v_min_u32_dpp v8, v8, v8 row_half_mirror row_mask:0xf bank_mask:0xf
    s_nop 1
    v_min_u32_dpp v8, v8, v8 row_mirror row_mask:0xf bank_mask:0xf
    s_nop 0
    v_readlane_b32 s61, v8, 0
    v_readlane_b32 s56, v8, 16
    s_min_u32 s61, s61, s56
    v_readlane_b32 s56, v8, 32
    s_min_u32 s61, s61, s56
    v_readlane_b32 s56, v8, 48
    s_min_u32 s61, s61, s56
L_wd_46:
    s_waitcnt lgkmcnt(0)
    s_barrier
    v_bfe_u32 v2, v1, 4, 1
    v_lshlrev_b32 v2, 10, v2
    v_lshrrev_b32_e64 v3, 5, v1
    v_lshl_add_u32 v2, v3, 8, v2
    v_and_b32 v3, 0xf0, v0
    v_add_u32_e64 v2, v2, v3
    s_mul_i32 s60, s4, 9216
    s_add_u32 s59, s60, 1048576
    s_lshl_b32 s54, s52, 7
    s_lshl_b32 s55, s4, 2
    s_add_u32 s57, s54, s55
    s_add_u32 s57, s57, 4096
    s_lshl_b32 s54, s52, 2
    s_add_u32 s54, s54, s4
    s_lshl_b32 s58, s54, 12
    s_add_u32 s58, s58, 4196352
    v_mov_b32 v3, v0
    v_mov_b32 v6, 0
    s_mov_b32 s62, 0
    s_lshl_b32 s69, s52, 7
    s_add_u32 s69, s69, 8204
    s_add_u32 m0, s60, 0
    s_add_u32 s54, s59, 0
    buffer_load_dwordx4 v0, s[8:11], s54 offen sc1 lds
    s_add_u32 m0, s60, 1024
    s_add_u32 s54, s59, 1024
    buffer_load_dwordx4 v0, s[8:11], s54 offen sc1 lds
    s_add_u32 m0, s60, 2048
    s_add_u32 s54, s59, 2048
    buffer_load_dwordx4 v0, s[8:11], s54 offen sc1 lds
    s_add_u32 m0, s60, 3072
    s_add_u32 s54, s59, 3072
    buffer_load_dwordx4 v0, s[8:11], s54 offen sc1 lds
    s_add_u32 m0, s60, 4096
    s_add_u32 s54, s59, 4096
    buffer_load_dwordx4 v0, s[8:11], s54 offen sc1 lds
    s_add_u32 m0, s60, 5120
    s_add_u32 s54, s59, 5120
    buffer_load_dwordx4 v0, s[8:11], s54 offen sc1 lds
    s_add_u32 m0, s60, 6144
    s_add_u32 s54, s59, 6144
    buffer_load_dwordx4 v0, s[8:11], s54 offen sc1 lds
    s_add_u32 m0, s60, 7168
    s_add_u32 s54, s59, 7168
    buffer_load_dwordx4 v0, s[8:11], s54 offen sc1 lds
    s_add_u32 m0, s60, 8192
    s_add_u32 s54, s59, 8192
    buffer_load_dwordx4 v0, s[8:11], s54 offen sc1 lds
    s_add_u32 s59, s59, 36864
    s_add_u32 s60, s60, 36864
    s_cmp_ge_u32 s60, 147456
    s_cselect_b32 s54, 147456, 0
    s_sub_u32 s60, s60, s54
    s_add_u32 m0, s60, 0
    s_add_u32 s54, s59, 0
    buffer_load_dwordx4 v0, s[8:11], s54 offen sc1 lds
    s_add_u32 m0, s60, 1024
    s_add_u32 s54, s59, 1024
    buffer_load_dwordx4 v0, s[8:11], s54 offen sc1 lds
    s_add_u32 m0, s60, 2048
    s_add_u32 s54, s59, 2048
    buffer_load_dwordx4 v0, s[8:11], s54 offen sc1 lds
    s_add_u32 m0, s60, 3072
    s_add_u32 s54, s59, 3072
    buffer_load_dwordx4 v0, s[8:11], s54 offen sc1 lds
    s_add_u32 m0, s60, 4096
    s_add_u32 s54, s59, 4096
    buffer_load_dwordx4 v0, s[8:11], s54 offen sc1 lds
    s_add_u32 m0, s60, 5120
    s_add_u32 s54, s59, 5120
    buffer_load_dwordx4 v0, s[8:11], s54 offen sc1 lds
    s_add_u32 m0, s60, 6144
    s_add_u32 s54, s59, 6144
    buffer_load_dwordx4 v0, s[8:11], s54 offen sc1 lds
    s_add_u32 m0, s60, 7168
    s_add_u32 s54, s59, 7168
    buffer_load_dwordx4 v0, s[8:11], s54 offen sc1 lds
    s_add_u32 m0, s60, 8192
    s_add_u32 s54, s59, 8192
    buffer_load_dwordx4 v0, s[8:11], s54 offen sc1 lds
    s_add_u32 s59, s59, 36864
    s_add_u32 s60, s60, 36864
    s_cmp_ge_u32 s60, 147456
    s_cselect_b32 s54, 147456, 0
    s_sub_u32 s60, s60, s54
    s_add_u32 m0, s60, 0
    s_add_u32 s54, s59, 0
    buffer_load_dwordx4 v0, s[8:11], s54 offen sc1 lds
    s_add_u32 m0, s60, 1024
    s_add_u32 s54, s59, 1024
    buffer_load_dwordx4 v0, s[8:11], s54 offen sc1 lds
    s_add_u32 m0, s60, 2048
    s_add_u32 s54, s59, 2048
    buffer_load_dwordx4 v0, s[8:11], s54 offen sc1 lds
    s_add_u32 m0, s60, 3072
    s_add_u32 s54, s59, 3072
    buffer_load_dwordx4 v0, s[8:11], s54 offen sc1 lds
    s_add_u32 m0, s60, 4096
    s_add_u32 s54, s59, 4096
    buffer_load_dwordx4 v0, s[8:11], s54 offen sc1 lds
    s_add_u32 m0, s60, 5120
    s_add_u32 s54, s59, 5120
    buffer_load_dwordx4 v0, s[8:11], s54 offen sc1 lds
    s_add_u32 m0, s60, 6144
    s_add_u32 s54, s59, 6144
    buffer_load_dwordx4 v0, s[8:11], s54 offen sc1 lds
    s_add_u32 m0, s60, 7168
    s_add_u32 s54, s59, 7168
    buffer_load_dwordx4 v0, s[8:11], s54 offen sc1 lds
    s_add_u32 m0, s60, 8192
    s_add_u32 s54, s59, 8192
    buffer_load_dwordx4 v0, s[8:11], s54 offen sc1 lds
    s_add_u32 s59, s59, 36864
    s_add_u32 s60, s60, 36864
    s_cmp_ge_u32 s60, 147456
    s_cselect_b32 s54, 147456, 0
    s_sub_u32 s60, s60, s54
    s_mov_b32 s53, 0
    s_waitcnt vmcnt(18)
    s_barrier
    ds_read_b128 v[48:51], v3 offset:0
    ds_read_b128 v[52:55], v3 offset:1024
    ds_read_b128 v[56:59], v3 offset:2048
    ds_read_b128 v[60:63], v3 offset:3072
    s_waitcnt lgkmcnt(3)
    v_mfma_f32_32x32x16_bf16 v[16:31], v[48:51], a[0:3], 0
    ds_read_b128 v[48:51], v3 offset:4096
    s_waitcnt lgkmcnt(3)
    v_mfma_f32_32x32x16_bf16 v[16:31], v[52:55], a[4:7], v[16:31]
    ds_read_b128 v[52:55], v3 offset:5120
    s_waitcnt lgkmcnt(3)
    v_mfma_f32_32x32x16_bf16 v[16:31], v[56:59], a[8:11], v[16:31]
    ds_read_b128 v[56:59], v3 offset:6144
    s_add_u32 m0, s60, 0
    s_add_u32 s54, s59, 0
    buffer_load_dwordx4 v0, s[8:11], s54 offen sc1 lds
    s_waitcnt lgkmcnt(3)
    v_mfma_f32_32x32x16_bf16 v[16:31], v[60:63], a[12:15], v[16:31]
    ds_read_b128 v[60:63], v3 offset:7168
    s_waitcnt lgkmcnt(3)
    v_mfma_f32_32x32x16_bf16 v[16:31], v[48:51], a[16:19], v[16:31]
    ds_read_b128 v[48:51], v3 offset:8192
    s_waitcnt lgkmcnt(3)
    v_mfma_f32_32x32x16_bf16 v[16:31], v[52:55], a[20:23], v[16:31]
    ds_read_b128 v[52:55], v3 offset:9216
    s_add_u32 m0, s60, 1024
    s_add_u32 s54, s59, 1024
    buffer_load_dwordx4 v0, s[8:11], s54 offen sc1 lds
    s_waitcnt lgkmcnt(3)
    v_mfma_f32_32x32x16_bf16 v[16:31], v[56:59], a[24:27], v[16:31]
    ds_read_b128 v[56:59], v3 offset:10240
    s_waitcnt lgkmcnt(3)
    v_mfma_f32_32x32x16_bf16 v[16:31], v[60:63], a[28:31], v[16:31]
    ds_read_b128 v[60:63], v3 offset:11264
    s_waitcnt lgkmcnt(3)
    v_mfma_f32_32x32x16_bf16 v[16:31], v[48:51], a[32:35], v[16:31]
    ds_read_b128 v[48:51], v3 offset:12288
    s_add_u32 m0, s60, 2048
    s_add_u32 s54, s59, 2048
    buffer_load_dwordx4 v0, s[8:11], s54 offen sc1 lds
    s_waitcnt lgkmcnt(3)
    v_mfma_f32_32x32x16_bf16 v[16:31], v[52:55], a[36:39], v[16:31]
    ds_read_b128 v[52:55], v3 offset:13312
    s_waitcnt lgkmcnt(3)
    v_mfma_f32_32x32x16_bf16 v[16:31], v[56:59], a[40:43], v[16:31]
    ds_read_b128 v[56:59], v3 offset:14336
    s_waitcnt lgkmcnt(3)
    v_mfma_f32_32x32x16_bf16 v[16:31], v[60:63], a[44:47], v[16:31]
    ds_read_b128 v[60:63], v3 offset:15360
    s_add_u32 m0, s60, 3072
    s_add_u32 s54, s59, 3072
    buffer_load_dwordx4 v0, s[8:11], s54 offen sc1 lds
    s_waitcnt lgkmcnt(3)
    v_mfma_f32_32x32x16_bf16 v[16:31], v[48:51], a[48:51], v[16:31]
    ds_read_b128 v[48:51], v3 offset:16384
    s_waitcnt lgkmcnt(3)
    v_mfma_f32_32x32x16_bf16 v[16:31], v[52:55], a[52:55], v[16:31]
    ds_read_b128 v[52:55], v3 offset:17408
    s_waitcnt lgkmcnt(3)
    v_mfma_f32_32x32x16_bf16 v[16:31], v[56:59], a[56:59], v[16:31]
    ds_read_b128 v[56:59], v3 offset:18432
    s_add_u32 m0, s60, 4096
    s_add_u32 s54, s59, 4096
    buffer_load_dwordx4 v0, s[8:11], s54 offen sc1 lds
    s_waitcnt lgkmcnt(3)
    v_mfma_f32_32x32x16_bf16 v[16:31], v[60:63], a[60:63], v[16:31]
    ds_read_b128 v[60:63], v3 offset:19456
    s_waitcnt lgkmcnt(3)
    v_mfma_f32_32x32x16_bf16 v[16:31], v[48:51], a[64:67], v[16:31]
    ds_read_b128 v[48:51], v3 offset:20480
    s_waitcnt lgkmcnt(3)
    v_mfma_f32_32x32x16_bf16 v[16:31], v[52:55], a[68:71], v[16:31]
    ds_read_b128 v[52:55], v3 offset:21504
    s_add_u32 m0, s60, 5120
    s_add_u32 s54, s59, 5120
    buffer_load_dwordx4 v0, s[8:11], s54 offen sc1 lds
    s_waitcnt lgkmcnt(3)
    v_mfma_f32_32x32x16_bf16 v[16:31], v[56:59], a[72:75], v[16:31]
    ds_read_b128 v[56:59], v3 offset:22528
    s_waitcnt lgkmcnt(3)
    v_mfma_f32_32x32x16_bf16 v[16:31], v[60:63], a[76:79], v[16:31]
    ds_read_b128 v[60:63], v3 offset:23552
    s_waitcnt lgkmcnt(3)
    v_mfma_f32_32x32x16_bf16 v[16:31], v[48:51], a[80:83], v[16:31]
    ds_read_b128 v[48:51], v3 offset:24576
    s_add_u32 m0, s60, 6144
    s_add_u32 s54, s59, 6144
    buffer_load_dwordx4 v0, s[8:11], s54 offen sc1 lds
    s_waitcnt lgkmcnt(3)
    v_mfma_f32_32x32x16_bf16 v[16:31], v[52:55], a[84:87], v[16:31]
    ds_read_b128 v[52:55], v3 offset:25600
    s_waitcnt lgkmcnt(3)
    v_mfma_f32_32x32x16_bf16 v[16:31], v[56:59], a[88:91], v[16:31]
    ds_read_b128 v[56:59], v3 offset:26624
    s_waitcnt lgkmcnt(3)
    v_mfma_f32_32x32x16_bf16 v[16:31], v[60:63], a[92:95], v[16:31]
    ds_read_b128 v[60:63], v3 offset:27648
    s_add_u32 m0, s60, 7168
    s_add_u32 s54, s59, 7168
    buffer_load_dwordx4 v0, s[8:11], s54 offen sc1 lds
    s_waitcnt lgkmcnt(3)
    v_mfma_f32_32x32x16_bf16 v[16:31], v[48:51], a[96:99], v[16:31]
    ds_read_b128 v[48:51], v3 offset:28672
    s_waitcnt lgkmcnt(3)
    v_mfma_f32_32x32x16_bf16 v[16:31], v[52:55], a[100:103], v[16:31]
    ds_read_b128 v[52:55], v3 offset:29696
    s_waitcnt lgkmcnt(3)
    v_mfma_f32_32x32x16_bf16 v[16:31], v[56:59], a[104:107], v[16:31]
    ds_read_b128 v[56:59], v3 offset:30720
    s_add_u32 m0, s60, 8192
    s_add_u32 s54, s59, 8192
    buffer_load_dwordx4 v0, s[8:11], s54 offen sc1 lds
    s_add_u32 s59, s59, 36864
    s_add_u32 s60, s60, 36864
    s_cmp_ge_u32 s60, 147456
    s_cselect_b32 s54, 147456, 0
    s_sub_u32 s60, s60, s54
    s_waitcnt lgkmcnt(3)
    v_mfma_f32_32x32x16_bf16 v[16:31], v[60:63], a[108:111], v[16:31]
    ds_read_b128 v[60:63], v3 offset:31744
    s_waitcnt lgkmcnt(3)
    v_mfma_f32_32x32x16_bf16 v[16:31], v[48:51], a[112:115], v[16:31]
    ds_read_b128 v[48:51], v3 offset:32768
    s_waitcnt lgkmcnt(3)
    v_mfma_f32_32x32x16_bf16 v[16:31], v[52:55], a[116:119], v[16:31]
    ds_read_b128 v[52:55], v3 offset:33792
    s_waitcnt lgkmcnt(3)
    v_mfma_f32_32x32x16_bf16 v[16:31], v[56:59], a[120:123], v[16:31]
    ds_read_b128 v[56:59], v3 offset:34816
    s_waitcnt lgkmcnt(3)
    v_mfma_f32_32x32x16_bf16 v[16:31], v[60:63], a[124:127], v[16:31]
    ds_read_b128 v[60:63], v3 offset:35840
    s_waitcnt lgkmcnt(3)
    v_mfma_f32_32x32x16_bf16 v[16:31], v[48:51], a[128:131], v[16:31]
    s_waitcnt lgkmcnt(2)
    v_mfma_f32_32x32x16_bf16 v[16:31], v[52:55], a[132:135], v[16:31]
    s_waitcnt lgkmcnt(1)
    v_mfma_f32_32x32x16_bf16 v[16:31], v[56:59], a[136:139], v[16:31]
    s_waitcnt lgkmcnt(0)
    v_mfma_f32_32x32x16_bf16 v[16:31], v[60:63], a[140:143], v[16:31]
    v_add_u32 v3, 36864, v3
    v_subrev_u32 v4, 147456, v3
    v_min_u32 v3, v3, v4
    s_waitcnt vmcnt(18)
    s_branch L_pj_in_48
L_pj_49:
    s_waitcnt vmcnt(12)
L_pj_in_48:
    s_barrier
    s_max_u32 s54, s53, 1
    s_sub_u32 s54, s54, 1
    v_mov_b32 v5, s54
    s_mov_b64 exec, 1
    buffer_store_dword v5, off, s[8:11], s57 sc1
    s_mov_b64 exec, -1
    ds_read_b128 v[48:51], v3 offset:0
    ds_read_b128 v[52:55], v3 offset:1024
    ds_read_b128 v[56:59], v3 offset:2048
    ds_read_b128 v[60:63], v3 offset:3072
    s_waitcnt lgkmcnt(3)
    v_mfma_f32_32x32x16_bf16 v[32:47], v[48:51], a[0:3], 0
    ds_read_b128 v[48:51], v3 offset:4096
    s_add_u32 m0, s60, 0
    s_add_u32 s54, s59, 0
    buffer_load_dwordx4 v0, s[8:11], s54 offen sc1 lds
    s_waitcnt lgkmcnt(3)
    v_mfma_f32_32x32x16_bf16 v[32:47], v[52:55], a[4:7], v[32:47]
    ds_read_b128 v[52:55], v3 offset:5120
    s_add_u32 m0, s60, 1024
    s_add_u32 s54, s59, 1024
    buffer_load_dwordx4 v0, s[8:11], s54 offen sc1 lds
    s_waitcnt lgkmcnt(3)
    v_mfma_f32_32x32x16_bf16 v[32:47], v[56:59], a[8:11], v[32:47]
    ds_read_b128 v[56:59], v3 offset:6144
    s_add_u32 m0, s60, 2048
    s_add_u32 s54, s59, 2048
    buffer_load_dwordx4 v0, s[8:11], s54 offen sc1 lds
    s_waitcnt lgkmcnt(3)
    v_mfma_f32_32x32x16_bf16 v[32:47], v[60:63], a[12:15], v[32:47]
    ds_read_b128 v[60:63], v3 offset:7168
    s_add_u32 m0, s60, 3072
    s_add_u32 s54, s59, 3072
    buffer_load_dwordx4 v0, s[8:11], s54 offen sc1 lds
    s_waitcnt lgkmcnt(3)
    v_mfma_f32_32x32x16_bf16 v[32:47], v[48:51], a[16:19], v[32:47]
    ds_read_b128 v[48:51], v3 offset:8192
    s_add_u32 m0, s60, 4096
    s_add_u32 s54, s59, 4096
    buffer_load_dwordx4 v0, s[8:11], s54 offen sc1 lds
    s_waitcnt lgkmcnt(3)
    v_mfma_f32_32x32x16_bf16 v[32:47], v[52:55], a[20:23], v[32:47]
    ds_read_b128 v[52:55], v3 offset:9216
    s_add_u32 m0, s60, 5120
    s_add_u32 s54, s59, 5120
    buffer_load_dwordx4 v0, s[8:11], s54 offen sc1 lds
    s_waitcnt lgkmcnt(3)
    v_mfma_f32_32x32x16_bf16 v[32:47], v[56:59], a[24:27], v[32:47]
    ds_read_b128 v[56:59], v3 offset:10240
    s_add_u32 m0, s60, 6144
    s_add_u32 s54, s59, 6144
    buffer_load_dwordx4 v0, s[8:11], s54 offen sc1 lds
    s_waitcnt lgkmcnt(3)
    v_mfma_f32_32x32x16_bf16 v[32:47], v[60:63], a[28:31], v[32:47]
    ds_read_b128 v[60:63], v3 offset:11264
    s_add_u32 m0, s60, 7168
    s_add_u32 s54, s59, 7168
    buffer_load_dwordx4 v0, s[8:11], s54 offen sc1 lds
    s_waitcnt lgkmcnt(3)
    v_mfma_f32_32x32x16_bf16 v[32:47], v[48:51], a[32:35], v[32:47]
    ds_read_b128 v[48:51], v3 offset:12288
    s_add_u32 m0, s60, 8192
    s_add_u32 s54, s59, 8192
    buffer_load_dwordx4 v0, s[8:11], s54 offen sc1 lds
    s_add_u32 s59, s59, 36864
    s_add_u32 s60, s60, 36864
    s_cmp_ge_u32 s60, 147456
    s_cselect_b32 s54, 147456, 0
    s_sub_u32 s60, s60, s54
    s_waitcnt lgkmcnt(3)
    v_mfma_f32_32x32x16_bf16 v[32:47], v[52:55], a[36:39], v[32:47]
    ds_read_b128 v[52:55], v3 offset:13312
    v_cvt_pk_bf16_f32 v64, v16, v17
    s_waitcnt lgkmcnt(3)
    v_mfma_f32_32x32x16_bf16 v[32:47], v[56:59], a[40:43], v[32:47]
    ds_read_b128 v[56:59], v3 offset:14336
    v_cvt_pk_bf16_f32 v65, v18, v19
    s_waitcnt lgkmcnt(3)
    v_mfma_f32_32x32x16_bf16 v[32:47], v[60:63], a[44:47], v[32:47]
    ds_read_b128 v[60:63], v3 offset:15360
    v_cvt_pk_bf16_f32 v66, v24, v25
    s_waitcnt lgkmcnt(3)
    v_mfma_f32_32x32x16_bf16 v[32:47], v[48:51], a[48:51], v[32:47]
    ds_read_b128 v[48:51], v3 offset:16384
    v_cvt_pk_bf16_f32 v67, v26, v27
    s_waitcnt lgkmcnt(3)
    v_mfma_f32_32x32x16_bf16 v[32:47], v[52:55], a[52:55], v[32:47]
    ds_read_b128 v[52:55], v3 offset:17408
    buffer_store_dwordx4 v[64:67], v2, s[8:11], s58 offen offset:0 sc1
    s_waitcnt lgkmcnt(3)
    v_mfma_f32_32x32x16_bf16 v[32:47], v[56:59], a[56:59], v[32:47]
    ds_read_b128 v[56:59], v3 offset:18432
    v_cvt_pk_bf16_f32 v68, v20, v21
    s_waitcnt lgkmcnt(3)
    v_mfma_f32_32x32x16_bf16 v[32:47], v[60:63], a[60:63], v[32:47]
    ds_read_b128 v[60:63], v3 offset:19456
    v_cvt_pk_bf16_f32 v69, v22, v23
    s_waitcnt lgkmcnt(3)
    v_mfma_f32_32x32x16_bf16 v[32:47], v[48:51], a[64:67], v[32:47]
    ds_read_b128 v[48:51], v3 offset:20480
    v_cvt_pk_bf16_f32 v70, v28, v29
    s_waitcnt lgkmcnt(3)
    v_mfma_f32_32x32x16_bf16 v[32:47], v[52:55], a[68:71], v[32:47]
    ds_read_b128 v[52:55], v3 offset:21504
    v_cvt_pk_bf16_f32 v71, v30, v31
    s_waitcnt lgkmcnt(3)
    v_mfma_f32_32x32x16_bf16 v[32:47], v[56:59], a[72:75], v[32:47]
    ds_read_b128 v[56:59], v3 offset:22528
    buffer_store_dwordx4 v[68:71], v2, s[8:11], s58 offen offset:512 sc1
    s_waitcnt lgkmcnt(3)
    v_mfma_f32_32x32x16_bf16 v[32:47], v[60:63], a[76:79], v[32:47]
    ds_read_b128 v[60:63], v3 offset:23552
    s_add_u32 s58, s58, 524288
    s_waitcnt lgkmcnt(3)
    v_mfma_f32_32x32x16_bf16 v[32:47], v[48:51], a[80:83], v[32:47]
    ds_read_b128 v[48:51], v3 offset:24576
    s_waitcnt lgkmcnt(3)
    v_mfma_f32_32x32x16_bf16 v[32:47], v[52:55], a[84:87], v[32:47]
    ds_read_b128 v[52:55], v3 offset:25600
    s_waitcnt lgkmcnt(3)
    v_mfma_f32_32x32x16_bf16 v[32:47], v[56:59], a[88:91], v[32:47]
    ds_read_b128 v[56:59], v3 offset:26624
    s_waitcnt lgkmcnt(3)
    v_mfma_f32_32x32x16_bf16 v[32:47], v[60:63], a[92:95], v[32:47]
    ds_read_b128 v[60:63], v3 offset:27648
    s_waitcnt lgkmcnt(3)
    v_mfma_f32_32x32x16_bf16 v[32:47], v[48:51], a[96:99], v[32:47]
    ds_read_b128 v[48:51], v3 offset:28672
    s_waitcnt lgkmcnt(3)
    v_mfma_f32_32x32x16_bf16 v[32:47], v[52:55], a[100:103], v[32:47]
    ds_read_b128 v[52:55], v3 offset:29696
    s_waitcnt lgkmcnt(3)
    v_mfma_f32_32x32x16_bf16 v[32:47], v[56:59], a[104:107], v[32:47]
    ds_read_b128 v[56:59], v3 offset:30720
    s_waitcnt lgkmcnt(3)
    v_mfma_f32_32x32x16_bf16 v[32:47], v[60:63], a[108:111], v[32:47]
    ds_read_b128 v[60:63], v3 offset:31744
    s_waitcnt lgkmcnt(3)
    v_mfma_f32_32x32x16_bf16 v[32:47], v[48:51], a[112:115], v[32:47]
    ds_read_b128 v[48:51], v3 offset:32768
    s_waitcnt lgkmcnt(3)
    v_mfma_f32_32x32x16_bf16 v[32:47], v[52:55], a[116:119], v[32:47]
    ds_read_b128 v[52:55], v3 offset:33792
    s_waitcnt lgkmcnt(3)
    v_mfma_f32_32x32x16_bf16 v[32:47], v[56:59], a[120:123], v[32:47]
    ds_read_b128 v[56:59], v3 offset:34816
    s_waitcnt lgkmcnt(3)
    v_mfma_f32_32x32x16_bf16 v[32:47], v[60:63], a[124:127], v[32:47]
    ds_read_b128 v[60:63], v3 offset:35840
    s_waitcnt lgkmcnt(3)
    v_mfma_f32_32x32x16_bf16 v[32:47], v[48:51], a[128:131], v[32:47]
    s_waitcnt lgkmcnt(2)
    v_mfma_f32_32x32x16_bf16 v[32:47], v[52:55], a[132:135], v[32:47]
    s_waitcnt lgkmcnt(1)
    v_mfma_f32_32x32x16_bf16 v[32:47], v[56:59], a[136:139], v[32:47]
    s_waitcnt lgkmcnt(0)
    v_mfma_f32_32x32x16_bf16 v[32:47], v[60:63], a[140:143], v[32:47]
    v_add_u32 v3, 36864, v3
    v_subrev_u32 v4, 147456, v3
    v_min_u32 v3, v3, v4
    s_add_u32 s53, s53, 1
    s_cmp_ge_u32 s53, 63
    s_cbranch_scc1 L_pj_49_end
    s_waitcnt vmcnt(12)
    s_barrier
    s_max_u32 s54, s53, 1
    s_sub_u32 s54, s54, 1
    v_mov_b32 v5, s54
    s_mov_b64 exec, 1
    buffer_store_dword v5, off, s[8:11], s57 sc1
    s_mov_b64 exec, -1
    ds_read_b128 v[48:51], v3 offset:0
    ds_read_b128 v[52:55], v3 offset:1024
    ds_read_b128 v[56:59], v3 offset:2048
    ds_read_b128 v[60:63], v3 offset:3072
    s_waitcnt lgkmcnt(3)
    v_mfma_f32_32x32x16_bf16 v[16:31], v[48:51], a[0:3], 0
    ds_read_b128 v[48:51], v3 offset:4096
    s_add_u32 m0, s60, 0
    s_add_u32 s54, s59, 0
    buffer_load_dwordx4 v0, s[8:11], s54 offen sc1 lds
    s_waitcnt lgkmcnt(3)
    v_mfma_f32_32x32x16_bf16 v[16:31], v[52:55], a[4:7], v[16:31]
    ds_read_b128 v[52:55], v3 offset:5120
    s_add_u32 m0, s60, 1024
    s_add_u32 s54, s59, 1024
    buffer_load_dwordx4 v0, s[8:11], s54 offen sc1 lds
    s_waitcnt lgkmcnt(3)
    v_mfma_f32_32x32x16_bf16 v[16:31], v[56:59], a[8:11], v[16:31]
    ds_read_b128 v[56:59], v3 offset:6144
    s_add_u32 m0, s60, 2048
    s_add_u32 s54, s59, 2048
    buffer_load_dwordx4 v0, s[8:11], s54 offen sc1 lds
    s_waitcnt lgkmcnt(3)
    v_mfma_f32_32x32x16_bf16 v[16:31], v[60:63], a[12:15], v[16:31]
    ds_read_b128 v[60:63], v3 offset:7168
    s_add_u32 m0, s60, 3072
    s_add_u32 s54, s59, 3072
    buffer_load_dwordx4 v0, s[8:11], s54 offen sc1 lds
    s_waitcnt lgkmcnt(3)
    v_mfma_f32_32x32x16_bf16 v[16:31], v[48:51], a[16:19], v[16:31]
    ds_read_b128 v[48:51], v3 offset:8192
    s_add_u32 m0, s60, 4096
    s_add_u32 s54, s59, 4096
    buffer_load_dwordx4 v0, s[8:11], s54 offen sc1 lds
    s_waitcnt lgkmcnt(3)
    v_mfma_f32_32x32x16_bf16 v[16:31], v[52:55], a[20:23], v[16:31]
    ds_read_b128 v[52:55], v3 offset:9216
    s_add_u32 m0, s60, 5120
    s_add_u32 s54, s59, 5120
    buffer_load_dwordx4 v0, s[8:11], s54 offen sc1 lds
    s_waitcnt lgkmcnt(3)
    v_mfma_f32_32x32x16_bf16 v[16:31], v[56:59], a[24:27], v[16:31]
    ds_read_b128 v[56:59], v3 offset:10240
    s_add_u32 m0, s60, 6144
    s_add_u32 s54, s59, 6144
    buffer_load_dwordx4 v0, s[8:11], s54 offen sc1 lds
    s_waitcnt lgkmcnt(3)
    v_mfma_f32_32x32x16_bf16 v[16:31], v[60:63], a[28:31], v[16:31]
    ds_read_b128 v[60:63], v3 offset:11264
    s_add_u32 m0, s60, 7168
    s_add_u32 s54, s59, 7168
    buffer_load_dwordx4 v0, s[8:11], s54 offen sc1 lds
    s_waitcnt lgkmcnt(3)
    v_mfma_f32_32x32x16_bf16 v[16:31], v[48:51], a[32:35], v[16:31]
    ds_read_b128 v[48:51], v3 offset:12288
    s_add_u32 m0, s60, 8192
    s_add_u32 s54, s59, 8192
    buffer_load_dwordx4 v0, s[8:11], s54 offen sc1 lds
    s_add_u32 s59, s59, 36864
    s_add_u32 s60, s60, 36864
    s_cmp_ge_u32 s60, 147456
    s_cselect_b32 s54, 147456, 0
    s_sub_u32 s60, s60, s54
    s_waitcnt lgkmcnt(3)
    v_mfma_f32_32x32x16_bf16 v[16:31], v[52:55], a[36:39], v[16:31]
    ds_read_b128 v[52:55], v3 offset:13312
    v_cvt_pk_bf16_f32 v64, v32, v33
    s_waitcnt lgkmcnt(3)
    v_mfma_f32_32x32x16_bf16 v[16:31], v[56:59], a[40:43], v[16:31]
    ds_read_b128 v[56:59], v3 offset:14336
    v_cvt_pk_bf16_f32 v65, v34, v35
    s_waitcnt lgkmcnt(3)
    v_mfma_f32_32x32x16_bf16 v[16:31], v[60:63], a[44:47], v[16:31]
    ds_read_b128 v[60:63], v3 offset:15360
    v_cvt_pk_bf16_f32 v66, v40, v41
    s_waitcnt lgkmcnt(3)
    v_mfma_f32_32x32x16_bf16 v[16:31], v[48:51], a[48:51], v[16:31]
    ds_read_b128 v[48:51], v3 offset:16384
    v_cvt_pk_bf16_f32 v67, v42, v43
    s_waitcnt lgkmcnt(3)
    v_mfma_f32_32x32x16_bf16 v[16:31], v[52:55], a[52:55], v[16:31]
    ds_read_b128 v[52:55], v3 offset:17408
    buffer_store_dwordx4 v[64:67], v2, s[8:11], s58 offen offset:0 sc1
    s_waitcnt lgkmcnt(3)
    v_mfma_f32_32x32x16_bf16 v[16:31], v[56:59], a[56:59], v[16:31]
    ds_read_b128 v[56:59], v3 offset:18432
    v_cvt_pk_bf16_f32 v68, v36, v37
    s_waitcnt lgkmcnt(3)
    v_mfma_f32_32x32x16_bf16 v[16:31], v[60:63], a[60:63], v[16:31]
    ds_read_b128 v[60:63], v3 offset:19456
    v_cvt_pk_bf16_f32 v69, v38, v39
    s_waitcnt lgkmcnt(3)
    v_mfma_f32_32x32x16_bf16 v[16:31], v[48:51], a[64:67], v[16:31]
    ds_read_b128 v[48:51], v3 offset:20480
    v_cvt_pk_bf16_f32 v70, v44, v45
    s_waitcnt lgkmcnt(3)
    v_mfma_f32_32x32x16_bf16 v[16:31], v[52:55], a[68:71], v[16:31]
    ds_read_b128 v[52:55], v3 offset:21504
    v_cvt_pk_bf16_f32 v71, v46, v47
    s_waitcnt lgkmcnt(3)
    v_mfma_f32_32x32x16_bf16 v[16:31], v[56:59], a[72:75], v[16:31]
    ds_read_b128 v[56:59], v3 offset:22528
    buffer_store_dwordx4 v[68:71], v2, s[8:11], s58 offen offset:512 sc1
    s_waitcnt lgkmcnt(3)
    v_mfma_f32_32x32x16_bf16 v[16:31], v[60:63], a[76:79], v[16:31]
    ds_read_b128 v[60:63], v3 offset:23552
    s_add_u32 s58, s58, 524288
    s_waitcnt lgkmcnt(3)
    v_mfma_f32_32x32x16_bf16 v[16:31], v[48:51], a[80:83], v[16:31]
    ds_read_b128 v[48:51], v3 offset:24576
    s_waitcnt lgkmcnt(3)
    v_mfma_f32_32x32x16_bf16 v[16:31], v[52:55], a[84:87], v[16:31]
    ds_read_b128 v[52:55], v3 offset:25600
    s_waitcnt lgkmcnt(3)
    v_mfma_f32_32x32x16_bf16 v[16:31], v[56:59], a[88:91], v[16:31]
    ds_read_b128 v[56:59], v3 offset:26624
    s_waitcnt lgkmcnt(3)
    v_mfma_f32_32x32x16_bf16 v[16:31], v[60:63], a[92:95], v[16:31]
    ds_read_b128 v[60:63], v3 offset:27648
    s_waitcnt lgkmcnt(3)
    v_mfma_f32_32x32x16_bf16 v[16:31], v[48:51], a[96:99], v[16:31]
    ds_read_b128 v[48:51], v3 offset:28672
    s_waitcnt lgkmcnt(3)
    v_mfma_f32_32x32x16_bf16 v[16:31], v[52:55], a[100:103], v[16:31]
    ds_read_b128 v[52:55], v3 offset:29696
    s_waitcnt lgkmcnt(3)
    v_mfma_f32_32x32x16_bf16 v[16:31], v[56:59], a[104:107], v[16:31]
    ds_read_b128 v[56:59], v3 offset:30720
    s_waitcnt lgkmcnt(3)
    v_mfma_f32_32x32x16_bf16 v[16:31], v[60:63], a[108:111], v[16:31]
    ds_read_b128 v[60:63], v3 offset:31744
    s_waitcnt lgkmcnt(3)
    v_mfma_f32_32x32x16_bf16 v[16:31], v[48:51], a[112:115], v[16:31]
    ds_read_b128 v[48:51], v3 offset:32768
    s_waitcnt lgkmcnt(3)
    v_mfma_f32_32x32x16_bf16 v[16:31], v[52:55], a[116:119], v[16:31]
    ds_read_b128 v[52:55], v3 offset:33792
    s_waitcnt lgkmcnt(3)
    v_mfma_f32_32x32x16_bf16 v[16:31], v[56:59], a[120:123], v[16:31]
    ds_read_b128 v[56:59], v3 offset:34816
    s_waitcnt lgkmcnt(3)
    v_mfma_f32_32x32x16_bf16 v[16:31], v[60:63], a[124:127], v[16:31]
    ds_read_b128 v[60:63], v3 offset:35840
    s_waitcnt lgkmcnt(3)
    v_mfma_f32_32x32x16_bf16 v[16:31], v[48:51], a[128:131], v[16:31]
    s_waitcnt lgkmcnt(2)
    v_mfma_f32_32x32x16_bf16 v[16:31], v[52:55], a[132:135], v[16:31]
    s_waitcnt lgkmcnt(1)
    v_mfma_f32_32x32x16_bf16 v[16:31], v[56:59], a[136:139], v[16:31]
    s_waitcnt lgkmcnt(0)
    v_mfma_f32_32x32x16_bf16 v[16:31], v[60:63], a[140:143], v[16:31]
    v_add_u32 v3, 36864, v3
    v_subrev_u32 v4, 147456, v3
    v_min_u32_e64 v3, v3, v4
    s_add_u32 s53, s53, 1
    s_branch L_pj_49
L_pj_49_end:
    s_nop 7
    s_nop 3
    v_cvt_pk_bf16_f32 v64, v32, v33
    v_cvt_pk_bf16_f32 v65, v34, v35
    v_cvt_pk_bf16_f32 v66, v40, v41
    v_cvt_pk_bf16_f32 v67, v42, v43
    buffer_store_dwordx4 v[64:67], v2, s[8:11], s58 offen offset:0 sc1
    v_cvt_pk_bf16_f32 v68, v36, v37
    v_cvt_pk_bf16_f32 v69, v38, v39
    v_cvt_pk_bf16_f32 v70, v44, v45
    v_cvt_pk_bf16_f32 v71, v46, v47
    buffer_store_dwordx4 v[68:71], v2, s[8:11], s58 offen offset:512 sc1
    s_add_u32 s58, s58, 524288
    s_waitcnt vmcnt(0)
    v_mov_b32_e64 v5, 64
    s_mov_b64 exec, 1
    buffer_store_dword v5, off, s[8:11], s57 sc1
    s_mov_b64 exec, -1
    s_cmp_lt_u32 s52, 18
    s_cbranch_scc1 L_toC
    s_endpgm
L_toC:
    s_mov_b32 s64, s52
    s_mov_b32 s63, 32
    s_barrier
    s_mov_b32 s84, -1
    s_branch L_roleC
L_notV:
    s_sub_u32 s52, s52, 32
    s_cmp_ge_u32 s52, 32
    s_cbranch_scc1 L_notQ
    s_mov_b32 s76, 0
L_roleQ:
    s_cmp_lg_u32 s4, 0
    s_cbranch_scc1 L_gook_51
    s_mov_b32 s79, 524288
    s_mov_b32 s55, 39936
L_go_50:
    buffer_load_dword v2, off, s[8:11], s55 sc1
    s_waitcnt vmcnt(0)
    v_readfirstlane_b32 s54, v2
    s_cmp_lg_u32 s54, 0
    s_cbranch_scc1 L_gook_51
    s_sleep 4
    s_sub_u32 s79, s79, 1
    s_cbranch_scc1 L_fail
    s_branch L_go_50
L_gook_51:
    s_barrier
    v_lshrrev_b32 v1, 4, v0
    v_lshrrev_b32 v2, 4, v1
    v_and_b32 v3, 15, v1
    v_lshlrev_b32 v4, 2, v2
    v_xor_b32_e64 v3, v3, v4
    v_mul_u32_u24 v2, 8192, v2
    v_lshl_add_u32 v4, v3, 4, v2
    s_mul_i32 s54, s4, 1179648
    s_lshl_b32 s55, s52, 8
    s_add_u32 s54, s54, s55
    s_mul_i32 s55, s4, 36864
    s_mov_b32 m0, s55
    s_add_u32 s55, s55, 1024
    buffer_load_dwordx4 v4, s[12:15], s54 offen lds
    s_add_u32 s54, s54, 32768
    s_mov_b32 m0, s55
    s_add_u32 s55, s55, 1024
    buffer_load_dwordx4 v4, s[12:15], s54 offen lds
    s_add_u32 s54, s54, 32768
    s_mov_b32 m0, s55
    s_add_u32 s55, s55, 1024
    buffer_load_dwordx4 v4, s[12:15], s54 offen lds
    s_add_u32 s54, s54, 32768
    s_mov_b32 m0, s55
    s_add_u32 s55, s55, 1024
    buffer_load_dwordx4 v4, s[12:15], s54 offen lds
    s_add_u32 s54, s54, 32768
    s_mov_b32 m0, s55
    s_add_u32 s55, s55, 1024
    buffer_load_dwordx4 v4, s[12:15], s54 offen lds
    s_add_u32 s54, s54, 32768
    s_mov_b32 m0, s55
    s_add_u32 s55, s55, 1024
    buffer_load_dwordx4 v4, s[12:15], s54 offen lds
    s_add_u32 s54, s54, 32768
    s_mov_b32 m0, s55
    s_add_u32 s55, s55, 1024
    buffer_load_dwordx4 v4, s[12:15], s54 offen lds
    s_add_u32 s54, s54, 32768
    s_mov_b32 m0, s55
    s_add_u32 s55, s55, 1024
    buffer_load_dwordx4 v4, s[12:15], s54 offen lds
    s_add_u32 s54, s54, 32768
    s_mov_b32 m0, s55
    s_add_u32 s55, s55, 1024
    buffer_load_dwordx4 v4, s[12:15], s54 offen lds
    s_add_u32 s54, s54, 32768
    s_mov_b32 m0, s55
    s_add_u32 s55, s55, 1024
    buffer_load_dwordx4 v4, s[12:15], s54 offen lds
    s_add_u32 s54, s54, 32768
    s_mov_b32 m0, s55
    s_add_u32 s55, s55, 1024
    buffer_load_dwordx4 v4, s[12:15], s54 offen lds
    s_add_u32 s54, s54, 32768
    s_mov_b32 m0, s55
    s_add_u32 s55, s55, 1024
    buffer_load_dwordx4 v4, s[12:15], s54 offen lds
    s_add_u32 s54, s54, 32768
    s_mov_b32 m0, s55
    s_add_u32 s55, s55, 1024
    buffer_load_dwordx4 v4, s[12:15], s54 offen lds
    s_add_u32 s54, s54, 32768
    s_mov_b32 m0, s55
    s_add_u32 s55, s55, 1024
    buffer_load_dwordx4 v4, s[12:15], s54 offen lds
    s_add_u32 s54, s54, 32768
    s_mov_b32 m0, s55
    s_add_u32 s55, s55, 1024
    buffer_load_dwordx4 v4, s[12:15], s54 offen lds
    s_add_u32 s54, s54, 32768
    s_mov_b32 m0, s55
    s_add_u32 s55, s55, 1024
    buffer_load_dwordx4 v4, s[12:15], s54 offen lds
    s_add_u32 s54, s54, 32768
    s_mov_b32 m0, s55
    s_add_u32 s55, s55, 1024
    buffer_load_dwordx4 v4, s[12:15], s54 offen lds
    s_add_u32 s54, s54, 32768
    s_mov_b32 m0, s55
    s_add_u32 s55, s55, 1024
    buffer_load_dwordx4 v4, s[12:15], s54 offen lds
    s_add_u32 s54, s54, 32768
    s_mov_b32 m0, s55
    s_add_u32 s55, s55, 1024
    buffer_load_dwordx4 v4, s[12:15], s54 offen lds
    s_add_u32 s54, s54, 32768
    s_mov_b32 m0, s55
    s_add_u32 s55, s55, 1024
    buffer_load_dwordx4 v4, s[12:15], s54 offen lds
    s_add_u32 s54, s54, 32768
    s_mov_b32 m0, s55
    s_add_u32 s55, s55, 1024
    buffer_load_dwordx4 v4, s[12:15], s54 offen lds
    s_add_u32 s54, s54, 32768
    s_mov_b32 m0, s55
    s_add_u32 s55, s55, 1024
    buffer_load_dwordx4 v4, s[12:15], s54 offen lds
    s_add_u32 s54, s54, 32768
    s_mov_b32 m0, s55
    s_add_u32 s55, s55, 1024
    buffer_load_dwordx4 v4, s[12:15], s54 offen lds
    s_add_u32 s54, s54, 32768
    s_mov_b32 m0, s55
    s_add_u32 s55, s55, 1024
    buffer_load_dwordx4 v4, s[12:15], s54 offen lds
    s_add_u32 s54, s54, 32768
    s_mov_b32 m0, s55
    s_add_u32 s55, s55, 1024
    buffer_load_dwordx4 v4, s[12:15], s54 offen lds
    s_add_u32 s54, s54, 32768
    s_mov_b32 m0, s55
    s_add_u32 s55, s55, 1024
    buffer_load_dwordx4 v4, s[12:15], s54 offen lds
    s_add_u32 s54, s54, 32768
    s_mov_b32 m0, s55
    s_add_u32 s55, s55, 1024
    buffer_load_dwordx4 v4, s[12:15], s54 offen lds
    s_add_u32 s54, s54, 32768
    s_mov_b32 m0, s55
    s_add_u32 s55, s55, 1024
    buffer_load_dwordx4 v4, s[12:15], s54 offen lds
    s_add_u32 s54, s54, 32768
    s_mov_b32 m0, s55
    s_add_u32 s55, s55, 1024
    buffer_load_dwordx4 v4, s[12:15], s54 offen lds
    s_add_u32 s54, s54, 32768
    s_mov_b32 m0, s55
    s_add_u32 s55, s55, 1024
    buffer_load_dwordx4 v4, s[12:15], s54 offen lds
    s_add_u32 s54, s54, 32768
    s_mov_b32 m0, s55
    s_add_u32 s55, s55, 1024
    buffer_load_dwordx4 v4, s[12:15], s54 offen lds
    s_add_u32 s54, s54, 32768
    s_mov_b32 m0, s55
    s_add_u32 s55, s55, 1024
    buffer_load_dwordx4 v4, s[12:15], s54 offen lds
    s_add_u32 s54, s54, 32768
    s_mov_b32 m0, s55
    s_add_u32 s55, s55, 1024
    buffer_load_dwordx4 v4, s[12:15], s54 offen lds
    s_add_u32 s54, s54, 32768
    s_mov_b32 m0, s55
    s_add_u32 s55, s55, 1024
    buffer_load_dwordx4 v4, s[12:15], s54 offen lds
    s_add_u32 s54, s54, 32768
    s_mov_b32 m0, s55
    s_add_u32 s55, s55, 1024
    buffer_load_dwordx4 v4, s[12:15], s54 offen lds
    s_add_u32 s54, s54, 32768
    s_mov_b32 m0, s55
    s_add_u32 s55, s55, 1024
    buffer_load_dwordx4 v4, s[12:15], s54 offen lds
    s_add_u32 s54, s54, 32768
    v_lshrrev_b32_e64 v5, 5, v1
    v_bfe_u32 v6, v1, 2, 2
    v_bfe_u32 v7, v1, 4, 1
    v_and_b32_e64 v8, 3, v1
    v_lshl_add_u32 v7, v7, 2, v8
    v_and_b32_e64 v8, 1, v7
    v_bfe_u32 v9, v7, 1, 1
    v_lshl_add_u32 v8, v9, 2, v8
    v_lshrrev_b32_e64 v9, 2, v7
    v_lshl_add_u32 v7, v9, 1, v8
    v_lshrrev_b32 v8, 1, v7
    s_lshl_b32 s54, s4, 2
    v_add_u32 v8, s54, v8
    v_lshlrev_b32 v9, 2, v6
    v_xor_b32 v8, v8, v9
    v_and_b32 v7, 1, v7
    v_lshlrev_b32_e64 v7, 3, v7
    v_lshl_add_u32 v7, v8, 4, v7
    v_lshl_add_u32 v5, v5, 3, v6
    v_lshl_add_u32 v5, v5, 8, v7
    s_waitcnt vmcnt(0)
    s_barrier
    ds_read_b64_tr_b16 a[0:1], v5 offset:0
    ds_read_b64_tr_b16 a[2:3], v5 offset:1024
    ds_read_b64_tr_b16 a[4:5], v5 offset:4096
    ds_read_b64_tr_b16 a[6:7], v5 offset:5120
    ds_read_b64_tr_b16 a[8:9], v5 offset:8192
    ds_read_b64_tr_b16 a[10:11], v5 offset:9216
    ds_read_b64_tr_b16 a[12:13], v5 offset:12288
    ds_read_b64_tr_b16 a[14:15], v5 offset:13312
    ds_read_b64_tr_b16 a[16:17], v5 offset:16384
    ds_read_b64_tr_b16 a[18:19], v5 offset:17408
    ds_read_b64_tr_b16 a[20:21], v5 offset:20480
    ds_read_b64_tr_b16 a[22:23], v5 offset:21504
    ds_read_b64_tr_b16 a[24:25], v5 offset:24576
    ds_read_b64_tr_b16 a[26:27], v5 offset:25600
    ds_read_b64_tr_b16 a[28:29], v5 offset:28672
    ds_read_b64_tr_b16 a[30:31], v5 offset:29696
    ds_read_b64_tr_b16 a[32:33], v5 offset:32768
    ds_read_b64_tr_b16 a[34:35], v5 offset:33792
    ds_read_b64_tr_b16 a[36:37], v5 offset:36864
    ds_read_b64_tr_b16 a[38:39], v5 offset:37888
    ds_read_b64_tr_b16 a[40:41], v5 offset:40960
    ds_read_b64_tr_b16 a[42:43], v5 offset:41984
    ds_read_b64_tr_b16 a[44:45], v5 offset:45056
    ds_read_b64_tr_b16 a[46:47], v5 offset:46080
    ds_read_b64_tr_b16 a[48:49], v5 offset:49152
    ds_read_b64_tr_b16 a[50:51], v5 offset:50176
    ds_read_b64_tr_b16 a[52:53], v5 offset:53248
    ds_read_b64_tr_b16 a[54:55], v5 offset:54272
    ds_read_b64_tr_b16 a[56:57], v5 offset:57344
    ds_read_b64_tr_b16 a[58:59], v5 offset:58368
    ds_read_b64_tr_b16 a[60:61], v5 offset:61440
    ds_read_b64_tr_b16 a[62:63], v5 offset:62464
    v_add_u32 v5, 0x10000, v5
    ds_read_b64_tr_b16 a[64:65], v5 offset:0
    ds_read_b64_tr_b16 a[66:67], v5 offset:1024
    ds_read_b64_tr_b16 a[68:69], v5 offset:4096
    ds_read_b64_tr_b16 a[70:71], v5 offset:5120
    ds_read_b64_tr_b16 a[72:73], v5 offset:8192
    ds_read_b64_tr_b16 a[74:75], v5 offset:9216
    ds_read_b64_tr_b16 a[76:77], v5 offset:12288
    ds_read_b64_tr_b16 a[78:79], v5 offset:13312
    ds_read_b64_tr_b16 a[80:81], v5 offset:16384
    ds_read_b64_tr_b16 a[82:83], v5 offset:17408
    ds_read_b64_tr_b16 a[84:85], v5 offset:20480
    ds_read_b64_tr_b16 a[86:87], v5 offset:21504
    ds_read_b64_tr_b16 a[88:89], v5 offset:24576
    ds_read_b64_tr_b16 a[90:91], v5 offset:25600
    ds_read_b64_tr_b16 a[92:93], v5 offset:28672
    ds_read_b64_tr_b16 a[94:95], v5 offset:29696
    ds_read_b64_tr_b16 a[96:97], v5 offset:32768
    ds_read_b64_tr_b16 a[98:99], v5 offset:33792
    ds_read_b64_tr_b16 a[100:101], v5 offset:36864
    ds_read_b64_tr_b16 a[102:103], v5 offset:37888
    ds_read_b64_tr_b16 a[104:105], v5 offset:40960
    ds_read_b64_tr_b16 a[106:107], v5 offset:41984
    ds_read_b64_tr_b16 a[108:109], v5 offset:45056
    ds_read_b64_tr_b16 a[110:111], v5 offset:46080
    ds_read_b64_tr_b16 a[112:113], v5 offset:49152
    ds_read_b64_tr_b16 a[114:115], v5 offset:50176
    ds_read_b64_tr_b16 a[116:117], v5 offset:53248
    ds_read_b64_tr_b16 a[118:119], v5 offset:54272
    ds_read_b64_tr_b16 a[120:121], v5 offset:57344
    ds_read_b64_tr_b16 a[122:123], v5 offset:58368
    ds_read_b64_tr_b16 a[124:125], v5 offset:61440
    ds_read_b64_tr_b16 a[126:127], v5 offset:62464
    v_add_u32 v5, 0x10000, v5
    ds_read_b64_tr_b16 a[128:129], v5 offset:0
    ds_read_b64_tr_b16 a[130:131], v5 offset:1024
    ds_read_b64_tr_b16 a[132:133], v5 offset:4096
    ds_read_b64_tr_b16 a[134:135], v5 offset:5120
    ds_read_b64_tr_b16 a[136:137], v5 offset:8192
    ds_read_b64_tr_b16 a[138:139], v5 offset:9216
    ds_read_b64_tr_b16 a[140:141], v5 offset:12288
    ds_read_b64_tr_b16 a[142:143], v5 offset:13312
    v_lshlrev_b32_e64 v6, 3, v0
    s_mov_b32 s61, 0
    s_mov_b32 s54, 1
    s_mov_b32 s55, 16384
    s_cmp_ge_u32 s61, s54
    s_cbranch_scc1 L_wd_53
    s_mov_b32 s79, 524288
L_w_52:
    buffer_load_dwordx4 v[8:11], v6, s[8:11], s55 offen sc1
    s_waitcnt vmcnt(0)
    v_min3_u32 v8, v8, v9, v10
    v_min_u32 v8, v8, v11
    v_cmp_gt_u32 vcc, s54, v8
    s_cbranch_vccz L_wo_54
    s_sub_u32 s79, s79, 1
    s_cbranch_scc1 L_fail
    s_branch L_w_52
L_wo_54:
    s_nop 1
    v_min_u32_dpp v8, v8, v8 quad_perm:[1,0,3,2] row_mask:0xf bank_mask:0xf
    s_nop 1
    v_min_u32_dpp v8, v8, v8 quad_perm:[2,3,0,1] row_mask:0xf bank_mask:0xf
    s_nop 1
    v_min_u32_dpp v8, v8, v8 row_half_mirror row_mask:0xf bank_mask:0xf
    s_nop 1
    v_min_u32_dpp v8, v8, v8 row_mirror row_mask:0xf bank_mask:0xf
    s_nop 0
    v_readlane_b32 s61, v8, 0
    v_readlane_b32 s56, v8, 16
    s_min_u32 s61, s61, s56
    v_readlane_b32 s56, v8, 32
    s_min_u32 s61, s61, s56
    v_readlane_b32 s56, v8, 48
    s_min_u32 s61, s61, s56
L_wd_53:
    s_waitcnt lgkmcnt(0)
    s_barrier
    v_bfe_u32 v2, v1, 4, 1
    v_lshlrev_b32 v2, 10, v2
    v_lshrrev_b32_e64 v3, 5, v1
    v_lshl_add_u32 v2, v3, 8, v2
    v_and_b32 v3, 0xf0, v0
    v_add_u32_e64 v2, v2, v3
    s_mul_i32 s60, s4, 9216
    s_add_u32 s59, s60, 1048576
    s_lshl_b32 s54, s52, 7
    s_lshl_b32 s55, s4, 2
    s_add_u32 s57, s54, s55
    s_add_u32 s57, s57, 12288
    s_mov_b32 s71, 0x3e0293ee
    s_mov_b32 s72, 0xbe0293ee
    v_and_b32 v11, 15, v1
    v_lshrrev_b32 v12, 4, v1
    v_lshrrev_b32 v13, 2, v11
    v_lshlrev_b32 v13, 1, v13
    v_and_b32 v14, 1, v11
    v_add3_u32 v13, v13, v14, 8
    v_lshl_add_u32 v13, v12, 4, v13
    v_lshlrev_b32 v6, 4, v13
    s_and_b32 s54, s4, 1
    s_lshl_b32 s55, s54, 4
    v_add_u32 v13, s55, v11
    v_lshrrev_b32 v14, 1, v12
    v_lshlrev_b32 v14, 10, v14
    v_and_b32_e64 v15, 1, v12
    v_lshl_add_u32 v14, v15, 9, v14
    v_lshl_add_u32 v7, v13, 4, v14
    v_lshlrev_b32_e64 v12, 2, v12
    v_mov_b32 v15, 0xd028965f
    v_add_u32 v14, 0, v12
    v_cmp_gt_u32 vcc, v14, v13
    s_nop 1
    v_cndmask_b32 v160, 0, v15, vcc
    v_add_u32 v14, 1, v12
    v_cmp_gt_u32 vcc, v14, v13
    s_nop 1
    v_cndmask_b32 v161, 0, v15, vcc
    v_add_u32 v14, 2, v12
    v_cmp_gt_u32 vcc, v14, v13
    s_nop 1
    v_cndmask_b32 v162, 0, v15, vcc
    v_add_u32 v14, 3, v12
    v_cmp_gt_u32 vcc, v14, v13
    s_nop 1
    v_cndmask_b32 v163, 0, v15, vcc
    v_add_u32 v14, 16, v12
    v_cmp_gt_u32 vcc, v14, v13
    s_nop 1
    v_cndmask_b32 v164, 0, v15, vcc
    v_add_u32 v14, 17, v12
    v_cmp_gt_u32 vcc, v14, v13
    s_nop 1
    v_cndmask_b32 v165, 0, v15, vcc
    v_add_u32 v14, 18, v12
    v_cmp_gt_u32 vcc, v14, v13
    s_nop 1
    v_cndmask_b32 v166, 0, v15, vcc
    v_add_u32_e64 v14, 19, v12
    v_cmp_gt_u32 vcc, v14, v13
    s_nop 1
    v_cndmask_b32 v167, 0, v15, vcc
    s_lshl_b32 s54, s54, 10
    s_add_u32 s54, s54, 147456
    v_add_u32 v9, s54, v0
    s_lshl_b32 s54, s4, 11
    s_add_u32 s54, s54, 147456
    v_add_u32 v2, s54, v2
    v_lshrrev_b32 v10, 1, v0
    v_and_b32 v8, 1, v1
    v_lshlrev_b32 v8, 12, v8
    s_lshl_b32 s54, s52, 7
    s_add_u32 s68, s54, 0
    s_add_u32 s69, s54, 8204
    s_lshl_b32 s65, s52, 14
    s_add_u32 s65, s65, 4194304
    s_lshl_b32 s66, s52, 12
    s_add_u32 s66, s66, 37748736
    s_lshr_b32 s55, s4, 1
    s_lshl_b32 s67, s52, 11
    s_lshl_b32 s54, s55, 10
    s_add_u32 s67, s67, s54
    s_add_u32 s67, s67, 46137344
    s_lshl_b32 s70, s55, 13
    s_lshl_b32 s58, s52, 13
    s_lshl_b32 s54, s55, 12
    s_add_u32 s58, s58, s54
    s_add_u32 s58, s58, 50331648
    s_mul_i32 s54, s76, 262144
    s_add_u32 s58, s58, s54
    s_mul_i32 s54, s76, 524288
    s_add_u32 s65, s65, s54
    s_mul_i32 s54, s76, 131072
    s_add_u32 s66, s66, s54
    s_mul_i32 s54, s76, 65536
    s_add_u32 s67, s67, s54
    s_mul_i32 s54, s76, 36864
    s_add_u32 s59, s59, s54
    s_cmp_lg_u32 s76, 0
    s_cselect_b32 s54, 28672, 0
    s_add_u32 s57, s57, s54
    v_mov_b32 v11, 0
    v_mov_b32 v3, v0
    s_mov_b32 s61, 0
    s_mov_b32 s62, 0
    s_mov_b32 s77, 0
    s_add_u32 m0, s60, 0
    s_add_u32 s54, s59, 0
    buffer_load_dwordx4 v0, s[8:11], s54 offen sc1 lds
    s_add_u32 m0, s60, 1024
    s_add_u32 s54, s59, 1024
    buffer_load_dwordx4 v0, s[8:11], s54 offen sc1 lds
    s_add_u32 m0, s60, 2048
    s_add_u32 s54, s59, 2048
    buffer_load_dwordx4 v0, s[8:11], s54 offen sc1 lds
    s_add_u32 m0, s60, 3072
    s_add_u32 s54, s59, 3072
    buffer_load_dwordx4 v0, s[8:11], s54 offen sc1 lds
    s_add_u32 m0, s60, 4096
    s_add_u32 s54, s59, 4096
    buffer_load_dwordx4 v0, s[8:11], s54 offen sc1 lds
    s_add_u32 m0, s60, 5120
    s_add_u32 s54, s59, 5120
    buffer_load_dwordx4 v0, s[8:11], s54 offen sc1 lds
    s_add_u32 m0, s60, 6144
    s_add_u32 s54, s59, 6144
    buffer_load_dwordx4 v0, s[8:11], s54 offen sc1 lds
    s_add_u32 m0, s60, 7168
    s_add_u32 s54, s59, 7168
    buffer_load_dwordx4 v0, s[8:11], s54 offen sc1 lds
    s_add_u32 m0, s60, 8192
    s_add_u32 s54, s59, 8192
    buffer_load_dwordx4 v0, s[8:11], s54 offen sc1 lds
    s_cmp_ge_u32 s59, 1933312
    s_cselect_b32 s54, 36864, 0
    s_add_u32 s59, s59, s54
    s_add_u32 s59, s59, 36864
    s_add_u32 s60, s60, 36864
    s_cmp_ge_u32 s60, 147456
    s_cselect_b32 s54, 147456, 0
    s_sub_u32 s60, s60, s54
    s_add_u32 m0, s60, 0
    s_add_u32 s54, s59, 0
    buffer_load_dwordx4 v0, s[8:11], s54 offen sc1 lds
    s_add_u32 m0, s60, 1024
    s_add_u32 s54, s59, 1024
    buffer_load_dwordx4 v0, s[8:11], s54 offen sc1 lds
    s_add_u32 m0, s60, 2048
    s_add_u32 s54, s59, 2048
    buffer_load_dwordx4 v0, s[8:11], s54 offen sc1 lds
    s_add_u32 m0, s60, 3072
    s_add_u32 s54, s59, 3072
    buffer_load_dwordx4 v0, s[8:11], s54 offen sc1 lds
    s_add_u32 m0, s60, 4096
    s_add_u32 s54, s59, 4096
    buffer_load_dwordx4 v0, s[8:11], s54 offen sc1 lds
    s_add_u32 m0, s60, 5120
    s_add_u32 s54, s59, 5120
    buffer_load_dwordx4 v0, s[8:11], s54 offen sc1 lds
    s_add_u32 m0, s60, 6144
    s_add_u32 s54, s59, 6144
    buffer_load_dwordx4 v0, s[8:11], s54 offen sc1 lds
    s_add_u32 m0, s60, 7168
    s_add_u32 s54, s59, 7168
    buffer_load_dwordx4 v0, s[8:11], s54 offen sc1 lds
    s_add_u32 m0, s60, 8192
    s_add_u32 s54, s59, 8192
    buffer_load_dwordx4 v0, s[8:11], s54 offen sc1 lds
    s_cmp_ge_u32 s59, 1933312
    s_cselect_b32 s54, 36864, 0
    s_add_u32 s59, s59, s54
    s_add_u32 s59, s59, 36864
    s_add_u32 s60, s60, 36864
    s_cmp_ge_u32 s60, 147456
    s_cselect_b32 s54, 147456, 0
    s_sub_u32 s60, s60, s54
    s_add_u32 m0, s60, 0
    s_add_u32 s54, s59, 0
    buffer_load_dwordx4 v0, s[8:11], s54 offen sc1 lds
    s_add_u32 m0, s60, 1024
    s_add_u32 s54, s59, 1024
    buffer_load_dwordx4 v0, s[8:11], s54 offen sc1 lds
    s_add_u32 m0, s60, 2048
    s_add_u32 s54, s59, 2048
    buffer_load_dwordx4 v0, s[8:11], s54 offen sc1 lds
    s_add_u32 m0, s60, 3072
    s_add_u32 s54, s59, 3072
    buffer_load_dwordx4 v0, s[8:11], s54 offen sc1 lds
    s_add_u32 m0, s60, 4096
    s_add_u32 s54, s59, 4096
    buffer_load_dwordx4 v0, s[8:11], s54 offen sc1 lds
    s_add_u32 m0, s60, 5120
    s_add_u32 s54, s59, 5120
    buffer_load_dwordx4 v0, s[8:11], s54 offen sc1 lds
    s_add_u32 m0, s60, 6144
    s_add_u32 s54, s59, 6144
    buffer_load_dwordx4 v0, s[8:11], s54 offen sc1 lds
    s_add_u32 m0, s60, 7168
    s_add_u32 s54, s59, 7168
    buffer_load_dwordx4 v0, s[8:11], s54 offen sc1 lds
    s_add_u32 m0, s60, 8192
    s_add_u32 s54, s59, 8192
    buffer_load_dwordx4 v0, s[8:11], s54 offen sc1 lds
    s_cmp_ge_u32 s59, 1933312
    s_cselect_b32 s54, 36864, 0
    s_add_u32 s59, s59, s54
    s_add_u32 s59, s59, 36864
    s_add_u32 s60, s60, 36864
    s_cmp_ge_u32 s60, 147456
    s_cselect_b32 s54, 147456, 0
    s_sub_u32 s60, s60, s54
    s_mov_b32 s53, s76
    s_waitcnt vmcnt(0)
    s_mov_b32 s64, s53
    s_mov_b32 s63, 0
L_at_55:
    s_cmp_ge_u32 s64, 64
    s_cbranch_scc1 L_nos1_56
    s_barrier
    s_add_u32 s75, s64, 1
    s_cmp_ge_u32 s61, s75
    s_cbranch_scc1 L_wd_60
    s_mov_b32 s79, 524288
L_w_59:
    buffer_load_dwordx4 v[12:15], v8, s[8:11], s68 offen sc1
    s_waitcnt vmcnt(0)
    v_min3_u32 v12, v12, v13, v14
    v_min_u32 v12, v12, v15
    v_cmp_gt_u32 vcc, s75, v12
    s_cbranch_vccz L_wo_61
    s_sub_u32 s79, s79, 1
    s_cbranch_scc1 L_fail
    s_branch L_w_59
L_wo_61:
    s_nop 1
    v_min_u32_dpp v12, v12, v12 quad_perm:[1,0,3,2] row_mask:0xf bank_mask:0xf
    s_nop 1
    v_min_u32_dpp v12, v12, v12 quad_perm:[2,3,0,1] row_mask:0xf bank_mask:0xf
    s_nop 1
    v_min_u32_dpp v12, v12, v12 row_half_mirror row_mask:0xf bank_mask:0xf
    s_nop 1
    v_min_u32_dpp v12, v12, v12 row_mirror row_mask:0xf bank_mask:0xf
    s_nop 0
    v_readlane_b32 s61, v12, 0
    v_readlane_b32 s56, v12, 16
    s_min_u32 s61, s61, s56
    v_readlane_b32 s56, v12, 32
    s_min_u32 s61, s61, s56
    v_readlane_b32 s56, v12, 48
    s_min_u32 s61, s61, s56
L_wd_60:
    ds_read_b128 v[48:51], v3 offset:0
    ds_read_b128 v[52:55], v3 offset:1024
    ds_read_b128 v[56:59], v3 offset:2048
    ds_read_b128 v[60:63], v3 offset:3072
    s_waitcnt lgkmcnt(3)
    v_mfma_f32_32x32x16_bf16 v[16:31], a[0:3], v[48:51], 0
    ds_read_b128 v[48:51], v3 offset:4096
    s_add_u32 s55, s65, 0
    buffer_load_dwordx4 v[88:91], v0, s[8:11], s55 offen offset:0 sc1
    s_waitcnt lgkmcnt(3)
    v_mfma_f32_32x32x16_bf16 v[16:31], a[4:7], v[52:55], v[16:31]
    ds_read_b128 v[52:55], v3 offset:5120
    buffer_load_dwordx4 v[104:107], v0, s[8:11], s55 offen offset:1024 sc1
    s_waitcnt lgkmcnt(3)
    v_mfma_f32_32x32x16_bf16 v[16:31], a[8:11], v[56:59], v[16:31]
    ds_read_b128 v[56:59], v3 offset:6144
    s_add_u32 s55, s65, 4096
    buffer_load_dwordx4 v[92:95], v0, s[8:11], s55 offen offset:0 sc1
    s_waitcnt lgkmcnt(3)
    v_mfma_f32_32x32x16_bf16 v[16:31], a[12:15], v[60:63], v[16:31]
    ds_read_b128 v[60:63], v3 offset:7168
    buffer_load_dwordx4 v[108:111], v0, s[8:11], s55 offen offset:1024 sc1
    s_waitcnt lgkmcnt(3)
    v_mfma_f32_32x32x16_bf16 v[16:31], a[16:19], v[48:51], v[16:31]
    ds_read_b128 v[48:51], v3 offset:8192
    s_add_u32 s55, s65, 8192
    buffer_load_dwordx4 v[96:99], v0, s[8:11], s55 offen offset:0 sc1
    s_waitcnt lgkmcnt(3)
    v_mfma_f32_32x32x16_bf16 v[16:31], a[20:23], v[52:55], v[16:31]
    ds_read_b128 v[52:55], v3 offset:9216
    buffer_load_dwordx4 v[112:115], v0, s[8:11], s55 offen offset:1024 sc1
    s_waitcnt lgkmcnt(3)
    v_mfma_f32_32x32x16_bf16 v[16:31], a[24:27], v[56:59], v[16:31]
    ds_read_b128 v[56:59], v3 offset:10240
    s_add_u32 s55, s65, 12288
    buffer_load_dwordx4 v[100:103], v0, s[8:11], s55 offen offset:0 sc1
    s_waitcnt lgkmcnt(3)
    v_mfma_f32_32x32x16_bf16 v[16:31], a[28:31], v[60:63], v[16:31]
    ds_read_b128 v[60:63], v3 offset:11264
    buffer_load_dwordx4 v[116:119], v0, s[8:11], s55 offen offset:1024 sc1
    s_waitcnt lgkmcnt(3)
    v_mfma_f32_32x32x16_bf16 v[16:31], a[32:35], v[48:51], v[16:31]
    ds_read_b128 v[48:51], v3 offset:12288
    s_add_u32 s55, s65, s70
    buffer_load_dwordx4 v[224:227], v0, s[8:11], s55 offen offset:2048 sc1
    s_waitcnt lgkmcnt(3)
    v_mfma_f32_32x32x16_bf16 v[16:31], a[36:39], v[52:55], v[16:31]
    ds_read_b128 v[52:55], v3 offset:13312
    buffer_load_dwordx4 v[228:231], v0, s[8:11], s55 offen offset:3072 sc1
    s_waitcnt lgkmcnt(3)
    v_mfma_f32_32x32x16_bf16 v[16:31], a[40:43], v[56:59], v[16:31]
    ds_read_b128 v[56:59], v3 offset:14336
    s_add_u32 s55, s55, 4096
    buffer_load_dwordx4 v[232:235], v0, s[8:11], s55 offen offset:2048 sc1
    s_waitcnt lgkmcnt(3)
    v_mfma_f32_32x32x16_bf16 v[16:31], a[44:47], v[60:63], v[16:31]
    ds_read_b128 v[60:63], v3 offset:15360
    buffer_load_dwordx4 v[236:239], v0, s[8:11], s55 offen offset:3072 sc1
    s_waitcnt lgkmcnt(3)
    v_mfma_f32_32x32x16_bf16 v[16:31], a[48:51], v[48:51], v[16:31]
    ds_read_b128 v[48:51], v3 offset:16384
    s_waitcnt lgkmcnt(3)
    v_mfma_f32_32x32x16_bf16 v[16:31], a[52:55], v[52:55], v[16:31]
    ds_read_b128 v[52:55], v3 offset:17408
    s_waitcnt lgkmcnt(3)
    v_mfma_f32_32x32x16_bf16 v[16:31], a[56:59], v[56:59], v[16:31]
    ds_read_b128 v[56:59], v3 offset:18432
    v_mov_b32_e64 v5, s77
    s_waitcnt vmcnt(12)
    s_mov_b64 exec, 1
    buffer_store_dword v5, off, s[8:11], s57 sc1
    s_mov_b64 exec, -1
    s_waitcnt lgkmcnt(3)
    v_mfma_f32_32x32x16_bf16 v[16:31], a[60:63], v[60:63], v[16:31]
    ds_read_b128 v[60:63], v3 offset:19456
    s_waitcnt lgkmcnt(3)
    v_mfma_f32_32x32x16_bf16 v[16:31], a[64:67], v[48:51], v[16:31]
    ds_read_b128 v[48:51], v3 offset:20480
    s_add_u32 m0, s60, 0
    s_add_u32 s54, s59, 0
    buffer_load_dwordx4 v0, s[8:11], s54 offen sc1 lds
    s_waitcnt lgkmcnt(3)
    v_mfma_f32_32x32x16_bf16 v[16:31], a[68:71], v[52:55], v[16:31]
    ds_read_b128 v[52:55], v3 offset:21504
    s_waitcnt lgkmcnt(3)
    v_mfma_f32_32x32x16_bf16 v[16:31], a[72:75], v[56:59], v[16:31]
    ds_read_b128 v[56:59], v3 offset:22528
    s_add_u32 m0, s60, 1024
    s_add_u32 s54, s59, 1024
    buffer_load_dwordx4 v0, s[8:11], s54 offen sc1 lds
    s_waitcnt lgkmcnt(3)
    v_mfma_f32_32x32x16_bf16 v[16:31], a[76:79], v[60:63], v[16:31]
    ds_read_b128 v[60:63], v3 offset:23552
    s_waitcnt lgkmcnt(3)
    v_mfma_f32_32x32x16_bf16 v[16:31], a[80:83], v[48:51], v[16:31]
    ds_read_b128 v[48:51], v3 offset:24576
    s_add_u32 m0, s60, 2048
    s_add_u32 s54, s59, 2048
    buffer_load_dwordx4 v0, s[8:11], s54 offen sc1 lds
    s_waitcnt lgkmcnt(3)
    v_mfma_f32_32x32x16_bf16 v[16:31], a[84:87], v[52:55], v[16:31]
    ds_read_b128 v[52:55], v3 offset:25600
    s_waitcnt lgkmcnt(3)
    v_mfma_f32_32x32x16_bf16 v[16:31], a[88:91], v[56:59], v[16:31]
    ds_read_b128 v[56:59], v3 offset:26624
    s_add_u32 m0, s60, 3072
    s_add_u32 s54, s59, 3072
    buffer_load_dwordx4 v0, s[8:11], s54 offen sc1 lds
    s_waitcnt lgkmcnt(3)
    v_mfma_f32_32x32x16_bf16 v[16:31], a[92:95], v[60:63], v[16:31]
    ds_read_b128 v[60:63], v3 offset:27648
    s_waitcnt lgkmcnt(3)
    v_mfma_f32_32x32x16_bf16 v[16:31], a[96:99], v[48:51], v[16:31]
    ds_read_b128 v[48:51], v3 offset:28672
    s_add_u32 m0, s60, 4096
    s_add_u32 s54, s59, 4096
    buffer_load_dwordx4 v0, s[8:11], s54 offen sc1 lds
    s_waitcnt lgkmcnt(3)
    v_mfma_f32_32x32x16_bf16 v[16:31], a[100:103], v[52:55], v[16:31]
    ds_read_b128 v[52:55], v3 offset:29696
    s_waitcnt lgkmcnt(3)
    v_mfma_f32_32x32x16_bf16 v[16:31], a[104:107], v[56:59], v[16:31]
    ds_read_b128 v[56:59], v3 offset:30720
    s_add_u32 m0, s60, 5120
    s_add_u32 s54, s59, 5120
    buffer_load_dwordx4 v0, s[8:11], s54 offen sc1 lds
    s_waitcnt lgkmcnt(3)
    v_mfma_f32_32x32x16_bf16 v[16:31], a[108:111], v[60:63], v[16:31]
    ds_read_b128 v[60:63], v3 offset:31744
    s_waitcnt lgkmcnt(3)
    v_mfma_f32_32x32x16_bf16 v[16:31], a[112:115], v[48:51], v[16:31]
    ds_read_b128 v[48:51], v3 offset:32768
    s_add_u32 m0, s60, 6144
    s_add_u32 s54, s59, 6144
    buffer_load_dwordx4 v0, s[8:11], s54 offen sc1 lds
    s_waitcnt lgkmcnt(3)
    v_mfma_f32_32x32x16_bf16 v[16:31], a[116:119], v[52:55], v[16:31]
    ds_read_b128 v[52:55], v3 offset:33792
    s_waitcnt lgkmcnt(3)
    v_mfma_f32_32x32x16_bf16 v[16:31], a[120:123], v[56:59], v[16:31]
    ds_read_b128 v[56:59], v3 offset:34816
    s_add_u32 m0, s60, 7168
    s_add_u32 s54, s59, 7168
    buffer_load_dwordx4 v0, s[8:11], s54 offen sc1 lds
    s_waitcnt lgkmcnt(3)
    v_mfma_f32_32x32x16_bf16 v[16:31], a[124:127], v[60:63], v[16:31]
    ds_read_b128 v[60:63], v3 offset:35840
    s_waitcnt lgkmcnt(3)
    v_mfma_f32_32x32x16_bf16 v[16:31], a[128:131], v[48:51], v[16:31]
    s_add_u32 m0, s60, 8192
    s_add_u32 s54, s59, 8192
    buffer_load_dwordx4 v0, s[8:11], s54 offen sc1 lds
    s_cmp_ge_u32 s59, 1933312
    s_cselect_b32 s54, 36864, 0
    s_add_u32 s59, s59, s54
    s_add_u32 s59, s59, 36864
    s_add_u32 s60, s60, 36864
    s_cmp_ge_u32 s60, 147456
    s_cselect_b32 s54, 147456, 0
    s_sub_u32 s60, s60, s54
    s_waitcnt lgkmcnt(2)
    v_mfma_f32_32x32x16_bf16 v[16:31], a[132:135], v[52:55], v[16:31]
    s_waitcnt lgkmcnt(1)
    v_mfma_f32_32x32x16_bf16 v[16:31], a[136:139], v[56:59], v[16:31]
    s_waitcnt lgkmcnt(0)
    v_mfma_f32_32x32x16_bf16 v[16:31], a[140:143], v[60:63], v[16:31]
    v_add_u32 v3, 36864, v3
    v_subrev_u32 v4, 147456, v3
    v_min_u32_e64 v3, v3, v4
    s_nop 7
    s_nop 0
    v_cvt_pk_bf16_f32 v64, v16, v17
    v_cvt_pk_bf16_f32 v65, v18, v19
    v_cvt_pk_bf16_f32 v66, v20, v21
    v_cvt_pk_bf16_f32 v67, v22, v23
    ds_write_b128 v2, v[64:67] offset:0
    v_cvt_pk_bf16_f32 v68, v24, v25
    v_cvt_pk_bf16_f32 v69, v26, v27
    v_cvt_pk_bf16_f32 v70, v28, v29
    v_cvt_pk_bf16_f32 v71, v30, v31
    ds_write_b128 v2, v[68:71] offset:512
    s_waitcnt lgkmcnt(0)
    s_barrier
    ds_read_b128 v[200:203], v9 offset:0
    ds_read_b128 v[204:207], v9 offset:2048
    ds_read_b128 v[208:211], v9 offset:4096
    ds_read_b128 v[212:215], v9 offset:6144
    s_waitcnt vmcnt(10)
    s_waitcnt lgkmcnt(0)
    v_mfma_f32_16x16x32_bf16 v[216:219], v[88:91], v[200:203], v[160:163]
    v_mfma_f32_16x16x32_bf16 v[220:223], v[104:107], v[200:203], v[164:167]
    v_mfma_f32_16x16x32_bf16 v[216:219], v[92:95], v[204:207], v[216:219]
    v_mfma_f32_16x16x32_bf16 v[220:223], v[108:111], v[204:207], v[220:223]
    v_mfma_f32_16x16x32_bf16 v[216:219], v[96:99], v[208:211], v[216:219]
    v_mfma_f32_16x16x32_bf16 v[220:223], v[112:115], v[208:211], v[220:223]
    v_mfma_f32_16x16x32_bf16 v[216:219], v[100:103], v[212:215], v[216:219]
    v_mfma_f32_16x16x32_bf16 v[220:223], v[116:119], v[212:215], v[220:223]
    s_cmp_ge_u32 s64, 24
    s_cselect_b32 s55, 2, 1
    s_add_u32 s64, s64, s55
    s_mul_i32 s54, s55, 524288
    s_add_u32 s65, s65, s54
    s_cmp_lg_u32 s63, 0
    s_mov_b32 s63, 1
    s_cbranch_scc1 L_s2_57
    s_nop 7
    s_branch L_rot_58
L_nos1_56:
    v_mov_b32 v5, s77
    s_waitcnt vmcnt(0)
    s_mov_b64 exec, 1
    buffer_store_dword v5, off, s[8:11], s57 sc1
    s_mov_b64 exec, -1
L_s2_57:
    s_add_u32 s75, s53, 1
    s_cmp_ge_u32 s62, s75
    s_cbranch_scc1 L_wd_63
    s_mov_b32 s79, 524288
L_w_62:
    buffer_load_dword v12, v11, s[8:11], s69 offen sc1
    s_waitcnt vmcnt(0)
    v_cmp_gt_u32 vcc, s75, v12
    s_cbranch_vccz L_wo_64
    s_sub_u32 s79, s79, 1
    s_cbranch_scc1 L_fail
    s_branch L_w_62
L_wo_64:
    s_nop 1
    v_min_u32_dpp v12, v12, v12 quad_perm:[1,0,3,2] row_mask:0xf bank_mask:0xf
    s_nop 1
    v_min_u32_dpp v12, v12, v12 quad_perm:[2,3,0,1] row_mask:0xf bank_mask:0xf
    s_nop 1
    v_min_u32_dpp v12, v12, v12 row_half_mirror row_mask:0xf bank_mask:0xf
    s_nop 1
    v_min_u32_dpp v12, v12, v12 row_mirror row_mask:0xf bank_mask:0xf
    s_nop 0
    v_readlane_b32 s62, v12, 0
    v_readlane_b32 s56, v12, 16
    s_min_u32 s62, s62, s56
    v_readlane_b32 s56, v12, 32
    s_min_u32 s62, s62, s56
    v_readlane_b32 s56, v12, 48
    s_min_u32 s62, s62, s56
L_wd_63:
    buffer_load_dwordx4 v[120:123], v6, s[8:11], s66 offen offset:0 sc1
    buffer_load_dwordx4 v[124:127], v6, s[8:11], s66 offen offset:1024 sc1
    buffer_load_dwordx4 v[128:131], v6, s[8:11], s66 offen offset:2048 sc1
    buffer_load_dwordx4 v[132:135], v6, s[8:11], s66 offen offset:3072 sc1
    buffer_load_dwordx2 v[152:153], v10, s[8:11], s67 offen offset:0 sc1
    buffer_load_dwordx2 v[154:155], v10, s[8:11], s67 offen offset:512 sc1
    v_max3_f32 v12, v168, v169, v170
    v_max3_f32 v12, v12, v171, v172
    v_max3_f32 v12, v12, v173, v174
    s_waitcnt vmcnt(5)
    v_mfma_f32_16x16x32_bf16 v[176:179], v[120:123], v[72:75], 0
    s_waitcnt vmcnt(4)
    v_mfma_f32_16x16x32_bf16 v[176:179], v[124:127], v[76:79], v[176:179]
    s_waitcnt vmcnt(3)
    v_mfma_f32_16x16x32_bf16 v[176:179], v[128:131], v[80:83], v[176:179]
    s_waitcnt vmcnt(2)
    v_mfma_f32_16x16x32_bf16 v[176:179], v[132:135], v[84:87], v[176:179]
    v_max_f32 v12, v12, v175
    s_nop 6
    v_max3_f32 v12, v12, v176, v177
    v_mov_b32 v13, v12
    s_nop 1
    v_permlane16_swap_b32 v12, v13
    v_max_f32 v12, v12, v13
    v_mov_b32 v13, v12
    s_nop 1
    v_permlane32_swap_b32 v12, v13
    v_max_f32 v12, v12, v13
    v_mul_f32_e64 v12, s72, v12
    v_fma_f32 v168, v168, s71, v12
    v_fma_f32 v169, v169, s71, v12
    v_fma_f32 v170, v170, s71, v12
    v_fma_f32 v171, v171, s71, v12
    v_fma_f32 v172, v172, s71, v12
    v_fma_f32 v173, v173, s71, v12
    v_fma_f32 v174, v174, s71, v12
    v_fma_f32 v175, v175, s71, v12
    v_fma_f32 v176, v176, s71, v12
    v_fma_f32 v177, v177, s71, v12
    v_exp_f32 v168, v168
    v_exp_f32 v169, v169
    v_exp_f32 v170, v170
    v_exp_f32 v171, v171
    v_exp_f32 v172, v172
    v_exp_f32 v173, v173
    v_exp_f32 v174, v174
    v_exp_f32 v175, v175
    v_exp_f32 v176, v176
    v_exp_f32 v177, v177
    v_cvt_pk_bf16_f32 v64, v168, v169
    v_cvt_pk_bf16_f32 v65, v170, v171
    v_cvt_pk_bf16_f32 v66, v172, v173
    v_cvt_pk_bf16_f32 v67, v174, v175
    v_cvt_pk_bf16_f32 v68, v176, v177
    v_mov_b32 v69, 0
    v_mov_b32 v70, 0
    v_mov_b32_e64 v71, v68
    v_mfma_f32_16x16x32_bf16 v[180:183], v[136:139], v[64:67], 0
    v_mfma_f32_16x16x32_bf16 v[184:187], v[140:143], v[64:67], 0
    v_mfma_f32_16x16x32_bf16 v[188:191], v[144:147], v[64:67], 0
    v_mfma_f32_16x16x32_bf16 v[192:195], v[148:151], v[64:67], 0
    s_waitcnt vmcnt(0)
    v_mfma_f32_16x16x16_bf16 v[180:183], v[152:153], v[68:69], v[180:183]
    v_mfma_f32_16x16x16_bf16 v[184:187], v[152:153], v[70:71], v[184:187]
    v_mfma_f32_16x16x16_bf16 v[188:191], v[154:155], v[68:69], v[188:191]
    v_mfma_f32_16x16x16_bf16 v[192:195], v[154:155], v[70:71], v[192:195]
    s_nop 0
    v_pk_add_f32 v[168:169], v[168:169], v[170:171]
    v_pk_add_f32 v[172:173], v[172:173], v[174:175]
    v_pk_add_f32 v[168:169], v[168:169], v[176:177]
    v_pk_add_f32 v[168:169], v[168:169], v[172:173]
    v_add_f32 v12, v168, v169
    v_mov_b32 v13, v12
    s_nop 1
    v_permlane16_swap_b32 v12, v13
    v_add_f32 v12, v12, v13
    v_mov_b32 v13, v12
    s_nop 1
    v_permlane32_swap_b32 v12, v13
    v_add_f32 v12, v12, v13
    v_rcp_f32_e64 v12, v12
    s_nop 0
    v_pk_mul_f32 v[180:181], v[180:181], v[12:13] op_sel_hi:[1,0]
    v_pk_mul_f32 v[182:183], v[182:183], v[12:13] op_sel_hi:[1,0]
    v_pk_mul_f32 v[184:185], v[184:185], v[12:13] op_sel_hi:[1,0]
    v_pk_mul_f32 v[186:187], v[186:187], v[12:13] op_sel_hi:[1,0]
    v_pk_mul_f32 v[188:189], v[188:189], v[12:13] op_sel_hi:[1,0]
    v_pk_mul_f32 v[190:191], v[190:191], v[12:13] op_sel_hi:[1,0]
    v_pk_mul_f32 v[192:193], v[192:193], v[12:13] op_sel_hi:[1,0]
    v_pk_mul_f32 v[194:195], v[194:195], v[12:13] op_sel_hi:[1,0]
    v_cvt_pk_bf16_f32 v64, v180, v181
    v_cvt_pk_bf16_f32 v65, v182, v183
    v_cvt_pk_bf16_f32 v66, v184, v185
    v_cvt_pk_bf16_f32 v67, v186, v187
    buffer_store_dwordx4 v[64:67], v7, s[8:11], s58 offen offset:0 sc1
    v_cvt_pk_bf16_f32 v68, v188, v189
    v_cvt_pk_bf16_f32 v69, v190, v191
    v_cvt_pk_bf16_f32 v70, v192, v193
    v_cvt_pk_bf16_f32 v71, v194, v195
    buffer_store_dwordx4 v[68:71], v7, s[8:11], s58 offen offset:2048 sc1
    s_mov_b32 s77, s75
    s_cmp_ge_u32 s53, 24
    s_cselect_b32 s55, 2, 1
    s_mul_i32 s54, s55, 262144
    s_add_u32 s58, s58, s54
    s_mul_i32 s54, s55, 131072
    s_add_u32 s66, s66, s54
    s_mul_i32 s54, s55, 65536
    s_add_u32 s67, s67, s54
    s_mul_i32 s54, s55, 1
    s_add_u32 s53, s53, s54
L_rot_58:
    v_mov_b64 v[72:73], v[200:201]
    v_mov_b64 v[74:75], v[202:203]
    v_mov_b64 v[76:77], v[204:205]
    v_mov_b64 v[78:79], v[206:207]
    v_mov_b64 v[80:81], v[208:209]
    v_mov_b64 v[82:83], v[210:211]
    v_mov_b64 v[84:85], v[212:213]
    v_mov_b64 v[86:87], v[214:215]
    v_mov_b64 v[168:169], v[216:217]
    v_mov_b64 v[170:171], v[218:219]
    v_mov_b64 v[172:173], v[220:221]
    v_mov_b64 v[174:175], v[222:223]
    v_mov_b64 v[136:137], v[224:225]
    v_mov_b64 v[138:139], v[226:227]
    v_mov_b64 v[140:141], v[228:229]
    v_mov_b64 v[142:143], v[230:231]
    v_mov_b64 v[144:145], v[232:233]
    v_mov_b64 v[146:147], v[234:235]
    v_mov_b64 v[148:149], v[236:237]
    v_mov_b64 v[150:151], v[238:239]
    s_cmp_lt_u32 s53, 64
    s_cbranch_scc1 L_at_55
    s_waitcnt vmcnt(0)
    v_mov_b32_e64 v5, 64
    s_mov_b64 exec, 1
    buffer_store_dword v5, off, s[8:11], s57 sc1
    s_mov_b64 exec, -1
    s_endpgm
L_notQ:
    s_sub_u32 s52, s52, 32
    s_cmp_ge_u32 s52, 36
    s_cbranch_scc1 L_notH
    s_cmp_lg_u32 s4, 0
    s_cbranch_scc1 L_gook_66
    s_mov_b32 s79, 524288
    s_mov_b32 s55, 39936
L_go_65:
    buffer_load_dword v2, off, s[8:11], s55 sc1
    s_waitcnt vmcnt(0)
    v_readfirstlane_b32 s54, v2
    s_cmp_lg_u32 s54, 0
    s_cbranch_scc1 L_gook_66
    s_sleep 4
    s_sub_u32 s79, s79, 1
    s_cbranch_scc1 L_fail
    s_branch L_go_65
L_gook_66:
    s_barrier
    v_lshrrev_b32 v1, 4, v0
    v_lshrrev_b32 v2, 4, v1
    v_and_b32 v3, 15, v1
    v_lshlrev_b32 v4, 2, v2
    v_xor_b32_e64 v3, v3, v4
    v_mul_u32_u24 v2, 9216, v2
    v_lshl_add_u32 v4, v3, 4, v2
    s_mul_i32 s54, s4, 1327104
    s_lshl_b32 s55, s52, 8
    s_add_u32 s54, s54, s55
    s_mul_i32 s55, s4, 36864
    s_mov_b32 m0, s55
    s_add_u32 s55, s55, 1024
    buffer_load_dwordx4 v4, s[40:43], s54 offen lds
    s_add_u32 s54, s54, 36864
    s_mov_b32 m0, s55
    s_add_u32 s55, s55, 1024
    buffer_load_dwordx4 v4, s[40:43], s54 offen lds
    s_add_u32 s54, s54, 36864
    s_mov_b32 m0, s55
    s_add_u32 s55, s55, 1024
    buffer_load_dwordx4 v4, s[40:43], s54 offen lds
    s_add_u32 s54, s54, 36864
    s_mov_b32 m0, s55
    s_add_u32 s55, s55, 1024
    buffer_load_dwordx4 v4, s[40:43], s54 offen lds
    s_add_u32 s54, s54, 36864
    s_mov_b32 m0, s55
    s_add_u32 s55, s55, 1024
    buffer_load_dwordx4 v4, s[40:43], s54 offen lds
    s_add_u32 s54, s54, 36864
    s_mov_b32 m0, s55
    s_add_u32 s55, s55, 1024
    buffer_load_dwordx4 v4, s[40:43], s54 offen lds
    s_add_u32 s54, s54, 36864
    s_mov_b32 m0, s55
    s_add_u32 s55, s55, 1024
    buffer_load_dwordx4 v4, s[40:43], s54 offen lds
    s_add_u32 s54, s54, 36864
    s_mov_b32 m0, s55
    s_add_u32 s55, s55, 1024
    buffer_load_dwordx4 v4, s[40:43], s54 offen lds
    s_add_u32 s54, s54, 36864
    s_mov_b32 m0, s55
    s_add_u32 s55, s55, 1024
    buffer_load_dwordx4 v4, s[40:43], s54 offen lds
    s_add_u32 s54, s54, 36864
    s_mov_b32 m0, s55
    s_add_u32 s55, s55, 1024
    buffer_load_dwordx4 v4, s[40:43], s54 offen lds
    s_add_u32 s54, s54, 36864
    s_mov_b32 m0, s55
    s_add_u32 s55, s55, 1024
    buffer_load_dwordx4 v4, s[40:43], s54 offen lds
    s_add_u32 s54, s54, 36864
    s_mov_b32 m0, s55
    s_add_u32 s55, s55, 1024
    buffer_load_dwordx4 v4, s[40:43], s54 offen lds
    s_add_u32 s54, s54, 36864
    s_mov_b32 m0, s55
    s_add_u32 s55, s55, 1024
    buffer_load_dwordx4 v4, s[40:43], s54 offen lds
    s_add_u32 s54, s54, 36864
    s_mov_b32 m0, s55
    s_add_u32 s55, s55, 1024
    buffer_load_dwordx4 v4, s[40:43], s54 offen lds
    s_add_u32 s54, s54, 36864
    s_mov_b32 m0, s55
    s_add_u32 s55, s55, 1024
    buffer_load_dwordx4 v4, s[40:43], s54 offen lds
    s_add_u32 s54, s54, 36864
    s_mov_b32 m0, s55
    s_add_u32 s55, s55, 1024
    buffer_load_dwordx4 v4, s[40:43], s54 offen lds
    s_add_u32 s54, s54, 36864
    s_mov_b32 m0, s55
    s_add_u32 s55, s55, 1024
    buffer_load_dwordx4 v4, s[40:43], s54 offen lds
    s_add_u32 s54, s54, 36864
    s_mov_b32 m0, s55
    s_add_u32 s55, s55, 1024
    buffer_load_dwordx4 v4, s[40:43], s54 offen lds
    s_add_u32 s54, s54, 36864
    s_mov_b32 m0, s55
    s_add_u32 s55, s55, 1024
    buffer_load_dwordx4 v4, s[40:43], s54 offen lds
    s_add_u32 s54, s54, 36864
    s_mov_b32 m0, s55
    s_add_u32 s55, s55, 1024
    buffer_load_dwordx4 v4, s[40:43], s54 offen lds
    s_add_u32 s54, s54, 36864
    s_mov_b32 m0, s55
    s_add_u32 s55, s55, 1024
    buffer_load_dwordx4 v4, s[40:43], s54 offen lds
    s_add_u32 s54, s54, 36864
    s_mov_b32 m0, s55
    s_add_u32 s55, s55, 1024
    buffer_load_dwordx4 v4, s[40:43], s54 offen lds
    s_add_u32 s54, s54, 36864
    s_mov_b32 m0, s55
    s_add_u32 s55, s55, 1024
    buffer_load_dwordx4 v4, s[40:43], s54 offen lds
    s_add_u32 s54, s54, 36864
    s_mov_b32 m0, s55
    s_add_u32 s55, s55, 1024
    buffer_load_dwordx4 v4, s[40:43], s54 offen lds
    s_add_u32 s54, s54, 36864
    s_mov_b32 m0, s55
    s_add_u32 s55, s55, 1024
    buffer_load_dwordx4 v4, s[40:43], s54 offen lds
    s_add_u32 s54, s54, 36864
    s_mov_b32 m0, s55
    s_add_u32 s55, s55, 1024
    buffer_load_dwordx4 v4, s[40:43], s54 offen lds
    s_add_u32 s54, s54, 36864
    s_mov_b32 m0, s55
    s_add_u32 s55, s55, 1024
    buffer_load_dwordx4 v4, s[40:43], s54 offen lds
    s_add_u32 s54, s54, 36864
    s_mov_b32 m0, s55
    s_add_u32 s55, s55, 1024
    buffer_load_dwordx4 v4, s[40:43], s54 offen lds
    s_add_u32 s54, s54, 36864
    s_mov_b32 m0, s55
    s_add_u32 s55, s55, 1024
    buffer_load_dwordx4 v4, s[40:43], s54 offen lds
    s_add_u32 s54, s54, 36864
    s_mov_b32 m0, s55
    s_add_u32 s55, s55, 1024
    buffer_load_dwordx4 v4, s[40:43], s54 offen lds
    s_add_u32 s54, s54, 36864
    s_mov_b32 m0, s55
    s_add_u32 s55, s55, 1024
    buffer_load_dwordx4 v4, s[40:43], s54 offen lds
    s_add_u32 s54, s54, 36864
    s_mov_b32 m0, s55
    s_add_u32 s55, s55, 1024
    buffer_load_dwordx4 v4, s[40:43], s54 offen lds
    s_add_u32 s54, s54, 36864
    s_mov_b32 m0, s55
    s_add_u32 s55, s55, 1024
    buffer_load_dwordx4 v4, s[40:43], s54 offen lds
    s_add_u32 s54, s54, 36864
    s_mov_b32 m0, s55
    s_add_u32 s55, s55, 1024
    buffer_load_dwordx4 v4, s[40:43], s54 offen lds
    s_add_u32 s54, s54, 36864
    s_mov_b32 m0, s55
    s_add_u32 s55, s55, 1024
    buffer_load_dwordx4 v4, s[40:43], s54 offen lds
    s_add_u32 s54, s54, 36864
    s_mov_b32 m0, s55
    s_add_u32 s55, s55, 1024
    buffer_load_dwordx4 v4, s[40:43], s54 offen lds
    s_add_u32 s54, s54, 36864
    v_lshrrev_b32_e64 v5, 5, v1
    v_bfe_u32 v6, v1, 2, 2
    v_bfe_u32 v7, v1, 4, 1
    v_and_b32_e64 v8, 3, v1
    v_lshl_add_u32 v7, v7, 2, v8
    v_lshrrev_b32 v8, 1, v7
    s_lshl_b32 s54, s4, 2
    v_add_u32 v8, s54, v8
    v_lshlrev_b32 v9, 2, v6
    v_xor_b32 v8, v8, v9
    v_and_b32 v7, 1, v7
    v_lshlrev_b32_e64 v7, 3, v7
    v_lshl_add_u32 v7, v8, 4, v7
    v_lshl_add_u32 v5, v5, 3, v6
    v_lshl_add_u32 v5, v5, 8, v7
    s_waitcnt vmcnt(0)
    s_barrier
    ds_read_b64_tr_b16 a[0:1], v5 offset:0
    ds_read_b64_tr_b16 a[2:3], v5 offset:1024
    ds_read_b64_tr_b16 a[4:5], v5 offset:4096
    ds_read_b64_tr_b16 a[6:7], v5 offset:5120
    ds_read_b64_tr_b16 a[8:9], v5 offset:8192
    ds_read_b64_tr_b16 a[10:11], v5 offset:9216
    ds_read_b64_tr_b16 a[12:13], v5 offset:12288
    ds_read_b64_tr_b16 a[14:15], v5 offset:13312
    ds_read_b64_tr_b16 a[16:17], v5 offset:16384
    ds_read_b64_tr_b16 a[18:19], v5 offset:17408
    ds_read_b64_tr_b16 a[20:21], v5 offset:20480
    ds_read_b64_tr_b16 a[22:23], v5 offset:21504
    ds_read_b64_tr_b16 a[24:25], v5 offset:24576
    ds_read_b64_tr_b16 a[26:27], v5 offset:25600
    ds_read_b64_tr_b16 a[28:29], v5 offset:28672
    ds_read_b64_tr_b16 a[30:31], v5 offset:29696
    ds_read_b64_tr_b16 a[32:33], v5 offset:32768
    ds_read_b64_tr_b16 a[34:35], v5 offset:33792
    ds_read_b64_tr_b16 a[36:37], v5 offset:36864
    ds_read_b64_tr_b16 a[38:39], v5 offset:37888
    ds_read_b64_tr_b16 a[40:41], v5 offset:40960
    ds_read_b64_tr_b16 a[42:43], v5 offset:41984
    ds_read_b64_tr_b16 a[44:45], v5 offset:45056
    ds_read_b64_tr_b16 a[46:47], v5 offset:46080
    ds_read_b64_tr_b16 a[48:49], v5 offset:49152
    ds_read_b64_tr_b16 a[50:51], v5 offset:50176
    ds_read_b64_tr_b16 a[52:53], v5 offset:53248
    ds_read_b64_tr_b16 a[54:55], v5 offset:54272
    ds_read_b64_tr_b16 a[56:57], v5 offset:57344
    ds_read_b64_tr_b16 a[58:59], v5 offset:58368
    ds_read_b64_tr_b16 a[60:61], v5 offset:61440
    ds_read_b64_tr_b16 a[62:63], v5 offset:62464
    v_add_u32 v5, 0x10000, v5
    ds_read_b64_tr_b16 a[64:65], v5 offset:0
    ds_read_b64_tr_b16 a[66:67], v5 offset:1024
    ds_read_b64_tr_b16 a[68:69], v5 offset:4096
    ds_read_b64_tr_b16 a[70:71], v5 offset:5120
    ds_read_b64_tr_b16 a[72:73], v5 offset:8192
    ds_read_b64_tr_b16 a[74:75], v5 offset:9216
    ds_read_b64_tr_b16 a[76:77], v5 offset:12288
    ds_read_b64_tr_b16 a[78:79], v5 offset:13312
    ds_read_b64_tr_b16 a[80:81], v5 offset:16384
    ds_read_b64_tr_b16 a[82:83], v5 offset:17408
    ds_read_b64_tr_b16 a[84:85], v5 offset:20480
    ds_read_b64_tr_b16 a[86:87], v5 offset:21504
    ds_read_b64_tr_b16 a[88:89], v5 offset:24576
    ds_read_b64_tr_b16 a[90:91], v5 offset:25600
    ds_read_b64_tr_b16 a[92:93], v5 offset:28672
    ds_read_b64_tr_b16 a[94:95], v5 offset:29696
    ds_read_b64_tr_b16 a[96:97], v5 offset:32768
    ds_read_b64_tr_b16 a[98:99], v5 offset:33792
    ds_read_b64_tr_b16 a[100:101], v5 offset:36864
    ds_read_b64_tr_b16 a[102:103], v5 offset:37888
    ds_read_b64_tr_b16 a[104:105], v5 offset:40960
    ds_read_b64_tr_b16 a[106:107], v5 offset:41984
    ds_read_b64_tr_b16 a[108:109], v5 offset:45056
    ds_read_b64_tr_b16 a[110:111], v5 offset:46080
    ds_read_b64_tr_b16 a[112:113], v5 offset:49152
    ds_read_b64_tr_b16 a[114:115], v5 offset:50176
    ds_read_b64_tr_b16 a[116:117], v5 offset:53248
    ds_read_b64_tr_b16 a[118:119], v5 offset:54272
    ds_read_b64_tr_b16 a[120:121], v5 offset:57344
    ds_read_b64_tr_b16 a[122:123], v5 offset:58368
    ds_read_b64_tr_b16 a[124:125], v5 offset:61440
    ds_read_b64_tr_b16 a[126:127], v5 offset:62464
    v_add_u32 v5, 0x10000, v5
    ds_read_b64_tr_b16 a[128:129], v5 offset:0
    ds_read_b64_tr_b16 a[130:131], v5 offset:1024
    ds_read_b64_tr_b16 a[132:133], v5 offset:4096
    ds_read_b64_tr_b16 a[134:135], v5 offset:5120
    ds_read_b64_tr_b16 a[136:137], v5 offset:8192
    ds_read_b64_tr_b16 a[138:139], v5 offset:9216
    ds_read_b64_tr_b16 a[140:141], v5 offset:12288
    ds_read_b64_tr_b16 a[142:143], v5 offset:13312
    v_lshlrev_b32_e64 v6, 3, v0
    s_mov_b32 s61, 0
    s_mov_b32 s54, 1
    s_mov_b32 s55, 16384
    s_cmp_ge_u32 s61, s54
    s_cbranch_scc1 L_wd_68
    s_mov_b32 s79, 524288
L_w_67:
    buffer_load_dwordx4 v[8:11], v6, s[8:11], s55 offen sc1
    s_waitcnt vmcnt(0)
    v_min3_u32 v8, v8, v9, v10
    v_min_u32 v8, v8, v11
    v_cmp_gt_u32 vcc, s54, v8
    s_cbranch_vccz L_wo_69
    s_sub_u32 s79, s79, 1
    s_cbranch_scc1 L_fail
    s_branch L_w_67
L_wo_69:
    s_nop 1
    v_min_u32_dpp v8, v8, v8 quad_perm:[1,0,3,2] row_mask:0xf bank_mask:0xf
    s_nop 1
    v_min_u32_dpp v8, v8, v8 quad_perm:[2,3,0,1] row_mask:0xf bank_mask:0xf
    s_nop 1
    v_min_u32_dpp v8, v8, v8 row_half_mirror row_mask:0xf bank_mask:0xf
    s_nop 1
    v_min_u32_dpp v8, v8, v8 row_mirror row_mask:0xf bank_mask:0xf
    s_nop 0
    v_readlane_b32 s61, v8, 0
    v_readlane_b32 s56, v8, 16
    s_min_u32 s61, s61, s56
    v_readlane_b32 s56, v8, 32
    s_min_u32 s61, s61, s56
    v_readlane_b32 s56, v8, 48
    s_min_u32 s61, s61, s56
L_wd_68:
    s_waitcnt lgkmcnt(0)
    s_barrier
    v_bfe_u32 v2, v1, 4, 1
    v_lshlrev_b32 v2, 10, v2
    v_lshrrev_b32_e64 v3, 5, v1
    v_lshl_add_u32 v2, v3, 8, v2
    v_and_b32 v3, 0xf0, v0
    v_add_u32_e64 v2, v2, v3
    s_mul_i32 s60, s4, 9216
    s_add_u32 s59, s60, 1048576
    s_lshl_b32 s54, s52, 7
    s_lshl_b32 s55, s4, 2
    s_add_u32 s57, s54, s55
    s_add_u32 s57, s57, 24576
    s_lshl_b32 s54, s52, 2
    s_add_u32 s54, s54, s4
    s_lshl_b32 s58, s54, 11
    s_add_u32 s58, s58, 67108864
    s_mov_b32 s72, 0xbfb8aa3b
    v_mov_b32 v3, v0
    v_mov_b32 v6, 0
    s_mov_b32 s62, 0
    s_lshl_b32 s69, s52, 7
    s_add_u32 s69, s69, 8204
    s_add_u32 m0, s60, 0
    s_add_u32 s54, s59, 0
    buffer_load_dwordx4 v0, s[8:11], s54 offen sc1 lds
    s_add_u32 m0, s60, 1024
    s_add_u32 s54, s59, 1024
    buffer_load_dwordx4 v0, s[8:11], s54 offen sc1 lds
    s_add_u32 m0, s60, 2048
    s_add_u32 s54, s59, 2048
    buffer_load_dwordx4 v0, s[8:11], s54 offen sc1 lds
    s_add_u32 m0, s60, 3072
    s_add_u32 s54, s59, 3072
    buffer_load_dwordx4 v0, s[8:11], s54 offen sc1 lds
    s_add_u32 m0, s60, 4096
    s_add_u32 s54, s59, 4096
    buffer_load_dwordx4 v0, s[8:11], s54 offen sc1 lds
    s_add_u32 m0, s60, 5120
    s_add_u32 s54, s59, 5120
    buffer_load_dwordx4 v0, s[8:11], s54 offen sc1 lds
    s_add_u32 m0, s60, 6144
    s_add_u32 s54, s59, 6144
    buffer_load_dwordx4 v0, s[8:11], s54 offen sc1 lds
    s_add_u32 m0, s60, 7168
    s_add_u32 s54, s59, 7168
    buffer_load_dwordx4 v0, s[8:11], s54 offen sc1 lds
    s_add_u32 m0, s60, 8192
    s_add_u32 s54, s59, 8192
    buffer_load_dwordx4 v0, s[8:11], s54 offen sc1 lds
    s_add_u32 s59, s59, 36864
    s_add_u32 s60, s60, 36864
    s_cmp_ge_u32 s60, 147456
    s_cselect_b32 s54, 147456, 0
    s_sub_u32 s60, s60, s54
    s_add_u32 m0, s60, 0
    s_add_u32 s54, s59, 0
    buffer_load_dwordx4 v0, s[8:11], s54 offen sc1 lds
    s_add_u32 m0, s60, 1024
    s_add_u32 s54, s59, 1024
    buffer_load_dwordx4 v0, s[8:11], s54 offen sc1 lds
    s_add_u32 m0, s60, 2048
    s_add_u32 s54, s59, 2048
    buffer_load_dwordx4 v0, s[8:11], s54 offen sc1 lds
    s_add_u32 m0, s60, 3072
    s_add_u32 s54, s59, 3072
    buffer_load_dwordx4 v0, s[8:11], s54 offen sc1 lds
    s_add_u32 m0, s60, 4096
    s_add_u32 s54, s59, 4096
    buffer_load_dwordx4 v0, s[8:11], s54 offen sc1 lds
    s_add_u32 m0, s60, 5120
    s_add_u32 s54, s59, 5120
    buffer_load_dwordx4 v0, s[8:11], s54 offen sc1 lds
    s_add_u32 m0, s60, 6144
    s_add_u32 s54, s59, 6144
    buffer_load_dwordx4 v0, s[8:11], s54 offen sc1 lds
    s_add_u32 m0, s60, 7168
    s_add_u32 s54, s59, 7168
    buffer_load_dwordx4 v0, s[8:11], s54 offen sc1 lds
    s_add_u32 m0, s60, 8192
    s_add_u32 s54, s59, 8192
    buffer_load_dwordx4 v0, s[8:11], s54 offen sc1 lds
    s_add_u32 s59, s59, 36864
    s_add_u32 s60, s60, 36864
    s_cmp_ge_u32 s60, 147456
    s_cselect_b32 s54, 147456, 0
    s_sub_u32 s60, s60, s54
    s_add_u32 m0, s60, 0
    s_add_u32 s54, s59, 0
    buffer_load_dwordx4 v0, s[8:11], s54 offen sc1 lds
    s_add_u32 m0, s60, 1024
    s_add_u32 s54, s59, 1024
    buffer_load_dwordx4 v0, s[8:11], s54 offen sc1 lds
    s_add_u32 m0, s60, 2048
    s_add_u32 s54, s59, 2048
    buffer_load_dwordx4 v0, s[8:11], s54 offen sc1 lds
    s_add_u32 m0, s60, 3072
    s_add_u32 s54, s59, 3072
    buffer_load_dwordx4 v0, s[8:11], s54 offen sc1 lds
    s_add_u32 m0, s60, 4096
    s_add_u32 s54, s59, 4096
    buffer_load_dwordx4 v0, s[8:11], s54 offen sc1 lds
    s_add_u32 m0, s60, 5120
    s_add_u32 s54, s59, 5120
    buffer_load_dwordx4 v0, s[8:11], s54 offen sc1 lds
    s_add_u32 m0, s60, 6144
    s_add_u32 s54, s59, 6144
    buffer_load_dwordx4 v0, s[8:11], s54 offen sc1 lds
    s_add_u32 m0, s60, 7168
    s_add_u32 s54, s59, 7168
    buffer_load_dwordx4 v0, s[8:11], s54 offen sc1 lds
    s_add_u32 m0, s60, 8192
    s_add_u32 s54, s59, 8192
    buffer_load_dwordx4 v0, s[8:11], s54 offen sc1 lds
    s_add_u32 s59, s59, 36864
    s_add_u32 s60, s60, 36864
    s_cmp_ge_u32 s60, 147456
    s_cselect_b32 s54, 147456, 0
    s_sub_u32 s60, s60, s54
    s_mov_b32 s53, 0
    s_waitcnt vmcnt(18)
    s_barrier
    ds_read_b128 v[48:51], v3 offset:0
    ds_read_b128 v[52:55], v3 offset:1024
    ds_read_b128 v[56:59], v3 offset:2048
    ds_read_b128 v[60:63], v3 offset:3072
    s_waitcnt lgkmcnt(3)
    v_mfma_f32_32x32x16_bf16 v[16:31], a[0:3], v[48:51], 0
    ds_read_b128 v[48:51], v3 offset:4096
    s_waitcnt lgkmcnt(3)
    v_mfma_f32_32x32x16_bf16 v[16:31], a[4:7], v[52:55], v[16:31]
    ds_read_b128 v[52:55], v3 offset:5120
    s_waitcnt lgkmcnt(3)
    v_mfma_f32_32x32x16_bf16 v[16:31], a[8:11], v[56:59], v[16:31]
    ds_read_b128 v[56:59], v3 offset:6144
    s_add_u32 m0, s60, 0
    s_add_u32 s54, s59, 0
    buffer_load_dwordx4 v0, s[8:11], s54 offen sc1 lds
    s_waitcnt lgkmcnt(3)
    v_mfma_f32_32x32x16_bf16 v[16:31], a[12:15], v[60:63], v[16:31]
    ds_read_b128 v[60:63], v3 offset:7168
    s_waitcnt lgkmcnt(3)
    v_mfma_f32_32x32x16_bf16 v[16:31], a[16:19], v[48:51], v[16:31]
    ds_read_b128 v[48:51], v3 offset:8192
    s_waitcnt lgkmcnt(3)
    v_mfma_f32_32x32x16_bf16 v[16:31], a[20:23], v[52:55], v[16:31]
    ds_read_b128 v[52:55], v3 offset:9216
    s_add_u32 m0, s60, 1024
    s_add_u32 s54, s59, 1024
    buffer_load_dwordx4 v0, s[8:11], s54 offen sc1 lds
    s_waitcnt lgkmcnt(3)
    v_mfma_f32_32x32x16_bf16 v[16:31], a[24:27], v[56:59], v[16:31]
    ds_read_b128 v[56:59], v3 offset:10240
    s_waitcnt lgkmcnt(3)
    v_mfma_f32_32x32x16_bf16 v[16:31], a[28:31], v[60:63], v[16:31]
    ds_read_b128 v[60:63], v3 offset:11264
    s_waitcnt lgkmcnt(3)
    v_mfma_f32_32x32x16_bf16 v[16:31], a[32:35], v[48:51], v[16:31]
    ds_read_b128 v[48:51], v3 offset:12288
    s_add_u32 m0, s60, 2048
    s_add_u32 s54, s59, 2048
    buffer_load_dwordx4 v0, s[8:11], s54 offen sc1 lds
    s_waitcnt lgkmcnt(3)
    v_mfma_f32_32x32x16_bf16 v[16:31], a[36:39], v[52:55], v[16:31]
    ds_read_b128 v[52:55], v3 offset:13312
    s_waitcnt lgkmcnt(3)
    v_mfma_f32_32x32x16_bf16 v[16:31], a[40:43], v[56:59], v[16:31]
    ds_read_b128 v[56:59], v3 offset:14336
    s_waitcnt lgkmcnt(3)
    v_mfma_f32_32x32x16_bf16 v[16:31], a[44:47], v[60:63], v[16:31]
    ds_read_b128 v[60:63], v3 offset:15360
    s_add_u32 m0, s60, 3072
    s_add_u32 s54, s59, 3072
    buffer_load_dwordx4 v0, s[8:11], s54 offen sc1 lds
    s_waitcnt lgkmcnt(3)
    v_mfma_f32_32x32x16_bf16 v[16:31], a[48:51], v[48:51], v[16:31]
    ds_read_b128 v[48:51], v3 offset:16384
    s_waitcnt lgkmcnt(3)
    v_mfma_f32_32x32x16_bf16 v[16:31], a[52:55], v[52:55], v[16:31]
    ds_read_b128 v[52:55], v3 offset:17408
    s_waitcnt lgkmcnt(3)
    v_mfma_f32_32x32x16_bf16 v[16:31], a[56:59], v[56:59], v[16:31]
    ds_read_b128 v[56:59], v3 offset:18432
    s_add_u32 m0, s60, 4096
    s_add_u32 s54, s59, 4096
    buffer_load_dwordx4 v0, s[8:11], s54 offen sc1 lds
    s_waitcnt lgkmcnt(3)
    v_mfma_f32_32x32x16_bf16 v[16:31], a[60:63], v[60:63], v[16:31]
    ds_read_b128 v[60:63], v3 offset:19456
    s_waitcnt lgkmcnt(3)
    v_mfma_f32_32x32x16_bf16 v[16:31], a[64:67], v[48:51], v[16:31]
    ds_read_b128 v[48:51], v3 offset:20480
    s_waitcnt lgkmcnt(3)
    v_mfma_f32_32x32x16_bf16 v[16:31], a[68:71], v[52:55], v[16:31]
    ds_read_b128 v[52:55], v3 offset:21504
    s_add_u32 m0, s60, 5120
    s_add_u32 s54, s59, 5120
    buffer_load_dwordx4 v0, s[8:11], s54 offen sc1 lds
    s_waitcnt lgkmcnt(3)
    v_mfma_f32_32x32x16_bf16 v[16:31], a[72:75], v[56:59], v[16:31]
    ds_read_b128 v[56:59], v3 offset:22528
    s_waitcnt lgkmcnt(3)
    v_mfma_f32_32x32x16_bf16 v[16:31], a[76:79], v[60:63], v[16:31]
    ds_read_b128 v[60:63], v3 offset:23552
    s_waitcnt lgkmcnt(3)
    v_mfma_f32_32x32x16_bf16 v[16:31], a[80:83], v[48:51], v[16:31]
    ds_read_b128 v[48:51], v3 offset:24576
    s_add_u32 m0, s60, 6144
    s_add_u32 s54, s59, 6144
    buffer_load_dwordx4 v0, s[8:11], s54 offen sc1 lds
    s_waitcnt lgkmcnt(3)
    v_mfma_f32_32x32x16_bf16 v[16:31], a[84:87], v[52:55], v[16:31]
    ds_read_b128 v[52:55], v3 offset:25600
    s_waitcnt lgkmcnt(3)
    v_mfma_f32_32x32x16_bf16 v[16:31], a[88:91], v[56:59], v[16:31]
    ds_read_b128 v[56:59], v3 offset:26624
    s_waitcnt lgkmcnt(3)
    v_mfma_f32_32x32x16_bf16 v[16:31], a[92:95], v[60:63], v[16:31]
    ds_read_b128 v[60:63], v3 offset:27648
    s_add_u32 m0, s60, 7168
    s_add_u32 s54, s59, 7168
    buffer_load_dwordx4 v0, s[8:11], s54 offen sc1 lds
    s_waitcnt lgkmcnt(3)
    v_mfma_f32_32x32x16_bf16 v[16:31], a[96:99], v[48:51], v[16:31]
    ds_read_b128 v[48:51], v3 offset:28672
    s_waitcnt lgkmcnt(3)
    v_mfma_f32_32x32x16_bf16 v[16:31], a[100:103], v[52:55], v[16:31]
    ds_read_b128 v[52:55], v3 offset:29696
    s_waitcnt lgkmcnt(3)
    v_mfma_f32_32x32x16_bf16 v[16:31], a[104:107], v[56:59], v[16:31]
    ds_read_b128 v[56:59], v3 offset:30720
    s_add_u32 m0, s60, 8192
    s_add_u32 s54, s59, 8192
    buffer_load_dwordx4 v0, s[8:11], s54 offen sc1 lds
    s_add_u32 s59, s59, 36864
    s_add_u32 s60, s60, 36864
    s_cmp_ge_u32 s60, 147456
    s_cselect_b32 s54, 147456, 0
    s_sub_u32 s60, s60, s54
    s_waitcnt lgkmcnt(3)
    v_mfma_f32_32x32x16_bf16 v[16:31], a[108:111], v[60:63], v[16:31]
    ds_read_b128 v[60:63], v3 offset:31744
    s_waitcnt lgkmcnt(3)
    v_mfma_f32_32x32x16_bf16 v[16:31], a[112:115], v[48:51], v[16:31]
    ds_read_b128 v[48:51], v3 offset:32768
    s_waitcnt lgkmcnt(3)
    v_mfma_f32_32x32x16_bf16 v[16:31], a[116:119], v[52:55], v[16:31]
    ds_read_b128 v[52:55], v3 offset:33792
    s_waitcnt lgkmcnt(3)
    v_mfma_f32_32x32x16_bf16 v[16:31], a[120:123], v[56:59], v[16:31]
    ds_read_b128 v[56:59], v3 offset:34816
    s_waitcnt lgkmcnt(3)
    v_mfma_f32_32x32x16_bf16 v[16:31], a[124:127], v[60:63], v[16:31]
    ds_read_b128 v[60:63], v3 offset:35840
    s_waitcnt lgkmcnt(3)
    v_mfma_f32_32x32x16_bf16 v[16:31], a[128:131], v[48:51], v[16:31]
    s_waitcnt lgkmcnt(2)
    v_mfma_f32_32x32x16_bf16 v[16:31], a[132:135], v[52:55], v[16:31]
    s_waitcnt lgkmcnt(1)
    v_mfma_f32_32x32x16_bf16 v[16:31], a[136:139], v[56:59], v[16:31]
    s_waitcnt lgkmcnt(0)
    v_mfma_f32_32x32x16_bf16 v[16:31], a[140:143], v[60:63], v[16:31]
    v_add_u32 v3, 36864, v3
    v_subrev_u32 v4, 147456, v3
    v_min_u32 v3, v3, v4
    s_waitcnt vmcnt(18)
    s_branch L_pj_in_70
L_pj_71:
    s_waitcnt vmcnt(12)
L_pj_in_70:
    s_barrier
    s_max_u32 s54, s53, 1
    s_sub_u32 s54, s54, 1
    v_mov_b32 v5, s54
    s_mov_b64 exec, 1
    buffer_store_dword v5, off, s[8:11], s57 sc1
    s_mov_b64 exec, -1
    ds_read_b128 v[48:51], v3 offset:0
    ds_read_b128 v[52:55], v3 offset:1024
    ds_read_b128 v[56:59], v3 offset:2048
    ds_read_b128 v[60:63], v3 offset:3072
    s_waitcnt lgkmcnt(3)
    v_mfma_f32_32x32x16_bf16 v[32:47], a[0:3], v[48:51], 0
    ds_read_b128 v[48:51], v3 offset:4096
    s_add_u32 m0, s60, 0
    s_add_u32 s54, s59, 0
    buffer_load_dwordx4 v0, s[8:11], s54 offen sc1 lds
    s_waitcnt lgkmcnt(3)
    v_mfma_f32_32x32x16_bf16 v[32:47], a[4:7], v[52:55], v[32:47]
    ds_read_b128 v[52:55], v3 offset:5120
    s_add_u32 m0, s60, 1024
    s_add_u32 s54, s59, 1024
    buffer_load_dwordx4 v0, s[8:11], s54 offen sc1 lds
    s_waitcnt lgkmcnt(3)
    v_mfma_f32_32x32x16_bf16 v[32:47], a[8:11], v[56:59], v[32:47]
    ds_read_b128 v[56:59], v3 offset:6144
    s_add_u32 m0, s60, 2048
    s_add_u32 s54, s59, 2048
    buffer_load_dwordx4 v0, s[8:11], s54 offen sc1 lds
    s_waitcnt lgkmcnt(3)
    v_mfma_f32_32x32x16_bf16 v[32:47], a[12:15], v[60:63], v[32:47]
    ds_read_b128 v[60:63], v3 offset:7168
    s_add_u32 m0, s60, 3072
    s_add_u32 s54, s59, 3072
    buffer_load_dwordx4 v0, s[8:11], s54 offen sc1 lds
    s_waitcnt lgkmcnt(3)
    v_mfma_f32_32x32x16_bf16 v[32:47], a[16:19], v[48:51], v[32:47]
    ds_read_b128 v[48:51], v3 offset:8192
    s_add_u32 m0, s60, 4096
    s_add_u32 s54, s59, 4096
    buffer_load_dwordx4 v0, s[8:11], s54 offen sc1 lds
    s_waitcnt lgkmcnt(3)
    v_mfma_f32_32x32x16_bf16 v[32:47], a[20:23], v[52:55], v[32:47]
    ds_read_b128 v[52:55], v3 offset:9216
    s_add_u32 m0, s60, 5120
    s_add_u32 s54, s59, 5120
    buffer_load_dwordx4 v0, s[8:11], s54 offen sc1 lds
    s_waitcnt lgkmcnt(3)
    v_mfma_f32_32x32x16_bf16 v[32:47], a[24:27], v[56:59], v[32:47]
    ds_read_b128 v[56:59], v3 offset:10240
    s_add_u32 m0, s60, 6144
    s_add_u32 s54, s59, 6144
    buffer_load_dwordx4 v0, s[8:11], s54 offen sc1 lds
    s_waitcnt lgkmcnt(3)
    v_mfma_f32_32x32x16_bf16 v[32:47], a[28:31], v[60:63], v[32:47]
    ds_read_b128 v[60:63], v3 offset:11264
    s_add_u32 m0, s60, 7168
    s_add_u32 s54, s59, 7168
    buffer_load_dwordx4 v0, s[8:11], s54 offen sc1 lds
    s_waitcnt lgkmcnt(3)
    v_mfma_f32_32x32x16_bf16 v[32:47], a[32:35], v[48:51], v[32:47]
    ds_read_b128 v[48:51], v3 offset:12288
    s_add_u32 m0, s60, 8192
    s_add_u32 s54, s59, 8192
    buffer_load_dwordx4 v0, s[8:11], s54 offen sc1 lds
    s_add_u32 s59, s59, 36864
    s_add_u32 s60, s60, 36864
    s_cmp_ge_u32 s60, 147456
    s_cselect_b32 s54, 147456, 0
    s_sub_u32 s60, s60, s54
    s_waitcnt lgkmcnt(3)
    v_mfma_f32_32x32x16_bf16 v[32:47], a[36:39], v[52:55], v[32:47]
    ds_read_b128 v[52:55], v3 offset:13312
    v_mul_f32 v72, s72, v16
    v_exp_f32 v72, v72
    s_nop 0
    v_add_f32 v72, 1.0, v72
    v_rcp_f32 v72, v72
    s_waitcnt lgkmcnt(3)
    v_mfma_f32_32x32x16_bf16 v[32:47], a[40:43], v[56:59], v[32:47]
    ds_read_b128 v[56:59], v3 offset:14336
    s_nop 0
    v_mul_f32 v16, v16, v72
    v_mul_f32 v73, s72, v17
    v_exp_f32 v73, v73
    s_nop 0
    s_waitcnt lgkmcnt(3)
    v_mfma_f32_32x32x16_bf16 v[32:47], a[44:47], v[60:63], v[32:47]
    ds_read_b128 v[60:63], v3 offset:15360
    v_add_f32 v73, 1.0, v73
    v_rcp_f32 v73, v73
    s_nop 0
    v_mul_f32 v17, v17, v73
    v_mul_f32 v74, s72, v18
    s_waitcnt lgkmcnt(3)
    v_mfma_f32_32x32x16_bf16 v[32:47], a[48:51], v[48:51], v[32:47]
    ds_read_b128 v[48:51], v3 offset:16384
    v_exp_f32 v74, v74
    s_nop 0
    v_add_f32 v74, 1.0, v74
    v_rcp_f32 v74, v74
    s_nop 0
    s_waitcnt lgkmcnt(3)
    v_mfma_f32_32x32x16_bf16 v[32:47], a[52:55], v[52:55], v[32:47]
    ds_read_b128 v[52:55], v3 offset:17408
    v_mul_f32 v18, v18, v74
    v_mul_f32 v75, s72, v19
    v_exp_f32 v75, v75
    s_nop 0
    v_add_f32 v75, 1.0, v75
    s_waitcnt lgkmcnt(3)
    v_mfma_f32_32x32x16_bf16 v[32:47], a[56:59], v[56:59], v[32:47]
    ds_read_b128 v[56:59], v3 offset:18432
    v_rcp_f32 v75, v75
    s_nop 0
    v_mul_f32 v19, v19, v75
    v_mul_f32 v72, s72, v20
    v_exp_f32 v72, v72
    s_waitcnt lgkmcnt(3)
    v_mfma_f32_32x32x16_bf16 v[32:47], a[60:63], v[60:63], v[32:47]
    ds_read_b128 v[60:63], v3 offset:19456
    s_nop 0
    v_add_f32 v72, 1.0, v72
    v_rcp_f32 v72, v72
    s_nop 0
    v_mul_f32 v20, v20, v72
    s_waitcnt lgkmcnt(3)
    v_mfma_f32_32x32x16_bf16 v[32:47], a[64:67], v[48:51], v[32:47]
    ds_read_b128 v[48:51], v3 offset:20480
    v_mul_f32 v73, s72, v21
    v_exp_f32 v73, v73
    s_nop 0
    v_add_f32 v73, 1.0, v73
    v_rcp_f32 v73, v73
    s_waitcnt lgkmcnt(3)
    v_mfma_f32_32x32x16_bf16 v[32:47], a[68:71], v[52:55], v[32:47]
    ds_read_b128 v[52:55], v3 offset:21504
    s_nop 0
    v_mul_f32 v21, v21, v73
    v_mul_f32 v74, s72, v22
    v_exp_f32 v74, v74
    s_nop 0
    s_waitcnt lgkmcnt(3)
    v_mfma_f32_32x32x16_bf16 v[32:47], a[72:75], v[56:59], v[32:47]
    ds_read_b128 v[56:59], v3 offset:22528
    v_add_f32 v74, 1.0, v74
    v_rcp_f32 v74, v74
    s_nop 0
    v_mul_f32 v22, v22, v74
    v_mul_f32 v75, s72, v23
    s_waitcnt lgkmcnt(3)
    v_mfma_f32_32x32x16_bf16 v[32:47], a[76:79], v[60:63], v[32:47]
    ds_read_b128 v[60:63], v3 offset:23552
    v_exp_f32 v75, v75
    s_nop 0
    v_add_f32 v75, 1.0, v75
    v_rcp_f32 v75, v75
    s_nop 0
    s_waitcnt lgkmcnt(3)
    v_mfma_f32_32x32x16_bf16 v[32:47], a[80:83], v[48:51], v[32:47]
    ds_read_b128 v[48:51], v3 offset:24576
    v_mul_f32 v23, v23, v75
    v_mul_f32 v72, s72, v24
    v_exp_f32 v72, v72
    s_nop 0
    v_add_f32 v72, 1.0, v72
    s_waitcnt lgkmcnt(3)
    v_mfma_f32_32x32x16_bf16 v[32:47], a[84:87], v[52:55], v[32:47]
    ds_read_b128 v[52:55], v3 offset:25600
    v_rcp_f32 v72, v72
    s_nop 0
    v_mul_f32 v24, v24, v72
    v_mul_f32 v73, s72, v25
    v_exp_f32 v73, v73
    s_waitcnt lgkmcnt(3)
    v_mfma_f32_32x32x16_bf16 v[32:47], a[88:91], v[56:59], v[32:47]
    ds_read_b128 v[56:59], v3 offset:26624
    s_nop 0
    v_add_f32 v73, 1.0, v73
    v_rcp_f32 v73, v73
    s_nop 0
    v_mul_f32 v25, v25, v73
    s_waitcnt lgkmcnt(3)
    v_mfma_f32_32x32x16_bf16 v[32:47], a[92:95], v[60:63], v[32:47]
    ds_read_b128 v[60:63], v3 offset:27648
    v_mul_f32 v74, s72, v26
    v_exp_f32 v74, v74
    s_nop 0
    v_add_f32 v74, 1.0, v74
    v_rcp_f32 v74, v74
    s_waitcnt lgkmcnt(3)
    v_mfma_f32_32x32x16_bf16 v[32:47], a[96:99], v[48:51], v[32:47]
    ds_read_b128 v[48:51], v3 offset:28672
    s_nop 0
    v_mul_f32 v26, v26, v74
    v_mul_f32 v75, s72, v27
    v_exp_f32 v75, v75
    s_nop 0
    s_waitcnt lgkmcnt(3)
    v_mfma_f32_32x32x16_bf16 v[32:47], a[100:103], v[52:55], v[32:47]
    ds_read_b128 v[52:55], v3 offset:29696
    v_add_f32 v75, 1.0, v75
    v_rcp_f32 v75, v75
    s_nop 0
    v_mul_f32 v27, v27, v75
    v_mul_f32 v72, s72, v28
    s_waitcnt lgkmcnt(3)
    v_mfma_f32_32x32x16_bf16 v[32:47], a[104:107], v[56:59], v[32:47]
    ds_read_b128 v[56:59], v3 offset:30720
    v_exp_f32 v72, v72
    s_nop 0
    v_add_f32 v72, 1.0, v72
    v_rcp_f32 v72, v72
    s_nop 0
    s_waitcnt lgkmcnt(3)
    v_mfma_f32_32x32x16_bf16 v[32:47], a[108:111], v[60:63], v[32:47]
    ds_read_b128 v[60:63], v3 offset:31744
    v_mul_f32 v28, v28, v72
    v_mul_f32 v73, s72, v29
    v_exp_f32 v73, v73
    s_nop 0
    v_add_f32 v73, 1.0, v73
    s_waitcnt lgkmcnt(3)
    v_mfma_f32_32x32x16_bf16 v[32:47], a[112:115], v[48:51], v[32:47]
    ds_read_b128 v[48:51], v3 offset:32768
    v_rcp_f32 v73, v73
    s_nop 0
    v_mul_f32 v29, v29, v73
    v_mul_f32 v74, s72, v30
    v_exp_f32 v74, v74
    s_waitcnt lgkmcnt(3)
    v_mfma_f32_32x32x16_bf16 v[32:47], a[116:119], v[52:55], v[32:47]
    ds_read_b128 v[52:55], v3 offset:33792
    s_nop 0
    v_add_f32 v74, 1.0, v74
    v_rcp_f32 v74, v74
    s_nop 0
    v_mul_f32 v30, v30, v74
    s_waitcnt lgkmcnt(3)
    v_mfma_f32_32x32x16_bf16 v[32:47], a[120:123], v[56:59], v[32:47]
    ds_read_b128 v[56:59], v3 offset:34816
    v_mul_f32 v75, s72, v31
    v_exp_f32 v75, v75
    s_nop 0
    v_add_f32 v75, 1.0, v75
    v_rcp_f32 v75, v75
    s_waitcnt lgkmcnt(3)
    v_mfma_f32_32x32x16_bf16 v[32:47], a[124:127], v[60:63], v[32:47]
    ds_read_b128 v[60:63], v3 offset:35840
    s_nop 0
    v_mul_f32 v31, v31, v75
    v_cvt_pk_bf16_f32 v64, v16, v17
    v_cvt_pk_bf16_f32 v65, v18, v19
    v_cvt_pk_bf16_f32 v66, v20, v21
    s_waitcnt lgkmcnt(3)
    v_mfma_f32_32x32x16_bf16 v[32:47], a[128:131], v[48:51], v[32:47]
    v_cvt_pk_bf16_f32 v67, v22, v23
    buffer_store_dwordx4 v[64:67], v0, s[8:11], s58 offen offset:0 sc1
    v_cvt_pk_bf16_f32 v68, v24, v25
    v_cvt_pk_bf16_f32 v69, v26, v27
    v_cvt_pk_bf16_f32 v70, v28, v29
    s_waitcnt lgkmcnt(2)
    v_mfma_f32_32x32x16_bf16 v[32:47], a[132:135], v[52:55], v[32:47]
    v_cvt_pk_bf16_f32 v71, v30, v31
    buffer_store_dwordx4 v[68:71], v0, s[8:11], s58 offen offset:1024 sc1
    s_add_u32 s58, s58, 294912
    s_waitcnt lgkmcnt(1)
    v_mfma_f32_32x32x16_bf16 v[32:47], a[136:139], v[56:59], v[32:47]
    s_waitcnt lgkmcnt(0)
    v_mfma_f32_32x32x16_bf16 v[32:47], a[140:143], v[60:63], v[32:47]
    v_add_u32 v3, 36864, v3
    v_subrev_u32 v4, 147456, v3
    v_min_u32 v3, v3, v4
    s_add_u32 s53, s53, 1
    s_cmp_ge_u32 s53, 63
    s_cbranch_scc1 L_pj_71_end
    s_waitcnt vmcnt(12)
    s_barrier
    s_max_u32 s54, s53, 1
    s_sub_u32 s54, s54, 1
    v_mov_b32 v5, s54
    s_mov_b64 exec, 1
    buffer_store_dword v5, off, s[8:11], s57 sc1
    s_mov_b64 exec, -1
    ds_read_b128 v[48:51], v3 offset:0
    ds_read_b128 v[52:55], v3 offset:1024
    ds_read_b128 v[56:59], v3 offset:2048
    ds_read_b128 v[60:63], v3 offset:3072
    s_waitcnt lgkmcnt(3)
    v_mfma_f32_32x32x16_bf16 v[16:31], a[0:3], v[48:51], 0
    ds_read_b128 v[48:51], v3 offset:4096
    s_add_u32 m0, s60, 0
    s_add_u32 s54, s59, 0
    buffer_load_dwordx4 v0, s[8:11], s54 offen sc1 lds
    s_waitcnt lgkmcnt(3)
    v_mfma_f32_32x32x16_bf16 v[16:31], a[4:7], v[52:55], v[16:31]
    ds_read_b128 v[52:55], v3 offset:5120
    s_add_u32 m0, s60, 1024
    s_add_u32 s54, s59, 1024
    buffer_load_dwordx4 v0, s[8:11], s54 offen sc1 lds
    s_waitcnt lgkmcnt(3)
    v_mfma_f32_32x32x16_bf16 v[16:31], a[8:11], v[56:59], v[16:31]
    ds_read_b128 v[56:59], v3 offset:6144
    s_add_u32 m0, s60, 2048
    s_add_u32 s54, s59, 2048
    buffer_load_dwordx4 v0, s[8:11], s54 offen sc1 lds
    s_waitcnt lgkmcnt(3)
    v_mfma_f32_32x32x16_bf16 v[16:31], a[12:15], v[60:63], v[16:31]
    ds_read_b128 v[60:63], v3 offset:7168
    s_add_u32 m0, s60, 3072
    s_add_u32 s54, s59, 3072
    buffer_load_dwordx4 v0, s[8:11], s54 offen sc1 lds
    s_waitcnt lgkmcnt(3)
    v_mfma_f32_32x32x16_bf16 v[16:31], a[16:19], v[48:51], v[16:31]
    ds_read_b128 v[48:51], v3 offset:8192
    s_add_u32 m0, s60, 4096
    s_add_u32 s54, s59, 4096
    buffer_load_dwordx4 v0, s[8:11], s54 offen sc1 lds
    s_waitcnt lgkmcnt(3)
    v_mfma_f32_32x32x16_bf16 v[16:31], a[20:23], v[52:55], v[16:31]
    ds_read_b128 v[52:55], v3 offset:9216
    s_add_u32 m0, s60, 5120
    s_add_u32 s54, s59, 5120
    buffer_load_dwordx4 v0, s[8:11], s54 offen sc1 lds
    s_waitcnt lgkmcnt(3)
    v_mfma_f32_32x32x16_bf16 v[16:31], a[24:27], v[56:59], v[16:31]
    ds_read_b128 v[56:59], v3 offset:10240
    s_add_u32 m0, s60, 6144
    s_add_u32 s54, s59, 6144
    buffer_load_dwordx4 v0, s[8:11], s54 offen sc1 lds
    s_waitcnt lgkmcnt(3)
    v_mfma_f32_32x32x16_bf16 v[16:31], a[28:31], v[60:63], v[16:31]
    ds_read_b128 v[60:63], v3 offset:11264
    s_add_u32 m0, s60, 7168
    s_add_u32 s54, s59, 7168
    buffer_load_dwordx4 v0, s[8:11], s54 offen sc1 lds
    s_waitcnt lgkmcnt(3)
    v_mfma_f32_32x32x16_bf16 v[16:31], a[32:35], v[48:51], v[16:31]
    ds_read_b128 v[48:51], v3 offset:12288
    s_add_u32 m0, s60, 8192
    s_add_u32 s54, s59, 8192
    buffer_load_dwordx4 v0, s[8:11], s54 offen sc1 lds
    s_add_u32 s59, s59, 36864
    s_add_u32 s60, s60, 36864
    s_cmp_ge_u32 s60, 147456
    s_cselect_b32 s54, 147456, 0
    s_sub_u32 s60, s60, s54
    s_waitcnt lgkmcnt(3)
    v_mfma_f32_32x32x16_bf16 v[16:31], a[36:39], v[52:55], v[16:31]
    ds_read_b128 v[52:55], v3 offset:13312
    v_mul_f32 v72, s72, v32
    v_exp_f32 v72, v72
    s_nop 0
    v_add_f32 v72, 1.0, v72
    v_rcp_f32 v72, v72
    s_waitcnt lgkmcnt(3)
    v_mfma_f32_32x32x16_bf16 v[16:31], a[40:43], v[56:59], v[16:31]
    ds_read_b128 v[56:59], v3 offset:14336
    s_nop 0
    v_mul_f32 v32, v32, v72
    v_mul_f32 v73, s72, v33
    v_exp_f32 v73, v73
    s_nop 0
    s_waitcnt lgkmcnt(3)
    v_mfma_f32_32x32x16_bf16 v[16:31], a[44:47], v[60:63], v[16:31]
    ds_read_b128 v[60:63], v3 offset:15360
    v_add_f32 v73, 1.0, v73
    v_rcp_f32 v73, v73
    s_nop 0
    v_mul_f32 v33, v33, v73
    v_mul_f32 v74, s72, v34
    s_waitcnt lgkmcnt(3)
    v_mfma_f32_32x32x16_bf16 v[16:31], a[48:51], v[48:51], v[16:31]
    ds_read_b128 v[48:51], v3 offset:16384
    v_exp_f32 v74, v74
    s_nop 0
    v_add_f32 v74, 1.0, v74
    v_rcp_f32 v74, v74
    s_nop 0
    s_waitcnt lgkmcnt(3)
    v_mfma_f32_32x32x16_bf16 v[16:31], a[52:55], v[52:55], v[16:31]
    ds_read_b128 v[52:55], v3 offset:17408
    v_mul_f32 v34, v34, v74
    v_mul_f32 v75, s72, v35
    v_exp_f32 v75, v75
    s_nop 0
    v_add_f32 v75, 1.0, v75
    s_waitcnt lgkmcnt(3)
    v_mfma_f32_32x32x16_bf16 v[16:31], a[56:59], v[56:59], v[16:31]
    ds_read_b128 v[56:59], v3 offset:18432
    v_rcp_f32 v75, v75
    s_nop 0
    v_mul_f32 v35, v35, v75
    v_mul_f32 v72, s72, v36
    v_exp_f32 v72, v72
    s_waitcnt lgkmcnt(3)
    v_mfma_f32_32x32x16_bf16 v[16:31], a[60:63], v[60:63], v[16:31]
    ds_read_b128 v[60:63], v3 offset:19456
    s_nop 0
    v_add_f32 v72, 1.0, v72
    v_rcp_f32 v72, v72
    s_nop 0
    v_mul_f32 v36, v36, v72
    s_waitcnt lgkmcnt(3)
    v_mfma_f32_32x32x16_bf16 v[16:31], a[64:67], v[48:51], v[16:31]
    ds_read_b128 v[48:51], v3 offset:20480
    v_mul_f32 v73, s72, v37
    v_exp_f32 v73, v73
    s_nop 0
    v_add_f32 v73, 1.0, v73
    v_rcp_f32 v73, v73
    s_waitcnt lgkmcnt(3)
    v_mfma_f32_32x32x16_bf16 v[16:31], a[68:71], v[52:55], v[16:31]
    ds_read_b128 v[52:55], v3 offset:21504
    s_nop 0
    v_mul_f32 v37, v37, v73
    v_mul_f32 v74, s72, v38
    v_exp_f32 v74, v74
    s_nop 0
    s_waitcnt lgkmcnt(3)
    v_mfma_f32_32x32x16_bf16 v[16:31], a[72:75], v[56:59], v[16:31]
    ds_read_b128 v[56:59], v3 offset:22528
    v_add_f32 v74, 1.0, v74
    v_rcp_f32 v74, v74
    s_nop 0
    v_mul_f32 v38, v38, v74
    v_mul_f32 v75, s72, v39
    s_waitcnt lgkmcnt(3)
    v_mfma_f32_32x32x16_bf16 v[16:31], a[76:79], v[60:63], v[16:31]
    ds_read_b128 v[60:63], v3 offset:23552
    v_exp_f32 v75, v75
    s_nop 0
    v_add_f32 v75, 1.0, v75
    v_rcp_f32 v75, v75
    s_nop 0
    s_waitcnt lgkmcnt(3)
    v_mfma_f32_32x32x16_bf16 v[16:31], a[80:83], v[48:51], v[16:31]
    ds_read_b128 v[48:51], v3 offset:24576
    v_mul_f32 v39, v39, v75
    v_mul_f32 v72, s72, v40
    v_exp_f32 v72, v72
    s_nop 0
    v_add_f32 v72, 1.0, v72
    s_waitcnt lgkmcnt(3)
    v_mfma_f32_32x32x16_bf16 v[16:31], a[84:87], v[52:55], v[16:31]
    ds_read_b128 v[52:55], v3 offset:25600
    v_rcp_f32 v72, v72
    s_nop 0
    v_mul_f32 v40, v40, v72
    v_mul_f32 v73, s72, v41
    v_exp_f32 v73, v73
    s_waitcnt lgkmcnt(3)
    v_mfma_f32_32x32x16_bf16 v[16:31], a[88:91], v[56:59], v[16:31]
    ds_read_b128 v[56:59], v3 offset:26624
    s_nop 0
    v_add_f32 v73, 1.0, v73
    v_rcp_f32 v73, v73
    s_nop 0
    v_mul_f32 v41, v41, v73
    s_waitcnt lgkmcnt(3)
    v_mfma_f32_32x32x16_bf16 v[16:31], a[92:95], v[60:63], v[16:31]
    ds_read_b128 v[60:63], v3 offset:27648
    v_mul_f32 v74, s72, v42
    v_exp_f32 v74, v74
    s_nop 0
    v_add_f32 v74, 1.0, v74
    v_rcp_f32 v74, v74
    s_waitcnt lgkmcnt(3)
    v_mfma_f32_32x32x16_bf16 v[16:31], a[96:99], v[48:51], v[16:31]
    ds_read_b128 v[48:51], v3 offset:28672
    s_nop 0
    v_mul_f32 v42, v42, v74
    v_mul_f32 v75, s72, v43
    v_exp_f32 v75, v75
    s_nop 0
    s_waitcnt lgkmcnt(3)
    v_mfma_f32_32x32x16_bf16 v[16:31], a[100:103], v[52:55], v[16:31]
    ds_read_b128 v[52:55], v3 offset:29696
    v_add_f32 v75, 1.0, v75
    v_rcp_f32 v75, v75
    s_nop 0
    v_mul_f32 v43, v43, v75
    v_mul_f32 v72, s72, v44
    s_waitcnt lgkmcnt(3)
    v_mfma_f32_32x32x16_bf16 v[16:31], a[104:107], v[56:59], v[16:31]
    ds_read_b128 v[56:59], v3 offset:30720
    v_exp_f32 v72, v72
    s_nop 0
    v_add_f32 v72, 1.0, v72
    v_rcp_f32 v72, v72
    s_nop 0
    s_waitcnt lgkmcnt(3)
    v_mfma_f32_32x32x16_bf16 v[16:31], a[108:111], v[60:63], v[16:31]
    ds_read_b128 v[60:63], v3 offset:31744
    v_mul_f32 v44, v44, v72
    v_mul_f32 v73, s72, v45
    v_exp_f32 v73, v73
    s_nop 0
    v_add_f32 v73, 1.0, v73
    s_waitcnt lgkmcnt(3)
    v_mfma_f32_32x32x16_bf16 v[16:31], a[112:115], v[48:51], v[16:31]
    ds_read_b128 v[48:51], v3 offset:32768
    v_rcp_f32 v73, v73
    s_nop 0
    v_mul_f32 v45, v45, v73
    v_mul_f32 v74, s72, v46
    v_exp_f32 v74, v74
    s_waitcnt lgkmcnt(3)
    v_mfma_f32_32x32x16_bf16 v[16:31], a[116:119], v[52:55], v[16:31]
    ds_read_b128 v[52:55], v3 offset:33792
    s_nop 0
    v_add_f32 v74, 1.0, v74
    v_rcp_f32 v74, v74
    s_nop 0
    v_mul_f32 v46, v46, v74
    s_waitcnt lgkmcnt(3)
    v_mfma_f32_32x32x16_bf16 v[16:31], a[120:123], v[56:59], v[16:31]
    ds_read_b128 v[56:59], v3 offset:34816
    v_mul_f32 v75, s72, v47
    v_exp_f32 v75, v75
    s_nop 0
    v_add_f32 v75, 1.0, v75
    v_rcp_f32 v75, v75
    s_waitcnt lgkmcnt(3)
    v_mfma_f32_32x32x16_bf16 v[16:31], a[124:127], v[60:63], v[16:31]
    ds_read_b128 v[60:63], v3 offset:35840
    s_nop 0
    v_mul_f32 v47, v47, v75
    v_cvt_pk_bf16_f32 v64, v32, v33
    v_cvt_pk_bf16_f32 v65, v34, v35
    v_cvt_pk_bf16_f32 v66, v36, v37
    s_waitcnt lgkmcnt(3)
    v_mfma_f32_32x32x16_bf16 v[16:31], a[128:131], v[48:51], v[16:31]
    v_cvt_pk_bf16_f32 v67, v38, v39
    buffer_store_dwordx4 v[64:67], v0, s[8:11], s58 offen offset:0 sc1
    v_cvt_pk_bf16_f32 v68, v40, v41
    v_cvt_pk_bf16_f32 v69, v42, v43
    v_cvt_pk_bf16_f32 v70, v44, v45
    s_waitcnt lgkmcnt(2)
    v_mfma_f32_32x32x16_bf16 v[16:31], a[132:135], v[52:55], v[16:31]
    v_cvt_pk_bf16_f32 v71, v46, v47
    buffer_store_dwordx4 v[68:71], v0, s[8:11], s58 offen offset:1024 sc1
    s_add_u32 s58, s58, 294912
    s_waitcnt lgkmcnt(1)
    v_mfma_f32_32x32x16_bf16 v[16:31], a[136:139], v[56:59], v[16:31]
    s_waitcnt lgkmcnt(0)
    v_mfma_f32_32x32x16_bf16 v[16:31], a[140:143], v[60:63], v[16:31]
    v_add_u32 v3, 36864, v3
    v_subrev_u32 v4, 147456, v3
    v_min_u32 v3, v3, v4
    s_add_u32 s53, s53, 1
    s_branch L_pj_71
L_pj_71_end:
    s_nop 7
    s_nop 3
    v_mul_f32 v72, s72, v32
    v_exp_f32 v72, v72
    s_nop 0
    v_add_f32 v72, 1.0, v72
    v_rcp_f32 v72, v72
    s_nop 0
    v_mul_f32 v32, v32, v72
    v_mul_f32 v73, s72, v33
    v_exp_f32 v73, v73
    s_nop 0
    v_add_f32 v73, 1.0, v73
    v_rcp_f32 v73, v73
    s_nop 0
    v_mul_f32 v33, v33, v73
    v_mul_f32 v74, s72, v34
    v_exp_f32 v74, v74
    s_nop 0
    v_add_f32 v74, 1.0, v74
    v_rcp_f32 v74, v74
    s_nop 0
    v_mul_f32 v34, v34, v74
    v_mul_f32 v75, s72, v35
    v_exp_f32 v75, v75
    s_nop 0
    v_add_f32 v75, 1.0, v75
    v_rcp_f32 v75, v75
    s_nop 0
    v_mul_f32 v35, v35, v75
    v_mul_f32 v72, s72, v36
    v_exp_f32 v72, v72
    s_nop 0
    v_add_f32 v72, 1.0, v72
    v_rcp_f32 v72, v72
    s_nop 0
    v_mul_f32 v36, v36, v72
    v_mul_f32 v73, s72, v37
    v_exp_f32 v73, v73
    s_nop 0
    v_add_f32 v73, 1.0, v73
    v_rcp_f32 v73, v73
    s_nop 0
    v_mul_f32 v37, v37, v73
    v_mul_f32 v74, s72, v38
    v_exp_f32 v74, v74
    s_nop 0
    v_add_f32 v74, 1.0, v74
    v_rcp_f32 v74, v74
    s_nop 0
    v_mul_f32 v38, v38, v74
    v_mul_f32 v75, s72, v39
    v_exp_f32 v75, v75
    s_nop 0
    v_add_f32 v75, 1.0, v75
    v_rcp_f32 v75, v75
    s_nop 0
    v_mul_f32 v39, v39, v75
    v_mul_f32 v72, s72, v40
    v_exp_f32 v72, v72
    s_nop 0
    v_add_f32 v72, 1.0, v72
    v_rcp_f32 v72, v72
    s_nop 0
    v_mul_f32 v40, v40, v72
    v_mul_f32 v73, s72, v41
    v_exp_f32 v73, v73
    s_nop 0
    v_add_f32 v73, 1.0, v73
    v_rcp_f32 v73, v73
    s_nop 0
    v_mul_f32 v41, v41, v73
    v_mul_f32 v74, s72, v42
    v_exp_f32 v74, v74
    s_nop 0
    v_add_f32 v74, 1.0, v74
    v_rcp_f32 v74, v74
    s_nop 0
    v_mul_f32 v42, v42, v74
    v_mul_f32 v75, s72, v43
    v_exp_f32 v75, v75
    s_nop 0
    v_add_f32 v75, 1.0, v75
    v_rcp_f32 v75, v75
    s_nop 0
    v_mul_f32 v43, v43, v75
    v_mul_f32 v72, s72, v44
    v_exp_f32 v72, v72
    s_nop 0
    v_add_f32 v72, 1.0, v72
    v_rcp_f32 v72, v72
    s_nop 0
    v_mul_f32 v44, v44, v72
    v_mul_f32 v73, s72, v45
    v_exp_f32 v73, v73
    s_nop 0
    v_add_f32 v73, 1.0, v73
    v_rcp_f32 v73, v73
    s_nop 0
    v_mul_f32 v45, v45, v73
    v_mul_f32 v74, s72, v46
    v_exp_f32 v74, v74
    s_nop 0
    v_add_f32 v74, 1.0, v74
    v_rcp_f32 v74, v74
    s_nop 0
    v_mul_f32 v46, v46, v74
    v_mul_f32 v75, s72, v47
    v_exp_f32 v75, v75
    s_nop 0
    v_add_f32 v75, 1.0, v75
    v_rcp_f32 v75, v75
    s_nop 0
    v_mul_f32_e64 v47, v47, v75
    v_cvt_pk_bf16_f32 v64, v32, v33
    v_cvt_pk_bf16_f32 v65, v34, v35
    v_cvt_pk_bf16_f32 v66, v36, v37
    v_cvt_pk_bf16_f32 v67, v38, v39
    buffer_store_dwordx4 v[64:67], v0, s[8:11], s58 offen offset:0 sc1
    v_cvt_pk_bf16_f32 v68, v40, v41
    v_cvt_pk_bf16_f32 v69, v42, v43
    v_cvt_pk_bf16_f32 v70, v44, v45
    v_cvt_pk_bf16_f32 v71, v46, v47
    buffer_store_dwordx4 v[68:71], v0, s[8:11], s58 offen offset:1024 sc1
    s_add_u32 s58, s58, 294912
    s_waitcnt vmcnt(0)
    v_mov_b32_e64 v5, 64
    s_mov_b64 exec, 1
    buffer_store_dword v5, off, s[8:11], s57 sc1
    s_mov_b64 exec, -1
    s_cmp_ge_u32 s52, 18
    s_cselect_b32 s54, 18, 0
    s_cselect_b32 s84, 256, 0
    s_sub_u32 s64, s52, s54
    s_mov_b32 s63, 55
    s_barrier
    s_branch L_roleC
L_notH:
    s_sub_u32 s52, s52, 36
L_exit:
    s_endpgm
L_fail:
    s_endpgm
L_chain:
    v_and_b32 v60, 63, v0
    v_lshlrev_b32_e64 v0, 4, v60
    s_lshl_b32 s69, s4, 12
    s_add_u32 s78, s69, 16384
    v_lshrrev_b32 v61, 4, v60
    v_and_b32 v62, 15, v60
    v_and_b32 v63, 2, v61
    v_xor_b32 v62, v62, v63
    s_lshl_b32 s69, s4, 17
    s_lshl_b32 s3, s5, 8
    s_add_u32 s69, s69, s3
    v_lshlrev_b32 v61, 13, v61
    v_add_u32 v61, s69, v61
    v_xor_b32 v63, 0, v62
    v_lshl_add_u32 v63, v63, 4, v61
    v_add_u32 v44, 0, v63
    v_xor_b32 v63, 4, v62
    v_lshl_add_u32 v63, v63, 4, v61
    v_add_u32 v45, 32768, v63
    v_xor_b32_e64 v63, 8, v62
    v_lshl_add_u32 v63, v63, 4, v61
    v_add_u32 v46, 65536, v63
    v_xor_b32_e64 v63, 12, v62
    v_lshl_add_u32 v63, v63, 4, v61
    v_add_u32 v47, 98304, v63
    s_mov_b32 s69, 0
    s_mov_b32 s3, s78
L_first:
    s_add_u32 m0, s3, 0
    s_nop 0
    buffer_load_dwordx4 v44, s[12:15], s69 offen lds
    s_add_u32 m0, s3, 1024
    s_nop 0
    buffer_load_dwordx4 v45, s[12:15], s69 offen lds
    s_add_u32 m0, s3, 2048
    s_nop 0
    buffer_load_dwordx4 v46, s[12:15], s69 offen lds
    s_add_u32 m0, s3, 3072
    s_nop 0
    buffer_load_dwordx4 v47, s[12:15], s69 offen lds
    s_add_u32 s3, s3, 16384
    s_add_u32 s69, s69, 524288
    s_cmp_lt_u32 s69, 4718592
    s_cbranch_scc1 L_first
    v_lshrrev_b32 v60, 4, v0
    v_lshrrev_b32 v61, 3, v60
    v_mul_u32_u24 v61, 1152, v61
    s_mul_i32 s69, s4, 36864
    s_mul_i32 s3, s5, 147456
    s_add_u32 s69, s69, s3
    v_add_u32 v61, s69, v61
    v_and_b32 v62, 7, v60
    s_and_b32 s3, s4, 1
    s_lshl_b32 s3, s3, 2
    v_xor_b32 v62, s3, v62
    v_lshl_add_u32 v48, v62, 4, v61
    v_xor_b32_e64 v62, 2, v62
    v_lshl_add_u32 v49, v62, 4, v61
    v_add_u32 v49, 18432, v49
    v_lshrrev_b32_e64 v61, 4, v60
    v_bfe_u32 v62, v60, 2, 2
    v_and_b32 v63, 3, v60
    v_lshrrev_b32 v64, 1, v61
    v_and_b32 v65, 1, v61
    v_lshrrev_b32 v66, 1, v62
    v_and_b32 v67, 1, v62
    v_lshlrev_b32 v69, 1, v65
    v_lshl_add_u32 v69, v62, 2, v69
    v_lshl_add_u32 v68, v64, 4, v69
    v_lshrrev_b32 v70, 1, v63
    s_lshl_b32 s69, s4, 2
    v_add_u32 v70, s69, v70
    v_xor_b32 v70, v70, v69
    v_and_b32 v71, 1, v63
    v_lshlrev_b32 v71, 3, v71
    v_lshl_add_u32 v71, v68, 8, v71
    v_lshl_add_u32 v50, v70, 4, v71
    v_xor_b32_e64 v70, 2, v70
    v_lshl_add_u32 v51, v70, 4, v71
    v_lshlrev_b32_e64 v68, 4, v65
    v_lshl_add_u32 v68, v64, 2, v68
    v_add_u32_e64 v68, v68, v67
    v_lshl_add_u32 v68, v66, 5, v68
    v_lshlrev_b32_e64 v69, 1, v65
    v_lshl_add_u32 v69, v66, 2, v69
    v_lshrrev_b32 v70, 1, v63
    s_lshl_b32 s69, s4, 1
    v_add_u32 v70, s69, v70
    v_xor_b32 v70, v70, v69
    v_and_b32 v71, 1, v63
    v_lshlrev_b32 v71, 3, v71
    v_lshl_add_u32 v71, v68, 7, v71
    v_lshl_add_u32 v52, v70, 4, v71
    v_lshrrev_b32 v12, 4, v0
    s_lshl_b32 s76, s4, 10
    s_lshl_b32 s69, s4, 11
    v_add_u32 v1, s69, v0
    v_and_b32 v13, 2, v12
    v_cmp_eq_u32 vcc, 0, v13
    v_mov_b32 v14, 0xeeeeeeee
    v_mov_b32 v15, 0x44444444
    v_cndmask_b32 v2, v14, v15, vcc
    v_and_b32 v13, 15, v12
    v_lshrrev_b32 v14, 4, v12
    v_lshrrev_b32 v15, 3, v13
    v_and_b32_e64 v16, 7, v12
    v_lshl_add_u32 v17, v14, 1, v15
    v_lshrrev_b32_e64 v18, 2, v17
    v_lshl_add_u32 v18, v18, 4, v16
    v_lshlrev_b32 v18, 4, v18
    v_and_b32 v17, 3, v17
    v_lshl_add_u32 v3, v17, 2, v18
    v_add_u32 v3, 13312, v3
    v_and_b32 v17, 1, v12
    v_lshlrev_b32 v17, 4, v17
    v_mov_b32 v18, 0x3f80
    v_lshlrev_b32 v17, v17, v18
    v_lshrrev_b32 v18, 1, v16
    v_cmp_eq_u32_e64 vcc, v18, v14
    s_mov_b32 s70, 0x00ff00ff
    s_mov_b32 s71, 0x00ff00ff
    v_cndmask_b32 v17, 0, v17, vcc
    v_cndmask_b32 v4, 0, v17, s[70:71]
    v_cndmask_b32 v5, v17, 0, s[70:71]
    v_lshrrev_b32 v17, 1, v16
    v_lshlrev_b32 v17, 2, v17
    v_and_b32 v18, 1, v16
    v_add_u32_e64 v17, v17, v18
    v_lshl_add_u32 v17, v14, 4, v17
    v_lshlrev_b32_e64 v17, 4, v17
    v_lshl_add_u32 v17, v15, 3, v17
    s_lshr_b32 s69, s4, 1
    s_lshl_b32 s69, s69, 10
    s_and_b32 s3, s4, 1
    s_lshl_b32 s3, s3, 5
    s_add_u32 s69, s69, s3
    v_add_u32 v6, s69, v17
    v_lshlrev_b32_e64 v17, 4, v13
    v_lshl_add_u32 v7, v14, 2, v17
    s_lshl_b32 s69, s4, 8
    v_lshlrev_b32 v17, 2, v12
    v_add_u32_e64 v11, s69, v17
    s_mov_b32 s74, 0x3e0293ee
    s_mov_b32 s75, 0xbe0293ee
    s_and_b32 s69, s4, 1
    s_lshl_b32 s69, s69, 7
    s_lshr_b32 s3, s4, 1
    s_lshl_b32 s3, s3, 9
    s_add_u32 s69, s69, s3
    s_add_u32 s69, s69, 12800
    v_add_u32 v17, s69, v0
    v_mov_b32 v18, 0x40000
    s_mov_b32 vcc_lo, 0
    s_mov_b32 vcc_hi, 0x00ff00ff
    v_cndmask_b32 v10, v18, v17, vcc
    s_mul_i32 s55, s5, 9344
    s_add_u32 s55, s55, 65536
    s_lshl_b32 s69, s5, 13
    s_lshl_b32 s3, s4, 11
    s_add_u32 s69, s69, s3
    s_lshl_b32 s3, s69, 1
    s_add_u32 s61, s3, 4194304
    s_lshr_b32 s3, s69, 1
    s_add_u32 s63, s3, 37748736
    s_lshr_b32 s3, s69, 2
    s_add_u32 s64, s3, 46137344
    s_lshl_b32 s69, s5, 7
    s_lshl_b32 s3, s4, 2
    s_add_u32 s82, s69, 0
    s_add_u32 s69, s69, s3
    s_add_u32 s65, s69, 8192
    s_lshr_b32 s69, s5, 3
    s_and_b32 s3, s5, 7
    s_lshl_b32 s3, s3, 7
    s_lshl_b32 s68, s69, 10
    s_add_u32 s68, s68, s3
    s_lshl_b32 s92, s76, 2
    s_add_u32 s68, s68, s92
    s_lshl_b32 s93, s69, 11
    s_add_u32 s93, s93, s3
    s_add_u32 s93, s93, s76
    s_lshl_b32 s69, s5, 5
    s_add_u32 s69, s69, 8192
    s_cmp_eq_u32 s4, 2
    s_cselect_b32 s68, s69, s68
    s_cselect_b32 s93, s69, s93
    s_add_u32 s56, s68, 65536
    s_add_u32 s57, s68, 140288
    s_add_u32 s58, s68, 215040
    s_add_u32 s59, s68, 289792
    s_lshl_b32 s69, s4, 8
    s_add_u32 s83, s55, s69
    s_add_u32 s77, s83, 4096
    s_add_u32 s91, s83, 8192
    v_lshrrev_b32 v60, 4, v0
    v_lshrrev_b32 v61, 2, v60
    v_lshrrev_b32 v62, 2, v61
    v_lshlrev_b32 v62, 1, v62
    v_and_b32 v63, 1, v61
    v_add_u32 v62, v62, v63
    v_mul_u32_u24 v62, 1152, v62
    v_and_b32_e64 v63, 2, v61
    v_lshl_add_u32 v62, v63, 3, v62
    v_and_b32_e64 v61, 3, v60
    v_lshl_add_u32 v62, v61, 1, v62
    s_and_b32 s69, s5, 1
    s_lshl_b32 s69, s69, 2
    s_lshr_b32 s3, s5, 1
    s_add_u32 s69, s69, s3
    s_cmp_eq_u32 s5, 8
    s_cselect_b32 s69, 8, s69
    s_lshl_b32 s69, s69, 7
    s_lshl_b32 s3, s4, 5
    s_add_u32 s69, s69, s3
    buffer_load_ushort v73, v62, s[28:31], s69 offen
    buffer_load_ushort v74, v62, s[28:31], s69 offen offset:8
    v_mov_b32 v12, 0
    v_mov_b32 v13, 0
    v_mov_b32 v14, 0
    v_mov_b32_e64 v15, 0
    buffer_store_dwordx4 v[12:15], v1, s[8:11], s55 offen sc1
    buffer_store_dwordx4 v[12:15], v1, s[8:11], s55 offen offset:1024 sc1
    s_add_u32 s69, s55, 8192
    buffer_store_dword v12, v11, s[8:11], s69 offen sc1
    s_cmp_eq_u32 s4, 1
    s_cbranch_scc1 L_stage1
    s_cmp_eq_u32 s4, 2
    s_cbranch_scc1 L_stage2
    s_cmp_eq_u32 s4, 3
    s_cbranch_scc1 L_stage3
L_stage0:
    s_waitcnt vmcnt(37) lgkmcnt(0)
    s_barrier
    v_add_u32 v54, 16384, v50
    v_add_u32 v55, 16384, v51
    ds_read_b64_tr_b16 a[0:1], v54 offset:0
    ds_read_b64_tr_b16 a[2:3], v54 offset:256
    ds_read_b64_tr_b16 a[4:5], v54 offset:8192
    ds_read_b64_tr_b16 a[6:7], v54 offset:8448
    ds_read_b64_tr_b16 a[8:9], v55 offset:0
    ds_read_b64_tr_b16 a[10:11], v55 offset:256
    ds_read_b64_tr_b16 a[12:13], v55 offset:8192
    ds_read_b64_tr_b16 a[14:15], v55 offset:8448
    s_waitcnt vmcnt(33) lgkmcnt(0)
    s_barrier
    s_add_u32 m0, s78, 0
    s_mov_b32 s69, 0
    buffer_load_dwordx4 v44, s[16:19], s69 offen lds
    s_add_u32 m0, s78, 1024
    s_mov_b32 s69, 0
    buffer_load_dwordx4 v45, s[16:19], s69 offen lds
    s_add_u32 m0, s78, 2048
    s_mov_b32 s69, 0
    buffer_load_dwordx4 v46, s[16:19], s69 offen lds
    s_add_u32 m0, s78, 3072
    s_mov_b32 s69, 0
    buffer_load_dwordx4 v47, s[16:19], s69 offen lds
    v_add_u32 v54, 32768, v50
    v_add_u32 v55, 32768, v51
    ds_read_b64_tr_b16 a[16:17], v54 offset:0
    ds_read_b64_tr_b16 a[18:19], v54 offset:256
    ds_read_b64_tr_b16 a[20:21], v54 offset:8192
    ds_read_b64_tr_b16 a[22:23], v54 offset:8448
    ds_read_b64_tr_b16 a[24:25], v55 offset:0
    ds_read_b64_tr_b16 a[26:27], v55 offset:256
    ds_read_b64_tr_b16 a[28:29], v55 offset:8192
    ds_read_b64_tr_b16 a[30:31], v55 offset:8448
    s_waitcnt vmcnt(33) lgkmcnt(0)
    s_barrier
    s_add_u32 m0, s78, 16384
    s_mov_b32 s69, 524288
    buffer_load_dwordx4 v44, s[16:19], s69 offen lds
    s_add_u32 m0, s78, 17408
    s_mov_b32 s69, 524288
    buffer_load_dwordx4 v45, s[16:19], s69 offen lds
    s_add_u32 m0, s78, 18432
    s_mov_b32 s69, 524288
    buffer_load_dwordx4 v46, s[16:19], s69 offen lds
    s_add_u32 m0, s78, 19456
    s_mov_b32 s69, 524288
    buffer_load_dwordx4 v47, s[16:19], s69 offen lds
    v_add_u32 v54, 49152, v50
    v_add_u32 v55, 49152, v51
    ds_read_b64_tr_b16 a[32:33], v54 offset:0
    ds_read_b64_tr_b16 a[34:35], v54 offset:256
    ds_read_b64_tr_b16 a[36:37], v54 offset:8192
    ds_read_b64_tr_b16 a[38:39], v54 offset:8448
    ds_read_b64_tr_b16 a[40:41], v55 offset:0
    ds_read_b64_tr_b16 a[42:43], v55 offset:256
    ds_read_b64_tr_b16 a[44:45], v55 offset:8192
    ds_read_b64_tr_b16 a[46:47], v55 offset:8448
    s_waitcnt vmcnt(33) lgkmcnt(0)
    s_barrier
    s_add_u32 m0, s78, 32768
    s_mov_b32 s69, 1048576
    buffer_load_dwordx4 v44, s[16:19], s69 offen lds
    s_add_u32 m0, s78, 33792
    s_mov_b32 s69, 1048576
    buffer_load_dwordx4 v45, s[16:19], s69 offen lds
    s_add_u32 m0, s78, 34816
    s_mov_b32 s69, 1048576
    buffer_load_dwordx4 v46, s[16:19], s69 offen lds
    s_add_u32 m0, s78, 35840
    s_mov_b32 s69, 1048576
    buffer_load_dwordx4 v47, s[16:19], s69 offen lds
    v_add_u32 v54, 65536, v50
    v_add_u32 v55, 65536, v51
    ds_read_b64_tr_b16 a[48:49], v54 offset:0
    ds_read_b64_tr_b16 a[50:51], v54 offset:256
    ds_read_b64_tr_b16 a[52:53], v54 offset:8192
    ds_read_b64_tr_b16 a[54:55], v54 offset:8448
    ds_read_b64_tr_b16 a[56:57], v55 offset:0
    ds_read_b64_tr_b16 a[58:59], v55 offset:256
    ds_read_b64_tr_b16 a[60:61], v55 offset:8192
    ds_read_b64_tr_b16 a[62:63], v55 offset:8448
    s_waitcnt vmcnt(33) lgkmcnt(0)
    s_barrier
    s_add_u32 m0, s78, 49152
    s_mov_b32 s69, 1572864
    buffer_load_dwordx4 v44, s[16:19], s69 offen lds
    s_add_u32 m0, s78, 50176
    s_mov_b32 s69, 1572864
    buffer_load_dwordx4 v45, s[16:19], s69 offen lds
    s_add_u32 m0, s78, 51200
    s_mov_b32 s69, 1572864
    buffer_load_dwordx4 v46, s[16:19], s69 offen lds
    s_add_u32 m0, s78, 52224
    s_mov_b32 s69, 1572864
    buffer_load_dwordx4 v47, s[16:19], s69 offen lds
    v_add_u32 v54, 81920, v50
    v_add_u32 v55, 81920, v51
    ds_read_b64_tr_b16 a[64:65], v54 offset:0
    ds_read_b64_tr_b16 a[66:67], v54 offset:256
    ds_read_b64_tr_b16 a[68:69], v54 offset:8192
    ds_read_b64_tr_b16 a[70:71], v54 offset:8448
    ds_read_b64_tr_b16 a[72:73], v55 offset:0
    ds_read_b64_tr_b16 a[74:75], v55 offset:256
    ds_read_b64_tr_b16 a[76:77], v55 offset:8192
    ds_read_b64_tr_b16 a[78:79], v55 offset:8448
    s_waitcnt vmcnt(33) lgkmcnt(0)
    s_barrier
    s_add_u32 m0, s78, 65536
    s_mov_b32 s69, 2097152
    buffer_load_dwordx4 v44, s[16:19], s69 offen lds
    s_add_u32 m0, s78, 66560
    s_mov_b32 s69, 2097152
    buffer_load_dwordx4 v45, s[16:19], s69 offen lds
    s_add_u32 m0, s78, 67584
    s_mov_b32 s69, 2097152
    buffer_load_dwordx4 v46, s[16:19], s69 offen lds
    s_add_u32 m0, s78, 68608
    s_mov_b32 s69, 2097152
    buffer_load_dwordx4 v47, s[16:19], s69 offen lds
    v_add_u32 v54, 98304, v50
    v_add_u32 v55, 98304, v51
    ds_read_b64_tr_b16 a[80:81], v54 offset:0
    ds_read_b64_tr_b16 a[82:83], v54 offset:256
    ds_read_b64_tr_b16 a[84:85], v54 offset:8192
    ds_read_b64_tr_b16 a[86:87], v54 offset:8448
    ds_read_b64_tr_b16 a[88:89], v55 offset:0
    ds_read_b64_tr_b16 a[90:91], v55 offset:256
    ds_read_b64_tr_b16 a[92:93], v55 offset:8192
    ds_read_b64_tr_b16 a[94:95], v55 offset:8448
    s_waitcnt vmcnt(33) lgkmcnt(0)
    s_barrier
    s_add_u32 m0, s78, 81920
    s_mov_b32 s69, 2621440
    buffer_load_dwordx4 v44, s[16:19], s69 offen lds
    s_add_u32 m0, s78, 82944
    s_mov_b32 s69, 2621440
    buffer_load_dwordx4 v45, s[16:19], s69 offen lds
    s_add_u32 m0, s78, 83968
    s_mov_b32 s69, 2621440
    buffer_load_dwordx4 v46, s[16:19], s69 offen lds
    s_add_u32 m0, s78, 84992
    s_mov_b32 s69, 2621440
    buffer_load_dwordx4 v47, s[16:19], s69 offen lds
    v_add_u32 v54, 114688, v50
    v_add_u32 v55, 114688, v51
    ds_read_b64_tr_b16 a[96:97], v54 offset:0
    ds_read_b64_tr_b16 a[98:99], v54 offset:256
    ds_read_b64_tr_b16 a[100:101], v54 offset:8192
    ds_read_b64_tr_b16 a[102:103], v54 offset:8448
    ds_read_b64_tr_b16 a[104:105], v55 offset:0
    ds_read_b64_tr_b16 a[106:107], v55 offset:256
    ds_read_b64_tr_b16 a[108:109], v55 offset:8192
    ds_read_b64_tr_b16 a[110:111], v55 offset:8448
    s_waitcnt vmcnt(33) lgkmcnt(0)
    s_barrier
    s_add_u32 m0, s78, 98304
    s_mov_b32 s69, 3145728
    buffer_load_dwordx4 v44, s[16:19], s69 offen lds
    s_add_u32 m0, s78, 99328
    s_mov_b32 s69, 3145728
    buffer_load_dwordx4 v45, s[16:19], s69 offen lds
    s_add_u32 m0, s78, 100352
    s_mov_b32 s69, 3145728
    buffer_load_dwordx4 v46, s[16:19], s69 offen lds
    s_add_u32 m0, s78, 101376
    s_mov_b32 s69, 3145728
    buffer_load_dwordx4 v47, s[16:19], s69 offen lds
    v_add_u32 v54, 131072, v50
    v_add_u32 v55, 131072, v51
    ds_read_b64_tr_b16 a[112:113], v54 offset:0
    ds_read_b64_tr_b16 a[114:115], v54 offset:256
    ds_read_b64_tr_b16 a[116:117], v54 offset:8192
    ds_read_b64_tr_b16 a[118:119], v54 offset:8448
    ds_read_b64_tr_b16 a[120:121], v55 offset:0
    ds_read_b64_tr_b16 a[122:123], v55 offset:256
    ds_read_b64_tr_b16 a[124:125], v55 offset:8192
    ds_read_b64_tr_b16 a[126:127], v55 offset:8448
    s_waitcnt vmcnt(33) lgkmcnt(0)
    s_barrier
    s_add_u32 m0, s78, 114688
    s_mov_b32 s69, 3670016
    buffer_load_dwordx4 v44, s[16:19], s69 offen lds
    s_add_u32 m0, s78, 115712
    s_mov_b32 s69, 3670016
    buffer_load_dwordx4 v45, s[16:19], s69 offen lds
    s_add_u32 m0, s78, 116736
    s_mov_b32 s69, 3670016
    buffer_load_dwordx4 v46, s[16:19], s69 offen lds
    s_add_u32 m0, s78, 117760
    s_mov_b32 s69, 3670016
    buffer_load_dwordx4 v47, s[16:19], s69 offen lds
    v_add_u32 v54, 147456, v50
    v_add_u32 v55, 147456, v51
    ds_read_b64_tr_b16 a[128:129], v54 offset:0
    ds_read_b64_tr_b16 a[130:131], v54 offset:256
    ds_read_b64_tr_b16 a[132:133], v54 offset:8192
    ds_read_b64_tr_b16 a[134:135], v54 offset:8448
    ds_read_b64_tr_b16 a[136:137], v55 offset:0
    ds_read_b64_tr_b16 a[138:139], v55 offset:256
    ds_read_b64_tr_b16 a[140:141], v55 offset:8192
    ds_read_b64_tr_b16 a[142:143], v55 offset:8448
    s_waitcnt vmcnt(28) lgkmcnt(0)
    s_barrier
    s_cmp_lt_u32 s5, 9
    s_cselect_b64 vcc, -1, 0
    v_lshl_or_b32 v73, v74, 16, v73
    v_min_u32_e64 v73, -2, v73
    v_cndmask_b32 v73, -1, v73, vcc
    s_min_u32 s69, s5, 27
    s_lshl_b32 s69, s69, 10
    s_add_u32 s69, s69, 393216
    buffer_store_dword v73, v11, s[8:11], s69 offen sc1
    buffer_load_dword v75, off, s[32:35], 0 offset:192 sc1
    s_add_u32 m0, s78, 131072
    s_mov_b32 s69, 4194304
    buffer_load_dwordx4 v44, s[16:19], s69 offen lds
    s_add_u32 m0, s78, 132096
    s_mov_b32 s69, 4194304
    buffer_load_dwordx4 v45, s[16:19], s69 offen lds
    s_add_u32 m0, s78, 133120
    s_mov_b32 s69, 4194304
    buffer_load_dwordx4 v46, s[16:19], s69 offen lds
    s_add_u32 m0, s78, 134144
    s_mov_b32 s69, 4194304
    buffer_load_dwordx4 v47, s[16:19], s69 offen lds
    v_add_u32 v54, 16384, v50
    v_add_u32 v55, 16384, v51
    ds_read_b64_tr_b16 a[144:145], v54 offset:0
    ds_read_b64_tr_b16 a[146:147], v54 offset:256
    ds_read_b64_tr_b16 a[148:149], v54 offset:8192
    ds_read_b64_tr_b16 a[150:151], v54 offset:8448
    ds_read_b64_tr_b16 a[152:153], v55 offset:0
    ds_read_b64_tr_b16 a[154:155], v55 offset:256
    ds_read_b64_tr_b16 a[156:157], v55 offset:8192
    ds_read_b64_tr_b16 a[158:159], v55 offset:8448
    s_waitcnt vmcnt(28) lgkmcnt(0)
    s_barrier
    s_add_u32 m0, s78, 0
    s_mov_b32 s69, 0
    buffer_load_dwordx4 v44, s[20:23], s69 offen lds
    s_add_u32 m0, s78, 1024
    s_mov_b32 s69, 0
    buffer_load_dwordx4 v45, s[20:23], s69 offen lds
    s_add_u32 m0, s78, 2048
    s_mov_b32 s69, 0
    buffer_load_dwordx4 v46, s[20:23], s69 offen lds
    s_add_u32 m0, s78, 3072
    s_mov_b32 s69, 0
    buffer_load_dwordx4 v47, s[20:23], s69 offen lds
    v_add_u32 v54, 32768, v50
    v_add_u32 v55, 32768, v51
    ds_read_b64_tr_b16 a[160:161], v54 offset:0
    ds_read_b64_tr_b16 a[162:163], v54 offset:256
    ds_read_b64_tr_b16 a[164:165], v54 offset:8192
    ds_read_b64_tr_b16 a[166:167], v54 offset:8448
    ds_read_b64_tr_b16 a[168:169], v55 offset:0
    ds_read_b64_tr_b16 a[170:171], v55 offset:256
    ds_read_b64_tr_b16 a[172:173], v55 offset:8192
    ds_read_b64_tr_b16 a[174:175], v55 offset:8448
    s_waitcnt vmcnt(28) lgkmcnt(0)
    s_barrier
    s_add_u32 m0, s78, 16384
    s_mov_b32 s69, 524288
    buffer_load_dwordx4 v44, s[20:23], s69 offen lds
    s_add_u32 m0, s78, 17408
    s_mov_b32 s69, 524288
    buffer_load_dwordx4 v45, s[20:23], s69 offen lds
    s_add_u32 m0, s78, 18432
    s_mov_b32 s69, 524288
    buffer_load_dwordx4 v46, s[20:23], s69 offen lds
    s_add_u32 m0, s78, 19456
    s_mov_b32 s69, 524288
    buffer_load_dwordx4 v47, s[20:23], s69 offen lds
    v_add_u32 v54, 49152, v50
    v_add_u32 v55, 49152, v51
    ds_read_b64_tr_b16 a[176:177], v54 offset:0
    ds_read_b64_tr_b16 a[178:179], v54 offset:256
    ds_read_b64_tr_b16 a[180:181], v54 offset:8192
    ds_read_b64_tr_b16 a[182:183], v54 offset:8448
    ds_read_b64_tr_b16 a[184:185], v55 offset:0
    ds_read_b64_tr_b16 a[186:187], v55 offset:256
    ds_read_b64_tr_b16 a[188:189], v55 offset:8192
    ds_read_b64_tr_b16 a[190:191], v55 offset:8448
    s_waitcnt vmcnt(28) lgkmcnt(0)
    s_barrier
    s_add_u32 m0, s78, 32768
    s_mov_b32 s69, 1048576
    buffer_load_dwordx4 v44, s[20:23], s69 offen lds
    s_add_u32 m0, s78, 33792
    s_mov_b32 s69, 1048576
    buffer_load_dwordx4 v45, s[20:23], s69 offen lds
    s_add_u32 m0, s78, 34816
    s_mov_b32 s69, 1048576
    buffer_load_dwordx4 v46, s[20:23], s69 offen lds
    s_add_u32 m0, s78, 35840
    s_mov_b32 s69, 1048576
    buffer_load_dwordx4 v47, s[20:23], s69 offen lds
    v_add_u32 v54, 65536, v50
    v_add_u32 v55, 65536, v51
    ds_read_b64_tr_b16 a[192:193], v54 offset:0
    ds_read_b64_tr_b16 a[194:195], v54 offset:256
    ds_read_b64_tr_b16 a[196:197], v54 offset:8192
    ds_read_b64_tr_b16 a[198:199], v54 offset:8448
    ds_read_b64_tr_b16 a[200:201], v55 offset:0
    ds_read_b64_tr_b16 a[202:203], v55 offset:256
    ds_read_b64_tr_b16 a[204:205], v55 offset:8192
    ds_read_b64_tr_b16 a[206:207], v55 offset:8448
    s_waitcnt vmcnt(28) lgkmcnt(0)
    s_barrier
    s_add_u32 m0, s78, 49152
    s_mov_b32 s69, 1572864
    buffer_load_dwordx4 v44, s[20:23], s69 offen lds
    s_add_u32 m0, s78, 50176
    s_mov_b32 s69, 1572864
    buffer_load_dwordx4 v45, s[20:23], s69 offen lds
    s_add_u32 m0, s78, 51200
    s_mov_b32 s69, 1572864
    buffer_load_dwordx4 v46, s[20:23], s69 offen lds
    s_add_u32 m0, s78, 52224
    s_mov_b32 s69, 1572864
    buffer_load_dwordx4 v47, s[20:23], s69 offen lds
    v_add_u32 v54, 81920, v50
    v_add_u32 v55, 81920, v51
    ds_read_b64_tr_b16 a[208:209], v54 offset:0
    ds_read_b64_tr_b16 a[210:211], v54 offset:256
    ds_read_b64_tr_b16 a[212:213], v54 offset:8192
    ds_read_b64_tr_b16 a[214:215], v54 offset:8448
    ds_read_b64_tr_b16 a[216:217], v55 offset:0
    ds_read_b64_tr_b16 a[218:219], v55 offset:256
    ds_read_b64_tr_b16 a[220:221], v55 offset:8192
    ds_read_b64_tr_b16 a[222:223], v55 offset:8448
    s_waitcnt vmcnt(28) lgkmcnt(0)
    s_barrier
    s_add_u32 m0, s78, 65536
    s_mov_b32 s69, 2097152
    buffer_load_dwordx4 v44, s[20:23], s69 offen lds
    s_add_u32 m0, s78, 66560
    s_mov_b32 s69, 2097152
    buffer_load_dwordx4 v45, s[20:23], s69 offen lds
    s_add_u32 m0, s78, 67584
    s_mov_b32 s69, 2097152
    buffer_load_dwordx4 v46, s[20:23], s69 offen lds
    s_add_u32 m0, s78, 68608
    s_mov_b32 s69, 2097152
    buffer_load_dwordx4 v47, s[20:23], s69 offen lds
    v_add_u32 v54, 98304, v50
    v_add_u32 v55, 98304, v51
    ds_read_b64_tr_b16 a[224:225], v54 offset:0
    ds_read_b64_tr_b16 a[226:227], v54 offset:256
    ds_read_b64_tr_b16 a[228:229], v54 offset:8192
    ds_read_b64_tr_b16 a[230:231], v54 offset:8448
    ds_read_b64_tr_b16 a[232:233], v55 offset:0
    ds_read_b64_tr_b16 a[234:235], v55 offset:256
    ds_read_b64_tr_b16 a[236:237], v55 offset:8192
    ds_read_b64_tr_b16 a[238:239], v55 offset:8448
    s_waitcnt vmcnt(28) lgkmcnt(0)
    s_barrier
    s_add_u32 m0, s78, 81920
    s_mov_b32 s69, 2621440
    buffer_load_dwordx4 v44, s[20:23], s69 offen lds
    s_add_u32 m0, s78, 82944
    s_mov_b32 s69, 2621440
    buffer_load_dwordx4 v45, s[20:23], s69 offen lds
    s_add_u32 m0, s78, 83968
    s_mov_b32 s69, 2621440
    buffer_load_dwordx4 v46, s[20:23], s69 offen lds
    s_add_u32 m0, s78, 84992
    s_mov_b32 s69, 2621440
    buffer_load_dwordx4 v47, s[20:23], s69 offen lds
    v_add_u32 v54, 114688, v50
    v_add_u32 v55, 114688, v51
    ds_read_b64_tr_b16 a[240:241], v54 offset:0
    ds_read_b64_tr_b16 a[242:243], v54 offset:256
    ds_read_b64_tr_b16 a[244:245], v54 offset:8192
    ds_read_b64_tr_b16 a[246:247], v54 offset:8448
    ds_read_b64_tr_b16 a[248:249], v55 offset:0
    ds_read_b64_tr_b16 a[250:251], v55 offset:256
    ds_read_b64_tr_b16 a[252:253], v55 offset:8192
    ds_read_b64_tr_b16 a[254:255], v55 offset:8448
    s_waitcnt vmcnt(28) lgkmcnt(0)
    s_barrier
    s_add_u32 m0, s78, 98304
    s_mov_b32 s69, 3145728
    buffer_load_dwordx4 v44, s[20:23], s69 offen lds
    s_add_u32 m0, s78, 99328
    s_mov_b32 s69, 3145728
    buffer_load_dwordx4 v45, s[20:23], s69 offen lds
    s_add_u32 m0, s78, 100352
    s_mov_b32 s69, 3145728
    buffer_load_dwordx4 v46, s[20:23], s69 offen lds
    s_add_u32 m0, s78, 101376
    s_mov_b32 s69, 3145728
    buffer_load_dwordx4 v47, s[20:23], s69 offen lds
    v_add_u32 v54, 131072, v50
    v_add_u32 v55, 131072, v51
    ds_read_b64_tr_b16 v[80:81], v54 offset:0
    ds_read_b64_tr_b16 v[82:83], v54 offset:256
    ds_read_b64_tr_b16 v[84:85], v54 offset:8192
    ds_read_b64_tr_b16 v[86:87], v54 offset:8448
    ds_read_b64_tr_b16 v[88:89], v55 offset:0
    ds_read_b64_tr_b16 v[90:91], v55 offset:256
    ds_read_b64_tr_b16 v[92:93], v55 offset:8192
    ds_read_b64_tr_b16 v[94:95], v55 offset:8448
    s_waitcnt vmcnt(28) lgkmcnt(0)
    s_barrier
    s_add_u32 m0, s78, 114688
    s_mov_b32 s69, 3670016
    buffer_load_dwordx4 v44, s[20:23], s69 offen lds
    s_add_u32 m0, s78, 115712
    s_mov_b32 s69, 3670016
    buffer_load_dwordx4 v45, s[20:23], s69 offen lds
    s_add_u32 m0, s78, 116736
    s_mov_b32 s69, 3670016
    buffer_load_dwordx4 v46, s[20:23], s69 offen lds
    s_add_u32 m0, s78, 117760
    s_mov_b32 s69, 3670016
    buffer_load_dwordx4 v47, s[20:23], s69 offen lds
    v_add_u32 v54, 147456, v50
    v_add_u32 v55, 147456, v51
    ds_read_b64_tr_b16 v[96:97], v54 offset:0
    ds_read_b64_tr_b16 v[98:99], v54 offset:256
    ds_read_b64_tr_b16 v[100:101], v54 offset:8192
    ds_read_b64_tr_b16 v[102:103], v54 offset:8448
    ds_read_b64_tr_b16 v[104:105], v55 offset:0
    ds_read_b64_tr_b16 v[106:107], v55 offset:256
    ds_read_b64_tr_b16 v[108:109], v55 offset:8192
    ds_read_b64_tr_b16 v[110:111], v55 offset:8448
    s_waitcnt vmcnt(28) lgkmcnt(0)
    s_barrier
    s_add_u32 m0, s78, 131072
    s_mov_b32 s69, 4194304
    buffer_load_dwordx4 v44, s[20:23], s69 offen lds
    s_add_u32 m0, s78, 132096
    s_mov_b32 s69, 4194304
    buffer_load_dwordx4 v45, s[20:23], s69 offen lds
    s_add_u32 m0, s78, 133120
    s_mov_b32 s69, 4194304
    buffer_load_dwordx4 v46, s[20:23], s69 offen lds
    s_add_u32 m0, s78, 134144
    s_mov_b32 s69, 4194304
    buffer_load_dwordx4 v47, s[20:23], s69 offen lds
    v_add_u32 v54, 16384, v50
    v_add_u32 v55, 16384, v51
    ds_read_b64_tr_b16 v[12:13], v54 offset:0
    ds_read_b64_tr_b16 v[14:15], v54 offset:256
    ds_read_b64_tr_b16 v[16:17], v54 offset:8192
    ds_read_b64_tr_b16 v[18:19], v54 offset:8448
    ds_read_b64_tr_b16 v[20:21], v55 offset:0
    ds_read_b64_tr_b16 v[22:23], v55 offset:256
    ds_read_b64_tr_b16 v[24:25], v55 offset:8192
    ds_read_b64_tr_b16 v[26:27], v55 offset:8448
    s_waitcnt vmcnt(28) lgkmcnt(0)
    s_barrier
    v_readfirstlane_b32 s84, v75
    s_cmp_lg_u32 s84, 0
    s_cbranch_scc1 L_isrdy_72
    s_mov_b32 s79, 524288
L_rdy_73:
    buffer_load_dword v75, off, s[32:35], 0 offset:192 sc1
    s_waitcnt vmcnt(0)
    v_readfirstlane_b32 s84, v75
    s_cmp_lg_u32 s84, 0
    s_cbranch_scc1 L_rdyok_74
    s_sub_u32 s79, s79, 1
    s_cbranch_scc1 L_fail
    s_branch L_rdy_73
L_rdyok_74:
L_isrdy_72:
    s_cmp_eq_u32 s90, 0
    s_cselect_b32 s69, 1, 0x10001
    v_mov_b32_e64 v53, s69
    s_mov_b32 s69, 40064
    s_mov_b64 exec, 1
    buffer_atomic_add v53, off, s[8:11], s69
    s_mov_b64 exec, -1
    s_add_u32 m0, s78, 0
    s_mov_b32 s69, 256
    buffer_load_dwordx4 v48, s[24:27], s69 offen lds
    s_add_u32 m0, s78, 1024
    s_mov_b32 s69, 9472
    buffer_load_dwordx4 v48, s[24:27], s69 offen lds
    s_add_u32 m0, s78, 2048
    s_mov_b32 s69, 256
    buffer_load_dwordx4 v49, s[24:27], s69 offen lds
    s_add_u32 m0, s78, 3072
    s_mov_b32 s69, 9472
    buffer_load_dwordx4 v49, s[24:27], s69 offen lds
    v_add_u32 v54, 32768, v50
    v_add_u32 v55, 32768, v51
    ds_read_b64_tr_b16 v[28:29], v54 offset:0
    ds_read_b64_tr_b16 v[30:31], v54 offset:256
    ds_read_b64_tr_b16 v[32:33], v54 offset:8192
    ds_read_b64_tr_b16 v[34:35], v54 offset:8448
    ds_read_b64_tr_b16 v[36:37], v55 offset:0
    ds_read_b64_tr_b16 v[38:39], v55 offset:256
    ds_read_b64_tr_b16 v[40:41], v55 offset:8192
    ds_read_b64_tr_b16 v[42:43], v55 offset:8448
    s_waitcnt vmcnt(28) lgkmcnt(0)
    s_barrier
    s_add_u32 m0, s78, 16384
    s_mov_b32 s69, 640
    buffer_load_dwordx4 v48, s[24:27], s69 offen lds
    s_add_u32 m0, s78, 17408
    s_mov_b32 s69, 9856
    buffer_load_dwordx4 v48, s[24:27], s69 offen lds
    s_add_u32 m0, s78, 18432
    s_mov_b32 s69, 640
    buffer_load_dwordx4 v49, s[24:27], s69 offen lds
    s_add_u32 m0, s78, 19456
    s_mov_b32 s69, 9856
    buffer_load_dwordx4 v49, s[24:27], s69 offen lds
    v_add_u32 v54, 49152, v50
    v_add_u32 v55, 49152, v51
    ds_read_b64_tr_b16 v[56:57], v54 offset:0
    ds_read_b64_tr_b16 v[58:59], v54 offset:256
    ds_read_b64_tr_b16 v[60:61], v54 offset:8192
    ds_read_b64_tr_b16 v[62:63], v54 offset:8448
    ds_read_b64_tr_b16 v[64:65], v55 offset:0
    ds_read_b64_tr_b16 v[66:67], v55 offset:256
    ds_read_b64_tr_b16 v[68:69], v55 offset:8192
    ds_read_b64_tr_b16 v[70:71], v55 offset:8448
    s_waitcnt vmcnt(28) lgkmcnt(0)
    s_barrier
    s_add_u32 m0, s78, 32768
    s_mov_b32 s69, 896
    buffer_load_dwordx4 v48, s[24:27], s69 offen lds
    s_add_u32 m0, s78, 33792
    s_mov_b32 s69, 10112
    buffer_load_dwordx4 v48, s[24:27], s69 offen lds
    s_add_u32 m0, s78, 34816
    s_mov_b32 s69, 896
    buffer_load_dwordx4 v49, s[24:27], s69 offen lds
    s_add_u32 m0, s78, 35840
    s_mov_b32 s69, 10112
    buffer_load_dwordx4 v49, s[24:27], s69 offen lds
    v_add_u32 v54, 65536, v50
    v_add_u32 v55, 65536, v51
    ds_read_b64_tr_b16 v[112:113], v54 offset:0
    ds_read_b64_tr_b16 v[114:115], v54 offset:256
    ds_read_b64_tr_b16 v[116:117], v54 offset:8192
    ds_read_b64_tr_b16 v[118:119], v54 offset:8448
    ds_read_b64_tr_b16 v[120:121], v55 offset:0
    ds_read_b64_tr_b16 v[122:123], v55 offset:256
    ds_read_b64_tr_b16 v[124:125], v55 offset:8192
    ds_read_b64_tr_b16 v[126:127], v55 offset:8448
    s_waitcnt vmcnt(28) lgkmcnt(0)
    s_barrier
    s_add_u32 m0, s78, 49152
    s_mov_b32 s69, 0
    buffer_load_dwordx4 v48, s[24:27], s69 offen lds
    s_add_u32 m0, s78, 50176
    s_mov_b32 s69, 9216
    buffer_load_dwordx4 v48, s[24:27], s69 offen lds
    s_add_u32 m0, s78, 51200
    s_mov_b32 s69, 0
    buffer_load_dwordx4 v49, s[24:27], s69 offen lds
    s_add_u32 m0, s78, 52224
    s_mov_b32 s69, 9216
    buffer_load_dwordx4 v49, s[24:27], s69 offen lds
    v_add_u32 v54, 81920, v50
    v_add_u32 v55, 81920, v51
    ds_read_b64_tr_b16 v[128:129], v54 offset:0
    ds_read_b64_tr_b16 v[130:131], v54 offset:256
    ds_read_b64_tr_b16 v[132:133], v54 offset:8192
    ds_read_b64_tr_b16 v[134:135], v54 offset:8448
    ds_read_b64_tr_b16 v[136:137], v55 offset:0
    ds_read_b64_tr_b16 v[138:139], v55 offset:256
    ds_read_b64_tr_b16 v[140:141], v55 offset:8192
    ds_read_b64_tr_b16 v[142:143], v55 offset:8448
    s_waitcnt vmcnt(28) lgkmcnt(0)
    s_barrier
    s_add_u32 m0, s78, 65536
    s_mov_b32 s69, 128
    buffer_load_dwordx4 v48, s[24:27], s69 offen lds
    s_add_u32 m0, s78, 66560
    s_mov_b32 s69, 9344
    buffer_load_dwordx4 v48, s[24:27], s69 offen lds
    s_add_u32 m0, s78, 67584
    s_mov_b32 s69, 128
    buffer_load_dwordx4 v49, s[24:27], s69 offen lds
    s_add_u32 m0, s78, 68608
    s_mov_b32 s69, 9344
    buffer_load_dwordx4 v49, s[24:27], s69 offen lds
    v_add_u32 v54, 98304, v50
    v_add_u32 v55, 98304, v51
    ds_read_b64_tr_b16 v[144:145], v54 offset:0
    ds_read_b64_tr_b16 v[146:147], v54 offset:256
    ds_read_b64_tr_b16 v[148:149], v54 offset:8192
    ds_read_b64_tr_b16 v[150:151], v54 offset:8448
    ds_read_b64_tr_b16 v[152:153], v55 offset:0
    ds_read_b64_tr_b16 v[154:155], v55 offset:256
    ds_read_b64_tr_b16 v[156:157], v55 offset:8192
    ds_read_b64_tr_b16 v[158:159], v55 offset:8448
    s_waitcnt vmcnt(28) lgkmcnt(0)
    s_barrier
    s_add_u32 m0, s78, 81920
    s_mov_b32 s69, 384
    buffer_load_dwordx4 v48, s[24:27], s69 offen lds
    s_add_u32 m0, s78, 82944
    s_mov_b32 s69, 9600
    buffer_load_dwordx4 v48, s[24:27], s69 offen lds
    s_add_u32 m0, s78, 83968
    s_mov_b32 s69, 384
    buffer_load_dwordx4 v49, s[24:27], s69 offen lds
    s_add_u32 m0, s78, 84992
    s_mov_b32 s69, 9600
    buffer_load_dwordx4 v49, s[24:27], s69 offen lds
    v_add_u32 v54, 114688, v50
    v_add_u32 v55, 114688, v51
    ds_read_b64_tr_b16 v[160:161], v54 offset:0
    ds_read_b64_tr_b16 v[162:163], v54 offset:256
    ds_read_b64_tr_b16 v[164:165], v54 offset:8192
    ds_read_b64_tr_b16 v[166:167], v54 offset:8448
    ds_read_b64_tr_b16 v[168:169], v55 offset:0
    ds_read_b64_tr_b16 v[170:171], v55 offset:256
    ds_read_b64_tr_b16 v[172:173], v55 offset:8192
    ds_read_b64_tr_b16 v[174:175], v55 offset:8448
    s_waitcnt vmcnt(28) lgkmcnt(0)
    s_barrier
    s_add_u32 m0, s78, 98304
    s_mov_b32 s69, 512
    buffer_load_dwordx4 v48, s[24:27], s69 offen lds
    s_add_u32 m0, s78, 99328
    s_mov_b32 s69, 9728
    buffer_load_dwordx4 v48, s[24:27], s69 offen lds
    s_add_u32 m0, s78, 100352
    s_mov_b32 s69, 512
    buffer_load_dwordx4 v49, s[24:27], s69 offen lds
    s_add_u32 m0, s78, 101376
    s_mov_b32 s69, 9728
    buffer_load_dwordx4 v49, s[24:27], s69 offen lds
    v_add_u32 v54, 131072, v50
    v_add_u32 v55, 131072, v51
    ds_read_b64_tr_b16 v[176:177], v54 offset:0
    ds_read_b64_tr_b16 v[178:179], v54 offset:256
    ds_read_b64_tr_b16 v[180:181], v54 offset:8192
    ds_read_b64_tr_b16 v[182:183], v54 offset:8448
    ds_read_b64_tr_b16 v[184:185], v55 offset:0
    ds_read_b64_tr_b16 v[186:187], v55 offset:256
    ds_read_b64_tr_b16 v[188:189], v55 offset:8192
    ds_read_b64_tr_b16 v[190:191], v55 offset:8448
    s_waitcnt vmcnt(28) lgkmcnt(0)
    s_barrier
    s_add_u32 m0, s78, 114688
    s_mov_b32 s69, 768
    buffer_load_dwordx4 v48, s[24:27], s69 offen lds
    s_add_u32 m0, s78, 115712
    s_mov_b32 s69, 9984
    buffer_load_dwordx4 v48, s[24:27], s69 offen lds
    s_add_u32 m0, s78, 116736
    s_mov_b32 s69, 768
    buffer_load_dwordx4 v49, s[24:27], s69 offen lds
    s_add_u32 m0, s78, 117760
    s_mov_b32 s69, 9984
    buffer_load_dwordx4 v49, s[24:27], s69 offen lds
    v_add_u32 v54, 147456, v50
    v_add_u32 v55, 147456, v51
    ds_read_b64_tr_b16 v[192:193], v54 offset:0
    ds_read_b64_tr_b16 v[194:195], v54 offset:256
    ds_read_b64_tr_b16 v[196:197], v54 offset:8192
    ds_read_b64_tr_b16 v[198:199], v54 offset:8448
    ds_read_b64_tr_b16 v[200:201], v55 offset:0
    ds_read_b64_tr_b16 v[202:203], v55 offset:256
    ds_read_b64_tr_b16 v[204:205], v55 offset:8192
    ds_read_b64_tr_b16 v[206:207], v55 offset:8448
    s_waitcnt vmcnt(28) lgkmcnt(0)
    s_barrier
    s_cmp_lg_u32 s5, 0
    s_cbranch_scc1 L_nogo_75
    v_mov_b32 v53, 1
    s_mov_b32 s69, 39936
    s_mov_b64 exec, 1
    buffer_store_dword v53, off, s[8:11], s69 sc1
    s_mov_b64 exec, -1
L_nogo_75:
    s_add_u32 m0, s78, 131072
    s_mov_b32 s69, 1024
    buffer_load_dwordx4 v48, s[24:27], s69 offen lds
    s_add_u32 m0, s78, 132096
    s_mov_b32 s69, 10240
    buffer_load_dwordx4 v48, s[24:27], s69 offen lds
    s_add_u32 m0, s78, 133120
    s_mov_b32 s69, 1024
    buffer_load_dwordx4 v49, s[24:27], s69 offen lds
    s_add_u32 m0, s78, 134144
    s_mov_b32 s69, 10240
    buffer_load_dwordx4 v49, s[24:27], s69 offen lds
    v_mov_b32 v76, 4096
    s_mov_b32 s69, 40064
    buffer_load_dword v45, off, s[8:11], s69 sc1
    buffer_load_dwordx4 v[72:75], off, s[8:11], s82 sc1
    buffer_load_dwordx4 v[76:79], v76, s[8:11], s82 offen sc1
    v_add_u32 v54, 16384, v52
    ds_read_b64_tr_b16 v[208:209], v54 offset:0
    ds_read_b64_tr_b16 v[210:211], v54 offset:256
    ds_read_b64_tr_b16 v[212:213], v54 offset:1024
    ds_read_b64_tr_b16 v[214:215], v54 offset:1280
    ds_read_b64_tr_b16 v[216:217], v54 offset:8192
    ds_read_b64_tr_b16 v[218:219], v54 offset:8448
    ds_read_b64_tr_b16 v[220:221], v54 offset:9216
    ds_read_b64_tr_b16 v[222:223], v54 offset:9472
    s_waitcnt vmcnt(31) lgkmcnt(0)
    s_barrier
    v_add_u32 v53, s78, v0
    v_add_u32 v53, 0, v53
    ds_write_b128 v53, v[12:15] offset:0
    ds_write_b128 v53, v[16:19] offset:1024
    ds_write_b128 v53, v[20:23] offset:2048
    ds_write_b128 v53, v[24:27] offset:3072
    v_add_u32 v54, 32768, v52
    ds_read_b64_tr_b16 v[224:225], v54 offset:0
    ds_read_b64_tr_b16 v[226:227], v54 offset:256
    ds_read_b64_tr_b16 v[228:229], v54 offset:1024
    ds_read_b64_tr_b16 v[230:231], v54 offset:1280
    ds_read_b64_tr_b16 v[232:233], v54 offset:8192
    ds_read_b64_tr_b16 v[234:235], v54 offset:8448
    ds_read_b64_tr_b16 v[236:237], v54 offset:9216
    ds_read_b64_tr_b16 v[238:239], v54 offset:9472
    s_waitcnt vmcnt(27) lgkmcnt(0)
    s_barrier
    v_add_u32_e64 v53, s78, v0
    v_add_u32 v53, 16384, v53
    ds_write_b128 v53, v[28:31] offset:0
    ds_write_b128 v53, v[32:35] offset:1024
    ds_write_b128 v53, v[36:39] offset:2048
    ds_write_b128 v53, v[40:43] offset:3072
    v_add_u32 v54, 49152, v52
    ds_read_b64_tr_b16 v[240:241], v54 offset:0
    ds_read_b64_tr_b16 v[242:243], v54 offset:256
    ds_read_b64_tr_b16 v[244:245], v54 offset:1024
    ds_read_b64_tr_b16 v[246:247], v54 offset:1280
    ds_read_b64_tr_b16 v[248:249], v54 offset:8192
    ds_read_b64_tr_b16 v[250:251], v54 offset:8448
    ds_read_b64_tr_b16 v[252:253], v54 offset:9216
    ds_read_b64_tr_b16 v[254:255], v54 offset:9472
    s_waitcnt vmcnt(23) lgkmcnt(0)
    s_barrier
    v_add_u32_e64 v53, s78, v0
    v_add_u32 v53, 32768, v53
    ds_write_b128 v53, v[56:59] offset:0
    ds_write_b128 v53, v[60:63] offset:1024
    ds_write_b128 v53, v[64:67] offset:2048
    ds_write_b128 v53, v[68:71] offset:3072
    v_add_u32 v54, 65536, v52
    ds_read_b64_tr_b16 v[56:57], v54 offset:0
    ds_read_b64_tr_b16 v[58:59], v54 offset:256
    ds_read_b64_tr_b16 v[60:61], v54 offset:1024
    ds_read_b64_tr_b16 v[62:63], v54 offset:1280
    ds_read_b64_tr_b16 v[64:65], v54 offset:8192
    ds_read_b64_tr_b16 v[66:67], v54 offset:8448
    ds_read_b64_tr_b16 v[68:69], v54 offset:9216
    ds_read_b64_tr_b16 v[70:71], v54 offset:9472
    s_waitcnt vmcnt(19) lgkmcnt(0)
    s_barrier
    v_add_u32_e64 v53, s78, v0
    v_add_u32 v53, 49152, v53
    ds_write_b128 v53, v[56:59] offset:0
    ds_write_b128 v53, v[60:63] offset:1024
    ds_write_b128 v53, v[64:67] offset:2048
    ds_write_b128 v53, v[68:71] offset:3072
    v_add_u32 v54, 81920, v52
    ds_read_b64_tr_b16 v[56:57], v54 offset:0
    ds_read_b64_tr_b16 v[58:59], v54 offset:256
    ds_read_b64_tr_b16 v[60:61], v54 offset:1024
    ds_read_b64_tr_b16 v[62:63], v54 offset:1280
    ds_read_b64_tr_b16 v[64:65], v54 offset:8192
    ds_read_b64_tr_b16 v[66:67], v54 offset:8448
    ds_read_b64_tr_b16 v[68:69], v54 offset:9216
    ds_read_b64_tr_b16 v[70:71], v54 offset:9472
    s_waitcnt vmcnt(15) lgkmcnt(0)
    s_barrier
    v_add_u32_e64 v53, s78, v0
    v_add_u32 v53, 65536, v53
    ds_write_b128 v53, v[56:59] offset:0
    ds_write_b128 v53, v[60:63] offset:1024
    ds_write_b128 v53, v[64:67] offset:2048
    ds_write_b128 v53, v[68:71] offset:3072
    v_add_u32 v54, 98304, v52
    ds_read_b64_tr_b16 v[56:57], v54 offset:0
    ds_read_b64_tr_b16 v[58:59], v54 offset:256
    ds_read_b64_tr_b16 v[60:61], v54 offset:1024
    ds_read_b64_tr_b16 v[62:63], v54 offset:1280
    ds_read_b64_tr_b16 v[64:65], v54 offset:8192
    ds_read_b64_tr_b16 v[66:67], v54 offset:8448
    ds_read_b64_tr_b16 v[68:69], v54 offset:9216
    ds_read_b64_tr_b16 v[70:71], v54 offset:9472
    s_waitcnt vmcnt(11) lgkmcnt(0)
    s_barrier
    v_add_u32_e64 v53, s78, v0
    v_add_u32 v53, 81920, v53
    ds_write_b128 v53, v[56:59] offset:0
    ds_write_b128 v53, v[60:63] offset:1024
    ds_write_b128 v53, v[64:67] offset:2048
    ds_write_b128 v53, v[68:71] offset:3072
    v_add_u32 v54, 114688, v52
    ds_read_b64_tr_b16 v[56:57], v54 offset:0
    ds_read_b64_tr_b16 v[58:59], v54 offset:256
    ds_read_b64_tr_b16 v[60:61], v54 offset:1024
    ds_read_b64_tr_b16 v[62:63], v54 offset:1280
    ds_read_b64_tr_b16 v[64:65], v54 offset:8192
    ds_read_b64_tr_b16 v[66:67], v54 offset:8448
    ds_read_b64_tr_b16 v[68:69], v54 offset:9216
    ds_read_b64_tr_b16 v[70:71], v54 offset:9472
    s_waitcnt vmcnt(7) lgkmcnt(0)
    s_barrier
    v_add_u32_e64 v53, s78, v0
    v_add_u32 v53, 98304, v53
    ds_write_b128 v53, v[56:59] offset:0
    ds_write_b128 v53, v[60:63] offset:1024
    ds_write_b128 v53, v[64:67] offset:2048
    ds_write_b128 v53, v[68:71] offset:3072
    v_add_u32 v54, 131072, v52
    ds_read_b64_tr_b16 v[56:57], v54 offset:0
    ds_read_b64_tr_b16 v[58:59], v54 offset:256
    ds_read_b64_tr_b16 v[60:61], v54 offset:1024
    ds_read_b64_tr_b16 v[62:63], v54 offset:1280
    ds_read_b64_tr_b16 v[64:65], v54 offset:8192
    ds_read_b64_tr_b16 v[66:67], v54 offset:8448
    ds_read_b64_tr_b16 v[68:69], v54 offset:9216
    ds_read_b64_tr_b16 v[70:71], v54 offset:9472
    s_waitcnt vmcnt(3) lgkmcnt(0)
    s_barrier
    v_add_u32_e64 v53, s78, v0
    v_add_u32 v53, 114688, v53
    ds_write_b128 v53, v[56:59] offset:0
    ds_write_b128 v53, v[60:63] offset:1024
    ds_write_b128 v53, v[64:67] offset:2048
    ds_write_b128 v53, v[68:71] offset:3072
    v_add_u32 v54, 147456, v52
    ds_read_b64_tr_b16 v[56:57], v54 offset:0
    ds_read_b64_tr_b16 v[58:59], v54 offset:256
    ds_read_b64_tr_b16 v[60:61], v54 offset:1024
    ds_read_b64_tr_b16 v[62:63], v54 offset:1280
    ds_read_b64_tr_b16 v[64:65], v54 offset:8192
    ds_read_b64_tr_b16 v[66:67], v54 offset:8448
    ds_read_b64_tr_b16 v[68:69], v54 offset:9216
    ds_read_b64_tr_b16 v[70:71], v54 offset:9472
    s_waitcnt lgkmcnt(0)
    s_barrier
    v_add_u32_e64 v53, s78, v0
    v_add_u32 v53, 131072, v53
    ds_write_b128 v53, v[56:59] offset:0
    ds_write_b128 v53, v[60:63] offset:1024
    ds_write_b128 v53, v[64:67] offset:2048
    ds_write_b128 v53, v[68:71] offset:3072
    s_branch L_staged
L_stage1:
    s_waitcnt vmcnt(37) lgkmcnt(0)
    s_barrier
    v_add_u32 v54, 16384, v50
    v_add_u32 v55, 16384, v51
    ds_read_b64_tr_b16 a[16:17], v54 offset:0
    ds_read_b64_tr_b16 a[18:19], v54 offset:256
    ds_read_b64_tr_b16 a[20:21], v54 offset:8192
    ds_read_b64_tr_b16 a[22:23], v54 offset:8448
    ds_read_b64_tr_b16 a[24:25], v55 offset:0
    ds_read_b64_tr_b16 a[26:27], v55 offset:256
    ds_read_b64_tr_b16 a[28:29], v55 offset:8192
    ds_read_b64_tr_b16 a[30:31], v55 offset:8448
    s_waitcnt vmcnt(33) lgkmcnt(0)
    s_barrier
    s_add_u32 m0, s78, 0
    s_mov_b32 s69, 0
    buffer_load_dwordx4 v44, s[16:19], s69 offen lds
    s_add_u32 m0, s78, 1024
    s_mov_b32 s69, 0
    buffer_load_dwordx4 v45, s[16:19], s69 offen lds
    s_add_u32 m0, s78, 2048
    s_mov_b32 s69, 0
    buffer_load_dwordx4 v46, s[16:19], s69 offen lds
    s_add_u32 m0, s78, 3072
    s_mov_b32 s69, 0
    buffer_load_dwordx4 v47, s[16:19], s69 offen lds
    v_add_u32 v54, 32768, v50
    v_add_u32 v55, 32768, v51
    ds_read_b64_tr_b16 a[0:1], v54 offset:0
    ds_read_b64_tr_b16 a[2:3], v54 offset:256
    ds_read_b64_tr_b16 a[4:5], v54 offset:8192
    ds_read_b64_tr_b16 a[6:7], v54 offset:8448
    ds_read_b64_tr_b16 a[8:9], v55 offset:0
    ds_read_b64_tr_b16 a[10:11], v55 offset:256
    ds_read_b64_tr_b16 a[12:13], v55 offset:8192
    ds_read_b64_tr_b16 a[14:15], v55 offset:8448
    s_waitcnt vmcnt(33) lgkmcnt(0)
    s_barrier
    s_add_u32 m0, s78, 16384
    s_mov_b32 s69, 524288
    buffer_load_dwordx4 v44, s[16:19], s69 offen lds
    s_add_u32 m0, s78, 17408
    s_mov_b32 s69, 524288
    buffer_load_dwordx4 v45, s[16:19], s69 offen lds
    s_add_u32 m0, s78, 18432
    s_mov_b32 s69, 524288
    buffer_load_dwordx4 v46, s[16:19], s69 offen lds
    s_add_u32 m0, s78, 19456
    s_mov_b32 s69, 524288
    buffer_load_dwordx4 v47, s[16:19], s69 offen lds
    v_add_u32 v54, 49152, v50
    v_add_u32 v55, 49152, v51
    ds_read_b64_tr_b16 a[48:49], v54 offset:0
    ds_read_b64_tr_b16 a[50:51], v54 offset:256
    ds_read_b64_tr_b16 a[52:53], v54 offset:8192
    ds_read_b64_tr_b16 a[54:55], v54 offset:8448
    ds_read_b64_tr_b16 a[56:57], v55 offset:0
    ds_read_b64_tr_b16 a[58:59], v55 offset:256
    ds_read_b64_tr_b16 a[60:61], v55 offset:8192
    ds_read_b64_tr_b16 a[62:63], v55 offset:8448
    s_waitcnt vmcnt(33) lgkmcnt(0)
    s_barrier
    s_add_u32 m0, s78, 32768
    s_mov_b32 s69, 1048576
    buffer_load_dwordx4 v44, s[16:19], s69 offen lds
    s_add_u32 m0, s78, 33792
    s_mov_b32 s69, 1048576
    buffer_load_dwordx4 v45, s[16:19], s69 offen lds
    s_add_u32 m0, s78, 34816
    s_mov_b32 s69, 1048576
    buffer_load_dwordx4 v46, s[16:19], s69 offen lds
    s_add_u32 m0, s78, 35840
    s_mov_b32 s69, 1048576
    buffer_load_dwordx4 v47, s[16:19], s69 offen lds
    v_add_u32 v54, 65536, v50
    v_add_u32 v55, 65536, v51
    ds_read_b64_tr_b16 a[32:33], v54 offset:0
    ds_read_b64_tr_b16 a[34:35], v54 offset:256
    ds_read_b64_tr_b16 a[36:37], v54 offset:8192
    ds_read_b64_tr_b16 a[38:39], v54 offset:8448
    ds_read_b64_tr_b16 a[40:41], v55 offset:0
    ds_read_b64_tr_b16 a[42:43], v55 offset:256
    ds_read_b64_tr_b16 a[44:45], v55 offset:8192
    ds_read_b64_tr_b16 a[46:47], v55 offset:8448
    s_waitcnt vmcnt(33) lgkmcnt(0)
    s_barrier
    s_add_u32 m0, s78, 49152
    s_mov_b32 s69, 1572864
    buffer_load_dwordx4 v44, s[16:19], s69 offen lds
    s_add_u32 m0, s78, 50176
    s_mov_b32 s69, 1572864
    buffer_load_dwordx4 v45, s[16:19], s69 offen lds
    s_add_u32 m0, s78, 51200
    s_mov_b32 s69, 1572864
    buffer_load_dwordx4 v46, s[16:19], s69 offen lds
    s_add_u32 m0, s78, 52224
    s_mov_b32 s69, 1572864
    buffer_load_dwordx4 v47, s[16:19], s69 offen lds
    v_add_u32 v54, 81920, v50
    v_add_u32 v55, 81920, v51
    ds_read_b64_tr_b16 a[80:81], v54 offset:0
    ds_read_b64_tr_b16 a[82:83], v54 offset:256
    ds_read_b64_tr_b16 a[84:85], v54 offset:8192
    ds_read_b64_tr_b16 a[86:87], v54 offset:8448
    ds_read_b64_tr_b16 a[88:89], v55 offset:0
    ds_read_b64_tr_b16 a[90:91], v55 offset:256
    ds_read_b64_tr_b16 a[92:93], v55 offset:8192
    ds_read_b64_tr_b16 a[94:95], v55 offset:8448
    s_waitcnt vmcnt(33) lgkmcnt(0)
    s_barrier
    s_add_u32 m0, s78, 65536
    s_mov_b32 s69, 2097152
    buffer_load_dwordx4 v44, s[16:19], s69 offen lds
    s_add_u32 m0, s78, 66560
    s_mov_b32 s69, 2097152
    buffer_load_dwordx4 v45, s[16:19], s69 offen lds
    s_add_u32 m0, s78, 67584
    s_mov_b32 s69, 2097152
    buffer_load_dwordx4 v46, s[16:19], s69 offen lds
    s_add_u32 m0, s78, 68608
    s_mov_b32 s69, 2097152
    buffer_load_dwordx4 v47, s[16:19], s69 offen lds
    v_add_u32 v54, 98304, v50
    v_add_u32 v55, 98304, v51
    ds_read_b64_tr_b16 a[64:65], v54 offset:0
    ds_read_b64_tr_b16 a[66:67], v54 offset:256
    ds_read_b64_tr_b16 a[68:69], v54 offset:8192
    ds_read_b64_tr_b16 a[70:71], v54 offset:8448
    ds_read_b64_tr_b16 a[72:73], v55 offset:0
    ds_read_b64_tr_b16 a[74:75], v55 offset:256
    ds_read_b64_tr_b16 a[76:77], v55 offset:8192
    ds_read_b64_tr_b16 a[78:79], v55 offset:8448
    s_waitcnt vmcnt(33) lgkmcnt(0)
    s_barrier
    s_add_u32 m0, s78, 81920
    s_mov_b32 s69, 2621440
    buffer_load_dwordx4 v44, s[16:19], s69 offen lds
    s_add_u32 m0, s78, 82944
    s_mov_b32 s69, 2621440
    buffer_load_dwordx4 v45, s[16:19], s69 offen lds
    s_add_u32 m0, s78, 83968
    s_mov_b32 s69, 2621440
    buffer_load_dwordx4 v46, s[16:19], s69 offen lds
    s_add_u32 m0, s78, 84992
    s_mov_b32 s69, 2621440
    buffer_load_dwordx4 v47, s[16:19], s69 offen lds
    v_add_u32 v54, 114688, v50
    v_add_u32 v55, 114688, v51
    ds_read_b64_tr_b16 a[112:113], v54 offset:0
    ds_read_b64_tr_b16 a[114:115], v54 offset:256
    ds_read_b64_tr_b16 a[116:117], v54 offset:8192
    ds_read_b64_tr_b16 a[118:119], v54 offset:8448
    ds_read_b64_tr_b16 a[120:121], v55 offset:0
    ds_read_b64_tr_b16 a[122:123], v55 offset:256
    ds_read_b64_tr_b16 a[124:125], v55 offset:8192
    ds_read_b64_tr_b16 a[126:127], v55 offset:8448
    s_waitcnt vmcnt(33) lgkmcnt(0)
    s_barrier
    s_add_u32 m0, s78, 98304
    s_mov_b32 s69, 3145728
    buffer_load_dwordx4 v44, s[16:19], s69 offen lds
    s_add_u32 m0, s78, 99328
    s_mov_b32 s69, 3145728
    buffer_load_dwordx4 v45, s[16:19], s69 offen lds
    s_add_u32 m0, s78, 100352
    s_mov_b32 s69, 3145728
    buffer_load_dwordx4 v46, s[16:19], s69 offen lds
    s_add_u32 m0, s78, 101376
    s_mov_b32 s69, 3145728
    buffer_load_dwordx4 v47, s[16:19], s69 offen lds
    v_add_u32 v54, 131072, v50
    v_add_u32 v55, 131072, v51
    ds_read_b64_tr_b16 a[96:97], v54 offset:0
    ds_read_b64_tr_b16 a[98:99], v54 offset:256
    ds_read_b64_tr_b16 a[100:101], v54 offset:8192
    ds_read_b64_tr_b16 a[102:103], v54 offset:8448
    ds_read_b64_tr_b16 a[104:105], v55 offset:0
    ds_read_b64_tr_b16 a[106:107], v55 offset:256
    ds_read_b64_tr_b16 a[108:109], v55 offset:8192
    ds_read_b64_tr_b16 a[110:111], v55 offset:8448
    s_waitcnt vmcnt(33) lgkmcnt(0)
    s_barrier
    s_add_u32 m0, s78, 114688
    s_mov_b32 s69, 3670016
    buffer_load_dwordx4 v44, s[16:19], s69 offen lds
    s_add_u32 m0, s78, 115712
    s_mov_b32 s69, 3670016
    buffer_load_dwordx4 v45, s[16:19], s69 offen lds
    s_add_u32 m0, s78, 116736
    s_mov_b32 s69, 3670016
    buffer_load_dwordx4 v46, s[16:19], s69 offen lds
    s_add_u32 m0, s78, 117760
    s_mov_b32 s69, 3670016
    buffer_load_dwordx4 v47, s[16:19], s69 offen lds
    v_add_u32 v54, 147456, v50
    v_add_u32 v55, 147456, v51
    ds_read_b64_tr_b16 a[128:129], v54 offset:0
    ds_read_b64_tr_b16 a[130:131], v54 offset:256
    ds_read_b64_tr_b16 a[132:133], v54 offset:8192
    ds_read_b64_tr_b16 a[134:135], v54 offset:8448
    ds_read_b64_tr_b16 a[136:137], v55 offset:0
    ds_read_b64_tr_b16 a[138:139], v55 offset:256
    ds_read_b64_tr_b16 a[140:141], v55 offset:8192
    ds_read_b64_tr_b16 a[142:143], v55 offset:8448
    s_waitcnt vmcnt(28) lgkmcnt(0)
    s_barrier
    s_cmp_lt_u32 s5, 9
    s_cselect_b64 vcc, -1, 0
    v_lshl_or_b32 v73, v74, 16, v73
    v_min_u32 v73, -2, v73
    v_cndmask_b32 v73, -1, v73, vcc
    s_min_u32 s69, s5, 27
    s_lshl_b32 s69, s69, 10
    s_add_u32 s69, s69, 393216
    buffer_store_dword v73, v11, s[8:11], s69 offen sc1
    buffer_load_dword v75, off, s[32:35], 0 offset:192 sc1
    s_add_u32 m0, s78, 131072
    s_mov_b32 s69, 4194304
    buffer_load_dwordx4 v44, s[16:19], s69 offen lds
    s_add_u32 m0, s78, 132096
    s_mov_b32 s69, 4194304
    buffer_load_dwordx4 v45, s[16:19], s69 offen lds
    s_add_u32 m0, s78, 133120
    s_mov_b32 s69, 4194304
    buffer_load_dwordx4 v46, s[16:19], s69 offen lds
    s_add_u32 m0, s78, 134144
    s_mov_b32 s69, 4194304
    buffer_load_dwordx4 v47, s[16:19], s69 offen lds
    v_add_u32 v54, 16384, v50
    v_add_u32 v55, 16384, v51
    ds_read_b64_tr_b16 a[160:161], v54 offset:0
    ds_read_b64_tr_b16 a[162:163], v54 offset:256
    ds_read_b64_tr_b16 a[164:165], v54 offset:8192
    ds_read_b64_tr_b16 a[166:167], v54 offset:8448
    ds_read_b64_tr_b16 a[168:169], v55 offset:0
    ds_read_b64_tr_b16 a[170:171], v55 offset:256
    ds_read_b64_tr_b16 a[172:173], v55 offset:8192
    ds_read_b64_tr_b16 a[174:175], v55 offset:8448
    s_waitcnt vmcnt(28) lgkmcnt(0)
    s_barrier
    s_add_u32 m0, s78, 0
    s_mov_b32 s69, 0
    buffer_load_dwordx4 v44, s[20:23], s69 offen lds
    s_add_u32 m0, s78, 1024
    s_mov_b32 s69, 0
    buffer_load_dwordx4 v45, s[20:23], s69 offen lds
    s_add_u32 m0, s78, 2048
    s_mov_b32 s69, 0
    buffer_load_dwordx4 v46, s[20:23], s69 offen lds
    s_add_u32 m0, s78, 3072
    s_mov_b32 s69, 0
    buffer_load_dwordx4 v47, s[20:23], s69 offen lds
    v_add_u32 v54, 32768, v50
    v_add_u32 v55, 32768, v51
    ds_read_b64_tr_b16 a[144:145], v54 offset:0
    ds_read_b64_tr_b16 a[146:147], v54 offset:256
    ds_read_b64_tr_b16 a[148:149], v54 offset:8192
    ds_read_b64_tr_b16 a[150:151], v54 offset:8448
    ds_read_b64_tr_b16 a[152:153], v55 offset:0
    ds_read_b64_tr_b16 a[154:155], v55 offset:256
    ds_read_b64_tr_b16 a[156:157], v55 offset:8192
    ds_read_b64_tr_b16 a[158:159], v55 offset:8448
    s_waitcnt vmcnt(28) lgkmcnt(0)
    s_barrier
    s_add_u32 m0, s78, 16384
    s_mov_b32 s69, 524288
    buffer_load_dwordx4 v44, s[20:23], s69 offen lds
    s_add_u32 m0, s78, 17408
    s_mov_b32 s69, 524288
    buffer_load_dwordx4 v45, s[20:23], s69 offen lds
    s_add_u32 m0, s78, 18432
    s_mov_b32 s69, 524288
    buffer_load_dwordx4 v46, s[20:23], s69 offen lds
    s_add_u32 m0, s78, 19456
    s_mov_b32 s69, 524288
    buffer_load_dwordx4 v47, s[20:23], s69 offen lds
    v_add_u32 v54, 49152, v50
    v_add_u32 v55, 49152, v51
    ds_read_b64_tr_b16 a[192:193], v54 offset:0
    ds_read_b64_tr_b16 a[194:195], v54 offset:256
    ds_read_b64_tr_b16 a[196:197], v54 offset:8192
    ds_read_b64_tr_b16 a[198:199], v54 offset:8448
    ds_read_b64_tr_b16 a[200:201], v55 offset:0
    ds_read_b64_tr_b16 a[202:203], v55 offset:256
    ds_read_b64_tr_b16 a[204:205], v55 offset:8192
    ds_read_b64_tr_b16 a[206:207], v55 offset:8448
    s_waitcnt vmcnt(28) lgkmcnt(0)
    s_barrier
    s_add_u32 m0, s78, 32768
    s_mov_b32 s69, 1048576
    buffer_load_dwordx4 v44, s[20:23], s69 offen lds
    s_add_u32 m0, s78, 33792
    s_mov_b32 s69, 1048576
    buffer_load_dwordx4 v45, s[20:23], s69 offen lds
    s_add_u32 m0, s78, 34816
    s_mov_b32 s69, 1048576
    buffer_load_dwordx4 v46, s[20:23], s69 offen lds
    s_add_u32 m0, s78, 35840
    s_mov_b32 s69, 1048576
    buffer_load_dwordx4 v47, s[20:23], s69 offen lds
    v_add_u32 v54, 65536, v50
    v_add_u32 v55, 65536, v51
    ds_read_b64_tr_b16 a[176:177], v54 offset:0
    ds_read_b64_tr_b16 a[178:179], v54 offset:256
    ds_read_b64_tr_b16 a[180:181], v54 offset:8192
    ds_read_b64_tr_b16 a[182:183], v54 offset:8448
    ds_read_b64_tr_b16 a[184:185], v55 offset:0
    ds_read_b64_tr_b16 a[186:187], v55 offset:256
    ds_read_b64_tr_b16 a[188:189], v55 offset:8192
    ds_read_b64_tr_b16 a[190:191], v55 offset:8448
    s_waitcnt vmcnt(28) lgkmcnt(0)
    s_barrier
    s_add_u32 m0, s78, 49152
    s_mov_b32 s69, 1572864
    buffer_load_dwordx4 v44, s[20:23], s69 offen lds
    s_add_u32 m0, s78, 50176
    s_mov_b32 s69, 1572864
    buffer_load_dwordx4 v45, s[20:23], s69 offen lds
    s_add_u32 m0, s78, 51200
    s_mov_b32 s69, 1572864
    buffer_load_dwordx4 v46, s[20:23], s69 offen lds
    s_add_u32 m0, s78, 52224
    s_mov_b32 s69, 1572864
    buffer_load_dwordx4 v47, s[20:23], s69 offen lds
    v_add_u32 v54, 81920, v50
    v_add_u32 v55, 81920, v51
    ds_read_b64_tr_b16 a[224:225], v54 offset:0
    ds_read_b64_tr_b16 a[226:227], v54 offset:256
    ds_read_b64_tr_b16 a[228:229], v54 offset:8192
    ds_read_b64_tr_b16 a[230:231], v54 offset:8448
    ds_read_b64_tr_b16 a[232:233], v55 offset:0
    ds_read_b64_tr_b16 a[234:235], v55 offset:256
    ds_read_b64_tr_b16 a[236:237], v55 offset:8192
    ds_read_b64_tr_b16 a[238:239], v55 offset:8448
    s_waitcnt vmcnt(28) lgkmcnt(0)
    s_barrier
    s_add_u32 m0, s78, 65536
    s_mov_b32 s69, 2097152
    buffer_load_dwordx4 v44, s[20:23], s69 offen lds
    s_add_u32 m0, s78, 66560
    s_mov_b32 s69, 2097152
    buffer_load_dwordx4 v45, s[20:23], s69 offen lds
    s_add_u32 m0, s78, 67584
    s_mov_b32 s69, 2097152
    buffer_load_dwordx4 v46, s[20:23], s69 offen lds
    s_add_u32 m0, s78, 68608
    s_mov_b32 s69, 2097152
    buffer_load_dwordx4 v47, s[20:23], s69 offen lds
    v_add_u32 v54, 98304, v50
    v_add_u32 v55, 98304, v51
    ds_read_b64_tr_b16 a[208:209], v54 offset:0
    ds_read_b64_tr_b16 a[210:211], v54 offset:256
    ds_read_b64_tr_b16 a[212:213], v54 offset:8192
    ds_read_b64_tr_b16 a[214:215], v54 offset:8448
    ds_read_b64_tr_b16 a[216:217], v55 offset:0
    ds_read_b64_tr_b16 a[218:219], v55 offset:256
    ds_read_b64_tr_b16 a[220:221], v55 offset:8192
    ds_read_b64_tr_b16 a[222:223], v55 offset:8448
    s_waitcnt vmcnt(28) lgkmcnt(0)
    s_barrier
    s_add_u32 m0, s78, 81920
    s_mov_b32 s69, 2621440
    buffer_load_dwordx4 v44, s[20:23], s69 offen lds
    s_add_u32 m0, s78, 82944
    s_mov_b32 s69, 2621440
    buffer_load_dwordx4 v45, s[20:23], s69 offen lds
    s_add_u32 m0, s78, 83968
    s_mov_b32 s69, 2621440
    buffer_load_dwordx4 v46, s[20:23], s69 offen lds
    s_add_u32 m0, s78, 84992
    s_mov_b32 s69, 2621440
    buffer_load_dwordx4 v47, s[20:23], s69 offen lds
    v_add_u32 v54, 114688, v50
    v_add_u32 v55, 114688, v51
    ds_read_b64_tr_b16 v[80:81], v54 offset:0
    ds_read_b64_tr_b16 v[82:83], v54 offset:256
    ds_read_b64_tr_b16 v[84:85], v54 offset:8192
    ds_read_b64_tr_b16 v[86:87], v54 offset:8448
    ds_read_b64_tr_b16 v[88:89], v55 offset:0
    ds_read_b64_tr_b16 v[90:91], v55 offset:256
    ds_read_b64_tr_b16 v[92:93], v55 offset:8192
    ds_read_b64_tr_b16 v[94:95], v55 offset:8448
    s_waitcnt vmcnt(28) lgkmcnt(0)
    s_barrier
    s_add_u32 m0, s78, 98304
    s_mov_b32 s69, 3145728
    buffer_load_dwordx4 v44, s[20:23], s69 offen lds
    s_add_u32 m0, s78, 99328
    s_mov_b32 s69, 3145728
    buffer_load_dwordx4 v45, s[20:23], s69 offen lds
    s_add_u32 m0, s78, 100352
    s_mov_b32 s69, 3145728
    buffer_load_dwordx4 v46, s[20:23], s69 offen lds
    s_add_u32 m0, s78, 101376
    s_mov_b32 s69, 3145728
    buffer_load_dwordx4 v47, s[20:23], s69 offen lds
    v_add_u32 v54, 131072, v50
    v_add_u32 v55, 131072, v51
    ds_read_b64_tr_b16 a[240:241], v54 offset:0
    ds_read_b64_tr_b16 a[242:243], v54 offset:256
    ds_read_b64_tr_b16 a[244:245], v54 offset:8192
    ds_read_b64_tr_b16 a[246:247], v54 offset:8448
    ds_read_b64_tr_b16 a[248:249], v55 offset:0
    ds_read_b64_tr_b16 a[250:251], v55 offset:256
    ds_read_b64_tr_b16 a[252:253], v55 offset:8192
    ds_read_b64_tr_b16 a[254:255], v55 offset:8448
    s_waitcnt vmcnt(28) lgkmcnt(0)
    s_barrier
    s_add_u32 m0, s78, 114688
    s_mov_b32 s69, 3670016
    buffer_load_dwordx4 v44, s[20:23], s69 offen lds
    s_add_u32 m0, s78, 115712
    s_mov_b32 s69, 3670016
    buffer_load_dwordx4 v45, s[20:23], s69 offen lds
    s_add_u32 m0, s78, 116736
    s_mov_b32 s69, 3670016
    buffer_load_dwordx4 v46, s[20:23], s69 offen lds
    s_add_u32 m0, s78, 117760
    s_mov_b32 s69, 3670016
    buffer_load_dwordx4 v47, s[20:23], s69 offen lds
    v_add_u32 v54, 147456, v50
    v_add_u32 v55, 147456, v51
    ds_read_b64_tr_b16 v[96:97], v54 offset:0
    ds_read_b64_tr_b16 v[98:99], v54 offset:256
    ds_read_b64_tr_b16 v[100:101], v54 offset:8192
    ds_read_b64_tr_b16 v[102:103], v54 offset:8448
    ds_read_b64_tr_b16 v[104:105], v55 offset:0
    ds_read_b64_tr_b16 v[106:107], v55 offset:256
    ds_read_b64_tr_b16 v[108:109], v55 offset:8192
    ds_read_b64_tr_b16 v[110:111], v55 offset:8448
    s_waitcnt vmcnt(28) lgkmcnt(0)
    s_barrier
    s_add_u32 m0, s78, 131072
    s_mov_b32 s69, 4194304
    buffer_load_dwordx4 v44, s[20:23], s69 offen lds
    s_add_u32 m0, s78, 132096
    s_mov_b32 s69, 4194304
    buffer_load_dwordx4 v45, s[20:23], s69 offen lds
    s_add_u32 m0, s78, 133120
    s_mov_b32 s69, 4194304
    buffer_load_dwordx4 v46, s[20:23], s69 offen lds
    s_add_u32 m0, s78, 134144
    s_mov_b32 s69, 4194304
    buffer_load_dwordx4 v47, s[20:23], s69 offen lds
    v_add_u32 v54, 16384, v50
    v_add_u32 v55, 16384, v51
    ds_read_b64_tr_b16 v[28:29], v54 offset:0
    ds_read_b64_tr_b16 v[30:31], v54 offset:256
    ds_read_b64_tr_b16 v[32:33], v54 offset:8192
    ds_read_b64_tr_b16 v[34:35], v54 offset:8448
    ds_read_b64_tr_b16 v[36:37], v55 offset:0
    ds_read_b64_tr_b16 v[38:39], v55 offset:256
    ds_read_b64_tr_b16 v[40:41], v55 offset:8192
    ds_read_b64_tr_b16 v[42:43], v55 offset:8448
    s_waitcnt vmcnt(28) lgkmcnt(0)
    s_barrier
    v_readfirstlane_b32 s84, v75
    s_cmp_lg_u32 s84, 0
    s_cbranch_scc1 L_isrdy_76
    s_mov_b32 s79, 524288
L_rdy_77:
    buffer_load_dword v75, off, s[32:35], 0 offset:192 sc1
    s_waitcnt vmcnt(0)
    v_readfirstlane_b32 s84, v75
    s_cmp_lg_u32 s84, 0
    s_cbranch_scc1 L_rdyok_78
    s_sub_u32 s79, s79, 1
    s_cbranch_scc1 L_fail
    s_branch L_rdy_77
L_rdyok_78:
L_isrdy_76:
    s_add_u32 m0, s78, 0
    s_mov_b32 s69, 256
    buffer_load_dwordx4 v48, s[24:27], s69 offen lds
    s_add_u32 m0, s78, 1024
    s_mov_b32 s69, 9472
    buffer_load_dwordx4 v48, s[24:27], s69 offen lds
    s_add_u32 m0, s78, 2048
    s_mov_b32 s69, 256
    buffer_load_dwordx4 v49, s[24:27], s69 offen lds
    s_add_u32 m0, s78, 3072
    s_mov_b32 s69, 9472
    buffer_load_dwordx4 v49, s[24:27], s69 offen lds
    v_add_u32 v54, 32768, v50
    v_add_u32 v55, 32768, v51
    ds_read_b64_tr_b16 v[12:13], v54 offset:0
    ds_read_b64_tr_b16 v[14:15], v54 offset:256
    ds_read_b64_tr_b16 v[16:17], v54 offset:8192
    ds_read_b64_tr_b16 v[18:19], v54 offset:8448
    ds_read_b64_tr_b16 v[20:21], v55 offset:0
    ds_read_b64_tr_b16 v[22:23], v55 offset:256
    ds_read_b64_tr_b16 v[24:25], v55 offset:8192
    ds_read_b64_tr_b16 v[26:27], v55 offset:8448
    s_waitcnt vmcnt(28) lgkmcnt(0)
    s_barrier
    s_add_u32 m0, s78, 16384
    s_mov_b32 s69, 640
    buffer_load_dwordx4 v48, s[24:27], s69 offen lds
    s_add_u32 m0, s78, 17408
    s_mov_b32 s69, 9856
    buffer_load_dwordx4 v48, s[24:27], s69 offen lds
    s_add_u32 m0, s78, 18432
    s_mov_b32 s69, 640
    buffer_load_dwordx4 v49, s[24:27], s69 offen lds
    s_add_u32 m0, s78, 19456
    s_mov_b32 s69, 9856
    buffer_load_dwordx4 v49, s[24:27], s69 offen lds
    v_add_u32 v54, 49152, v50
    v_add_u32 v55, 49152, v51
    ds_read_b64_tr_b16 v[112:113], v54 offset:0
    ds_read_b64_tr_b16 v[114:115], v54 offset:256
    ds_read_b64_tr_b16 v[116:117], v54 offset:8192
    ds_read_b64_tr_b16 v[118:119], v54 offset:8448
    ds_read_b64_tr_b16 v[120:121], v55 offset:0
    ds_read_b64_tr_b16 v[122:123], v55 offset:256
    ds_read_b64_tr_b16 v[124:125], v55 offset:8192
    ds_read_b64_tr_b16 v[126:127], v55 offset:8448
    s_waitcnt vmcnt(28) lgkmcnt(0)
    s_barrier
    s_add_u32 m0, s78, 32768
    s_mov_b32 s69, 896
    buffer_load_dwordx4 v48, s[24:27], s69 offen lds
    s_add_u32 m0, s78, 33792
    s_mov_b32 s69, 10112
    buffer_load_dwordx4 v48, s[24:27], s69 offen lds
    s_add_u32 m0, s78, 34816
    s_mov_b32 s69, 896
    buffer_load_dwordx4 v49, s[24:27], s69 offen lds
    s_add_u32 m0, s78, 35840
    s_mov_b32 s69, 10112
    buffer_load_dwordx4 v49, s[24:27], s69 offen lds
    v_add_u32 v54, 65536, v50
    v_add_u32 v55, 65536, v51
    ds_read_b64_tr_b16 v[56:57], v54 offset:0
    ds_read_b64_tr_b16 v[58:59], v54 offset:256
    ds_read_b64_tr_b16 v[60:61], v54 offset:8192
    ds_read_b64_tr_b16 v[62:63], v54 offset:8448
    ds_read_b64_tr_b16 v[64:65], v55 offset:0
    ds_read_b64_tr_b16 v[66:67], v55 offset:256
    ds_read_b64_tr_b16 v[68:69], v55 offset:8192
    ds_read_b64_tr_b16 v[70:71], v55 offset:8448
    s_waitcnt vmcnt(28) lgkmcnt(0)
    s_barrier
    s_add_u32 m0, s78, 49152
    s_mov_b32 s69, 0
    buffer_load_dwordx4 v48, s[24:27], s69 offen lds
    s_add_u32 m0, s78, 50176
    s_mov_b32 s69, 9216
    buffer_load_dwordx4 v48, s[24:27], s69 offen lds
    s_add_u32 m0, s78, 51200
    s_mov_b32 s69, 0
    buffer_load_dwordx4 v49, s[24:27], s69 offen lds
    s_add_u32 m0, s78, 52224
    s_mov_b32 s69, 9216
    buffer_load_dwordx4 v49, s[24:27], s69 offen lds
    v_add_u32 v54, 81920, v50
    v_add_u32 v55, 81920, v51
    ds_read_b64_tr_b16 v[144:145], v54 offset:0
    ds_read_b64_tr_b16 v[146:147], v54 offset:256
    ds_read_b64_tr_b16 v[148:149], v54 offset:8192
    ds_read_b64_tr_b16 v[150:151], v54 offset:8448
    ds_read_b64_tr_b16 v[152:153], v55 offset:0
    ds_read_b64_tr_b16 v[154:155], v55 offset:256
    ds_read_b64_tr_b16 v[156:157], v55 offset:8192
    ds_read_b64_tr_b16 v[158:159], v55 offset:8448
    s_waitcnt vmcnt(28) lgkmcnt(0)
    s_barrier
    s_add_u32 m0, s78, 65536
    s_mov_b32 s69, 128
    buffer_load_dwordx4 v48, s[24:27], s69 offen lds
    s_add_u32 m0, s78, 66560
    s_mov_b32 s69, 9344
    buffer_load_dwordx4 v48, s[24:27], s69 offen lds
    s_add_u32 m0, s78, 67584
    s_mov_b32 s69, 128
    buffer_load_dwordx4 v49, s[24:27], s69 offen lds
    s_add_u32 m0, s78, 68608
    s_mov_b32 s69, 9344
    buffer_load_dwordx4 v49, s[24:27], s69 offen lds
    v_add_u32 v54, 98304, v50
    v_add_u32 v55, 98304, v51
    ds_read_b64_tr_b16 v[128:129], v54 offset:0
    ds_read_b64_tr_b16 v[130:131], v54 offset:256
    ds_read_b64_tr_b16 v[132:133], v54 offset:8192
    ds_read_b64_tr_b16 v[134:135], v54 offset:8448
    ds_read_b64_tr_b16 v[136:137], v55 offset:0
    ds_read_b64_tr_b16 v[138:139], v55 offset:256
    ds_read_b64_tr_b16 v[140:141], v55 offset:8192
    ds_read_b64_tr_b16 v[142:143], v55 offset:8448
    s_waitcnt vmcnt(28) lgkmcnt(0)
    s_barrier
    s_add_u32 m0, s78, 81920
    s_mov_b32 s69, 384
    buffer_load_dwordx4 v48, s[24:27], s69 offen lds
    s_add_u32 m0, s78, 82944
    s_mov_b32 s69, 9600
    buffer_load_dwordx4 v48, s[24:27], s69 offen lds
    s_add_u32 m0, s78, 83968
    s_mov_b32 s69, 384
    buffer_load_dwordx4 v49, s[24:27], s69 offen lds
    s_add_u32 m0, s78, 84992
    s_mov_b32 s69, 9600
    buffer_load_dwordx4 v49, s[24:27], s69 offen lds
    v_add_u32 v54, 114688, v50
    v_add_u32 v55, 114688, v51
    ds_read_b64_tr_b16 v[176:177], v54 offset:0
    ds_read_b64_tr_b16 v[178:179], v54 offset:256
    ds_read_b64_tr_b16 v[180:181], v54 offset:8192
    ds_read_b64_tr_b16 v[182:183], v54 offset:8448
    ds_read_b64_tr_b16 v[184:185], v55 offset:0
    ds_read_b64_tr_b16 v[186:187], v55 offset:256
    ds_read_b64_tr_b16 v[188:189], v55 offset:8192
    ds_read_b64_tr_b16 v[190:191], v55 offset:8448
    s_waitcnt vmcnt(28) lgkmcnt(0)
    s_barrier
    s_add_u32 m0, s78, 98304
    s_mov_b32 s69, 512
    buffer_load_dwordx4 v48, s[24:27], s69 offen lds
    s_add_u32 m0, s78, 99328
    s_mov_b32 s69, 9728
    buffer_load_dwordx4 v48, s[24:27], s69 offen lds
    s_add_u32 m0, s78, 100352
    s_mov_b32 s69, 512
    buffer_load_dwordx4 v49, s[24:27], s69 offen lds
    s_add_u32 m0, s78, 101376
    s_mov_b32 s69, 9728
    buffer_load_dwordx4 v49, s[24:27], s69 offen lds
    v_add_u32 v54, 131072, v50
    v_add_u32 v55, 131072, v51
    ds_read_b64_tr_b16 v[160:161], v54 offset:0
    ds_read_b64_tr_b16 v[162:163], v54 offset:256
    ds_read_b64_tr_b16 v[164:165], v54 offset:8192
    ds_read_b64_tr_b16 v[166:167], v54 offset:8448
    ds_read_b64_tr_b16 v[168:169], v55 offset:0
    ds_read_b64_tr_b16 v[170:171], v55 offset:256
    ds_read_b64_tr_b16 v[172:173], v55 offset:8192
    ds_read_b64_tr_b16 v[174:175], v55 offset:8448
    s_waitcnt vmcnt(28) lgkmcnt(0)
    s_barrier
    s_add_u32 m0, s78, 114688
    s_mov_b32 s69, 768
    buffer_load_dwordx4 v48, s[24:27], s69 offen lds
    s_add_u32 m0, s78, 115712
    s_mov_b32 s69, 9984
    buffer_load_dwordx4 v48, s[24:27], s69 offen lds
    s_add_u32 m0, s78, 116736
    s_mov_b32 s69, 768
    buffer_load_dwordx4 v49, s[24:27], s69 offen lds
    s_add_u32 m0, s78, 117760
    s_mov_b32 s69, 9984
    buffer_load_dwordx4 v49, s[24:27], s69 offen lds
    v_add_u32 v54, 147456, v50
    v_add_u32 v55, 147456, v51
    ds_read_b64_tr_b16 v[192:193], v54 offset:0
    ds_read_b64_tr_b16 v[194:195], v54 offset:256
    ds_read_b64_tr_b16 v[196:197], v54 offset:8192
    ds_read_b64_tr_b16 v[198:199], v54 offset:8448
    ds_read_b64_tr_b16 v[200:201], v55 offset:0
    ds_read_b64_tr_b16 v[202:203], v55 offset:256
    ds_read_b64_tr_b16 v[204:205], v55 offset:8192
    ds_read_b64_tr_b16 v[206:207], v55 offset:8448
    s_waitcnt vmcnt(28) lgkmcnt(0)
    s_barrier
    s_add_u32 m0, s78, 131072
    s_mov_b32 s69, 1024
    buffer_load_dwordx4 v48, s[24:27], s69 offen lds
    s_add_u32 m0, s78, 132096
    s_mov_b32 s69, 10240
    buffer_load_dwordx4 v48, s[24:27], s69 offen lds
    s_add_u32 m0, s78, 133120
    s_mov_b32 s69, 1024
    buffer_load_dwordx4 v49, s[24:27], s69 offen lds
    s_add_u32 m0, s78, 134144
    s_mov_b32 s69, 10240
    buffer_load_dwordx4 v49, s[24:27], s69 offen lds
    v_mov_b32 v76, 4096
    s_mov_b32 s69, 40064
    buffer_load_dword v45, off, s[8:11], s69 sc1
    buffer_load_dwordx4 v[72:75], off, s[8:11], s82 sc1
    buffer_load_dwordx4 v[76:79], v76, s[8:11], s82 offen sc1
    v_add_u32 v54, 16384, v52
    ds_read_b64_tr_b16 v[208:209], v54 offset:0
    ds_read_b64_tr_b16 v[210:211], v54 offset:256
    ds_read_b64_tr_b16 v[212:213], v54 offset:1024
    ds_read_b64_tr_b16 v[214:215], v54 offset:1280
    ds_read_b64_tr_b16 v[216:217], v54 offset:8192
    ds_read_b64_tr_b16 v[218:219], v54 offset:8448
    ds_read_b64_tr_b16 v[220:221], v54 offset:9216
    ds_read_b64_tr_b16 v[222:223], v54 offset:9472
    s_waitcnt vmcnt(31) lgkmcnt(0)
    s_barrier
    v_add_u32 v53, s78, v0
    v_add_u32 v53, 0, v53
    ds_write_b128 v53, v[12:15] offset:0
    ds_write_b128 v53, v[16:19] offset:1024
    ds_write_b128 v53, v[20:23] offset:2048
    ds_write_b128 v53, v[24:27] offset:3072
    v_add_u32 v54, 32768, v52
    ds_read_b64_tr_b16 v[224:225], v54 offset:0
    ds_read_b64_tr_b16 v[226:227], v54 offset:256
    ds_read_b64_tr_b16 v[228:229], v54 offset:1024
    ds_read_b64_tr_b16 v[230:231], v54 offset:1280
    ds_read_b64_tr_b16 v[232:233], v54 offset:8192
    ds_read_b64_tr_b16 v[234:235], v54 offset:8448
    ds_read_b64_tr_b16 v[236:237], v54 offset:9216
    ds_read_b64_tr_b16 v[238:239], v54 offset:9472
    s_waitcnt vmcnt(27) lgkmcnt(0)
    s_barrier
    v_add_u32_e64 v53, s78, v0
    v_add_u32 v53, 16384, v53
    ds_write_b128 v53, v[28:31] offset:0
    ds_write_b128 v53, v[32:35] offset:1024
    ds_write_b128 v53, v[36:39] offset:2048
    ds_write_b128 v53, v[40:43] offset:3072
    v_add_u32 v54, 49152, v52
    ds_read_b64_tr_b16 v[240:241], v54 offset:0
    ds_read_b64_tr_b16 v[242:243], v54 offset:256
    ds_read_b64_tr_b16 v[244:245], v54 offset:1024
    ds_read_b64_tr_b16 v[246:247], v54 offset:1280
    ds_read_b64_tr_b16 v[248:249], v54 offset:8192
    ds_read_b64_tr_b16 v[250:251], v54 offset:8448
    ds_read_b64_tr_b16 v[252:253], v54 offset:9216
    ds_read_b64_tr_b16 v[254:255], v54 offset:9472
    s_waitcnt vmcnt(23) lgkmcnt(0)
    s_barrier
    v_add_u32_e64 v53, s78, v0
    v_add_u32 v53, 32768, v53
    ds_write_b128 v53, v[56:59] offset:0
    ds_write_b128 v53, v[60:63] offset:1024
    ds_write_b128 v53, v[64:67] offset:2048
    ds_write_b128 v53, v[68:71] offset:3072
    v_add_u32 v54, 65536, v52
    ds_read_b64_tr_b16 v[56:57], v54 offset:0
    ds_read_b64_tr_b16 v[58:59], v54 offset:256
    ds_read_b64_tr_b16 v[60:61], v54 offset:1024
    ds_read_b64_tr_b16 v[62:63], v54 offset:1280
    ds_read_b64_tr_b16 v[64:65], v54 offset:8192
    ds_read_b64_tr_b16 v[66:67], v54 offset:8448
    ds_read_b64_tr_b16 v[68:69], v54 offset:9216
    ds_read_b64_tr_b16 v[70:71], v54 offset:9472
    s_waitcnt vmcnt(19) lgkmcnt(0)
    s_barrier
    v_add_u32_e64 v53, s78, v0
    v_add_u32 v53, 49152, v53
    ds_write_b128 v53, v[56:59] offset:0
    ds_write_b128 v53, v[60:63] offset:1024
    ds_write_b128 v53, v[64:67] offset:2048
    ds_write_b128 v53, v[68:71] offset:3072
    v_add_u32 v54, 81920, v52
    ds_read_b64_tr_b16 v[56:57], v54 offset:0
    ds_read_b64_tr_b16 v[58:59], v54 offset:256
    ds_read_b64_tr_b16 v[60:61], v54 offset:1024
    ds_read_b64_tr_b16 v[62:63], v54 offset:1280
    ds_read_b64_tr_b16 v[64:65], v54 offset:8192
    ds_read_b64_tr_b16 v[66:67], v54 offset:8448
    ds_read_b64_tr_b16 v[68:69], v54 offset:9216
    ds_read_b64_tr_b16 v[70:71], v54 offset:9472
    s_waitcnt vmcnt(15) lgkmcnt(0)
    s_barrier
    v_add_u32_e64 v53, s78, v0
    v_add_u32 v53, 65536, v53
    ds_write_b128 v53, v[56:59] offset:0
    ds_write_b128 v53, v[60:63] offset:1024
    ds_write_b128 v53, v[64:67] offset:2048
    ds_write_b128 v53, v[68:71] offset:3072
    v_add_u32 v54, 98304, v52
    ds_read_b64_tr_b16 v[56:57], v54 offset:0
    ds_read_b64_tr_b16 v[58:59], v54 offset:256
    ds_read_b64_tr_b16 v[60:61], v54 offset:1024
    ds_read_b64_tr_b16 v[62:63], v54 offset:1280
    ds_read_b64_tr_b16 v[64:65], v54 offset:8192
    ds_read_b64_tr_b16 v[66:67], v54 offset:8448
    ds_read_b64_tr_b16 v[68:69], v54 offset:9216
    ds_read_b64_tr_b16 v[70:71], v54 offset:9472
    s_waitcnt vmcnt(11) lgkmcnt(0)
    s_barrier
    v_add_u32_e64 v53, s78, v0
    v_add_u32 v53, 81920, v53
    ds_write_b128 v53, v[56:59] offset:0
    ds_write_b128 v53, v[60:63] offset:1024
    ds_write_b128 v53, v[64:67] offset:2048
    ds_write_b128 v53, v[68:71] offset:3072
    v_add_u32 v54, 114688, v52
    ds_read_b64_tr_b16 v[56:57], v54 offset:0
    ds_read_b64_tr_b16 v[58:59], v54 offset:256
    ds_read_b64_tr_b16 v[60:61], v54 offset:1024
    ds_read_b64_tr_b16 v[62:63], v54 offset:1280
    ds_read_b64_tr_b16 v[64:65], v54 offset:8192
    ds_read_b64_tr_b16 v[66:67], v54 offset:8448
    ds_read_b64_tr_b16 v[68:69], v54 offset:9216
    ds_read_b64_tr_b16 v[70:71], v54 offset:9472
    s_waitcnt vmcnt(7) lgkmcnt(0)
    s_barrier
    v_add_u32_e64 v53, s78, v0
    v_add_u32 v53, 98304, v53
    ds_write_b128 v53, v[56:59] offset:0
    ds_write_b128 v53, v[60:63] offset:1024
    ds_write_b128 v53, v[64:67] offset:2048
    ds_write_b128 v53, v[68:71] offset:3072
    v_add_u32 v54, 131072, v52
    ds_read_b64_tr_b16 v[56:57], v54 offset:0
    ds_read_b64_tr_b16 v[58:59], v54 offset:256
    ds_read_b64_tr_b16 v[60:61], v54 offset:1024
    ds_read_b64_tr_b16 v[62:63], v54 offset:1280
    ds_read_b64_tr_b16 v[64:65], v54 offset:8192
    ds_read_b64_tr_b16 v[66:67], v54 offset:8448
    ds_read_b64_tr_b16 v[68:69], v54 offset:9216
    ds_read_b64_tr_b16 v[70:71], v54 offset:9472
    s_waitcnt vmcnt(3) lgkmcnt(0)
    s_barrier
    v_add_u32_e64 v53, s78, v0
    v_add_u32 v53, 114688, v53
    ds_write_b128 v53, v[56:59] offset:0
    ds_write_b128 v53, v[60:63] offset:1024
    ds_write_b128 v53, v[64:67] offset:2048
    ds_write_b128 v53, v[68:71] offset:3072
    v_add_u32 v54, 147456, v52
    ds_read_b64_tr_b16 v[56:57], v54 offset:0
    ds_read_b64_tr_b16 v[58:59], v54 offset:256
    ds_read_b64_tr_b16 v[60:61], v54 offset:1024
    ds_read_b64_tr_b16 v[62:63], v54 offset:1280
    ds_read_b64_tr_b16 v[64:65], v54 offset:8192
    ds_read_b64_tr_b16 v[66:67], v54 offset:8448
    ds_read_b64_tr_b16 v[68:69], v54 offset:9216
    ds_read_b64_tr_b16 v[70:71], v54 offset:9472
    s_waitcnt lgkmcnt(0)
    s_barrier
    v_add_u32_e64 v53, s78, v0
    v_add_u32 v53, 131072, v53
    ds_write_b128 v53, v[56:59] offset:0
    ds_write_b128 v53, v[60:63] offset:1024
    ds_write_b128 v53, v[64:67] offset:2048
    ds_write_b128 v53, v[68:71] offset:3072
    s_branch L_staged
L_stage2:
    s_waitcnt vmcnt(37) lgkmcnt(0)
    s_barrier
    v_add_u32 v54, 16384, v50
    v_add_u32 v55, 16384, v51
    ds_read_b64_tr_b16 a[32:33], v54 offset:0
    ds_read_b64_tr_b16 a[34:35], v54 offset:256
    ds_read_b64_tr_b16 a[36:37], v54 offset:8192
    ds_read_b64_tr_b16 a[38:39], v54 offset:8448
    ds_read_b64_tr_b16 a[40:41], v55 offset:0
    ds_read_b64_tr_b16 a[42:43], v55 offset:256
    ds_read_b64_tr_b16 a[44:45], v55 offset:8192
    ds_read_b64_tr_b16 a[46:47], v55 offset:8448
    s_waitcnt vmcnt(33) lgkmcnt(0)
    s_barrier
    s_add_u32 m0, s78, 0
    s_mov_b32 s69, 0
    buffer_load_dwordx4 v44, s[16:19], s69 offen lds
    s_add_u32 m0, s78, 1024
    s_mov_b32 s69, 0
    buffer_load_dwordx4 v45, s[16:19], s69 offen lds
    s_add_u32 m0, s78, 2048
    s_mov_b32 s69, 0
    buffer_load_dwordx4 v46, s[16:19], s69 offen lds
    s_add_u32 m0, s78, 3072
    s_mov_b32 s69, 0
    buffer_load_dwordx4 v47, s[16:19], s69 offen lds
    v_add_u32 v54, 32768, v50
    v_add_u32 v55, 32768, v51
    ds_read_b64_tr_b16 a[48:49], v54 offset:0
    ds_read_b64_tr_b16 a[50:51], v54 offset:256
    ds_read_b64_tr_b16 a[52:53], v54 offset:8192
    ds_read_b64_tr_b16 a[54:55], v54 offset:8448
    ds_read_b64_tr_b16 a[56:57], v55 offset:0
    ds_read_b64_tr_b16 a[58:59], v55 offset:256
    ds_read_b64_tr_b16 a[60:61], v55 offset:8192
    ds_read_b64_tr_b16 a[62:63], v55 offset:8448
    s_waitcnt vmcnt(33) lgkmcnt(0)
    s_barrier
    s_add_u32 m0, s78, 16384
    s_mov_b32 s69, 524288
    buffer_load_dwordx4 v44, s[16:19], s69 offen lds
    s_add_u32 m0, s78, 17408
    s_mov_b32 s69, 524288
    buffer_load_dwordx4 v45, s[16:19], s69 offen lds
    s_add_u32 m0, s78, 18432
    s_mov_b32 s69, 524288
    buffer_load_dwordx4 v46, s[16:19], s69 offen lds
    s_add_u32 m0, s78, 19456
    s_mov_b32 s69, 524288
    buffer_load_dwordx4 v47, s[16:19], s69 offen lds
    v_add_u32 v54, 49152, v50
    v_add_u32 v55, 49152, v51
    ds_read_b64_tr_b16 a[0:1], v54 offset:0
    ds_read_b64_tr_b16 a[2:3], v54 offset:256
    ds_read_b64_tr_b16 a[4:5], v54 offset:8192
    ds_read_b64_tr_b16 a[6:7], v54 offset:8448
    ds_read_b64_tr_b16 a[8:9], v55 offset:0
    ds_read_b64_tr_b16 a[10:11], v55 offset:256
    ds_read_b64_tr_b16 a[12:13], v55 offset:8192
    ds_read_b64_tr_b16 a[14:15], v55 offset:8448
    s_waitcnt vmcnt(33) lgkmcnt(0)
    s_barrier
    s_add_u32 m0, s78, 32768
    s_mov_b32 s69, 1048576
    buffer_load_dwordx4 v44, s[16:19], s69 offen lds
    s_add_u32 m0, s78, 33792
    s_mov_b32 s69, 1048576
    buffer_load_dwordx4 v45, s[16:19], s69 offen lds
    s_add_u32 m0, s78, 34816
    s_mov_b32 s69, 1048576
    buffer_load_dwordx4 v46, s[16:19], s69 offen lds
    s_add_u32 m0, s78, 35840
    s_mov_b32 s69, 1048576
    buffer_load_dwordx4 v47, s[16:19], s69 offen lds
    v_add_u32 v54, 65536, v50
    v_add_u32 v55, 65536, v51
    ds_read_b64_tr_b16 a[16:17], v54 offset:0
    ds_read_b64_tr_b16 a[18:19], v54 offset:256
    ds_read_b64_tr_b16 a[20:21], v54 offset:8192
    ds_read_b64_tr_b16 a[22:23], v54 offset:8448
    ds_read_b64_tr_b16 a[24:25], v55 offset:0
    ds_read_b64_tr_b16 a[26:27], v55 offset:256
    ds_read_b64_tr_b16 a[28:29], v55 offset:8192
    ds_read_b64_tr_b16 a[30:31], v55 offset:8448
    s_waitcnt vmcnt(33) lgkmcnt(0)
    s_barrier
    s_add_u32 m0, s78, 49152
    s_mov_b32 s69, 1572864
    buffer_load_dwordx4 v44, s[16:19], s69 offen lds
    s_add_u32 m0, s78, 50176
    s_mov_b32 s69, 1572864
    buffer_load_dwordx4 v45, s[16:19], s69 offen lds
    s_add_u32 m0, s78, 51200
    s_mov_b32 s69, 1572864
    buffer_load_dwordx4 v46, s[16:19], s69 offen lds
    s_add_u32 m0, s78, 52224
    s_mov_b32 s69, 1572864
    buffer_load_dwordx4 v47, s[16:19], s69 offen lds
    v_add_u32 v54, 81920, v50
    v_add_u32 v55, 81920, v51
    ds_read_b64_tr_b16 a[96:97], v54 offset:0
    ds_read_b64_tr_b16 a[98:99], v54 offset:256
    ds_read_b64_tr_b16 a[100:101], v54 offset:8192
    ds_read_b64_tr_b16 a[102:103], v54 offset:8448
    ds_read_b64_tr_b16 a[104:105], v55 offset:0
    ds_read_b64_tr_b16 a[106:107], v55 offset:256
    ds_read_b64_tr_b16 a[108:109], v55 offset:8192
    ds_read_b64_tr_b16 a[110:111], v55 offset:8448
    s_waitcnt vmcnt(33) lgkmcnt(0)
    s_barrier
    s_add_u32 m0, s78, 65536
    s_mov_b32 s69, 2097152
    buffer_load_dwordx4 v44, s[16:19], s69 offen lds
    s_add_u32 m0, s78, 66560
    s_mov_b32 s69, 2097152
    buffer_load_dwordx4 v45, s[16:19], s69 offen lds
    s_add_u32 m0, s78, 67584
    s_mov_b32 s69, 2097152
    buffer_load_dwordx4 v46, s[16:19], s69 offen lds
    s_add_u32 m0, s78, 68608
    s_mov_b32 s69, 2097152
    buffer_load_dwordx4 v47, s[16:19], s69 offen lds
    v_add_u32 v54, 98304, v50
    v_add_u32 v55, 98304, v51
    ds_read_b64_tr_b16 a[112:113], v54 offset:0
    ds_read_b64_tr_b16 a[114:115], v54 offset:256
    ds_read_b64_tr_b16 a[116:117], v54 offset:8192
    ds_read_b64_tr_b16 a[118:119], v54 offset:8448
    ds_read_b64_tr_b16 a[120:121], v55 offset:0
    ds_read_b64_tr_b16 a[122:123], v55 offset:256
    ds_read_b64_tr_b16 a[124:125], v55 offset:8192
    ds_read_b64_tr_b16 a[126:127], v55 offset:8448
    s_waitcnt vmcnt(33) lgkmcnt(0)
    s_barrier
    s_add_u32 m0, s78, 81920
    s_mov_b32 s69, 2621440
    buffer_load_dwordx4 v44, s[16:19], s69 offen lds
    s_add_u32 m0, s78, 82944
    s_mov_b32 s69, 2621440
    buffer_load_dwordx4 v45, s[16:19], s69 offen lds
    s_add_u32 m0, s78, 83968
    s_mov_b32 s69, 2621440
    buffer_load_dwordx4 v46, s[16:19], s69 offen lds
    s_add_u32 m0, s78, 84992
    s_mov_b32 s69, 2621440
    buffer_load_dwordx4 v47, s[16:19], s69 offen lds
    v_add_u32 v54, 114688, v50
    v_add_u32 v55, 114688, v51
    ds_read_b64_tr_b16 a[64:65], v54 offset:0
    ds_read_b64_tr_b16 a[66:67], v54 offset:256
    ds_read_b64_tr_b16 a[68:69], v54 offset:8192
    ds_read_b64_tr_b16 a[70:71], v54 offset:8448
    ds_read_b64_tr_b16 a[72:73], v55 offset:0
    ds_read_b64_tr_b16 a[74:75], v55 offset:256
    ds_read_b64_tr_b16 a[76:77], v55 offset:8192
    ds_read_b64_tr_b16 a[78:79], v55 offset:8448
    s_waitcnt vmcnt(33) lgkmcnt(0)
    s_barrier
    s_add_u32 m0, s78, 98304
    s_mov_b32 s69, 3145728
    buffer_load_dwordx4 v44, s[16:19], s69 offen lds
    s_add_u32 m0, s78, 99328
    s_mov_b32 s69, 3145728
    buffer_load_dwordx4 v45, s[16:19], s69 offen lds
    s_add_u32 m0, s78, 100352
    s_mov_b32 s69, 3145728
    buffer_load_dwordx4 v46, s[16:19], s69 offen lds
    s_add_u32 m0, s78, 101376
    s_mov_b32 s69, 3145728
    buffer_load_dwordx4 v47, s[16:19], s69 offen lds
    v_add_u32 v54, 131072, v50
    v_add_u32 v55, 131072, v51
    ds_read_b64_tr_b16 a[80:81], v54 offset:0
    ds_read_b64_tr_b16 a[82:83], v54 offset:256
    ds_read_b64_tr_b16 a[84:85], v54 offset:8192
    ds_read_b64_tr_b16 a[86:87], v54 offset:8448
    ds_read_b64_tr_b16 a[88:89], v55 offset:0
    ds_read_b64_tr_b16 a[90:91], v55 offset:256
    ds_read_b64_tr_b16 a[92:93], v55 offset:8192
    ds_read_b64_tr_b16 a[94:95], v55 offset:8448
    s_waitcnt vmcnt(33) lgkmcnt(0)
    s_barrier
    s_add_u32 m0, s78, 114688
    s_mov_b32 s69, 3670016
    buffer_load_dwordx4 v44, s[16:19], s69 offen lds
    s_add_u32 m0, s78, 115712
    s_mov_b32 s69, 3670016
    buffer_load_dwordx4 v45, s[16:19], s69 offen lds
    s_add_u32 m0, s78, 116736
    s_mov_b32 s69, 3670016
    buffer_load_dwordx4 v46, s[16:19], s69 offen lds
    s_add_u32 m0, s78, 117760
    s_mov_b32 s69, 3670016
    buffer_load_dwordx4 v47, s[16:19], s69 offen lds
    v_add_u32 v54, 147456, v50
    v_add_u32 v55, 147456, v51
    ds_read_b64_tr_b16 a[128:129], v54 offset:0
    ds_read_b64_tr_b16 a[130:131], v54 offset:256
    ds_read_b64_tr_b16 a[132:133], v54 offset:8192
    ds_read_b64_tr_b16 a[134:135], v54 offset:8448
    ds_read_b64_tr_b16 a[136:137], v55 offset:0
    ds_read_b64_tr_b16 a[138:139], v55 offset:256
    ds_read_b64_tr_b16 a[140:141], v55 offset:8192
    ds_read_b64_tr_b16 a[142:143], v55 offset:8448
    s_waitcnt vmcnt(28) lgkmcnt(0)
    s_barrier
    s_cmp_lt_u32 s5, 9
    s_cselect_b64 vcc, -1, 0
    v_lshl_or_b32 v73, v74, 16, v73
    v_min_u32 v73, -2, v73
    v_cndmask_b32 v73, -1, v73, vcc
    s_min_u32 s69, s5, 27
    s_lshl_b32 s69, s69, 10
    s_add_u32 s69, s69, 393216
    buffer_store_dword v73, v11, s[8:11], s69 offen sc1
    buffer_load_dword v75, off, s[32:35], 0 offset:192 sc1
    s_add_u32 m0, s78, 131072
    s_mov_b32 s69, 4194304
    buffer_load_dwordx4 v44, s[16:19], s69 offen lds
    s_add_u32 m0, s78, 132096
    s_mov_b32 s69, 4194304
    buffer_load_dwordx4 v45, s[16:19], s69 offen lds
    s_add_u32 m0, s78, 133120
    s_mov_b32 s69, 4194304
    buffer_load_dwordx4 v46, s[16:19], s69 offen lds
    s_add_u32 m0, s78, 134144
    s_mov_b32 s69, 4194304
    buffer_load_dwordx4 v47, s[16:19], s69 offen lds
    v_add_u32 v54, 16384, v50
    v_add_u32 v55, 16384, v51
    ds_read_b64_tr_b16 a[176:177], v54 offset:0
    ds_read_b64_tr_b16 a[178:179], v54 offset:256
    ds_read_b64_tr_b16 a[180:181], v54 offset:8192
    ds_read_b64_tr_b16 a[182:183], v54 offset:8448
    ds_read_b64_tr_b16 a[184:185], v55 offset:0
    ds_read_b64_tr_b16 a[186:187], v55 offset:256
    ds_read_b64_tr_b16 a[188:189], v55 offset:8192
    ds_read_b64_tr_b16 a[190:191], v55 offset:8448
    s_waitcnt vmcnt(28) lgkmcnt(0)
    s_barrier
    s_add_u32 m0, s78, 0
    s_mov_b32 s69, 0
    buffer_load_dwordx4 v44, s[20:23], s69 offen lds
    s_add_u32 m0, s78, 1024
    s_mov_b32 s69, 0
    buffer_load_dwordx4 v45, s[20:23], s69 offen lds
    s_add_u32 m0, s78, 2048
    s_mov_b32 s69, 0
    buffer_load_dwordx4 v46, s[20:23], s69 offen lds
    s_add_u32 m0, s78, 3072
    s_mov_b32 s69, 0
    buffer_load_dwordx4 v47, s[20:23], s69 offen lds
    v_add_u32 v54, 32768, v50
    v_add_u32 v55, 32768, v51
    ds_read_b64_tr_b16 a[192:193], v54 offset:0
    ds_read_b64_tr_b16 a[194:195], v54 offset:256
    ds_read_b64_tr_b16 a[196:197], v54 offset:8192
    ds_read_b64_tr_b16 a[198:199], v54 offset:8448
    ds_read_b64_tr_b16 a[200:201], v55 offset:0
    ds_read_b64_tr_b16 a[202:203], v55 offset:256
    ds_read_b64_tr_b16 a[204:205], v55 offset:8192
    ds_read_b64_tr_b16 a[206:207], v55 offset:8448
    s_waitcnt vmcnt(28) lgkmcnt(0)
    s_barrier
    s_add_u32 m0, s78, 16384
    s_mov_b32 s69, 524288
    buffer_load_dwordx4 v44, s[20:23], s69 offen lds
    s_add_u32 m0, s78, 17408
    s_mov_b32 s69, 524288
    buffer_load_dwordx4 v45, s[20:23], s69 offen lds
    s_add_u32 m0, s78, 18432
    s_mov_b32 s69, 524288
    buffer_load_dwordx4 v46, s[20:23], s69 offen lds
    s_add_u32 m0, s78, 19456
    s_mov_b32 s69, 524288
    buffer_load_dwordx4 v47, s[20:23], s69 offen lds
    v_add_u32 v54, 49152, v50
    v_add_u32 v55, 49152, v51
    ds_read_b64_tr_b16 a[144:145], v54 offset:0
    ds_read_b64_tr_b16 a[146:147], v54 offset:256
    ds_read_b64_tr_b16 a[148:149], v54 offset:8192
    ds_read_b64_tr_b16 a[150:151], v54 offset:8448
    ds_read_b64_tr_b16 a[152:153], v55 offset:0
    ds_read_b64_tr_b16 a[154:155], v55 offset:256
    ds_read_b64_tr_b16 a[156:157], v55 offset:8192
    ds_read_b64_tr_b16 a[158:159], v55 offset:8448
    s_waitcnt vmcnt(28) lgkmcnt(0)
    s_barrier
    s_add_u32 m0, s78, 32768
    s_mov_b32 s69, 1048576
    buffer_load_dwordx4 v44, s[20:23], s69 offen lds
    s_add_u32 m0, s78, 33792
    s_mov_b32 s69, 1048576
    buffer_load_dwordx4 v45, s[20:23], s69 offen lds
    s_add_u32 m0, s78, 34816
    s_mov_b32 s69, 1048576
    buffer_load_dwordx4 v46, s[20:23], s69 offen lds
    s_add_u32 m0, s78, 35840
    s_mov_b32 s69, 1048576
    buffer_load_dwordx4 v47, s[20:23], s69 offen lds
    v_add_u32 v54, 65536, v50
    v_add_u32 v55, 65536, v51
    ds_read_b64_tr_b16 a[160:161], v54 offset:0
    ds_read_b64_tr_b16 a[162:163], v54 offset:256
    ds_read_b64_tr_b16 a[164:165], v54 offset:8192
    ds_read_b64_tr_b16 a[166:167], v54 offset:8448
    ds_read_b64_tr_b16 a[168:169], v55 offset:0
    ds_read_b64_tr_b16 a[170:171], v55 offset:256
    ds_read_b64_tr_b16 a[172:173], v55 offset:8192
    ds_read_b64_tr_b16 a[174:175], v55 offset:8448
    s_waitcnt vmcnt(28) lgkmcnt(0)
    s_barrier
    s_add_u32 m0, s78, 49152
    s_mov_b32 s69, 1572864
    buffer_load_dwordx4 v44, s[20:23], s69 offen lds
    s_add_u32 m0, s78, 50176
    s_mov_b32 s69, 1572864
    buffer_load_dwordx4 v45, s[20:23], s69 offen lds
    s_add_u32 m0, s78, 51200
    s_mov_b32 s69, 1572864
    buffer_load_dwordx4 v46, s[20:23], s69 offen lds
    s_add_u32 m0, s78, 52224
    s_mov_b32 s69, 1572864
    buffer_load_dwordx4 v47, s[20:23], s69 offen lds
    v_add_u32 v54, 81920, v50
    v_add_u32 v55, 81920, v51
    ds_read_b64_tr_b16 a[240:241], v54 offset:0
    ds_read_b64_tr_b16 a[242:243], v54 offset:256
    ds_read_b64_tr_b16 a[244:245], v54 offset:8192
    ds_read_b64_tr_b16 a[246:247], v54 offset:8448
    ds_read_b64_tr_b16 a[248:249], v55 offset:0
    ds_read_b64_tr_b16 a[250:251], v55 offset:256
    ds_read_b64_tr_b16 a[252:253], v55 offset:8192
    ds_read_b64_tr_b16 a[254:255], v55 offset:8448
    s_waitcnt vmcnt(28) lgkmcnt(0)
    s_barrier
    s_add_u32 m0, s78, 65536
    s_mov_b32 s69, 2097152
    buffer_load_dwordx4 v44, s[20:23], s69 offen lds
    s_add_u32 m0, s78, 66560
    s_mov_b32 s69, 2097152
    buffer_load_dwordx4 v45, s[20:23], s69 offen lds
    s_add_u32 m0, s78, 67584
    s_mov_b32 s69, 2097152
    buffer_load_dwordx4 v46, s[20:23], s69 offen lds
    s_add_u32 m0, s78, 68608
    s_mov_b32 s69, 2097152
    buffer_load_dwordx4 v47, s[20:23], s69 offen lds
    v_add_u32 v54, 98304, v50
    v_add_u32 v55, 98304, v51
    ds_read_b64_tr_b16 v[80:81], v54 offset:0
    ds_read_b64_tr_b16 v[82:83], v54 offset:256
    ds_read_b64_tr_b16 v[84:85], v54 offset:8192
    ds_read_b64_tr_b16 v[86:87], v54 offset:8448
    ds_read_b64_tr_b16 v[88:89], v55 offset:0
    ds_read_b64_tr_b16 v[90:91], v55 offset:256
    ds_read_b64_tr_b16 v[92:93], v55 offset:8192
    ds_read_b64_tr_b16 v[94:95], v55 offset:8448
    s_waitcnt vmcnt(28) lgkmcnt(0)
    s_barrier
    s_add_u32 m0, s78, 81920
    s_mov_b32 s69, 2621440
    buffer_load_dwordx4 v44, s[20:23], s69 offen lds
    s_add_u32 m0, s78, 82944
    s_mov_b32 s69, 2621440
    buffer_load_dwordx4 v45, s[20:23], s69 offen lds
    s_add_u32 m0, s78, 83968
    s_mov_b32 s69, 2621440
    buffer_load_dwordx4 v46, s[20:23], s69 offen lds
    s_add_u32 m0, s78, 84992
    s_mov_b32 s69, 2621440
    buffer_load_dwordx4 v47, s[20:23], s69 offen lds
    v_add_u32 v54, 114688, v50
    v_add_u32 v55, 114688, v51
    ds_read_b64_tr_b16 a[208:209], v54 offset:0
    ds_read_b64_tr_b16 a[210:211], v54 offset:256
    ds_read_b64_tr_b16 a[212:213], v54 offset:8192
    ds_read_b64_tr_b16 a[214:215], v54 offset:8448
    ds_read_b64_tr_b16 a[216:217], v55 offset:0
    ds_read_b64_tr_b16 a[218:219], v55 offset:256
    ds_read_b64_tr_b16 a[220:221], v55 offset:8192
    ds_read_b64_tr_b16 a[222:223], v55 offset:8448
    s_waitcnt vmcnt(28) lgkmcnt(0)
    s_barrier
    s_add_u32 m0, s78, 98304
    s_mov_b32 s69, 3145728
    buffer_load_dwordx4 v44, s[20:23], s69 offen lds
    s_add_u32 m0, s78, 99328
    s_mov_b32 s69, 3145728
    buffer_load_dwordx4 v45, s[20:23], s69 offen lds
    s_add_u32 m0, s78, 100352
    s_mov_b32 s69, 3145728
    buffer_load_dwordx4 v46, s[20:23], s69 offen lds
    s_add_u32 m0, s78, 101376
    s_mov_b32 s69, 3145728
    buffer_load_dwordx4 v47, s[20:23], s69 offen lds
    v_add_u32 v54, 131072, v50
    v_add_u32 v55, 131072, v51
    ds_read_b64_tr_b16 a[224:225], v54 offset:0
    ds_read_b64_tr_b16 a[226:227], v54 offset:256
    ds_read_b64_tr_b16 a[228:229], v54 offset:8192
    ds_read_b64_tr_b16 a[230:231], v54 offset:8448
    ds_read_b64_tr_b16 a[232:233], v55 offset:0
    ds_read_b64_tr_b16 a[234:235], v55 offset:256
    ds_read_b64_tr_b16 a[236:237], v55 offset:8192
    ds_read_b64_tr_b16 a[238:239], v55 offset:8448
    s_waitcnt vmcnt(28) lgkmcnt(0)
    s_barrier
    s_add_u32 m0, s78, 114688
    s_mov_b32 s69, 3670016
    buffer_load_dwordx4 v44, s[20:23], s69 offen lds
    s_add_u32 m0, s78, 115712
    s_mov_b32 s69, 3670016
    buffer_load_dwordx4 v45, s[20:23], s69 offen lds
    s_add_u32 m0, s78, 116736
    s_mov_b32 s69, 3670016
    buffer_load_dwordx4 v46, s[20:23], s69 offen lds
    s_add_u32 m0, s78, 117760
    s_mov_b32 s69, 3670016
    buffer_load_dwordx4 v47, s[20:23], s69 offen lds
    v_add_u32 v54, 147456, v50
    v_add_u32 v55, 147456, v51
    ds_read_b64_tr_b16 v[96:97], v54 offset:0
    ds_read_b64_tr_b16 v[98:99], v54 offset:256
    ds_read_b64_tr_b16 v[100:101], v54 offset:8192
    ds_read_b64_tr_b16 v[102:103], v54 offset:8448
    ds_read_b64_tr_b16 v[104:105], v55 offset:0
    ds_read_b64_tr_b16 v[106:107], v55 offset:256
    ds_read_b64_tr_b16 v[108:109], v55 offset:8192
    ds_read_b64_tr_b16 v[110:111], v55 offset:8448
    s_waitcnt vmcnt(28) lgkmcnt(0)
    s_barrier
    s_add_u32 m0, s78, 131072
    s_mov_b32 s69, 4194304
    buffer_load_dwordx4 v44, s[20:23], s69 offen lds
    s_add_u32 m0, s78, 132096
    s_mov_b32 s69, 4194304
    buffer_load_dwordx4 v45, s[20:23], s69 offen lds
    s_add_u32 m0, s78, 133120
    s_mov_b32 s69, 4194304
    buffer_load_dwordx4 v46, s[20:23], s69 offen lds
    s_add_u32 m0, s78, 134144
    s_mov_b32 s69, 4194304
    buffer_load_dwordx4 v47, s[20:23], s69 offen lds
    v_add_u32 v54, 16384, v50
    v_add_u32 v55, 16384, v51
    ds_read_b64_tr_b16 v[56:57], v54 offset:0
    ds_read_b64_tr_b16 v[58:59], v54 offset:256
    ds_read_b64_tr_b16 v[60:61], v54 offset:8192
    ds_read_b64_tr_b16 v[62:63], v54 offset:8448
    ds_read_b64_tr_b16 v[64:65], v55 offset:0
    ds_read_b64_tr_b16 v[66:67], v55 offset:256
    ds_read_b64_tr_b16 v[68:69], v55 offset:8192
    ds_read_b64_tr_b16 v[70:71], v55 offset:8448
    s_waitcnt vmcnt(28) lgkmcnt(0)
    s_barrier
    v_readfirstlane_b32 s84, v75
    s_cmp_lg_u32 s84, 0
    s_cbranch_scc1 L_isrdy_79
    s_mov_b32 s79, 524288
L_rdy_80:
    buffer_load_dword v75, off, s[32:35], 0 offset:192 sc1
    s_waitcnt vmcnt(0)
    v_readfirstlane_b32 s84, v75
    s_cmp_lg_u32 s84, 0
    s_cbranch_scc1 L_rdyok_81
    s_sub_u32 s79, s79, 1
    s_cbranch_scc1 L_fail
    s_branch L_rdy_80
L_rdyok_81:
L_isrdy_79:
    s_add_u32 m0, s78, 0
    s_mov_b32 s69, 256
    buffer_load_dwordx4 v48, s[24:27], s69 offen lds
    s_add_u32 m0, s78, 1024
    s_mov_b32 s69, 9472
    buffer_load_dwordx4 v48, s[24:27], s69 offen lds
    s_add_u32 m0, s78, 2048
    s_mov_b32 s69, 256
    buffer_load_dwordx4 v49, s[24:27], s69 offen lds
    s_add_u32 m0, s78, 3072
    s_mov_b32 s69, 9472
    buffer_load_dwordx4 v49, s[24:27], s69 offen lds
    v_add_u32 v54, 32768, v50
    v_add_u32 v55, 32768, v51
    ds_read_b64_tr_b16 v[112:113], v54 offset:0
    ds_read_b64_tr_b16 v[114:115], v54 offset:256
    ds_read_b64_tr_b16 v[116:117], v54 offset:8192
    ds_read_b64_tr_b16 v[118:119], v54 offset:8448
    ds_read_b64_tr_b16 v[120:121], v55 offset:0
    ds_read_b64_tr_b16 v[122:123], v55 offset:256
    ds_read_b64_tr_b16 v[124:125], v55 offset:8192
    ds_read_b64_tr_b16 v[126:127], v55 offset:8448
    s_waitcnt vmcnt(28) lgkmcnt(0)
    s_barrier
    s_add_u32 m0, s78, 16384
    s_mov_b32 s69, 640
    buffer_load_dwordx4 v48, s[24:27], s69 offen lds
    s_add_u32 m0, s78, 17408
    s_mov_b32 s69, 9856
    buffer_load_dwordx4 v48, s[24:27], s69 offen lds
    s_add_u32 m0, s78, 18432
    s_mov_b32 s69, 640
    buffer_load_dwordx4 v49, s[24:27], s69 offen lds
    s_add_u32 m0, s78, 19456
    s_mov_b32 s69, 9856
    buffer_load_dwordx4 v49, s[24:27], s69 offen lds
    v_add_u32 v54, 49152, v50
    v_add_u32 v55, 49152, v51
    ds_read_b64_tr_b16 v[12:13], v54 offset:0
    ds_read_b64_tr_b16 v[14:15], v54 offset:256
    ds_read_b64_tr_b16 v[16:17], v54 offset:8192
    ds_read_b64_tr_b16 v[18:19], v54 offset:8448
    ds_read_b64_tr_b16 v[20:21], v55 offset:0
    ds_read_b64_tr_b16 v[22:23], v55 offset:256
    ds_read_b64_tr_b16 v[24:25], v55 offset:8192
    ds_read_b64_tr_b16 v[26:27], v55 offset:8448
    s_waitcnt vmcnt(28) lgkmcnt(0)
    s_barrier
    s_add_u32 m0, s78, 32768
    s_mov_b32 s69, 896
    buffer_load_dwordx4 v48, s[24:27], s69 offen lds
    s_add_u32 m0, s78, 33792
    s_mov_b32 s69, 10112
    buffer_load_dwordx4 v48, s[24:27], s69 offen lds
    s_add_u32 m0, s78, 34816
    s_mov_b32 s69, 896
    buffer_load_dwordx4 v49, s[24:27], s69 offen lds
    s_add_u32 m0, s78, 35840
    s_mov_b32 s69, 10112
    buffer_load_dwordx4 v49, s[24:27], s69 offen lds
    v_add_u32 v54, 65536, v50
    v_add_u32 v55, 65536, v51
    ds_read_b64_tr_b16 v[28:29], v54 offset:0
    ds_read_b64_tr_b16 v[30:31], v54 offset:256
    ds_read_b64_tr_b16 v[32:33], v54 offset:8192
    ds_read_b64_tr_b16 v[34:35], v54 offset:8448
    ds_read_b64_tr_b16 v[36:37], v55 offset:0
    ds_read_b64_tr_b16 v[38:39], v55 offset:256
    ds_read_b64_tr_b16 v[40:41], v55 offset:8192
    ds_read_b64_tr_b16 v[42:43], v55 offset:8448
    s_waitcnt vmcnt(28) lgkmcnt(0)
    s_barrier
    s_add_u32 m0, s78, 49152
    s_mov_b32 s69, 0
    buffer_load_dwordx4 v48, s[24:27], s69 offen lds
    s_add_u32 m0, s78, 50176
    s_mov_b32 s69, 9216
    buffer_load_dwordx4 v48, s[24:27], s69 offen lds
    s_add_u32 m0, s78, 51200
    s_mov_b32 s69, 0
    buffer_load_dwordx4 v49, s[24:27], s69 offen lds
    s_add_u32 m0, s78, 52224
    s_mov_b32 s69, 9216
    buffer_load_dwordx4 v49, s[24:27], s69 offen lds
    v_add_u32 v54, 81920, v50
    v_add_u32 v55, 81920, v51
    ds_read_b64_tr_b16 v[160:161], v54 offset:0
    ds_read_b64_tr_b16 v[162:163], v54 offset:256
    ds_read_b64_tr_b16 v[164:165], v54 offset:8192
    ds_read_b64_tr_b16 v[166:167], v54 offset:8448
    ds_read_b64_tr_b16 v[168:169], v55 offset:0
    ds_read_b64_tr_b16 v[170:171], v55 offset:256
    ds_read_b64_tr_b16 v[172:173], v55 offset:8192
    ds_read_b64_tr_b16 v[174:175], v55 offset:8448
    s_waitcnt vmcnt(28) lgkmcnt(0)
    s_barrier
    s_add_u32 m0, s78, 65536
    s_mov_b32 s69, 128
    buffer_load_dwordx4 v48, s[24:27], s69 offen lds
    s_add_u32 m0, s78, 66560
    s_mov_b32 s69, 9344
    buffer_load_dwordx4 v48, s[24:27], s69 offen lds
    s_add_u32 m0, s78, 67584
    s_mov_b32 s69, 128
    buffer_load_dwordx4 v49, s[24:27], s69 offen lds
    s_add_u32 m0, s78, 68608
    s_mov_b32 s69, 9344
    buffer_load_dwordx4 v49, s[24:27], s69 offen lds
    v_add_u32 v54, 98304, v50
    v_add_u32 v55, 98304, v51
    ds_read_b64_tr_b16 v[176:177], v54 offset:0
    ds_read_b64_tr_b16 v[178:179], v54 offset:256
    ds_read_b64_tr_b16 v[180:181], v54 offset:8192
    ds_read_b64_tr_b16 v[182:183], v54 offset:8448
    ds_read_b64_tr_b16 v[184:185], v55 offset:0
    ds_read_b64_tr_b16 v[186:187], v55 offset:256
    ds_read_b64_tr_b16 v[188:189], v55 offset:8192
    ds_read_b64_tr_b16 v[190:191], v55 offset:8448
    s_waitcnt vmcnt(28) lgkmcnt(0)
    s_barrier
    s_add_u32 m0, s78, 81920
    s_mov_b32 s69, 384
    buffer_load_dwordx4 v48, s[24:27], s69 offen lds
    s_add_u32 m0, s78, 82944
    s_mov_b32 s69, 9600
    buffer_load_dwordx4 v48, s[24:27], s69 offen lds
    s_add_u32 m0, s78, 83968
    s_mov_b32 s69, 384
    buffer_load_dwordx4 v49, s[24:27], s69 offen lds
    s_add_u32 m0, s78, 84992
    s_mov_b32 s69, 9600
    buffer_load_dwordx4 v49, s[24:27], s69 offen lds
    v_add_u32 v54, 114688, v50
    v_add_u32 v55, 114688, v51
    ds_read_b64_tr_b16 v[128:129], v54 offset:0
    ds_read_b64_tr_b16 v[130:131], v54 offset:256
    ds_read_b64_tr_b16 v[132:133], v54 offset:8192
    ds_read_b64_tr_b16 v[134:135], v54 offset:8448
    ds_read_b64_tr_b16 v[136:137], v55 offset:0
    ds_read_b64_tr_b16 v[138:139], v55 offset:256
    ds_read_b64_tr_b16 v[140:141], v55 offset:8192
    ds_read_b64_tr_b16 v[142:143], v55 offset:8448
    s_waitcnt vmcnt(28) lgkmcnt(0)
    s_barrier
    s_add_u32 m0, s78, 98304
    s_mov_b32 s69, 512
    buffer_load_dwordx4 v48, s[24:27], s69 offen lds
    s_add_u32 m0, s78, 99328
    s_mov_b32 s69, 9728
    buffer_load_dwordx4 v48, s[24:27], s69 offen lds
    s_add_u32 m0, s78, 100352
    s_mov_b32 s69, 512
    buffer_load_dwordx4 v49, s[24:27], s69 offen lds
    s_add_u32 m0, s78, 101376
    s_mov_b32 s69, 9728
    buffer_load_dwordx4 v49, s[24:27], s69 offen lds
    v_add_u32 v54, 131072, v50
    v_add_u32 v55, 131072, v51
    ds_read_b64_tr_b16 v[144:145], v54 offset:0
    ds_read_b64_tr_b16 v[146:147], v54 offset:256
    ds_read_b64_tr_b16 v[148:149], v54 offset:8192
    ds_read_b64_tr_b16 v[150:151], v54 offset:8448
    ds_read_b64_tr_b16 v[152:153], v55 offset:0
    ds_read_b64_tr_b16 v[154:155], v55 offset:256
    ds_read_b64_tr_b16 v[156:157], v55 offset:8192
    ds_read_b64_tr_b16 v[158:159], v55 offset:8448
    s_waitcnt vmcnt(28) lgkmcnt(0)
    s_barrier
    s_add_u32 m0, s78, 114688
    s_mov_b32 s69, 768
    buffer_load_dwordx4 v48, s[24:27], s69 offen lds
    s_add_u32 m0, s78, 115712
    s_mov_b32 s69, 9984
    buffer_load_dwordx4 v48, s[24:27], s69 offen lds
    s_add_u32 m0, s78, 116736
    s_mov_b32 s69, 768
    buffer_load_dwordx4 v49, s[24:27], s69 offen lds
    s_add_u32 m0, s78, 117760
    s_mov_b32 s69, 9984
    buffer_load_dwordx4 v49, s[24:27], s69 offen lds
    v_add_u32 v54, 147456, v50
    v_add_u32 v55, 147456, v51
    ds_read_b64_tr_b16 v[192:193], v54 offset:0
    ds_read_b64_tr_b16 v[194:195], v54 offset:256
    ds_read_b64_tr_b16 v[196:197], v54 offset:8192
    ds_read_b64_tr_b16 v[198:199], v54 offset:8448
    ds_read_b64_tr_b16 v[200:201], v55 offset:0
    ds_read_b64_tr_b16 v[202:203], v55 offset:256
    ds_read_b64_tr_b16 v[204:205], v55 offset:8192
    ds_read_b64_tr_b16 v[206:207], v55 offset:8448
    s_waitcnt vmcnt(28) lgkmcnt(0)
    s_barrier
    s_add_u32 m0, s78, 131072
    s_mov_b32 s69, 1024
    buffer_load_dwordx4 v48, s[24:27], s69 offen lds
    s_add_u32 m0, s78, 132096
    s_mov_b32 s69, 10240
    buffer_load_dwordx4 v48, s[24:27], s69 offen lds
    s_add_u32 m0, s78, 133120
    s_mov_b32 s69, 1024
    buffer_load_dwordx4 v49, s[24:27], s69 offen lds
    s_add_u32 m0, s78, 134144
    s_mov_b32 s69, 10240
    buffer_load_dwordx4 v49, s[24:27], s69 offen lds
    v_mov_b32 v76, 4096
    s_mov_b32 s69, 40064
    buffer_load_dword v45, off, s[8:11], s69 sc1
    buffer_load_dwordx4 v[72:75], off, s[8:11], s82 sc1
    buffer_load_dwordx4 v[76:79], v76, s[8:11], s82 offen sc1
    v_add_u32 v54, 16384, v52
    ds_read_b64_tr_b16 v[208:209], v54 offset:0
    ds_read_b64_tr_b16 v[210:211], v54 offset:256
    ds_read_b64_tr_b16 v[212:213], v54 offset:1024
    ds_read_b64_tr_b16 v[214:215], v54 offset:1280
    ds_read_b64_tr_b16 v[216:217], v54 offset:8192
    ds_read_b64_tr_b16 v[218:219], v54 offset:8448
    ds_read_b64_tr_b16 v[220:221], v54 offset:9216
    ds_read_b64_tr_b16 v[222:223], v54 offset:9472
    s_waitcnt vmcnt(31) lgkmcnt(0)
    s_barrier
    v_add_u32 v53, s78, v0
    v_add_u32 v53, 0, v53
    ds_write_b128 v53, v[12:15] offset:0
    ds_write_b128 v53, v[16:19] offset:1024
    ds_write_b128 v53, v[20:23] offset:2048
    ds_write_b128 v53, v[24:27] offset:3072
    v_add_u32 v54, 32768, v52
    ds_read_b64_tr_b16 v[224:225], v54 offset:0
    ds_read_b64_tr_b16 v[226:227], v54 offset:256
    ds_read_b64_tr_b16 v[228:229], v54 offset:1024
    ds_read_b64_tr_b16 v[230:231], v54 offset:1280
    ds_read_b64_tr_b16 v[232:233], v54 offset:8192
    ds_read_b64_tr_b16 v[234:235], v54 offset:8448
    ds_read_b64_tr_b16 v[236:237], v54 offset:9216
    ds_read_b64_tr_b16 v[238:239], v54 offset:9472
    s_waitcnt vmcnt(27) lgkmcnt(0)
    s_barrier
    v_add_u32_e64 v53, s78, v0
    v_add_u32 v53, 16384, v53
    ds_write_b128 v53, v[28:31] offset:0
    ds_write_b128 v53, v[32:35] offset:1024
    ds_write_b128 v53, v[36:39] offset:2048
    ds_write_b128 v53, v[40:43] offset:3072
    v_add_u32 v54, 49152, v52
    ds_read_b64_tr_b16 v[240:241], v54 offset:0
    ds_read_b64_tr_b16 v[242:243], v54 offset:256
    ds_read_b64_tr_b16 v[244:245], v54 offset:1024
    ds_read_b64_tr_b16 v[246:247], v54 offset:1280
    ds_read_b64_tr_b16 v[248:249], v54 offset:8192
    ds_read_b64_tr_b16 v[250:251], v54 offset:8448
    ds_read_b64_tr_b16 v[252:253], v54 offset:9216
    ds_read_b64_tr_b16 v[254:255], v54 offset:9472
    s_waitcnt vmcnt(23) lgkmcnt(0)
    s_barrier
    v_add_u32_e64 v53, s78, v0
    v_add_u32 v53, 32768, v53
    ds_write_b128 v53, v[56:59] offset:0
    ds_write_b128 v53, v[60:63] offset:1024
    ds_write_b128 v53, v[64:67] offset:2048
    ds_write_b128 v53, v[68:71] offset:3072
    v_add_u32 v54, 65536, v52
    ds_read_b64_tr_b16 v[56:57], v54 offset:0
    ds_read_b64_tr_b16 v[58:59], v54 offset:256
    ds_read_b64_tr_b16 v[60:61], v54 offset:1024
    ds_read_b64_tr_b16 v[62:63], v54 offset:1280
    ds_read_b64_tr_b16 v[64:65], v54 offset:8192
    ds_read_b64_tr_b16 v[66:67], v54 offset:8448
    ds_read_b64_tr_b16 v[68:69], v54 offset:9216
    ds_read_b64_tr_b16 v[70:71], v54 offset:9472
    s_waitcnt vmcnt(19) lgkmcnt(0)
    s_barrier
    v_add_u32_e64 v53, s78, v0
    v_add_u32 v53, 49152, v53
    ds_write_b128 v53, v[56:59] offset:0
    ds_write_b128 v53, v[60:63] offset:1024
    ds_write_b128 v53, v[64:67] offset:2048
    ds_write_b128 v53, v[68:71] offset:3072
    v_add_u32 v54, 81920, v52
    ds_read_b64_tr_b16 v[56:57], v54 offset:0
    ds_read_b64_tr_b16 v[58:59], v54 offset:256
    ds_read_b64_tr_b16 v[60:61], v54 offset:1024
    ds_read_b64_tr_b16 v[62:63], v54 offset:1280
    ds_read_b64_tr_b16 v[64:65], v54 offset:8192
    ds_read_b64_tr_b16 v[66:67], v54 offset:8448
    ds_read_b64_tr_b16 v[68:69], v54 offset:9216
    ds_read_b64_tr_b16 v[70:71], v54 offset:9472
    s_waitcnt vmcnt(15) lgkmcnt(0)
    s_barrier
    v_add_u32_e64 v53, s78, v0
    v_add_u32 v53, 65536, v53
    ds_write_b128 v53, v[56:59] offset:0
    ds_write_b128 v53, v[60:63] offset:1024
    ds_write_b128 v53, v[64:67] offset:2048
    ds_write_b128 v53, v[68:71] offset:3072
    v_add_u32 v54, 98304, v52
    ds_read_b64_tr_b16 v[56:57], v54 offset:0
    ds_read_b64_tr_b16 v[58:59], v54 offset:256
    ds_read_b64_tr_b16 v[60:61], v54 offset:1024
    ds_read_b64_tr_b16 v[62:63], v54 offset:1280
    ds_read_b64_tr_b16 v[64:65], v54 offset:8192
    ds_read_b64_tr_b16 v[66:67], v54 offset:8448
    ds_read_b64_tr_b16 v[68:69], v54 offset:9216
    ds_read_b64_tr_b16 v[70:71], v54 offset:9472
    s_waitcnt vmcnt(11) lgkmcnt(0)
    s_barrier
    v_add_u32_e64 v53, s78, v0
    v_add_u32 v53, 81920, v53
    ds_write_b128 v53, v[56:59] offset:0
    ds_write_b128 v53, v[60:63] offset:1024
    ds_write_b128 v53, v[64:67] offset:2048
    ds_write_b128 v53, v[68:71] offset:3072
    v_add_u32 v54, 114688, v52
    ds_read_b64_tr_b16 v[56:57], v54 offset:0
    ds_read_b64_tr_b16 v[58:59], v54 offset:256
    ds_read_b64_tr_b16 v[60:61], v54 offset:1024
    ds_read_b64_tr_b16 v[62:63], v54 offset:1280
    ds_read_b64_tr_b16 v[64:65], v54 offset:8192
    ds_read_b64_tr_b16 v[66:67], v54 offset:8448
    ds_read_b64_tr_b16 v[68:69], v54 offset:9216
    ds_read_b64_tr_b16 v[70:71], v54 offset:9472
    s_waitcnt vmcnt(7) lgkmcnt(0)
    s_barrier
    v_add_u32_e64 v53, s78, v0
    v_add_u32 v53, 98304, v53
    ds_write_b128 v53, v[56:59] offset:0
    ds_write_b128 v53, v[60:63] offset:1024
    ds_write_b128 v53, v[64:67] offset:2048
    ds_write_b128 v53, v[68:71] offset:3072
    v_add_u32 v54, 131072, v52
    ds_read_b64_tr_b16 v[56:57], v54 offset:0
    ds_read_b64_tr_b16 v[58:59], v54 offset:256
    ds_read_b64_tr_b16 v[60:61], v54 offset:1024
    ds_read_b64_tr_b16 v[62:63], v54 offset:1280
    ds_read_b64_tr_b16 v[64:65], v54 offset:8192
    ds_read_b64_tr_b16 v[66:67], v54 offset:8448
    ds_read_b64_tr_b16 v[68:69], v54 offset:9216
    ds_read_b64_tr_b16 v[70:71], v54 offset:9472
    s_waitcnt vmcnt(3) lgkmcnt(0)
    s_barrier
    v_add_u32_e64 v53, s78, v0
    v_add_u32 v53, 114688, v53
    ds_write_b128 v53, v[56:59] offset:0
    ds_write_b128 v53, v[60:63] offset:1024
    ds_write_b128 v53, v[64:67] offset:2048
    ds_write_b128 v53, v[68:71] offset:3072
    v_add_u32 v54, 147456, v52
    ds_read_b64_tr_b16 v[56:57], v54 offset:0
    ds_read_b64_tr_b16 v[58:59], v54 offset:256
    ds_read_b64_tr_b16 v[60:61], v54 offset:1024
    ds_read_b64_tr_b16 v[62:63], v54 offset:1280
    ds_read_b64_tr_b16 v[64:65], v54 offset:8192
    ds_read_b64_tr_b16 v[66:67], v54 offset:8448
    ds_read_b64_tr_b16 v[68:69], v54 offset:9216
    ds_read_b64_tr_b16 v[70:71], v54 offset:9472
    s_waitcnt lgkmcnt(0)
    s_barrier
    v_add_u32_e64 v53, s78, v0
    v_add_u32 v53, 131072, v53
    ds_write_b128 v53, v[56:59] offset:0
    ds_write_b128 v53, v[60:63] offset:1024
    ds_write_b128 v53, v[64:67] offset:2048
    ds_write_b128 v53, v[68:71] offset:3072
    s_branch L_staged
L_stage3:
    s_waitcnt vmcnt(37) lgkmcnt(0)
    s_barrier
    v_add_u32 v54, 16384, v50
    v_add_u32 v55, 16384, v51
    ds_read_b64_tr_b16 a[48:49], v54 offset:0
    ds_read_b64_tr_b16 a[50:51], v54 offset:256
    ds_read_b64_tr_b16 a[52:53], v54 offset:8192
    ds_read_b64_tr_b16 a[54:55], v54 offset:8448
    ds_read_b64_tr_b16 a[56:57], v55 offset:0
    ds_read_b64_tr_b16 a[58:59], v55 offset:256
    ds_read_b64_tr_b16 a[60:61], v55 offset:8192
    ds_read_b64_tr_b16 a[62:63], v55 offset:8448
    s_waitcnt vmcnt(33) lgkmcnt(0)
    s_barrier
    s_add_u32 m0, s78, 0
    s_mov_b32 s69, 0
    buffer_load_dwordx4 v44, s[16:19], s69 offen lds
    s_add_u32 m0, s78, 1024
    s_mov_b32 s69, 0
    buffer_load_dwordx4 v45, s[16:19], s69 offen lds
    s_add_u32 m0, s78, 2048
    s_mov_b32 s69, 0
    buffer_load_dwordx4 v46, s[16:19], s69 offen lds
    s_add_u32 m0, s78, 3072
    s_mov_b32 s69, 0
    buffer_load_dwordx4 v47, s[16:19], s69 offen lds
    v_add_u32 v54, 32768, v50
    v_add_u32 v55, 32768, v51
    ds_read_b64_tr_b16 a[32:33], v54 offset:0
    ds_read_b64_tr_b16 a[34:35], v54 offset:256
    ds_read_b64_tr_b16 a[36:37], v54 offset:8192
    ds_read_b64_tr_b16 a[38:39], v54 offset:8448
    ds_read_b64_tr_b16 a[40:41], v55 offset:0
    ds_read_b64_tr_b16 a[42:43], v55 offset:256
    ds_read_b64_tr_b16 a[44:45], v55 offset:8192
    ds_read_b64_tr_b16 a[46:47], v55 offset:8448
    s_waitcnt vmcnt(33) lgkmcnt(0)
    s_barrier
    s_add_u32 m0, s78, 16384
    s_mov_b32 s69, 524288
    buffer_load_dwordx4 v44, s[16:19], s69 offen lds
    s_add_u32 m0, s78, 17408
    s_mov_b32 s69, 524288
    buffer_load_dwordx4 v45, s[16:19], s69 offen lds
    s_add_u32 m0, s78, 18432
    s_mov_b32 s69, 524288
    buffer_load_dwordx4 v46, s[16:19], s69 offen lds
    s_add_u32 m0, s78, 19456
    s_mov_b32 s69, 524288
    buffer_load_dwordx4 v47, s[16:19], s69 offen lds
    v_add_u32 v54, 49152, v50
    v_add_u32 v55, 49152, v51
    ds_read_b64_tr_b16 a[16:17], v54 offset:0
    ds_read_b64_tr_b16 a[18:19], v54 offset:256
    ds_read_b64_tr_b16 a[20:21], v54 offset:8192
    ds_read_b64_tr_b16 a[22:23], v54 offset:8448
    ds_read_b64_tr_b16 a[24:25], v55 offset:0
    ds_read_b64_tr_b16 a[26:27], v55 offset:256
    ds_read_b64_tr_b16 a[28:29], v55 offset:8192
    ds_read_b64_tr_b16 a[30:31], v55 offset:8448
    s_waitcnt vmcnt(33) lgkmcnt(0)
    s_barrier
    s_add_u32 m0, s78, 32768
    s_mov_b32 s69, 1048576
    buffer_load_dwordx4 v44, s[16:19], s69 offen lds
    s_add_u32 m0, s78, 33792
    s_mov_b32 s69, 1048576
    buffer_load_dwordx4 v45, s[16:19], s69 offen lds
    s_add_u32 m0, s78, 34816
    s_mov_b32 s69, 1048576
    buffer_load_dwordx4 v46, s[16:19], s69 offen lds
    s_add_u32 m0, s78, 35840
    s_mov_b32 s69, 1048576
    buffer_load_dwordx4 v47, s[16:19], s69 offen lds
    v_add_u32 v54, 65536, v50
    v_add_u32 v55, 65536, v51
    ds_read_b64_tr_b16 a[0:1], v54 offset:0
    ds_read_b64_tr_b16 a[2:3], v54 offset:256
    ds_read_b64_tr_b16 a[4:5], v54 offset:8192
    ds_read_b64_tr_b16 a[6:7], v54 offset:8448
    ds_read_b64_tr_b16 a[8:9], v55 offset:0
    ds_read_b64_tr_b16 a[10:11], v55 offset:256
    ds_read_b64_tr_b16 a[12:13], v55 offset:8192
    ds_read_b64_tr_b16 a[14:15], v55 offset:8448
    s_waitcnt vmcnt(33) lgkmcnt(0)
    s_barrier
    s_add_u32 m0, s78, 49152
    s_mov_b32 s69, 1572864
    buffer_load_dwordx4 v44, s[16:19], s69 offen lds
    s_add_u32 m0, s78, 50176
    s_mov_b32 s69, 1572864
    buffer_load_dwordx4 v45, s[16:19], s69 offen lds
    s_add_u32 m0, s78, 51200
    s_mov_b32 s69, 1572864
    buffer_load_dwordx4 v46, s[16:19], s69 offen lds
    s_add_u32 m0, s78, 52224
    s_mov_b32 s69, 1572864
    buffer_load_dwordx4 v47, s[16:19], s69 offen lds
    v_add_u32 v54, 81920, v50
    v_add_u32 v55, 81920, v51
    ds_read_b64_tr_b16 a[112:113], v54 offset:0
    ds_read_b64_tr_b16 a[114:115], v54 offset:256
    ds_read_b64_tr_b16 a[116:117], v54 offset:8192
    ds_read_b64_tr_b16 a[118:119], v54 offset:8448
    ds_read_b64_tr_b16 a[120:121], v55 offset:0
    ds_read_b64_tr_b16 a[122:123], v55 offset:256
    ds_read_b64_tr_b16 a[124:125], v55 offset:8192
    ds_read_b64_tr_b16 a[126:127], v55 offset:8448
    s_waitcnt vmcnt(33) lgkmcnt(0)
    s_barrier
    s_add_u32 m0, s78, 65536
    s_mov_b32 s69, 2097152
    buffer_load_dwordx4 v44, s[16:19], s69 offen lds
    s_add_u32 m0, s78, 66560
    s_mov_b32 s69, 2097152
    buffer_load_dwordx4 v45, s[16:19], s69 offen lds
    s_add_u32 m0, s78, 67584
    s_mov_b32 s69, 2097152
    buffer_load_dwordx4 v46, s[16:19], s69 offen lds
    s_add_u32 m0, s78, 68608
    s_mov_b32 s69, 2097152
    buffer_load_dwordx4 v47, s[16:19], s69 offen lds
    v_add_u32 v54, 98304, v50
    v_add_u32 v55, 98304, v51
    ds_read_b64_tr_b16 a[96:97], v54 offset:0
    ds_read_b64_tr_b16 a[98:99], v54 offset:256
    ds_read_b64_tr_b16 a[100:101], v54 offset:8192
    ds_read_b64_tr_b16 a[102:103], v54 offset:8448
    ds_read_b64_tr_b16 a[104:105], v55 offset:0
    ds_read_b64_tr_b16 a[106:107], v55 offset:256
    ds_read_b64_tr_b16 a[108:109], v55 offset:8192
    ds_read_b64_tr_b16 a[110:111], v55 offset:8448
    s_waitcnt vmcnt(33) lgkmcnt(0)
    s_barrier
    s_add_u32 m0, s78, 81920
    s_mov_b32 s69, 2621440
    buffer_load_dwordx4 v44, s[16:19], s69 offen lds
    s_add_u32 m0, s78, 82944
    s_mov_b32 s69, 2621440
    buffer_load_dwordx4 v45, s[16:19], s69 offen lds
    s_add_u32 m0, s78, 83968
    s_mov_b32 s69, 2621440
    buffer_load_dwordx4 v46, s[16:19], s69 offen lds
    s_add_u32 m0, s78, 84992
    s_mov_b32 s69, 2621440
    buffer_load_dwordx4 v47, s[16:19], s69 offen lds
    v_add_u32 v54, 114688, v50
    v_add_u32 v55, 114688, v51
    ds_read_b64_tr_b16 a[80:81], v54 offset:0
    ds_read_b64_tr_b16 a[82:83], v54 offset:256
    ds_read_b64_tr_b16 a[84:85], v54 offset:8192
    ds_read_b64_tr_b16 a[86:87], v54 offset:8448
    ds_read_b64_tr_b16 a[88:89], v55 offset:0
    ds_read_b64_tr_b16 a[90:91], v55 offset:256
    ds_read_b64_tr_b16 a[92:93], v55 offset:8192
    ds_read_b64_tr_b16 a[94:95], v55 offset:8448
    s_waitcnt vmcnt(33) lgkmcnt(0)
    s_barrier
    s_add_u32 m0, s78, 98304
    s_mov_b32 s69, 3145728
    buffer_load_dwordx4 v44, s[16:19], s69 offen lds
    s_add_u32 m0, s78, 99328
    s_mov_b32 s69, 3145728
    buffer_load_dwordx4 v45, s[16:19], s69 offen lds
    s_add_u32 m0, s78, 100352
    s_mov_b32 s69, 3145728
    buffer_load_dwordx4 v46, s[16:19], s69 offen lds
    s_add_u32 m0, s78, 101376
    s_mov_b32 s69, 3145728
    buffer_load_dwordx4 v47, s[16:19], s69 offen lds
    v_add_u32 v54, 131072, v50
    v_add_u32 v55, 131072, v51
    ds_read_b64_tr_b16 a[64:65], v54 offset:0
    ds_read_b64_tr_b16 a[66:67], v54 offset:256
    ds_read_b64_tr_b16 a[68:69], v54 offset:8192
    ds_read_b64_tr_b16 a[70:71], v54 offset:8448
    ds_read_b64_tr_b16 a[72:73], v55 offset:0
    ds_read_b64_tr_b16 a[74:75], v55 offset:256
    ds_read_b64_tr_b16 a[76:77], v55 offset:8192
    ds_read_b64_tr_b16 a[78:79], v55 offset:8448
    s_waitcnt vmcnt(33) lgkmcnt(0)
    s_barrier
    s_add_u32 m0, s78, 114688
    s_mov_b32 s69, 3670016
    buffer_load_dwordx4 v44, s[16:19], s69 offen lds
    s_add_u32 m0, s78, 115712
    s_mov_b32 s69, 3670016
    buffer_load_dwordx4 v45, s[16:19], s69 offen lds
    s_add_u32 m0, s78, 116736
    s_mov_b32 s69, 3670016
    buffer_load_dwordx4 v46, s[16:19], s69 offen lds
    s_add_u32 m0, s78, 117760
    s_mov_b32 s69, 3670016
    buffer_load_dwordx4 v47, s[16:19], s69 offen lds
    v_add_u32 v54, 147456, v50
    v_add_u32 v55, 147456, v51
    ds_read_b64_tr_b16 a[128:129], v54 offset:0
    ds_read_b64_tr_b16 a[130:131], v54 offset:256
    ds_read_b64_tr_b16 a[132:133], v54 offset:8192
    ds_read_b64_tr_b16 a[134:135], v54 offset:8448
    ds_read_b64_tr_b16 a[136:137], v55 offset:0
    ds_read_b64_tr_b16 a[138:139], v55 offset:256
    ds_read_b64_tr_b16 a[140:141], v55 offset:8192
    ds_read_b64_tr_b16 a[142:143], v55 offset:8448
    s_waitcnt vmcnt(28) lgkmcnt(0)
    s_barrier
    s_cmp_lt_u32 s5, 9
    s_cselect_b64 vcc, -1, 0
    v_lshl_or_b32 v73, v74, 16, v73
    v_min_u32 v73, -2, v73
    v_cndmask_b32 v73, -1, v73, vcc
    s_min_u32 s69, s5, 27
    s_lshl_b32 s69, s69, 10
    s_add_u32 s69, s69, 393216
    buffer_store_dword v73, v11, s[8:11], s69 offen sc1
    buffer_load_dword v75, off, s[32:35], 0 offset:192 sc1
    s_add_u32 m0, s78, 131072
    s_mov_b32 s69, 4194304
    buffer_load_dwordx4 v44, s[16:19], s69 offen lds
    s_add_u32 m0, s78, 132096
    s_mov_b32 s69, 4194304
    buffer_load_dwordx4 v45, s[16:19], s69 offen lds
    s_add_u32 m0, s78, 133120
    s_mov_b32 s69, 4194304
    buffer_load_dwordx4 v46, s[16:19], s69 offen lds
    s_add_u32 m0, s78, 134144
    s_mov_b32 s69, 4194304
    buffer_load_dwordx4 v47, s[16:19], s69 offen lds
    v_add_u32 v54, 16384, v50
    v_add_u32 v55, 16384, v51
    ds_read_b64_tr_b16 a[192:193], v54 offset:0
    ds_read_b64_tr_b16 a[194:195], v54 offset:256
    ds_read_b64_tr_b16 a[196:197], v54 offset:8192
    ds_read_b64_tr_b16 a[198:199], v54 offset:8448
    ds_read_b64_tr_b16 a[200:201], v55 offset:0
    ds_read_b64_tr_b16 a[202:203], v55 offset:256
    ds_read_b64_tr_b16 a[204:205], v55 offset:8192
    ds_read_b64_tr_b16 a[206:207], v55 offset:8448
    s_waitcnt vmcnt(28) lgkmcnt(0)
    s_barrier
    s_add_u32 m0, s78, 0
    s_mov_b32 s69, 0
    buffer_load_dwordx4 v44, s[20:23], s69 offen lds
    s_add_u32 m0, s78, 1024
    s_mov_b32 s69, 0
    buffer_load_dwordx4 v45, s[20:23], s69 offen lds
    s_add_u32 m0, s78, 2048
    s_mov_b32 s69, 0
    buffer_load_dwordx4 v46, s[20:23], s69 offen lds
    s_add_u32 m0, s78, 3072
    s_mov_b32 s69, 0
    buffer_load_dwordx4 v47, s[20:23], s69 offen lds
    v_add_u32 v54, 32768, v50
    v_add_u32 v55, 32768, v51
    ds_read_b64_tr_b16 a[176:177], v54 offset:0
    ds_read_b64_tr_b16 a[178:179], v54 offset:256
    ds_read_b64_tr_b16 a[180:181], v54 offset:8192
    ds_read_b64_tr_b16 a[182:183], v54 offset:8448
    ds_read_b64_tr_b16 a[184:185], v55 offset:0
    ds_read_b64_tr_b16 a[186:187], v55 offset:256
    ds_read_b64_tr_b16 a[188:189], v55 offset:8192
    ds_read_b64_tr_b16 a[190:191], v55 offset:8448
    s_waitcnt vmcnt(28) lgkmcnt(0)
    s_barrier
    s_add_u32 m0, s78, 16384
    s_mov_b32 s69, 524288
    buffer_load_dwordx4 v44, s[20:23], s69 offen lds
    s_add_u32 m0, s78, 17408
    s_mov_b32 s69, 524288
    buffer_load_dwordx4 v45, s[20:23], s69 offen lds
    s_add_u32 m0, s78, 18432
    s_mov_b32 s69, 524288
    buffer_load_dwordx4 v46, s[20:23], s69 offen lds
    s_add_u32 m0, s78, 19456
    s_mov_b32 s69, 524288
    buffer_load_dwordx4 v47, s[20:23], s69 offen lds
    v_add_u32 v54, 49152, v50
    v_add_u32 v55, 49152, v51
    ds_read_b64_tr_b16 a[160:161], v54 offset:0
    ds_read_b64_tr_b16 a[162:163], v54 offset:256
    ds_read_b64_tr_b16 a[164:165], v54 offset:8192
    ds_read_b64_tr_b16 a[166:167], v54 offset:8448
    ds_read_b64_tr_b16 a[168:169], v55 offset:0
    ds_read_b64_tr_b16 a[170:171], v55 offset:256
    ds_read_b64_tr_b16 a[172:173], v55 offset:8192
    ds_read_b64_tr_b16 a[174:175], v55 offset:8448
    s_waitcnt vmcnt(28) lgkmcnt(0)
    s_barrier
    s_add_u32 m0, s78, 32768
    s_mov_b32 s69, 1048576
    buffer_load_dwordx4 v44, s[20:23], s69 offen lds
    s_add_u32 m0, s78, 33792
    s_mov_b32 s69, 1048576
    buffer_load_dwordx4 v45, s[20:23], s69 offen lds
    s_add_u32 m0, s78, 34816
    s_mov_b32 s69, 1048576
    buffer_load_dwordx4 v46, s[20:23], s69 offen lds
    s_add_u32 m0, s78, 35840
    s_mov_b32 s69, 1048576
    buffer_load_dwordx4 v47, s[20:23], s69 offen lds
    v_add_u32 v54, 65536, v50
    v_add_u32 v55, 65536, v51
    ds_read_b64_tr_b16 a[144:145], v54 offset:0
    ds_read_b64_tr_b16 a[146:147], v54 offset:256
    ds_read_b64_tr_b16 a[148:149], v54 offset:8192
    ds_read_b64_tr_b16 a[150:151], v54 offset:8448
    ds_read_b64_tr_b16 a[152:153], v55 offset:0
    ds_read_b64_tr_b16 a[154:155], v55 offset:256
    ds_read_b64_tr_b16 a[156:157], v55 offset:8192
    ds_read_b64_tr_b16 a[158:159], v55 offset:8448
    s_waitcnt vmcnt(28) lgkmcnt(0)
    s_barrier
    s_add_u32 m0, s78, 49152
    s_mov_b32 s69, 1572864
    buffer_load_dwordx4 v44, s[20:23], s69 offen lds
    s_add_u32 m0, s78, 50176
    s_mov_b32 s69, 1572864
    buffer_load_dwordx4 v45, s[20:23], s69 offen lds
    s_add_u32 m0, s78, 51200
    s_mov_b32 s69, 1572864
    buffer_load_dwordx4 v46, s[20:23], s69 offen lds
    s_add_u32 m0, s78, 52224
    s_mov_b32 s69, 1572864
    buffer_load_dwordx4 v47, s[20:23], s69 offen lds
    v_add_u32 v54, 81920, v50
    v_add_u32 v55, 81920, v51
    ds_read_b64_tr_b16 v[80:81], v54 offset:0
    ds_read_b64_tr_b16 v[82:83], v54 offset:256
    ds_read_b64_tr_b16 v[84:85], v54 offset:8192
    ds_read_b64_tr_b16 v[86:87], v54 offset:8448
    ds_read_b64_tr_b16 v[88:89], v55 offset:0
    ds_read_b64_tr_b16 v[90:91], v55 offset:256
    ds_read_b64_tr_b16 v[92:93], v55 offset:8192
    ds_read_b64_tr_b16 v[94:95], v55 offset:8448
    s_waitcnt vmcnt(28) lgkmcnt(0)
    s_barrier
    s_add_u32 m0, s78, 65536
    s_mov_b32 s69, 2097152
    buffer_load_dwordx4 v44, s[20:23], s69 offen lds
    s_add_u32 m0, s78, 66560
    s_mov_b32 s69, 2097152
    buffer_load_dwordx4 v45, s[20:23], s69 offen lds
    s_add_u32 m0, s78, 67584
    s_mov_b32 s69, 2097152
    buffer_load_dwordx4 v46, s[20:23], s69 offen lds
    s_add_u32 m0, s78, 68608
    s_mov_b32 s69, 2097152
    buffer_load_dwordx4 v47, s[20:23], s69 offen lds
    v_add_u32 v54, 98304, v50
    v_add_u32 v55, 98304, v51
    ds_read_b64_tr_b16 a[240:241], v54 offset:0
    ds_read_b64_tr_b16 a[242:243], v54 offset:256
    ds_read_b64_tr_b16 a[244:245], v54 offset:8192
    ds_read_b64_tr_b16 a[246:247], v54 offset:8448
    ds_read_b64_tr_b16 a[248:249], v55 offset:0
    ds_read_b64_tr_b16 a[250:251], v55 offset:256
    ds_read_b64_tr_b16 a[252:253], v55 offset:8192
    ds_read_b64_tr_b16 a[254:255], v55 offset:8448
    s_waitcnt vmcnt(28) lgkmcnt(0)
    s_barrier
    s_add_u32 m0, s78, 81920
    s_mov_b32 s69, 2621440
    buffer_load_dwordx4 v44, s[20:23], s69 offen lds
    s_add_u32 m0, s78, 82944
    s_mov_b32 s69, 2621440
    buffer_load_dwordx4 v45, s[20:23], s69 offen lds
    s_add_u32 m0, s78, 83968
    s_mov_b32 s69, 2621440
    buffer_load_dwordx4 v46, s[20:23], s69 offen lds
    s_add_u32 m0, s78, 84992
    s_mov_b32 s69, 2621440
    buffer_load_dwordx4 v47, s[20:23], s69 offen lds
    v_add_u32 v54, 114688, v50
    v_add_u32 v55, 114688, v51
    ds_read_b64_tr_b16 a[224:225], v54 offset:0
    ds_read_b64_tr_b16 a[226:227], v54 offset:256
    ds_read_b64_tr_b16 a[228:229], v54 offset:8192
    ds_read_b64_tr_b16 a[230:231], v54 offset:8448
    ds_read_b64_tr_b16 a[232:233], v55 offset:0
    ds_read_b64_tr_b16 a[234:235], v55 offset:256
    ds_read_b64_tr_b16 a[236:237], v55 offset:8192
    ds_read_b64_tr_b16 a[238:239], v55 offset:8448
    s_waitcnt vmcnt(28) lgkmcnt(0)
    s_barrier
    s_add_u32 m0, s78, 98304
    s_mov_b32 s69, 3145728
    buffer_load_dwordx4 v44, s[20:23], s69 offen lds
    s_add_u32 m0, s78, 99328
    s_mov_b32 s69, 3145728
    buffer_load_dwordx4 v45, s[20:23], s69 offen lds
    s_add_u32 m0, s78, 100352
    s_mov_b32 s69, 3145728
    buffer_load_dwordx4 v46, s[20:23], s69 offen lds
    s_add_u32 m0, s78, 101376
    s_mov_b32 s69, 3145728
    buffer_load_dwordx4 v47, s[20:23], s69 offen lds
    v_add_u32 v54, 131072, v50
    v_add_u32 v55, 131072, v51
    ds_read_b64_tr_b16 a[208:209], v54 offset:0
    ds_read_b64_tr_b16 a[210:211], v54 offset:256
    ds_read_b64_tr_b16 a[212:213], v54 offset:8192
    ds_read_b64_tr_b16 a[214:215], v54 offset:8448
    ds_read_b64_tr_b16 a[216:217], v55 offset:0
    ds_read_b64_tr_b16 a[218:219], v55 offset:256
    ds_read_b64_tr_b16 a[220:221], v55 offset:8192
    ds_read_b64_tr_b16 a[222:223], v55 offset:8448
    s_waitcnt vmcnt(28) lgkmcnt(0)
    s_barrier
    s_add_u32 m0, s78, 114688
    s_mov_b32 s69, 3670016
    buffer_load_dwordx4 v44, s[20:23], s69 offen lds
    s_add_u32 m0, s78, 115712
    s_mov_b32 s69, 3670016
    buffer_load_dwordx4 v45, s[20:23], s69 offen lds
    s_add_u32 m0, s78, 116736
    s_mov_b32 s69, 3670016
    buffer_load_dwordx4 v46, s[20:23], s69 offen lds
    s_add_u32 m0, s78, 117760
    s_mov_b32 s69, 3670016
    buffer_load_dwordx4 v47, s[20:23], s69 offen lds
    v_add_u32 v54, 147456, v50
    v_add_u32 v55, 147456, v51
    ds_read_b64_tr_b16 v[96:97], v54 offset:0
    ds_read_b64_tr_b16 v[98:99], v54 offset:256
    ds_read_b64_tr_b16 v[100:101], v54 offset:8192
    ds_read_b64_tr_b16 v[102:103], v54 offset:8448
    ds_read_b64_tr_b16 v[104:105], v55 offset:0
    ds_read_b64_tr_b16 v[106:107], v55 offset:256
    ds_read_b64_tr_b16 v[108:109], v55 offset:8192
    ds_read_b64_tr_b16 v[110:111], v55 offset:8448
    s_waitcnt vmcnt(28) lgkmcnt(0)
    s_barrier
    s_add_u32 m0, s78, 131072
    s_mov_b32 s69, 4194304
    buffer_load_dwordx4 v44, s[20:23], s69 offen lds
    s_add_u32 m0, s78, 132096
    s_mov_b32 s69, 4194304
    buffer_load_dwordx4 v45, s[20:23], s69 offen lds
    s_add_u32 m0, s78, 133120
    s_mov_b32 s69, 4194304
    buffer_load_dwordx4 v46, s[20:23], s69 offen lds
    s_add_u32 m0, s78, 134144
    s_mov_b32 s69, 4194304
    buffer_load_dwordx4 v47, s[20:23], s69 offen lds
    v_add_u32 v54, 16384, v50
    v_add_u32 v55, 16384, v51
    ds_read_b64_tr_b16 v[112:113], v54 offset:0
    ds_read_b64_tr_b16 v[114:115], v54 offset:256
    ds_read_b64_tr_b16 v[116:117], v54 offset:8192
    ds_read_b64_tr_b16 v[118:119], v54 offset:8448
    ds_read_b64_tr_b16 v[120:121], v55 offset:0
    ds_read_b64_tr_b16 v[122:123], v55 offset:256
    ds_read_b64_tr_b16 v[124:125], v55 offset:8192
    ds_read_b64_tr_b16 v[126:127], v55 offset:8448
    s_waitcnt vmcnt(28) lgkmcnt(0)
    s_barrier
    v_readfirstlane_b32 s84, v75
    s_cmp_lg_u32 s84, 0
    s_cbranch_scc1 L_isrdy_82
    s_mov_b32 s79, 524288
L_rdy_83:
    buffer_load_dword v75, off, s[32:35], 0 offset:192 sc1
    s_waitcnt vmcnt(0)
    v_readfirstlane_b32 s84, v75
    s_cmp_lg_u32 s84, 0
    s_cbranch_scc1 L_rdyok_84
    s_sub_u32 s79, s79, 1
    s_cbranch_scc1 L_fail
    s_branch L_rdy_83
L_rdyok_84:
L_isrdy_82:
    s_add_u32 m0, s78, 0
    s_mov_b32 s69, 256
    buffer_load_dwordx4 v48, s[24:27], s69 offen lds
    s_add_u32 m0, s78, 1024
    s_mov_b32 s69, 9472
    buffer_load_dwordx4 v48, s[24:27], s69 offen lds
    s_add_u32 m0, s78, 2048
    s_mov_b32 s69, 256
    buffer_load_dwordx4 v49, s[24:27], s69 offen lds
    s_add_u32 m0, s78, 3072
    s_mov_b32 s69, 9472
    buffer_load_dwordx4 v49, s[24:27], s69 offen lds
    v_add_u32 v54, 32768, v50
    v_add_u32 v55, 32768, v51
    ds_read_b64_tr_b16 v[56:57], v54 offset:0
    ds_read_b64_tr_b16 v[58:59], v54 offset:256
    ds_read_b64_tr_b16 v[60:61], v54 offset:8192
    ds_read_b64_tr_b16 v[62:63], v54 offset:8448
    ds_read_b64_tr_b16 v[64:65], v55 offset:0
    ds_read_b64_tr_b16 v[66:67], v55 offset:256
    ds_read_b64_tr_b16 v[68:69], v55 offset:8192
    ds_read_b64_tr_b16 v[70:71], v55 offset:8448
    s_waitcnt vmcnt(28) lgkmcnt(0)
    s_barrier
    s_add_u32 m0, s78, 16384
    s_mov_b32 s69, 640
    buffer_load_dwordx4 v48, s[24:27], s69 offen lds
    s_add_u32 m0, s78, 17408
    s_mov_b32 s69, 9856
    buffer_load_dwordx4 v48, s[24:27], s69 offen lds
    s_add_u32 m0, s78, 18432
    s_mov_b32 s69, 640
    buffer_load_dwordx4 v49, s[24:27], s69 offen lds
    s_add_u32 m0, s78, 19456
    s_mov_b32 s69, 9856
    buffer_load_dwordx4 v49, s[24:27], s69 offen lds
    v_add_u32 v54, 49152, v50
    v_add_u32 v55, 49152, v51
    ds_read_b64_tr_b16 v[28:29], v54 offset:0
    ds_read_b64_tr_b16 v[30:31], v54 offset:256
    ds_read_b64_tr_b16 v[32:33], v54 offset:8192
    ds_read_b64_tr_b16 v[34:35], v54 offset:8448
    ds_read_b64_tr_b16 v[36:37], v55 offset:0
    ds_read_b64_tr_b16 v[38:39], v55 offset:256
    ds_read_b64_tr_b16 v[40:41], v55 offset:8192
    ds_read_b64_tr_b16 v[42:43], v55 offset:8448
    s_waitcnt vmcnt(28) lgkmcnt(0)
    s_barrier
    s_add_u32 m0, s78, 32768
    s_mov_b32 s69, 896
    buffer_load_dwordx4 v48, s[24:27], s69 offen lds
    s_add_u32 m0, s78, 33792
    s_mov_b32 s69, 10112
    buffer_load_dwordx4 v48, s[24:27], s69 offen lds
    s_add_u32 m0, s78, 34816
    s_mov_b32 s69, 896
    buffer_load_dwordx4 v49, s[24:27], s69 offen lds
    s_add_u32 m0, s78, 35840
    s_mov_b32 s69, 10112
    buffer_load_dwordx4 v49, s[24:27], s69 offen lds
    v_add_u32 v54, 65536, v50
    v_add_u32 v55, 65536, v51
    ds_read_b64_tr_b16 v[12:13], v54 offset:0
    ds_read_b64_tr_b16 v[14:15], v54 offset:256
    ds_read_b64_tr_b16 v[16:17], v54 offset:8192
    ds_read_b64_tr_b16 v[18:19], v54 offset:8448
    ds_read_b64_tr_b16 v[20:21], v55 offset:0
    ds_read_b64_tr_b16 v[22:23], v55 offset:256
    ds_read_b64_tr_b16 v[24:25], v55 offset:8192
    ds_read_b64_tr_b16 v[26:27], v55 offset:8448
    s_waitcnt vmcnt(28) lgkmcnt(0)
    s_barrier
    s_add_u32 m0, s78, 49152
    s_mov_b32 s69, 0
    buffer_load_dwordx4 v48, s[24:27], s69 offen lds
    s_add_u32 m0, s78, 50176
    s_mov_b32 s69, 9216
    buffer_load_dwordx4 v48, s[24:27], s69 offen lds
    s_add_u32 m0, s78, 51200
    s_mov_b32 s69, 0
    buffer_load_dwordx4 v49, s[24:27], s69 offen lds
    s_add_u32 m0, s78, 52224
    s_mov_b32 s69, 9216
    buffer_load_dwordx4 v49, s[24:27], s69 offen lds
    v_add_u32 v54, 81920, v50
    v_add_u32 v55, 81920, v51
    ds_read_b64_tr_b16 v[176:177], v54 offset:0
    ds_read_b64_tr_b16 v[178:179], v54 offset:256
    ds_read_b64_tr_b16 v[180:181], v54 offset:8192
    ds_read_b64_tr_b16 v[182:183], v54 offset:8448
    ds_read_b64_tr_b16 v[184:185], v55 offset:0
    ds_read_b64_tr_b16 v[186:187], v55 offset:256
    ds_read_b64_tr_b16 v[188:189], v55 offset:8192
    ds_read_b64_tr_b16 v[190:191], v55 offset:8448
    s_waitcnt vmcnt(28) lgkmcnt(0)
    s_barrier
    s_add_u32 m0, s78, 65536
    s_mov_b32 s69, 128
    buffer_load_dwordx4 v48, s[24:27], s69 offen lds
    s_add_u32 m0, s78, 66560
    s_mov_b32 s69, 9344
    buffer_load_dwordx4 v48, s[24:27], s69 offen lds
    s_add_u32 m0, s78, 67584
    s_mov_b32 s69, 128
    buffer_load_dwordx4 v49, s[24:27], s69 offen lds
    s_add_u32 m0, s78, 68608
    s_mov_b32 s69, 9344
    buffer_load_dwordx4 v49, s[24:27], s69 offen lds
    v_add_u32 v54, 98304, v50
    v_add_u32 v55, 98304, v51
    ds_read_b64_tr_b16 v[160:161], v54 offset:0
    ds_read_b64_tr_b16 v[162:163], v54 offset:256
    ds_read_b64_tr_b16 v[164:165], v54 offset:8192
    ds_read_b64_tr_b16 v[166:167], v54 offset:8448
    ds_read_b64_tr_b16 v[168:169], v55 offset:0
    ds_read_b64_tr_b16 v[170:171], v55 offset:256
    ds_read_b64_tr_b16 v[172:173], v55 offset:8192
    ds_read_b64_tr_b16 v[174:175], v55 offset:8448
    s_waitcnt vmcnt(28) lgkmcnt(0)
    s_barrier
    s_add_u32 m0, s78, 81920
    s_mov_b32 s69, 384
    buffer_load_dwordx4 v48, s[24:27], s69 offen lds
    s_add_u32 m0, s78, 82944
    s_mov_b32 s69, 9600
    buffer_load_dwordx4 v48, s[24:27], s69 offen lds
    s_add_u32 m0, s78, 83968
    s_mov_b32 s69, 384
    buffer_load_dwordx4 v49, s[24:27], s69 offen lds
    s_add_u32 m0, s78, 84992
    s_mov_b32 s69, 9600
    buffer_load_dwordx4 v49, s[24:27], s69 offen lds
    v_add_u32 v54, 114688, v50
    v_add_u32 v55, 114688, v51
    ds_read_b64_tr_b16 v[144:145], v54 offset:0
    ds_read_b64_tr_b16 v[146:147], v54 offset:256
    ds_read_b64_tr_b16 v[148:149], v54 offset:8192
    ds_read_b64_tr_b16 v[150:151], v54 offset:8448
    ds_read_b64_tr_b16 v[152:153], v55 offset:0
    ds_read_b64_tr_b16 v[154:155], v55 offset:256
    ds_read_b64_tr_b16 v[156:157], v55 offset:8192
    ds_read_b64_tr_b16 v[158:159], v55 offset:8448
    s_waitcnt vmcnt(28) lgkmcnt(0)
    s_barrier
    s_add_u32 m0, s78, 98304
    s_mov_b32 s69, 512
    buffer_load_dwordx4 v48, s[24:27], s69 offen lds
    s_add_u32 m0, s78, 99328
    s_mov_b32 s69, 9728
    buffer_load_dwordx4 v48, s[24:27], s69 offen lds
    s_add_u32 m0, s78, 100352
    s_mov_b32 s69, 512
    buffer_load_dwordx4 v49, s[24:27], s69 offen lds
    s_add_u32 m0, s78, 101376
    s_mov_b32 s69, 9728
    buffer_load_dwordx4 v49, s[24:27], s69 offen lds
    v_add_u32 v54, 131072, v50
    v_add_u32 v55, 131072, v51
    ds_read_b64_tr_b16 v[128:129], v54 offset:0
    ds_read_b64_tr_b16 v[130:131], v54 offset:256
    ds_read_b64_tr_b16 v[132:133], v54 offset:8192
    ds_read_b64_tr_b16 v[134:135], v54 offset:8448
    ds_read_b64_tr_b16 v[136:137], v55 offset:0
    ds_read_b64_tr_b16 v[138:139], v55 offset:256
    ds_read_b64_tr_b16 v[140:141], v55 offset:8192
    ds_read_b64_tr_b16 v[142:143], v55 offset:8448
    s_waitcnt vmcnt(28) lgkmcnt(0)
    s_barrier
    s_add_u32 m0, s78, 114688
    s_mov_b32 s69, 768
    buffer_load_dwordx4 v48, s[24:27], s69 offen lds
    s_add_u32 m0, s78, 115712
    s_mov_b32 s69, 9984
    buffer_load_dwordx4 v48, s[24:27], s69 offen lds
    s_add_u32 m0, s78, 116736
    s_mov_b32 s69, 768
    buffer_load_dwordx4 v49, s[24:27], s69 offen lds
    s_add_u32 m0, s78, 117760
    s_mov_b32 s69, 9984
    buffer_load_dwordx4 v49, s[24:27], s69 offen lds
    v_add_u32 v54, 147456, v50
    v_add_u32 v55, 147456, v51
    ds_read_b64_tr_b16 v[192:193], v54 offset:0
    ds_read_b64_tr_b16 v[194:195], v54 offset:256
    ds_read_b64_tr_b16 v[196:197], v54 offset:8192
    ds_read_b64_tr_b16 v[198:199], v54 offset:8448
    ds_read_b64_tr_b16 v[200:201], v55 offset:0
    ds_read_b64_tr_b16 v[202:203], v55 offset:256
    ds_read_b64_tr_b16 v[204:205], v55 offset:8192
    ds_read_b64_tr_b16 v[206:207], v55 offset:8448
    s_waitcnt vmcnt(28) lgkmcnt(0)
    s_barrier
    s_add_u32 m0, s78, 131072
    s_mov_b32 s69, 1024
    buffer_load_dwordx4 v48, s[24:27], s69 offen lds
    s_add_u32 m0, s78, 132096
    s_mov_b32 s69, 10240
    buffer_load_dwordx4 v48, s[24:27], s69 offen lds
    s_add_u32 m0, s78, 133120
    s_mov_b32 s69, 1024
    buffer_load_dwordx4 v49, s[24:27], s69 offen lds
    s_add_u32 m0, s78, 134144
    s_mov_b32 s69, 10240
    buffer_load_dwordx4 v49, s[24:27], s69 offen lds
    v_mov_b32 v76, 4096
    s_mov_b32 s69, 40064
    buffer_load_dword v45, off, s[8:11], s69 sc1
    buffer_load_dwordx4 v[72:75], off, s[8:11], s82 sc1
    buffer_load_dwordx4 v[76:79], v76, s[8:11], s82 offen sc1
    v_add_u32 v54, 16384, v52
    ds_read_b64_tr_b16 v[208:209], v54 offset:0
    ds_read_b64_tr_b16 v[210:211], v54 offset:256
    ds_read_b64_tr_b16 v[212:213], v54 offset:1024
    ds_read_b64_tr_b16 v[214:215], v54 offset:1280
    ds_read_b64_tr_b16 v[216:217], v54 offset:8192
    ds_read_b64_tr_b16 v[218:219], v54 offset:8448
    ds_read_b64_tr_b16 v[220:221], v54 offset:9216
    ds_read_b64_tr_b16 v[222:223], v54 offset:9472
    s_waitcnt vmcnt(31) lgkmcnt(0)
    s_barrier
    v_add_u32 v53, s78, v0
    v_add_u32 v53, 0, v53
    ds_write_b128 v53, v[12:15] offset:0
    ds_write_b128 v53, v[16:19] offset:1024
    ds_write_b128 v53, v[20:23] offset:2048
    ds_write_b128 v53, v[24:27] offset:3072
    v_add_u32 v54, 32768, v52
    ds_read_b64_tr_b16 v[224:225], v54 offset:0
    ds_read_b64_tr_b16 v[226:227], v54 offset:256
    ds_read_b64_tr_b16 v[228:229], v54 offset:1024
    ds_read_b64_tr_b16 v[230:231], v54 offset:1280
    ds_read_b64_tr_b16 v[232:233], v54 offset:8192
    ds_read_b64_tr_b16 v[234:235], v54 offset:8448
    ds_read_b64_tr_b16 v[236:237], v54 offset:9216
    ds_read_b64_tr_b16 v[238:239], v54 offset:9472
    s_waitcnt vmcnt(27) lgkmcnt(0)
    s_barrier
    v_add_u32_e64 v53, s78, v0
    v_add_u32 v53, 16384, v53
    ds_write_b128 v53, v[28:31] offset:0
    ds_write_b128 v53, v[32:35] offset:1024
    ds_write_b128 v53, v[36:39] offset:2048
    ds_write_b128 v53, v[40:43] offset:3072
    v_add_u32 v54, 49152, v52
    ds_read_b64_tr_b16 v[240:241], v54 offset:0
    ds_read_b64_tr_b16 v[242:243], v54 offset:256
    ds_read_b64_tr_b16 v[244:245], v54 offset:1024
    ds_read_b64_tr_b16 v[246:247], v54 offset:1280
    ds_read_b64_tr_b16 v[248:249], v54 offset:8192
    ds_read_b64_tr_b16 v[250:251], v54 offset:8448
    ds_read_b64_tr_b16 v[252:253], v54 offset:9216
    ds_read_b64_tr_b16 v[254:255], v54 offset:9472
    s_waitcnt vmcnt(23) lgkmcnt(0)
    s_barrier
    v_add_u32_e64 v53, s78, v0
    v_add_u32 v53, 32768, v53
    ds_write_b128 v53, v[56:59] offset:0
    ds_write_b128 v53, v[60:63] offset:1024
    ds_write_b128 v53, v[64:67] offset:2048
    ds_write_b128 v53, v[68:71] offset:3072
    v_add_u32 v54, 65536, v52
    ds_read_b64_tr_b16 v[56:57], v54 offset:0
    ds_read_b64_tr_b16 v[58:59], v54 offset:256
    ds_read_b64_tr_b16 v[60:61], v54 offset:1024
    ds_read_b64_tr_b16 v[62:63], v54 offset:1280
    ds_read_b64_tr_b16 v[64:65], v54 offset:8192
    ds_read_b64_tr_b16 v[66:67], v54 offset:8448
    ds_read_b64_tr_b16 v[68:69], v54 offset:9216
    ds_read_b64_tr_b16 v[70:71], v54 offset:9472
    s_waitcnt vmcnt(19) lgkmcnt(0)
    s_barrier
    v_add_u32_e64 v53, s78, v0
    v_add_u32 v53, 49152, v53
    ds_write_b128 v53, v[56:59] offset:0
    ds_write_b128 v53, v[60:63] offset:1024
    ds_write_b128 v53, v[64:67] offset:2048
    ds_write_b128 v53, v[68:71] offset:3072
    v_add_u32 v54, 81920, v52
    ds_read_b64_tr_b16 v[56:57], v54 offset:0
    ds_read_b64_tr_b16 v[58:59], v54 offset:256
    ds_read_b64_tr_b16 v[60:61], v54 offset:1024
    ds_read_b64_tr_b16 v[62:63], v54 offset:1280
    ds_read_b64_tr_b16 v[64:65], v54 offset:8192
    ds_read_b64_tr_b16 v[66:67], v54 offset:8448
    ds_read_b64_tr_b16 v[68:69], v54 offset:9216
    ds_read_b64_tr_b16 v[70:71], v54 offset:9472
    s_waitcnt vmcnt(15) lgkmcnt(0)
    s_barrier
    v_add_u32_e64 v53, s78, v0
    v_add_u32 v53, 65536, v53
    ds_write_b128 v53, v[56:59] offset:0
    ds_write_b128 v53, v[60:63] offset:1024
    ds_write_b128 v53, v[64:67] offset:2048
    ds_write_b128 v53, v[68:71] offset:3072
    v_add_u32 v54, 98304, v52
    ds_read_b64_tr_b16 v[56:57], v54 offset:0
    ds_read_b64_tr_b16 v[58:59], v54 offset:256
    ds_read_b64_tr_b16 v[60:61], v54 offset:1024
    ds_read_b64_tr_b16 v[62:63], v54 offset:1280
    ds_read_b64_tr_b16 v[64:65], v54 offset:8192
    ds_read_b64_tr_b16 v[66:67], v54 offset:8448
    ds_read_b64_tr_b16 v[68:69], v54 offset:9216
    ds_read_b64_tr_b16 v[70:71], v54 offset:9472
    s_waitcnt vmcnt(11) lgkmcnt(0)
    s_barrier
    v_add_u32_e64 v53, s78, v0
    v_add_u32 v53, 81920, v53
    ds_write_b128 v53, v[56:59] offset:0
    ds_write_b128 v53, v[60:63] offset:1024
    ds_write_b128 v53, v[64:67] offset:2048
    ds_write_b128 v53, v[68:71] offset:3072
    v_add_u32 v54, 114688, v52
    ds_read_b64_tr_b16 v[56:57], v54 offset:0
    ds_read_b64_tr_b16 v[58:59], v54 offset:256
    ds_read_b64_tr_b16 v[60:61], v54 offset:1024
    ds_read_b64_tr_b16 v[62:63], v54 offset:1280
    ds_read_b64_tr_b16 v[64:65], v54 offset:8192
    ds_read_b64_tr_b16 v[66:67], v54 offset:8448
    ds_read_b64_tr_b16 v[68:69], v54 offset:9216
    ds_read_b64_tr_b16 v[70:71], v54 offset:9472
    s_waitcnt vmcnt(7) lgkmcnt(0)
    s_barrier
    v_add_u32_e64 v53, s78, v0
    v_add_u32 v53, 98304, v53
    ds_write_b128 v53, v[56:59] offset:0
    ds_write_b128 v53, v[60:63] offset:1024
    ds_write_b128 v53, v[64:67] offset:2048
    ds_write_b128 v53, v[68:71] offset:3072
    v_add_u32 v54, 131072, v52
    ds_read_b64_tr_b16 v[56:57], v54 offset:0
    ds_read_b64_tr_b16 v[58:59], v54 offset:256
    ds_read_b64_tr_b16 v[60:61], v54 offset:1024
    ds_read_b64_tr_b16 v[62:63], v54 offset:1280
    ds_read_b64_tr_b16 v[64:65], v54 offset:8192
    ds_read_b64_tr_b16 v[66:67], v54 offset:8448
    ds_read_b64_tr_b16 v[68:69], v54 offset:9216
    ds_read_b64_tr_b16 v[70:71], v54 offset:9472
    s_waitcnt vmcnt(3) lgkmcnt(0)
    s_barrier
    v_add_u32_e64 v53, s78, v0
    v_add_u32 v53, 114688, v53
    ds_write_b128 v53, v[56:59] offset:0
    ds_write_b128 v53, v[60:63] offset:1024
    ds_write_b128 v53, v[64:67] offset:2048
    ds_write_b128 v53, v[68:71] offset:3072
    v_add_u32 v54, 147456, v52
    ds_read_b64_tr_b16 v[56:57], v54 offset:0
    ds_read_b64_tr_b16 v[58:59], v54 offset:256
    ds_read_b64_tr_b16 v[60:61], v54 offset:1024
    ds_read_b64_tr_b16 v[62:63], v54 offset:1280
    ds_read_b64_tr_b16 v[64:65], v54 offset:8192
    ds_read_b64_tr_b16 v[66:67], v54 offset:8448
    ds_read_b64_tr_b16 v[68:69], v54 offset:9216
    ds_read_b64_tr_b16 v[70:71], v54 offset:9472
    s_waitcnt lgkmcnt(0)
    s_barrier
    v_add_u32_e64 v53, s78, v0
    v_add_u32 v53, 131072, v53
    ds_write_b128 v53, v[56:59] offset:0
    ds_write_b128 v53, v[60:63] offset:1024
    ds_write_b128 v53, v[64:67] offset:2048
    ds_write_b128 v53, v[68:71] offset:3072
L_staged:
    s_getpc_b64 s[84:85]
    v_and_b32 v60, 0x1f0, v0
    v_lshlrev_b32 v60, 3, v60
    s_lshl_b32 s86, s4, 12
    v_add_u32 v60, s86, v60
    global_load_dword v9, v60, s[84:85]
    s_mov_b32 s79, 524288
    s_waitcnt vmcnt(1)
    v_min3_u32 v72, v72, v73, v74
    v_min3_u32 v72, v72, v75, v76
    v_min3_u32 v72, v72, v77, v78
    v_min_u32 v72, v72, v79
    s_nop 0
    v_readfirstlane_b32 s66, v72
    s_mov_b32 s69, 40064
    s_branch L_cichk_87
L_ci_85:
    buffer_load_dword v45, off, s[8:11], s69 sc1
    s_waitcnt vmcnt(0)
L_cichk_87:
    v_readfirstlane_b32 s3, v45
    s_and_b32 s84, s3, 0xffff
    s_cmp_ge_u32 s84, 32
    s_cbranch_scc1 L_ciok_86
    s_sub_u32 s79, s79, 1
    s_cbranch_scc1 L_fail
    s_branch L_ci_85
L_ciok_86:
    s_cmp_eq_u32 s3, 32
    s_cselect_b32 s6, 1, 0
    s_mov_b32 s7, 0
    s_mov_b32 s60, 1
    s_mov_b32 s54, 393216
    s_mov_b32 s53, 402432
    s_add_u32 s81, s61, 1036288
    s_add_u32 s73, s81, 8192
    s_sub_u32 s62, s64, 1536
    s_mov_b32 s72, 0
    s_mov_b32 s69, 3
    s_cmp_ge_u32 s66, s69
    s_cbranch_scc1 L_kvd_89
    s_mov_b32 s79, 524288
L_kv_88:
    v_mov_b32 v76, 4096
    buffer_load_dwordx4 v[72:75], off, s[8:11], s82 sc1
    buffer_load_dwordx4 v[76:79], v76, s[8:11], s82 offen sc1
    s_waitcnt vmcnt(0)
    v_min3_u32 v72, v72, v73, v74
    v_min3_u32 v72, v72, v75, v76
    v_min3_u32 v72, v72, v77, v78
    v_min_u32 v72, v72, v79
    s_nop 0
    v_readfirstlane_b32 s66, v72
    v_mov_b64 v[72:73], 0
    v_mov_b64 v[74:75], 0
    v_mov_b64 v[76:77], 0
    v_mov_b64_e64 v[78:79], 0
    s_cmp_ge_u32 s66, s69
    s_cbranch_scc1 L_kvd_89
    s_sub_u32 s79, s79, 1
    s_cbranch_scc1 L_fail
    s_branch L_kv_88
L_kvd_89:
    v_and_b32 v60, 0x1f0, v0
    v_lshlrev_b32_e64 v60, 3, v60
    buffer_load_dword v9, v60, s[8:11], s61 offen sc1
    s_add_u32 s69, s61, 524288
    buffer_load_dword v9, v60, s[8:11], s69 offen sc1
    s_lshl_b32 s69, s76, 1
    s_add_u32 s52, s69, 393216
    s_mov_b32 s80, 401408
    s_mov_b32 s79, 524288
    s_waitcnt lgkmcnt(0)
    s_barrier
    s_cmp_eq_u32 s4, 1
    s_cbranch_scc1 L_wave1
    s_cmp_eq_u32 s4, 2
    s_cbranch_scc1 L_wave2
    s_cmp_eq_u32 s4, 3
    s_cbranch_scc1 L_wave3
L_wave0:
    v_lshrrev_b32 v11, 2, v0
    v_lshrrev_b32_e64 v60, 7, v0
    v_mul_u32_u24 v60, 9344, v60
    v_and_b32 v1, 0x70, v0
    v_add_u32_e64 v1, v1, v60
    s_mov_b32 s40, 0x3030303
    s_mov_b32 s41, 0x3030303
    s_mov_b32 s42, 0xc0c0c0c
    s_mov_b32 s43, 0xc0c0c0c
    s_mov_b32 s44, 0x30303030
    s_mov_b32 s45, 0x30303030
    s_mov_b32 s46, 0xc0c0c0c0
    s_mov_b32 s47, 0xc0c0c0c0
    v_mov_b64 v[72:73], 0
    v_mov_b64 v[74:75], 0
    v_mov_b64 v[76:77], 0
    v_mov_b64 v[78:79], 0
    v_bfe_u32 v7, v0, 6, 1
    v_mul_u32_u24 v7, 4080, v7
    v_and_or_b32 v9, v11, 28, 0
    v_add_u32 v7, v7, v9
    v_mov_b32 v24, -1
    v_mov_b32 v27, -1
    s_mov_b32 s67, 0
    s_cmp_eq_u32 s6, 0
    s_cbranch_scc1 L_poll_s0
L_poll_f0:
    buffer_load_dwordx4 v[12:15], v0, s[8:11], s52 offen sc1
L_poll_f0_2:
    s_waitcnt vmcnt(3)
    ds_read_b128 v[32:35], v0 offset:16384
    ds_read_b128 v[36:39], v0 offset:17408
    ds_read_b128 v[40:43], v0 offset:18432
    ds_read_b128 v[44:47], v0 offset:19456
    ds_read_b128 v[64:67], v0 offset:32768
    ds_read_b128 v[68:71], v0 offset:33792
    v_mov_b64 v[48:49], 0
    v_mov_b64 v[50:51], 0
    v_mov_b64 v[52:53], 0
    v_mov_b64 v[54:55], 0
    v_mov_b64 v[56:57], 0
    v_mov_b64 v[58:59], 0
    v_mov_b64 v[60:61], 0
    v_mov_b64_e64 v[62:63], 0
L_retry_f0:
    buffer_load_dwordx4 v[12:15], v0, s[8:11], s52 offen sc1
    s_waitcnt vmcnt(1)
L_step_f0:
    v_max3_u32 v9, v12, v13, v14
    v_max_u32 v9, v9, v15
    v_cmp_eq_u32_e64 vcc, -1, v9
    ds_write_b128 v0, v[12:15] offset:0
    s_sub_u32 s79, s79, 1
    s_cbranch_scc1 L_fail
    s_cbranch_vccnz L_retry_f0
    v_smfmac_f32_16x16x64_bf16 v[48:51], v[12:15], a[0:7], v2
    buffer_load_dwordx4 v[28:31], v0, s[8:11], s52 offen offset:1024 sc1
    v_smfmac_f32_16x16x64_bf16 v[56:59], v[12:15], a[144:151], v2
    v_smfmac_f32_16x16x64_bf16 v[52:55], v[12:15], a[8:15], v2
    s_waitcnt lgkmcnt(0)
    s_barrier
    ds_read_b128 v[16:19], v0 offset:2048
    ds_read_b128 v[20:23], v0 offset:4096
    buffer_load_dword v8, v11, s[8:11], s80 offen offset:0 sc1
    v_smfmac_f32_16x16x64_bf16 v[60:63], v[12:15], a[152:159], v2
    ds_read_b128 v[24:27], v0 offset:6144
    v_smfmac_f32_16x16x64_bf16 v[72:75], v[12:15], v[32:39], v2
    v_smfmac_f32_16x16x64_bf16 v[76:79], v[12:15], v[40:47], v2
    s_waitcnt lgkmcnt(2)
    v_smfmac_f32_16x16x64_bf16 v[48:51], v[16:19], a[16:23], v2
    ds_read_b128 v[32:35], v0 offset:34816
    v_smfmac_f32_16x16x64_bf16 v[56:59], v[16:19], a[160:167], v2
    ds_read_b128 v[36:39], v0 offset:35840
    v_smfmac_f32_16x16x64_bf16 v[52:55], v[16:19], a[24:31], v2
    ds_read_b128 v[40:43], v0 offset:49152
    buffer_load_dwordx4 v[28:31], v0, s[8:11], s52 offen offset:1024 sc1
    v_smfmac_f32_16x16x64_bf16 v[60:63], v[16:19], a[168:175], v2
    ds_read_b128 v[44:47], v0 offset:50176
    v_smfmac_f32_16x16x64_bf16 v[72:75], v[16:19], v[64:71], v2
    buffer_load_dword v8, v11, s[8:11], s80 offen offset:0 sc1
    buffer_load_dwordx4 v[64:67], v0, s[8:11], s61 offen sc1
    s_waitcnt lgkmcnt(2)
    v_smfmac_f32_16x16x64_bf16 v[76:79], v[16:19], v[32:39], v2
    ds_read_b128 v[32:35], v0 offset:51200
    s_waitcnt lgkmcnt(6)
    v_smfmac_f32_16x16x64_bf16 v[48:51], v[20:23], a[32:39], v2
    ds_read_b128 v[36:39], v0 offset:52224
    v_smfmac_f32_16x16x64_bf16 v[56:59], v[20:23], a[176:183], v2
    v_smfmac_f32_16x16x64_bf16 v[52:55], v[20:23], a[40:47], v2
    buffer_load_dwordx4 v[68:71], v0, s[8:11], s61 offen offset:1024 sc1
    v_smfmac_f32_16x16x64_bf16 v[60:63], v[20:23], a[184:191], v2
    s_waitcnt vmcnt(4)
    v_max3_u32 v9, v28, v29, v30
    s_waitcnt lgkmcnt(2)
    v_smfmac_f32_16x16x64_bf16 v[72:75], v[20:23], v[40:47], v2
    v_max3_u32 v9, v9, v31, v8
    s_waitcnt lgkmcnt(0)
    v_smfmac_f32_16x16x64_bf16 v[76:79], v[20:23], v[32:39], v2
    v_cmp_eq_u32 vcc, -1, v9
    ds_write_b128 v0, v[28:31] offset:1024
    s_waitcnt lgkmcnt(7)
    v_smfmac_f32_16x16x64_bf16 v[48:51], v[24:27], a[48:55], v2
    ds_write_b32 v11, v8 offset:8192
    buffer_load_dwordx4 v[12:15], v0, s[8:11], s61 offen offset:2048 sc1
    v_smfmac_f32_16x16x64_bf16 v[56:59], v[24:27], a[192:199], v2
    v_smfmac_f32_16x16x64_bf16 v[52:55], v[24:27], a[56:63], v2
    s_cbranch_vccnz L_retry2_f0
L_back2_f0_go:
    v_smfmac_f32_16x16x64_bf16 v[60:63], v[24:27], a[200:207], v2
    s_waitcnt lgkmcnt(0)
    s_barrier
    ds_read_b128 v[32:35], v0 offset:3072
    v_smfmac_f32_16x16x64_bf16 v[48:51], v[28:31], a[64:71], v2
    ds_read_b128 v[36:39], v0 offset:5120
    buffer_load_dwordx4 v[16:19], v0, s[8:11], s61 offen offset:3072 sc1
    v_smfmac_f32_16x16x64_bf16 v[56:59], v[28:31], a[208:215], v2
    ds_read_b128 v[40:43], v0 offset:7168
    v_smfmac_f32_16x16x64_bf16 v[52:55], v[28:31], a[72:79], v2
    ds_read_b128 v[44:47], v0 offset:8192
    v_smfmac_f32_16x16x64_bf16 v[60:63], v[28:31], a[216:223], v2
    s_waitcnt lgkmcnt(3)
    v_smfmac_f32_16x16x64_bf16 v[48:51], v[32:35], a[80:87], v2
    v_smfmac_f32_16x16x64_bf16 v[56:59], v[32:35], a[224:231], v2
    v_smfmac_f32_16x16x64_bf16 v[52:55], v[32:35], a[88:95], v2
    buffer_load_dword v7, v7, s[8:11], s82 offen sc1
    v_smfmac_f32_16x16x64_bf16 v[60:63], v[32:35], a[232:239], v2
    s_waitcnt lgkmcnt(2)
    v_smfmac_f32_16x16x64_bf16 v[48:51], v[36:39], a[96:103], v2
    v_smfmac_f32_16x16x64_bf16 v[56:59], v[36:39], a[240:247], v2
    s_waitcnt vmcnt(2)
    v_smfmac_f32_16x16x64_bf16 v[52:55], v[36:39], a[104:111], v2
    v_smfmac_f32_16x16x64_bf16 v[60:63], v[36:39], a[248:255], v2
    s_waitcnt lgkmcnt(1)
    v_smfmac_f32_16x16x64_bf16 v[48:51], v[40:43], a[112:119], v2
    v_smfmac_f32_16x16x64_bf16 v[56:59], v[40:43], v[80:87], v2
    v_smfmac_f32_16x16x64_bf16 v[52:55], v[40:43], a[120:127], v2
    v_smfmac_f32_16x16x64_bf16 v[60:63], v[40:43], v[88:95], v2
    s_waitcnt lgkmcnt(0)
    v_smfmac_f32_16x16x64_bf16 v[48:51], v[44:47], a[128:135], v2
    v_smfmac_f32_16x16x64_bf16 v[56:59], v[44:47], v[96:103], v2
    v_smfmac_f32_16x16x64_bf16 v[52:55], v[44:47], a[136:143], v2
    s_waitcnt vmcnt(3)
    v_smfmac_f32_16x16x64_bf16 v[60:63], v[44:47], v[104:111], v2
    v_add_f32 v48, v48, v50
    v_add_f32 v49, v49, v51
    v_add_f32 v56, v56, v58
    v_add_f32 v57, v57, v59
    v_cvt_pk_bf16_f32 v50, v48, v49
    v_cvt_pk_bf16_f32 v51, v56, v57
    v_add_f32 v52, v52, v54
    v_add_f32 v53, v53, v55
    v_mfma_f32_16x16x16_bf16 v[56:59], v[50:51], v[4:5], 0
    v_add_f32 v60, v60, v62
    v_add_f32 v61, v61, v63
    v_cvt_pk_bf16_f32 v54, v52, v53
    v_cvt_pk_bf16_f32 v55, v60, v61
    v_smfmac_f32_16x16x64_bf16 v[72:75], v[24:27], v[112:119], v2
    v_mfma_f32_16x16x16_bf16 v[60:63], v[54:55], v[4:5], 0
    v_cvt_pk_bf16_f32 v48, v56, v57
    v_cvt_pk_bf16_f32 v49, v58, v59
    v_add_u32 v8, 65536, v0
    v_smfmac_f32_16x16x64_bf16 v[76:79], v[24:27], v[120:127], v2
    v_mov_b32 v9, 0
    v_mov_b32 v9, 0
    v_cvt_pk_bf16_f32 v50, v60, v61
    v_cvt_pk_bf16_f32 v51, v62, v63
    v_mov_b32 v9, 0
    v_mov_b32 v9, 0
    v_mfma_f32_16x16x32_bf16 v[60:63], v[68:71], v[48:51], 0
    v_mfma_f32_16x16x32_bf16 v[56:59], v[64:67], v[48:51], 0
    v_mfma_f32_16x16x32_bf16 v[52:55], v[48:51], v[48:51], 0
    s_cmp_ge_u32 s7, 63
    s_cbranch_scc1 L_chain_last0
    v_smfmac_f32_16x16x64_bf16 v[72:75], v[28:31], v[128:135], v2
    v_mov_b32_dpp v56, v60 row_ror:8 row_mask:0xf bank_mask:0xc
    v_mov_b32_dpp v57, v61 row_ror:8 row_mask:0xf bank_mask:0xc
    v_mov_b32_dpp v58, v62 row_ror:8 row_mask:0xf bank_mask:0xc
    v_mov_b32_dpp v59, v63 row_ror:8 row_mask:0xf bank_mask:0xc
    ds_write_b128 v0, v[56:59] offset:9216
    ds_write_b128 v10, v[52:55]
    v_smfmac_f32_16x16x64_bf16 v[76:79], v[28:31], v[136:143], v2
    buffer_store_dwordx4 v[48:51], v0, s[8:11], s63 offen sc1
    v_smfmac_f32_16x16x64_bf16 v[72:75], v[32:35], v[144:151], v2
    v_smfmac_f32_16x16x64_bf16 v[76:79], v[32:35], v[152:159], v2
    v_smfmac_f32_16x16x64_bf16 v[72:75], v[36:39], v[160:167], v2
    s_waitcnt lgkmcnt(0)
    s_barrier
    ds_read_b128 v[48:51], v0 offset:10240
    ds_read_b128 v[52:55], v0 offset:11264
    v_smfmac_f32_16x16x64_bf16 v[76:79], v[36:39], v[168:175], v2
    ds_read_b128 v[60:63], v0 offset:12288
    ds_read2_b32 v[64:65], v3 offset0:0 offset1:32
    v_smfmac_f32_16x16x64_bf16 v[72:75], v[40:43], v[176:183], v2
    ds_read2_b32 v[66:67], v3 offset0:128 offset1:160
    v_smfmac_f32_16x16x64_bf16 v[76:79], v[40:43], v[184:191], v2
    v_smfmac_f32_16x16x64_bf16 v[72:75], v[44:47], v[192:199], v2
    v_smfmac_f32_16x16x64_bf16 v[76:79], v[44:47], v[200:207], v2
    s_waitcnt lgkmcnt(4)
    v_add_f32 v56, v56, v48
    v_add_f32 v57, v57, v49
    v_add_f32 v58, v58, v50
    v_add_f32 v59, v59, v51
    s_waitcnt lgkmcnt(2)
    v_pk_add_f32 v[52:53], v[52:53], v[60:61]
    v_pk_add_f32 v[54:55], v[54:55], v[62:63]
    s_waitcnt lgkmcnt(0)
    v_pk_add_f32 v[64:65], v[64:65], v[66:67]
    v_pk_add_f32 v[56:57], v[56:57], v[52:53]
    v_pk_add_f32 v[58:59], v[58:59], v[54:55]
    v_add_f32 v64, v64, v65
    v_max3_f32 v68, v56, v57, v58
    v_max3_f32 v68, v68, v59, v64
    v_pk_add_f32 v[72:73], v[72:73], v[74:75]
    v_pk_add_f32 v[76:77], v[76:77], v[78:79]
    v_max_f32_dpp v69, v68, v68 row_ror:8 row_mask:0xf bank_mask:0xf
    v_max_f32_dpp v68, v68, v68 row_ror:8 row_mask:0xf bank_mask:0xf
    v_cvt_pk_bf16_f32 v74, v72, v73
    v_cvt_pk_bf16_f32 v75, v76, v77
    v_permlane16_swap_b32 v68, v69
    v_max_f32 v65, v68, v69
    v_max_f32 v69, v68, v69
    v_mov_b32 v49, 0
    v_mov_b32 v50, 0
    v_permlane32_swap_b32 v65, v69
    v_max_f32 v68, v65, v69
    v_mul_f32 v68, s75, v68
    v_fma_f32 v56, v56, s74, v68
    v_fma_f32 v57, v57, s74, v68
    v_fma_f32 v58, v58, s74, v68
    v_fma_f32 v59, v59, s74, v68
    v_fma_f32 v64, v64, s74, v68
    v_exp_f32 v56, v56
    v_exp_f32 v57, v57
    v_exp_f32 v58, v58
    v_exp_f32 v59, v59
    v_exp_f32_e64 v64, v64
    v_cvt_pk_bf16_f32 v60, v56, v57
    v_cvt_pk_bf16_f32 v61, v58, v59
    v_cndmask_b32 v52, 0, v60, s[70:71]
    v_cndmask_b32 v53, 0, v61, s[70:71]
    v_cndmask_b32 v54, v60, 0, s[70:71]
    v_cndmask_b32 v55, v61, 0, s[70:71]
    v_pk_add_f32 v[66:67], v[56:57], v[58:59]
    s_waitcnt vmcnt(2)
    v_mfma_f32_16x16x32_bf16 v[60:63], v[12:15], v[52:55], 0
    v_cvt_pk_bf16_f32 v72, v64, 0
    v_cvt_pk_bf16_f32 v73, 0, v64
    v_mfma_f32_16x16x32_bf16 v[68:71], v[16:19], v[52:55], 0
    v_cndmask_b32 v48, v73, v72, s[70:71]
    v_cndmask_b32 v51, v73, v72, s[70:71]
    v_add_f32 v65, v66, v67
    v_mfma_f32_16x16x16_bf16 v[60:63], v[74:75], v[48:49], v[60:63]
    v_add_f32_e64 v65, v65, v64
    ds_read_b128 v[20:23], v8 offset:0
    ds_read_b128 v[24:27], v8 offset:1024
    v_mfma_f32_16x16x16_bf16 v[68:71], v[74:75], v[50:51], v[68:71]
    v_add_f32_dpp v66, v65, v65 row_ror:8 row_mask:0xf bank_mask:0xf
    v_add_f32_dpp v65, v65, v65 row_ror:8 row_mask:0xf bank_mask:0xf
    ds_read_b128 v[28:31], v8 offset:2048
    ds_read_b128 v[32:35], v8 offset:3072
    v_permlane16_swap_b32 v65, v66
    v_add_f32 v64, v65, v66
    v_add_f32_e64 v65, v65, v66
    v_add_f32_dpp v56, v60, v60 row_ror:8 row_mask:0xf bank_mask:0x3
    v_add_f32_dpp v57, v61, v61 row_ror:8 row_mask:0xf bank_mask:0x3
    v_permlane32_swap_b32_e64 v64, v65
    v_add_f32_dpp v58, v62, v62 row_ror:8 row_mask:0xf bank_mask:0x3
    v_add_f32_dpp v59, v63, v63 row_ror:8 row_mask:0xf bank_mask:0x3
    v_add_f32 v64, v65, v64
    v_rcp_f32 v64, v64
    v_add_f32_dpp v56, v68, v68 row_ror:8 row_mask:0xf bank_mask:0xc
    v_add_f32_dpp v57, v69, v69 row_ror:8 row_mask:0xf bank_mask:0xc
    v_add_f32_dpp v58, v70, v70 row_ror:8 row_mask:0xf bank_mask:0xc
    v_add_f32_dpp v59, v71, v71 row_ror:8 row_mask:0xf bank_mask:0xc
    v_pk_mul_f32 v[56:57], v[56:57], v[64:65] op_sel_hi:[1,0]
    v_pk_mul_f32 v[58:59], v[58:59], v[64:65] op_sel_hi:[1,0]
    v_cvt_pk_bf16_f32 v78, v56, v57
    v_cvt_pk_bf16_f32 v79, v58, v59
    ds_write_b64 v6, v[78:79] offset:0
    v_mov_b64 v[48:49], 0
    v_mov_b64 v[50:51], 0
    ds_read_b128 v[36:39], v8 offset:16384
    v_mov_b64 v[52:53], 0
    v_mov_b64 v[54:55], 0
    v_lshlrev_b32 v76, 1, v11
    v_mov_b64 v[56:57], 0
    v_mov_b64 v[58:59], 0
    v_mov_b64 v[60:61], 0
    v_mov_b64 v[62:63], 0
    v_mov_b64 v[44:45], 0
    v_mov_b64 v[46:47], 0
    v_mov_b32 v9, 0
    v_mov_b32_e64 v9, 0
    s_waitcnt lgkmcnt(1)
    s_barrier
    ds_read_b128 v[12:15], v0 offset:0
    v_mov_b64_e64 v[64:65], 0
    ds_read_b128 v[16:19], v0 offset:1024
    v_mov_b64 v[66:67], 0
    v_mov_b64 v[68:69], 0
    v_mov_b64 v[70:71], 0
    v_mov_b64 v[72:73], 0
    ds_read_b128 v[40:43], v8 offset:17408
    v_mov_b64 v[78:79], 0
    v_mov_b32_e64 v9, 0
    s_waitcnt lgkmcnt(1)
    v_smfmac_f32_16x16x64_bf16 v[48:51], v[12:15], v[20:27], v2
    s_add_u32 s7, s7, 1
    ds_read_b128 v[20:23], v8 offset:18432
    v_smfmac_f32_16x16x64_bf16 v[48:51], v[16:19], v[28:35], v2
    s_add_u32 s92, s53, s93
    ds_read_b128 v[24:27], v8 offset:19456
    ds_read_b128 v[28:31], v8 offset:32768
    ds_write_b64 v76, v[74:75] offset:14336
    v_mov_b64 v[74:75], 0
    v_mov_b64_e64 v[76:77], 0
    s_waitcnt lgkmcnt(4)
    v_smfmac_f32_16x16x64_bf16 v[52:55], v[12:15], v[36:43], v2
    s_add_u32 s67, s54, s93
    ds_read_b128 v[32:35], v8 offset:33792
    ds_read_b128 v[36:39], v8 offset:34816
    s_waitcnt lgkmcnt(4)
    v_smfmac_f32_16x16x64_bf16 v[52:55], v[16:19], v[20:27], v2
    s_mov_b32 s68, s60
    ds_read_b128 v[40:43], v8 offset:35840
    ds_read_b128 v[20:23], v8 offset:49152
    v_add_f32 v48, v48, v50
    v_add_f32_e64 v49, v49, v51
    v_smfmac_f32_16x16x64_bf16 v[56:59], v[12:15], v[208:215], v2
    s_mov_b32 s54, s53
    ds_read_b128 v[24:27], v8 offset:50176
    v_cvt_pk_bf16_f32 v48, v48, v49
    v_and_or_b32 v48, v48, -2, s60
    v_smfmac_f32_16x16x64_bf16 v[56:59], v[16:19], v[216:223], v2
    buffer_store_dword v48, v11, s[8:11], s83 offen offset:0
    s_add_u32 s52, s53, 0
    v_add_f32 v52, v52, v54
    v_add_f32_e64 v53, v53, v55
    s_waitcnt lgkmcnt(4)
    v_smfmac_f32_16x16x64_bf16 v[60:63], v[12:15], v[28:35], v2
    s_add_u32 s80, s53, 8192
    ds_read_b128 v[28:31], v8 offset:51200
    v_cvt_pk_bf16_f32 v52, v52, v53
    v_and_or_b32 v52, v52, -2, s60
    s_waitcnt lgkmcnt(3)
    v_smfmac_f32_16x16x64_bf16 v[60:63], v[16:19], v[36:43], v2
    buffer_store_dword v52, v11, s[8:11], s83 offen offset:1024
    s_add_u32 s53, s53, 9216
    ds_read_b128 v[32:35], v8 offset:52224
    v_add_u32 v8, 65536, v8
    ds_read_b128 v[36:39], v8 offset:0
    v_add_f32 v56, v56, v58
    v_add_f32 v57, v57, v59
    s_waitcnt lgkmcnt(3)
    v_smfmac_f32_16x16x64_bf16 v[64:67], v[12:15], v[20:27], v2
    s_cmp_eq_u32 s53, 420864
    s_cselect_b32 s53, 393216, s53
    ds_read_b128 v[40:43], v8 offset:1024
    ds_read_b128 v[20:23], v8 offset:2048
    v_cvt_pk_bf16_f32 v56, v56, v57
    v_and_or_b32 v56, v56, -2, s60
    s_waitcnt lgkmcnt(3)
    v_smfmac_f32_16x16x64_bf16 v[64:67], v[16:19], v[28:35], v2
    buffer_store_dword v56, v11, s[8:11], s83 offen offset:2048
    s_add_u32 s61, s61, 524288
    ds_read_b128 v[24:27], v8 offset:3072
    ds_read_b128 v[28:31], v8 offset:16384
    v_add_f32 v60, v60, v62
    v_add_f32_e64 v61, v61, v63
    v_smfmac_f32_16x16x64_bf16 v[68:71], v[12:15], v[224:231], v2
    s_add_u32 s63, s63, 131072
    ds_read_b128 v[32:35], v8 offset:17408
    v_cvt_pk_bf16_f32 v60, v60, v61
    v_and_or_b32 v60, v60, -2, s60
    v_smfmac_f32_16x16x64_bf16 v[68:71], v[16:19], v[232:239], v2
    buffer_store_dword v60, v11, s[8:11], s83 offen offset:3072
    s_sub_u32 s62, s64, 0
    v_add_f32 v64, v64, v66
    v_add_f32 v65, v65, v67
    s_waitcnt lgkmcnt(4)
    v_smfmac_f32_16x16x64_bf16 v[72:75], v[12:15], v[36:43], v2
    s_add_u32 s64, s64, 65536
    ds_read_b128 v[36:39], v8 offset:18432
    v_cvt_pk_bf16_f32 v64, v64, v65
    v_and_or_b32 v64, v64, -2, s60
    s_waitcnt lgkmcnt(3)
    v_smfmac_f32_16x16x64_bf16 v[72:75], v[16:19], v[20:27], v2
    buffer_store_dword v64, v11, s[8:11], s77 offen offset:0
    s_add_u32 s69, s7, 3
    s_min_u32 s69, s69, 64
    ds_read_b128 v[40:43], v8 offset:19456
    v_add_f32 v68, v68, v70
    v_add_f32_e64 v69, v69, v71
    v_smfmac_f32_16x16x64_bf16 v[76:79], v[12:15], v[240:247], v2
    s_mov_b32 s79, 524288
    v_cvt_pk_bf16_f32 v68, v68, v69
    v_and_or_b32 v68, v68, -2, s60
    v_smfmac_f32_16x16x64_bf16 v[76:79], v[16:19], v[248:255], v2
    buffer_store_dword v68, v11, s[8:11], s77 offen offset:1024
    v_add_f32 v72, v72, v74
    v_add_f32_e64 v73, v73, v75
    s_waitcnt lgkmcnt(2)
    v_smfmac_f32_16x16x64_bf16 v[44:47], v[12:15], v[28:35], v2
    v_cvt_pk_bf16_f32 v72, v72, v73
    v_and_or_b32 v72, v72, -2, s60
    s_waitcnt lgkmcnt(0)
    v_smfmac_f32_16x16x64_bf16 v[44:47], v[16:19], v[36:43], v2
    buffer_store_dword v72, v11, s[8:11], s77 offen offset:2048
    v_add_f32 v76, v76, v78
    v_add_f32_e64 v77, v77, v79
    v_cvt_pk_bf16_f32 v76, v76, v77
    v_and_or_b32 v76, v76, -2, s60
    buffer_store_dword v76, v11, s[8:11], s77 offen offset:3072
    v_mov_b32 v9, 0
    v_mov_b32 v9, 0
    v_add_f32 v44, v44, v46
    v_add_f32 v45, v45, v47
    v_cvt_pk_bf16_f32 v44, v44, v45
    v_and_or_b32 v44, v44, -2, s60
    buffer_store_dword v44, v11, s[8:11], s91 offen offset:0
    s_xor_b32 s60, s60, 1
    s_nop 3
    s_nop 3
    buffer_load_dwordx4 v[48:51], v1, s[8:11], s56 offen sc1
    buffer_load_dwordx4 v[52:55], v1, s[8:11], s57 offen sc1
    buffer_load_dwordx4 v[56:59], v1, s[8:11], s58 offen sc1
    buffer_load_dwordx4 v[60:63], v1, s[8:11], s59 offen sc1
    v_and_b32 v34, 16, v0
    v_mov_b32 v35, 0x3f80
    v_lshlrev_b32_e64 v35, v34, v35
    v_cndmask_b32 v64, 0, v35, s[40:41]
    v_cndmask_b32 v65, 0, v35, s[42:43]
    v_cndmask_b32 v66, 0, v35, s[44:45]
    v_cndmask_b32 v67, 0, v35, s[46:47]
    v_bfe_u32 v33, v0, 5, 2
    v_lshl_add_u32 v33, v33, 2, v34
    v_bfe_u32 v34, v0, 8, 1
    v_lshl_add_u32 v33, v34, 6, v33
    v_lshrrev_b32_e64 v34, 9, v0
    v_lshl_add_u32 v33, v34, 5, v33
    v_mov_b32 v36, -1
    v_mov_b64 v[72:73], 0
    v_mov_b64 v[74:75], 0
    v_mov_b64 v[76:77], 0
    v_mov_b64 v[78:79], 0
    s_waitcnt vmcnt(14)
    v_min_u32_dpp v7, v7, v7 quad_perm:[1,0,3,2] row_mask:0xf bank_mask:0xf
    s_nop 1
    v_min_u32_dpp v7, v7, v7 quad_perm:[2,3,0,1] row_mask:0xf bank_mask:0xf
    s_nop 1
    v_min_u32_dpp v7, v7, v7 row_half_mirror row_mask:0xf bank_mask:0xf
    s_nop 1
    v_readfirstlane_b32 s66, v7
    v_bfe_u32 v7, v0, 6, 1
    v_mul_u32_u24 v7, 4080, v7
    v_and_or_b32 v9, v11, 28, 0
    v_add_u32_e64 v7, v7, v9
    buffer_load_dwordx4 v[16:19], v1, s[8:11], s56 offen sc1
    buffer_load_dwordx4 v[20:23], v1, s[8:11], s57 offen sc1
    buffer_load_dwordx4 v[24:27], v1, s[8:11], s58 offen sc1
    buffer_load_dwordx4 v[28:31], v1, s[8:11], s59 offen sc1
L_redp_91:
    s_waitcnt vmcnt(6)
    v_bitop3_b32 v34, v48, v52, s68 bitop3:0x7e
    v_mfma_f32_16x16x32_bf16 v[68:71], v[48:51], v[64:67], 0
    v_mfma_f32_16x16x32_bf16 v[68:71], v[52:55], v[64:67], v[68:71]
    s_waitcnt vmcnt(4)
    v_bitop3_b32 v35, v56, v60, s68 bitop3:0x7e
    v_bitop3_b32 v34, v34, v35, 1 bitop3:0xa8
    v_cmp_ne_u32_e64 vcc, 0, v34
    v_mfma_f32_16x16x32_bf16 v[68:71], v[56:59], v[64:67], v[68:71]
    v_mfma_f32_16x16x32_bf16 v[68:71], v[60:63], v[64:67], v[68:71]
    s_cbranch_vccnz L_redr_93
    v_mov_b32 v9, 0
    v_mov_b32 v9, 0
    v_mov_b32 v9, 0
    v_mov_b32 v9, 0
    v_mov_b32 v9, 0
    v_mov_b32 v9, 0
    v_mov_b32 v9, 0
    v_permlane32_swap_b32 v68, v70
    v_permlane32_swap_b32 v69, v71
    v_pk_add_f32 v[68:69], v[68:69], v[70:71]
    v_cvt_pk_bf16_f32 v68, v68, v69
    v_min_u32_e64 v68, -2, v68
    buffer_store_dword v68, v33, s[8:11], s92 offen
    buffer_store_dword v36, v33, s[8:11], s67 offen
L_red_done_90:
    s_barrier
    s_nop 3
    s_nop 3
    s_nop 3
    s_nop 3
    s_nop 3
    s_nop 3
    s_nop 3
    s_nop 3
    s_nop 3
    s_nop 3
    s_nop 3
    s_nop 3
    s_nop 3
    s_nop 3
    s_nop 3
    s_nop 3
    s_nop 3
    s_cmp_ge_u32 s66, s69
    s_cbranch_scc1 L_poll_f0
    s_cmp_ge_u32 s66, s69
    s_cbranch_scc1 L_kvd_96
    s_mov_b32 s79, 524288
L_kv_95:
    v_mov_b32 v76, 4096
    buffer_load_dwordx4 v[72:75], off, s[8:11], s82 sc1
    buffer_load_dwordx4 v[76:79], v76, s[8:11], s82 offen sc1
    s_waitcnt vmcnt(0)
    v_min3_u32 v72, v72, v73, v74
    v_min3_u32 v72, v72, v75, v76
    v_min3_u32 v72, v72, v77, v78
    v_min_u32 v72, v72, v79
    s_nop 0
    v_readfirstlane_b32 s66, v72
    v_mov_b64 v[72:73], 0
    v_mov_b64 v[74:75], 0
    v_mov_b64 v[76:77], 0
    v_mov_b64_e64 v[78:79], 0
    s_cmp_ge_u32 s66, s69
    s_cbranch_scc1 L_kvd_96
    s_sub_u32 s79, s79, 1
    s_cbranch_scc1 L_fail
    s_branch L_kv_95
L_kvd_96:
    s_mov_b32 s79, 524288
    s_waitcnt vmcnt(0)
    s_branch L_poll_f0
L_redr_93:
    buffer_load_dwordx4 v[48:51], v1, s[8:11], s56 offen sc1
    buffer_load_dwordx4 v[52:55], v1, s[8:11], s57 offen sc1
    buffer_load_dwordx4 v[56:59], v1, s[8:11], s58 offen sc1
    buffer_load_dwordx4 v[60:63], v1, s[8:11], s59 offen sc1
L_redp_92:
    s_waitcnt vmcnt(6)
    v_bitop3_b32 v34, v16, v20, s68 bitop3:0x7e
    v_mfma_f32_16x16x32_bf16 v[68:71], v[16:19], v[64:67], 0
    v_mfma_f32_16x16x32_bf16 v[68:71], v[20:23], v[64:67], v[68:71]
    s_waitcnt vmcnt(4)
    v_bitop3_b32 v35, v24, v28, s68 bitop3:0x7e
    v_bitop3_b32 v34, v34, v35, 1 bitop3:0xa8
    v_cmp_ne_u32_e64 vcc, 0, v34
    v_mfma_f32_16x16x32_bf16 v[68:71], v[24:27], v[64:67], v[68:71]
    v_mfma_f32_16x16x32_bf16 v[68:71], v[28:31], v[64:67], v[68:71]
    s_cbranch_vccnz L_redr_94
    v_mov_b32 v9, 0
    v_mov_b32 v9, 0
    v_mov_b32 v9, 0
    v_mov_b32 v9, 0
    v_mov_b32 v9, 0
    v_mov_b32 v9, 0
    v_mov_b32 v9, 0
    v_permlane32_swap_b32 v68, v70
    v_permlane32_swap_b32 v69, v71
    v_pk_add_f32 v[68:69], v[68:69], v[70:71]
    v_cvt_pk_bf16_f32 v68, v68, v69
    v_min_u32_e64 v68, -2, v68
    buffer_store_dword v68, v33, s[8:11], s92 offen
    buffer_store_dword v36, v33, s[8:11], s67 offen
    s_branch L_red_done_90
L_redr_94:
    buffer_load_dwordx4 v[16:19], v1, s[8:11], s56 offen sc1
    buffer_load_dwordx4 v[20:23], v1, s[8:11], s57 offen sc1
    buffer_load_dwordx4 v[24:27], v1, s[8:11], s58 offen sc1
    buffer_load_dwordx4 v[28:31], v1, s[8:11], s59 offen sc1
    s_sub_u32 s79, s79, 1
    s_cbranch_scc1 L_fail
    s_branch L_redp_91
L_retry2_f0:
    s_waitcnt vmcnt(3)
    v_max3_u32 v9, v28, v29, v30
    v_max3_u32 v9, v9, v31, v8
    v_cmp_eq_u32 vcc, -1, v9
    ds_write_b128 v0, v[28:31] offset:1024
    ds_write_b32 v11, v8 offset:8192
    s_cbranch_vccz L_retry2_f0_ok
    buffer_load_dwordx4 v[28:31], v0, s[8:11], s52 offen offset:1024 sc1
    buffer_load_dword v8, v11, s[8:11], s80 offen offset:0 sc1
L_retry2_f0_l:
    buffer_load_dwordx4 v[28:31], v0, s[8:11], s52 offen offset:1024 sc1
    buffer_load_dword v8, v11, s[8:11], s80 offen offset:0 sc1
    s_waitcnt vmcnt(2)
    v_max3_u32 v9, v28, v29, v30
    v_max3_u32 v9, v9, v31, v8
    v_cmp_eq_u32_e64 vcc, -1, v9
    ds_write_b128 v0, v[28:31] offset:1024
    ds_write_b32 v11, v8 offset:8192
    s_sub_u32 s79, s79, 1
    s_cbranch_scc1 L_fail
    s_cbranch_vccnz L_retry2_f0_l
L_retry2_f0_ok:
    s_branch L_back2_f0_go
L_wave1:
    v_lshrrev_b32 v11, 2, v0
    v_lshrrev_b32 v60, 7, v0
    v_mul_u32_u24 v60, 9344, v60
    v_and_b32 v1, 0x70, v0
    v_add_u32_e64 v1, v1, v60
    s_mov_b32 s40, 0x3030303
    s_mov_b32 s41, 0x3030303
    s_mov_b32 s42, 0xc0c0c0c
    s_mov_b32 s43, 0xc0c0c0c
    s_mov_b32 s44, 0x30303030
    s_mov_b32 s45, 0x30303030
    s_mov_b32 s46, 0xc0c0c0c0
    s_mov_b32 s47, 0xc0c0c0c0
    v_mov_b64 v[72:73], 0
    v_mov_b64 v[74:75], 0
    v_mov_b64 v[76:77], 0
    v_mov_b64 v[78:79], 0
    v_bfe_u32 v7, v0, 6, 1
    v_mul_u32_u24 v7, 4080, v7
    v_and_or_b32 v9, v11, 28, 0
    v_add_u32 v7, v7, v9
    v_mov_b32 v24, -1
    v_mov_b32 v27, -1
    s_mov_b32 s67, 0
    s_cmp_eq_u32 s6, 0
    s_cbranch_scc1 L_poll_s1
L_poll_f1:
    buffer_load_dwordx4 v[12:15], v0, s[8:11], s52 offen sc1
L_poll_f1_2:
    s_waitcnt vmcnt(3)
    ds_read_b128 v[32:35], v0 offset:20480
    ds_read_b128 v[36:39], v0 offset:21504
    ds_read_b128 v[40:43], v0 offset:22528
    ds_read_b128 v[44:47], v0 offset:23552
    ds_read_b128 v[64:67], v0 offset:36864
    ds_read_b128 v[68:71], v0 offset:37888
    v_mov_b64 v[48:49], 0
    v_mov_b64 v[50:51], 0
    v_mov_b64 v[52:53], 0
    v_mov_b64 v[54:55], 0
    v_mov_b64 v[56:57], 0
    v_mov_b64 v[58:59], 0
    v_mov_b64 v[60:61], 0
    v_mov_b64_e64 v[62:63], 0
L_retry_f1:
    buffer_load_dwordx4 v[12:15], v0, s[8:11], s52 offen sc1
    s_waitcnt vmcnt(1)
L_step_f1:
    v_max3_u32 v9, v12, v13, v14
    v_max_u32 v9, v9, v15
    v_cmp_eq_u32_e64 vcc, -1, v9
    ds_write_b128 v0, v[12:15] offset:2048
    s_sub_u32 s79, s79, 1
    s_cbranch_scc1 L_fail
    s_cbranch_vccnz L_retry_f1
    v_smfmac_f32_16x16x64_bf16 v[48:51], v[12:15], a[0:7], v2
    buffer_load_dwordx4 v[28:31], v0, s[8:11], s52 offen offset:1024 sc1
    v_smfmac_f32_16x16x64_bf16 v[56:59], v[12:15], a[144:151], v2
    v_smfmac_f32_16x16x64_bf16 v[52:55], v[12:15], a[8:15], v2
    s_waitcnt lgkmcnt(0)
    s_barrier
    ds_read_b128 v[16:19], v0 offset:0
    ds_read_b128 v[20:23], v0 offset:6144
    buffer_load_dword v8, v11, s[8:11], s80 offen offset:256 sc1
    v_smfmac_f32_16x16x64_bf16 v[60:63], v[12:15], a[152:159], v2
    ds_read_b128 v[24:27], v0 offset:4096
    v_smfmac_f32_16x16x64_bf16 v[72:75], v[12:15], v[32:39], v2
    v_smfmac_f32_16x16x64_bf16 v[76:79], v[12:15], v[40:47], v2
    s_waitcnt lgkmcnt(2)
    v_smfmac_f32_16x16x64_bf16 v[48:51], v[16:19], a[16:23], v2
    ds_read_b128 v[32:35], v0 offset:38912
    v_smfmac_f32_16x16x64_bf16 v[56:59], v[16:19], a[160:167], v2
    ds_read_b128 v[36:39], v0 offset:39936
    v_smfmac_f32_16x16x64_bf16 v[52:55], v[16:19], a[24:31], v2
    ds_read_b128 v[40:43], v0 offset:53248
    buffer_load_dwordx4 v[28:31], v0, s[8:11], s52 offen offset:1024 sc1
    v_smfmac_f32_16x16x64_bf16 v[60:63], v[16:19], a[168:175], v2
    ds_read_b128 v[44:47], v0 offset:54272
    v_smfmac_f32_16x16x64_bf16 v[72:75], v[16:19], v[64:71], v2
    buffer_load_dword v8, v11, s[8:11], s80 offen offset:256 sc1
    s_waitcnt lgkmcnt(2)
    v_smfmac_f32_16x16x64_bf16 v[76:79], v[16:19], v[32:39], v2
    ds_read_b128 v[32:35], v0 offset:55296
    buffer_load_dwordx4 v[64:67], v0, s[8:11], s61 offen sc1
    s_waitcnt lgkmcnt(6)
    v_smfmac_f32_16x16x64_bf16 v[48:51], v[20:23], a[32:39], v2
    ds_read_b128 v[36:39], v0 offset:56320
    v_smfmac_f32_16x16x64_bf16 v[56:59], v[20:23], a[176:183], v2
    v_smfmac_f32_16x16x64_bf16 v[52:55], v[20:23], a[40:47], v2
    v_smfmac_f32_16x16x64_bf16 v[60:63], v[20:23], a[184:191], v2
    buffer_load_dwordx4 v[68:71], v0, s[8:11], s61 offen offset:1024 sc1
    s_waitcnt vmcnt(4)
    v_max3_u32 v9, v28, v29, v30
    s_waitcnt lgkmcnt(2)
    v_smfmac_f32_16x16x64_bf16 v[72:75], v[20:23], v[40:47], v2
    v_max3_u32 v9, v9, v31, v8
    s_waitcnt lgkmcnt(0)
    v_smfmac_f32_16x16x64_bf16 v[76:79], v[20:23], v[32:39], v2
    v_cmp_eq_u32 vcc, -1, v9
    ds_write_b128 v0, v[28:31] offset:3072
    s_waitcnt lgkmcnt(7)
    v_smfmac_f32_16x16x64_bf16 v[48:51], v[24:27], a[48:55], v2
    ds_write_b32 v11, v8 offset:8448
    v_smfmac_f32_16x16x64_bf16 v[56:59], v[24:27], a[192:199], v2
    buffer_load_dwordx4 v[12:15], v0, s[8:11], s61 offen offset:2048 sc1
    v_smfmac_f32_16x16x64_bf16 v[52:55], v[24:27], a[56:63], v2
    s_cbranch_vccnz L_retry2_f1
L_back2_f1_go:
    v_smfmac_f32_16x16x64_bf16 v[60:63], v[24:27], a[200:207], v2
    s_waitcnt lgkmcnt(0)
    s_barrier
    ds_read_b128 v[32:35], v0 offset:1024
    v_smfmac_f32_16x16x64_bf16 v[48:51], v[28:31], a[64:71], v2
    ds_read_b128 v[36:39], v0 offset:7168
    v_smfmac_f32_16x16x64_bf16 v[56:59], v[28:31], a[208:215], v2
    ds_read_b128 v[40:43], v0 offset:5120
    buffer_load_dwordx4 v[16:19], v0, s[8:11], s61 offen offset:3072 sc1
    v_smfmac_f32_16x16x64_bf16 v[52:55], v[28:31], a[72:79], v2
    ds_read_b128 v[44:47], v0 offset:8192
    v_smfmac_f32_16x16x64_bf16 v[60:63], v[28:31], a[216:223], v2
    s_waitcnt lgkmcnt(3)
    v_smfmac_f32_16x16x64_bf16 v[48:51], v[32:35], a[80:87], v2
    v_smfmac_f32_16x16x64_bf16 v[56:59], v[32:35], a[224:231], v2
    v_smfmac_f32_16x16x64_bf16 v[52:55], v[32:35], a[88:95], v2
    v_smfmac_f32_16x16x64_bf16 v[60:63], v[32:35], a[232:239], v2
    buffer_load_dword v7, v7, s[8:11], s82 offen sc1
    s_waitcnt lgkmcnt(2)
    v_smfmac_f32_16x16x64_bf16 v[48:51], v[36:39], a[96:103], v2
    v_smfmac_f32_16x16x64_bf16 v[56:59], v[36:39], a[240:247], v2
    s_waitcnt vmcnt(2)
    v_smfmac_f32_16x16x64_bf16 v[52:55], v[36:39], a[104:111], v2
    v_smfmac_f32_16x16x64_bf16 v[60:63], v[36:39], a[248:255], v2
    s_waitcnt lgkmcnt(1)
    v_smfmac_f32_16x16x64_bf16 v[48:51], v[40:43], a[112:119], v2
    v_smfmac_f32_16x16x64_bf16 v[56:59], v[40:43], v[80:87], v2
    v_smfmac_f32_16x16x64_bf16 v[52:55], v[40:43], a[120:127], v2
    v_smfmac_f32_16x16x64_bf16 v[60:63], v[40:43], v[88:95], v2
    s_waitcnt lgkmcnt(0)
    v_smfmac_f32_16x16x64_bf16 v[48:51], v[44:47], a[128:135], v2
    v_smfmac_f32_16x16x64_bf16 v[56:59], v[44:47], v[96:103], v2
    v_smfmac_f32_16x16x64_bf16 v[52:55], v[44:47], a[136:143], v2
    s_waitcnt vmcnt(3)
    v_smfmac_f32_16x16x64_bf16 v[60:63], v[44:47], v[104:111], v2
    v_add_f32 v48, v48, v50
    v_add_f32 v49, v49, v51
    v_add_f32 v56, v56, v58
    v_add_f32 v57, v57, v59
    v_cvt_pk_bf16_f32 v50, v48, v49
    v_cvt_pk_bf16_f32 v51, v56, v57
    v_add_f32 v52, v52, v54
    v_add_f32 v53, v53, v55
    v_mfma_f32_16x16x16_bf16 v[56:59], v[50:51], v[4:5], 0
    v_add_f32 v60, v60, v62
    v_add_f32 v61, v61, v63
    v_cvt_pk_bf16_f32 v54, v52, v53
    v_cvt_pk_bf16_f32 v55, v60, v61
    v_smfmac_f32_16x16x64_bf16 v[72:75], v[24:27], v[112:119], v2
    v_mfma_f32_16x16x16_bf16 v[60:63], v[54:55], v[4:5], 0
    v_cvt_pk_bf16_f32 v48, v56, v57
    v_cvt_pk_bf16_f32 v49, v58, v59
    v_add_u32 v8, 69632, v0
    v_smfmac_f32_16x16x64_bf16 v[76:79], v[24:27], v[120:127], v2
    v_mov_b32 v9, 0
    v_mov_b32 v9, 0
    v_cvt_pk_bf16_f32 v50, v60, v61
    v_cvt_pk_bf16_f32 v51, v62, v63
    v_mov_b32 v9, 0
    v_mov_b32 v9, 0
    v_mfma_f32_16x16x32_bf16 v[60:63], v[68:71], v[48:51], 0
    v_mfma_f32_16x16x32_bf16 v[56:59], v[64:67], v[48:51], 0
    v_mfma_f32_16x16x32_bf16 v[52:55], v[48:51], v[48:51], 0
    s_cmp_ge_u32 s7, 63
    s_cbranch_scc1 L_chain_last1
    v_smfmac_f32_16x16x64_bf16 v[72:75], v[28:31], v[128:135], v2
    v_mov_b32_dpp v56, v60 row_ror:8 row_mask:0xf bank_mask:0xc
    v_mov_b32_dpp v57, v61 row_ror:8 row_mask:0xf bank_mask:0xc
    v_mov_b32_dpp v58, v62 row_ror:8 row_mask:0xf bank_mask:0xc
    v_mov_b32_dpp v59, v63 row_ror:8 row_mask:0xf bank_mask:0xc
    ds_write_b128 v0, v[56:59] offset:10240
    ds_write_b128 v10, v[52:55]
    v_smfmac_f32_16x16x64_bf16 v[76:79], v[28:31], v[136:143], v2
    buffer_store_dwordx4 v[48:51], v0, s[8:11], s63 offen sc1
    v_smfmac_f32_16x16x64_bf16 v[72:75], v[32:35], v[144:151], v2
    v_smfmac_f32_16x16x64_bf16 v[76:79], v[32:35], v[152:159], v2
    v_smfmac_f32_16x16x64_bf16 v[72:75], v[36:39], v[160:167], v2
    s_waitcnt lgkmcnt(0)
    s_barrier
    ds_read_b128 v[48:51], v0 offset:9216
    ds_read_b128 v[52:55], v0 offset:12288
    v_smfmac_f32_16x16x64_bf16 v[76:79], v[36:39], v[168:175], v2
    ds_read_b128 v[60:63], v0 offset:11264
    ds_read2_b32 v[64:65], v3 offset0:0 offset1:32
    v_smfmac_f32_16x16x64_bf16 v[72:75], v[40:43], v[176:183], v2
    ds_read2_b32 v[66:67], v3 offset0:128 offset1:160
    v_smfmac_f32_16x16x64_bf16 v[76:79], v[40:43], v[184:191], v2
    v_smfmac_f32_16x16x64_bf16 v[72:75], v[44:47], v[192:199], v2
    v_smfmac_f32_16x16x64_bf16 v[76:79], v[44:47], v[200:207], v2
    s_waitcnt lgkmcnt(4)
    v_add_f32 v56, v56, v48
    v_add_f32 v57, v57, v49
    v_add_f32 v58, v58, v50
    v_add_f32 v59, v59, v51
    s_waitcnt lgkmcnt(2)
    v_pk_add_f32 v[52:53], v[52:53], v[60:61]
    v_pk_add_f32 v[54:55], v[54:55], v[62:63]
    s_waitcnt lgkmcnt(0)
    v_pk_add_f32 v[64:65], v[64:65], v[66:67]
    v_pk_add_f32 v[56:57], v[56:57], v[52:53]
    v_pk_add_f32 v[58:59], v[58:59], v[54:55]
    v_add_f32 v64, v64, v65
    v_max3_f32 v68, v56, v57, v58
    v_max3_f32 v68, v68, v59, v64
    v_pk_add_f32 v[72:73], v[72:73], v[74:75]
    v_pk_add_f32 v[76:77], v[76:77], v[78:79]
    v_max_f32_dpp v69, v68, v68 row_ror:8 row_mask:0xf bank_mask:0xf
    v_max_f32_dpp v68, v68, v68 row_ror:8 row_mask:0xf bank_mask:0xf
    v_cvt_pk_bf16_f32 v74, v72, v73
    v_cvt_pk_bf16_f32 v75, v76, v77
    v_permlane16_swap_b32 v68, v69
    v_max_f32 v65, v68, v69
    v_max_f32 v69, v68, v69
    v_mov_b32 v49, 0
    v_mov_b32 v50, 0
    v_permlane32_swap_b32 v65, v69
    v_max_f32 v68, v65, v69
    v_mul_f32 v68, s75, v68
    v_fma_f32 v56, v56, s74, v68
    v_fma_f32 v57, v57, s74, v68
    v_fma_f32 v58, v58, s74, v68
    v_fma_f32 v59, v59, s74, v68
    v_fma_f32 v64, v64, s74, v68
    v_exp_f32 v56, v56
    v_exp_f32 v57, v57
    v_exp_f32 v58, v58
    v_exp_f32 v59, v59
    v_exp_f32_e64 v64, v64
    v_cvt_pk_bf16_f32 v60, v56, v57
    v_cvt_pk_bf16_f32 v61, v58, v59
    v_cndmask_b32 v52, 0, v60, s[70:71]
    v_cndmask_b32 v53, 0, v61, s[70:71]
    v_cndmask_b32 v54, v60, 0, s[70:71]
    v_cndmask_b32 v55, v61, 0, s[70:71]
    v_pk_add_f32 v[66:67], v[56:57], v[58:59]
    s_waitcnt vmcnt(2)
    v_mfma_f32_16x16x32_bf16 v[60:63], v[12:15], v[52:55], 0
    v_cvt_pk_bf16_f32 v72, v64, 0
    v_cvt_pk_bf16_f32 v73, 0, v64
    v_mfma_f32_16x16x32_bf16 v[68:71], v[16:19], v[52:55], 0
    v_cndmask_b32 v48, v73, v72, s[70:71]
    v_cndmask_b32 v51, v73, v72, s[70:71]
    v_add_f32 v65, v66, v67
    v_mfma_f32_16x16x16_bf16 v[60:63], v[74:75], v[48:49], v[60:63]
    v_add_f32_e64 v65, v65, v64
    ds_read_b128 v[20:23], v8 offset:0
    ds_read_b128 v[24:27], v8 offset:1024
    v_mfma_f32_16x16x16_bf16 v[68:71], v[74:75], v[50:51], v[68:71]
    v_add_f32_dpp v66, v65, v65 row_ror:8 row_mask:0xf bank_mask:0xf
    v_add_f32_dpp v65, v65, v65 row_ror:8 row_mask:0xf bank_mask:0xf
    ds_read_b128 v[28:31], v8 offset:2048
    ds_read_b128 v[32:35], v8 offset:3072
    v_permlane16_swap_b32 v65, v66
    v_add_f32 v64, v65, v66
    v_add_f32_e64 v65, v65, v66
    v_add_f32_dpp v56, v60, v60 row_ror:8 row_mask:0xf bank_mask:0x3
    v_add_f32_dpp v57, v61, v61 row_ror:8 row_mask:0xf bank_mask:0x3
    v_permlane32_swap_b32_e64 v64, v65
    v_add_f32_dpp v58, v62, v62 row_ror:8 row_mask:0xf bank_mask:0x3
    v_add_f32_dpp v59, v63, v63 row_ror:8 row_mask:0xf bank_mask:0x3
    v_add_f32 v64, v65, v64
    v_rcp_f32 v64, v64
    v_add_f32_dpp v56, v68, v68 row_ror:8 row_mask:0xf bank_mask:0xc
    v_add_f32_dpp v57, v69, v69 row_ror:8 row_mask:0xf bank_mask:0xc
    v_add_f32_dpp v58, v70, v70 row_ror:8 row_mask:0xf bank_mask:0xc
    v_add_f32_dpp v59, v71, v71 row_ror:8 row_mask:0xf bank_mask:0xc
    v_pk_mul_f32 v[56:57], v[56:57], v[64:65] op_sel_hi:[1,0]
    v_pk_mul_f32 v[58:59], v[58:59], v[64:65] op_sel_hi:[1,0]
    v_cvt_pk_bf16_f32 v78, v56, v57
    v_cvt_pk_bf16_f32 v79, v58, v59
    ds_write_b64 v6, v[78:79] offset:0
    v_mov_b64 v[48:49], 0
    v_mov_b64 v[50:51], 0
    ds_read_b128 v[36:39], v8 offset:16384
    v_mov_b64 v[52:53], 0
    v_mov_b64 v[54:55], 0
    v_lshlrev_b32 v76, 1, v11
    v_mov_b64 v[56:57], 0
    v_mov_b64 v[58:59], 0
    v_mov_b64 v[60:61], 0
    v_mov_b64 v[62:63], 0
    v_mov_b64 v[44:45], 0
    v_mov_b64 v[46:47], 0
    v_mov_b32 v9, 0
    v_mov_b32_e64 v9, 0
    s_waitcnt lgkmcnt(1)
    s_barrier
    ds_read_b128 v[12:15], v0 offset:0
    v_mov_b64_e64 v[64:65], 0
    ds_read_b128 v[16:19], v0 offset:1024
    v_mov_b64 v[66:67], 0
    v_mov_b64 v[68:69], 0
    v_mov_b64 v[70:71], 0
    v_mov_b64 v[72:73], 0
    ds_read_b128 v[40:43], v8 offset:17408
    v_mov_b64 v[78:79], 0
    v_mov_b32_e64 v9, 0
    s_waitcnt lgkmcnt(1)
    v_smfmac_f32_16x16x64_bf16 v[48:51], v[12:15], v[20:27], v2
    s_add_u32 s7, s7, 1
    ds_read_b128 v[20:23], v8 offset:18432
    v_smfmac_f32_16x16x64_bf16 v[48:51], v[16:19], v[28:35], v2
    s_add_u32 s92, s53, s93
    ds_read_b128 v[24:27], v8 offset:19456
    ds_read_b128 v[28:31], v8 offset:32768
    ds_write_b64 v76, v[74:75] offset:14848
    v_mov_b64 v[74:75], 0
    v_mov_b64_e64 v[76:77], 0
    s_waitcnt lgkmcnt(4)
    v_smfmac_f32_16x16x64_bf16 v[52:55], v[12:15], v[36:43], v2
    s_add_u32 s67, s54, s93
    ds_read_b128 v[32:35], v8 offset:33792
    ds_read_b128 v[36:39], v8 offset:34816
    s_waitcnt lgkmcnt(4)
    v_smfmac_f32_16x16x64_bf16 v[52:55], v[16:19], v[20:27], v2
    s_mov_b32 s68, s60
    ds_read_b128 v[40:43], v8 offset:35840
    ds_read_b128 v[20:23], v8 offset:49152
    v_add_f32 v48, v48, v50
    v_add_f32_e64 v49, v49, v51
    v_smfmac_f32_16x16x64_bf16 v[56:59], v[12:15], v[208:215], v2
    s_mov_b32 s54, s53
    ds_read_b128 v[24:27], v8 offset:50176
    v_cvt_pk_bf16_f32 v48, v48, v49
    v_and_or_b32 v48, v48, -2, s60
    v_smfmac_f32_16x16x64_bf16 v[56:59], v[16:19], v[216:223], v2
    buffer_store_dword v48, v11, s[8:11], s83 offen offset:0
    s_add_u32 s52, s53, 2048
    v_add_f32 v52, v52, v54
    v_add_f32 v53, v53, v55
    s_waitcnt lgkmcnt(4)
    v_smfmac_f32_16x16x64_bf16 v[60:63], v[12:15], v[28:35], v2
    s_add_u32 s80, s53, 8192
    ds_read_b128 v[28:31], v8 offset:51200
    v_cvt_pk_bf16_f32 v52, v52, v53
    v_and_or_b32 v52, v52, -2, s60
    s_waitcnt lgkmcnt(3)
    v_smfmac_f32_16x16x64_bf16 v[60:63], v[16:19], v[36:43], v2
    buffer_store_dword v52, v11, s[8:11], s83 offen offset:1024
    s_add_u32 s53, s53, 9216
    ds_read_b128 v[32:35], v8 offset:52224
    v_add_u32 v8, 65536, v8
    ds_read_b128 v[36:39], v8 offset:0
    v_add_f32 v56, v56, v58
    v_add_f32 v57, v57, v59
    s_waitcnt lgkmcnt(3)
    v_smfmac_f32_16x16x64_bf16 v[64:67], v[12:15], v[20:27], v2
    s_cmp_eq_u32 s53, 420864
    s_cselect_b32 s53, 393216, s53
    ds_read_b128 v[40:43], v8 offset:1024
    ds_read_b128 v[20:23], v8 offset:2048
    v_cvt_pk_bf16_f32 v56, v56, v57
    v_and_or_b32 v56, v56, -2, s60
    s_waitcnt lgkmcnt(3)
    v_smfmac_f32_16x16x64_bf16 v[64:67], v[16:19], v[28:35], v2
    buffer_store_dword v56, v11, s[8:11], s83 offen offset:2048
    s_add_u32 s61, s61, 524288
    ds_read_b128 v[24:27], v8 offset:3072
    ds_read_b128 v[28:31], v8 offset:16384
    v_add_f32 v60, v60, v62
    v_add_f32_e64 v61, v61, v63
    v_smfmac_f32_16x16x64_bf16 v[68:71], v[12:15], v[224:231], v2
    s_add_u32 s63, s63, 131072
    ds_read_b128 v[32:35], v8 offset:17408
    v_cvt_pk_bf16_f32 v60, v60, v61
    v_and_or_b32 v60, v60, -2, s60
    v_smfmac_f32_16x16x64_bf16 v[68:71], v[16:19], v[232:239], v2
    buffer_store_dword v60, v11, s[8:11], s83 offen offset:3072
    s_sub_u32 s62, s64, 512
    v_add_f32 v64, v64, v66
    v_add_f32_e64 v65, v65, v67
    s_waitcnt lgkmcnt(4)
    v_smfmac_f32_16x16x64_bf16 v[72:75], v[12:15], v[36:43], v2
    s_add_u32 s64, s64, 65536
    ds_read_b128 v[36:39], v8 offset:18432
    v_cvt_pk_bf16_f32 v64, v64, v65
    v_and_or_b32 v64, v64, -2, s60
    s_waitcnt lgkmcnt(3)
    v_smfmac_f32_16x16x64_bf16 v[72:75], v[16:19], v[20:27], v2
    buffer_store_dword v64, v11, s[8:11], s77 offen offset:0
    s_add_u32 s69, s7, 3
    s_min_u32 s69, s69, 64
    ds_read_b128 v[40:43], v8 offset:19456
    v_add_f32 v68, v68, v70
    v_add_f32_e64 v69, v69, v71
    v_smfmac_f32_16x16x64_bf16 v[76:79], v[12:15], v[240:247], v2
    s_mov_b32 s79, 524288
    v_cvt_pk_bf16_f32 v68, v68, v69
    v_and_or_b32 v68, v68, -2, s60
    v_smfmac_f32_16x16x64_bf16 v[76:79], v[16:19], v[248:255], v2
    buffer_store_dword v68, v11, s[8:11], s77 offen offset:1024
    v_add_f32 v72, v72, v74
    v_add_f32_e64 v73, v73, v75
    s_waitcnt lgkmcnt(2)
    v_smfmac_f32_16x16x64_bf16 v[44:47], v[12:15], v[28:35], v2
    v_cvt_pk_bf16_f32 v72, v72, v73
    v_and_or_b32 v72, v72, -2, s60
    s_waitcnt lgkmcnt(0)
    v_smfmac_f32_16x16x64_bf16 v[44:47], v[16:19], v[36:43], v2
    buffer_store_dword v72, v11, s[8:11], s77 offen offset:2048
    v_add_f32 v76, v76, v78
    v_add_f32_e64 v77, v77, v79
    v_cvt_pk_bf16_f32 v76, v76, v77
    v_and_or_b32 v76, v76, -2, s60
    buffer_store_dword v76, v11, s[8:11], s77 offen offset:3072
    v_mov_b32 v9, 0
    v_mov_b32 v9, 0
    v_add_f32 v44, v44, v46
    v_add_f32 v45, v45, v47
    v_cvt_pk_bf16_f32 v44, v44, v45
    v_and_or_b32 v44, v44, -2, s60
    buffer_store_dword v44, v11, s[8:11], s91 offen offset:0
    s_xor_b32 s60, s60, 1
    v_and_b32 v34, 16, v0
    v_mov_b32 v35, 0x3f80
    v_lshlrev_b32_e64 v35, v34, v35
    v_cndmask_b32 v64, 0, v35, s[40:41]
    v_cndmask_b32 v65, 0, v35, s[42:43]
    v_cndmask_b32 v66, 0, v35, s[44:45]
    v_cndmask_b32 v67, 0, v35, s[46:47]
    v_bfe_u32 v33, v0, 5, 2
    v_lshl_add_u32 v33, v33, 2, v34
    v_bfe_u32 v34, v0, 8, 1
    v_lshl_add_u32 v33, v34, 6, v33
    v_lshrrev_b32_e64 v34, 9, v0
    v_lshl_add_u32 v33, v34, 5, v33
    v_mov_b32 v36, -1
    v_mov_b64 v[72:73], 0
    v_mov_b64 v[74:75], 0
    v_mov_b64 v[76:77], 0
    v_mov_b64 v[78:79], 0
    s_waitcnt vmcnt(10)
    v_min_u32_dpp v7, v7, v7 quad_perm:[1,0,3,2] row_mask:0xf bank_mask:0xf
    s_nop 1
    v_min_u32_dpp v7, v7, v7 quad_perm:[2,3,0,1] row_mask:0xf bank_mask:0xf
    s_nop 1
    v_min_u32_dpp v7, v7, v7 row_half_mirror row_mask:0xf bank_mask:0xf
    s_nop 1
    v_readfirstlane_b32 s66, v7
    v_bfe_u32 v7, v0, 6, 1
    v_mul_u32_u24 v7, 4080, v7
    v_and_or_b32 v9, v11, 28, 0
    v_add_u32_e64 v7, v7, v9
    s_nop 3
    s_nop 3
    s_nop 3
    s_nop 3
    s_nop 3
    s_nop 3
    s_nop 3
    s_nop 3
    s_nop 3
    s_nop 3
    buffer_load_dwordx4 v[48:51], v1, s[8:11], s56 offen sc1
    buffer_load_dwordx4 v[52:55], v1, s[8:11], s57 offen sc1
    buffer_load_dwordx4 v[56:59], v1, s[8:11], s58 offen sc1
    buffer_load_dwordx4 v[60:63], v1, s[8:11], s59 offen sc1
    s_barrier
L_redp_98:
    s_waitcnt vmcnt(2)
    v_bitop3_b32 v34, v48, v52, s68 bitop3:0x7e
    v_mfma_f32_16x16x32_bf16 v[68:71], v[48:51], v[64:67], 0
    v_mfma_f32_16x16x32_bf16 v[68:71], v[52:55], v[64:67], v[68:71]
    s_waitcnt vmcnt(0)
    v_bitop3_b32 v35, v56, v60, s68 bitop3:0x7e
    v_bitop3_b32 v34, v34, v35, 1 bitop3:0xa8
    v_cmp_ne_u32 vcc, 0, v34
    v_mfma_f32_16x16x32_bf16 v[68:71], v[56:59], v[64:67], v[68:71]
    v_mfma_f32_16x16x32_bf16 v[68:71], v[60:63], v[64:67], v[68:71]
    s_cbranch_vccnz L_redr_99
    v_mov_b32 v9, 0
    v_mov_b32 v9, 0
    v_mov_b32 v9, 0
    v_mov_b32 v9, 0
    v_mov_b32 v9, 0
    v_mov_b32 v9, 0
    v_mov_b32 v9, 0
    v_permlane32_swap_b32 v68, v70
    v_permlane32_swap_b32 v69, v71
    v_pk_add_f32 v[68:69], v[68:69], v[70:71]
    v_cvt_pk_bf16_f32 v68, v68, v69
    v_min_u32_e64 v68, -2, v68
    buffer_store_dword v68, v33, s[8:11], s92 offen
    buffer_store_dword v36, v33, s[8:11], s67 offen
L_red_done_97:
    s_cmp_ge_u32 s66, s69
    s_cbranch_scc1 L_poll_f1
    s_cmp_ge_u32 s66, s69
    s_cbranch_scc1 L_kvd_101
    s_mov_b32 s79, 524288
L_kv_100:
    v_mov_b32 v76, 4096
    buffer_load_dwordx4 v[72:75], off, s[8:11], s82 sc1
    buffer_load_dwordx4 v[76:79], v76, s[8:11], s82 offen sc1
    s_waitcnt vmcnt(0)
    v_min3_u32 v72, v72, v73, v74
    v_min3_u32 v72, v72, v75, v76
    v_min3_u32 v72, v72, v77, v78
    v_min_u32 v72, v72, v79
    s_nop 0
    v_readfirstlane_b32 s66, v72
    v_mov_b64 v[72:73], 0
    v_mov_b64 v[74:75], 0
    v_mov_b64 v[76:77], 0
    v_mov_b64_e64 v[78:79], 0
    s_cmp_ge_u32 s66, s69
    s_cbranch_scc1 L_kvd_101
    s_sub_u32 s79, s79, 1
    s_cbranch_scc1 L_fail
    s_branch L_kv_100
L_kvd_101:
    s_mov_b32 s79, 524288
    s_waitcnt vmcnt(0)
    s_branch L_poll_f1
L_redr_99:
    buffer_load_dwordx4 v[48:51], v1, s[8:11], s56 offen sc1
    buffer_load_dwordx4 v[52:55], v1, s[8:11], s57 offen sc1
    buffer_load_dwordx4 v[56:59], v1, s[8:11], s58 offen sc1
    buffer_load_dwordx4 v[60:63], v1, s[8:11], s59 offen sc1
    s_sub_u32 s79, s79, 1
    s_cbranch_scc1 L_fail
    s_branch L_redp_98
L_retry2_f1:
    s_waitcnt vmcnt(3)
    v_max3_u32 v9, v28, v29, v30
    v_max3_u32 v9, v9, v31, v8
    v_cmp_eq_u32_e64 vcc, -1, v9
    ds_write_b128 v0, v[28:31] offset:3072
    ds_write_b32 v11, v8 offset:8448
    s_cbranch_vccz L_retry2_f1_ok
    buffer_load_dwordx4 v[28:31], v0, s[8:11], s52 offen offset:1024 sc1
    buffer_load_dword v8, v11, s[8:11], s80 offen offset:256 sc1
L_retry2_f1_l:
    buffer_load_dwordx4 v[28:31], v0, s[8:11], s52 offen offset:1024 sc1
    buffer_load_dword v8, v11, s[8:11], s80 offen offset:256 sc1
    s_waitcnt vmcnt(2)
    v_max3_u32 v9, v28, v29, v30
    v_max3_u32 v9, v9, v31, v8
    v_cmp_eq_u32_e64 vcc, -1, v9
    ds_write_b128 v0, v[28:31] offset:3072
    ds_write_b32 v11, v8 offset:8448
    s_sub_u32 s79, s79, 1
    s_cbranch_scc1 L_fail
    s_cbranch_vccnz L_retry2_f1_l
L_retry2_f1_ok:
    s_branch L_back2_f1_go
L_wave2:
    v_lshrrev_b32_e64 v11, 2, v0
    v_bfe_u32 v60, v0, 4, 3
    v_lshrrev_b32_e64 v61, 8, v0
    v_lshl_add_u32 v60, v60, 2, v61
    v_mul_u32_u24 v60, 9344, v60
    v_bfe_u32 v61, v0, 7, 1
    v_lshl_add_u32 v1, v61, 4, v60
    s_mov_b32 s40, 0x3030303
    s_mov_b32 s41, 0x3030303
    s_mov_b32 s42, 0xc0c0c0c
    s_mov_b32 s43, 0xc0c0c0c
    s_mov_b32 s44, 0x30303030
    s_mov_b32 s45, 0x30303030
    s_mov_b32 s46, 0xc0c0c0c0
    s_mov_b32 s47, 0xc0c0c0c0
    v_mov_b64 v[72:73], 0
    v_mov_b64 v[74:75], 0
    v_mov_b64 v[76:77], 0
    v_mov_b64 v[78:79], 0
    v_bfe_u32 v7, v0, 6, 1
    v_mul_u32_u24 v7, 4080, v7
    v_and_or_b32 v9, v11, 28, 0
    v_add_u32 v7, v7, v9
    v_mov_b32 v24, -1
    v_mov_b32 v27, -1
    s_mov_b32 s67, 0
    s_cmp_eq_u32 s6, 0
    s_cbranch_scc1 L_poll_s2
L_poll_f2:
    buffer_load_dwordx4 v[12:15], v0, s[8:11], s52 offen sc1
L_poll_f2_2:
    s_waitcnt vmcnt(3)
    ds_read_b128 v[32:35], v0 offset:24576
    ds_read_b128 v[36:39], v0 offset:25600
    ds_read_b128 v[40:43], v0 offset:26624
    ds_read_b128 v[44:47], v0 offset:27648
    ds_read_b128 v[64:67], v0 offset:40960
    ds_read_b128 v[68:71], v0 offset:41984
    v_mov_b64 v[48:49], 0
    v_mov_b64 v[50:51], 0
    v_mov_b64 v[52:53], 0
    v_mov_b64 v[54:55], 0
    v_mov_b64 v[56:57], 0
    v_mov_b64 v[58:59], 0
    v_mov_b64 v[60:61], 0
    v_mov_b64_e64 v[62:63], 0
L_retry_f2:
    buffer_load_dwordx4 v[12:15], v0, s[8:11], s52 offen sc1
    s_waitcnt vmcnt(1)
L_step_f2:
    v_max3_u32 v9, v12, v13, v14
    v_max_u32 v9, v9, v15
    v_cmp_eq_u32_e64 vcc, -1, v9
    ds_write_b128 v0, v[12:15] offset:4096
    s_sub_u32 s79, s79, 1
    s_cbranch_scc1 L_fail
    s_cbranch_vccnz L_retry_f2
    v_smfmac_f32_16x16x64_bf16 v[48:51], v[12:15], a[0:7], v2
    v_smfmac_f32_16x16x64_bf16 v[56:59], v[12:15], a[144:151], v2
    buffer_load_dwordx4 v[28:31], v0, s[8:11], s52 offen offset:1024 sc1
    v_smfmac_f32_16x16x64_bf16 v[52:55], v[12:15], a[8:15], v2
    s_waitcnt lgkmcnt(0)
    s_barrier
    ds_read_b128 v[16:19], v0 offset:6144
    ds_read_b128 v[20:23], v0 offset:0
    v_smfmac_f32_16x16x64_bf16 v[60:63], v[12:15], a[152:159], v2
    ds_read_b128 v[24:27], v0 offset:2048
    buffer_load_dword v8, v11, s[8:11], s80 offen offset:512 sc1
    v_smfmac_f32_16x16x64_bf16 v[72:75], v[12:15], v[32:39], v2
    v_smfmac_f32_16x16x64_bf16 v[76:79], v[12:15], v[40:47], v2
    s_waitcnt lgkmcnt(2)
    v_smfmac_f32_16x16x64_bf16 v[48:51], v[16:19], a[16:23], v2
    ds_read_b128 v[32:35], v0 offset:43008
    v_smfmac_f32_16x16x64_bf16 v[56:59], v[16:19], a[160:167], v2
    ds_read_b128 v[36:39], v0 offset:44032
    v_smfmac_f32_16x16x64_bf16 v[52:55], v[16:19], a[24:31], v2
    ds_read_b128 v[40:43], v0 offset:57344
    v_smfmac_f32_16x16x64_bf16 v[60:63], v[16:19], a[168:175], v2
    ds_read_b128 v[44:47], v0 offset:58368
    buffer_load_dwordx4 v[28:31], v0, s[8:11], s52 offen offset:1024 sc1
    v_smfmac_f32_16x16x64_bf16 v[72:75], v[16:19], v[64:71], v2
    s_waitcnt lgkmcnt(2)
    v_smfmac_f32_16x16x64_bf16 v[76:79], v[16:19], v[32:39], v2
    ds_read_b128 v[32:35], v0 offset:59392
    buffer_load_dword v8, v11, s[8:11], s80 offen offset:512 sc1
    s_waitcnt lgkmcnt(6)
    v_smfmac_f32_16x16x64_bf16 v[48:51], v[20:23], a[32:39], v2
    ds_read_b128 v[36:39], v0 offset:60416
    buffer_load_dwordx4 v[64:67], v0, s[8:11], s61 offen sc1
    v_smfmac_f32_16x16x64_bf16 v[56:59], v[20:23], a[176:183], v2
    v_smfmac_f32_16x16x64_bf16 v[52:55], v[20:23], a[40:47], v2
    v_smfmac_f32_16x16x64_bf16 v[60:63], v[20:23], a[184:191], v2
    s_waitcnt vmcnt(3)
    v_max3_u32 v9, v28, v29, v30
    s_waitcnt lgkmcnt(2)
    v_smfmac_f32_16x16x64_bf16 v[72:75], v[20:23], v[40:47], v2
    buffer_load_dwordx4 v[68:71], v0, s[8:11], s61 offen offset:1024 sc1
    v_max3_u32 v9, v9, v31, v8
    s_waitcnt lgkmcnt(0)
    v_smfmac_f32_16x16x64_bf16 v[76:79], v[20:23], v[32:39], v2
    v_cmp_eq_u32_e64 vcc, -1, v9
    s_waitcnt lgkmcnt(6)
    v_smfmac_f32_16x16x64_bf16 v[48:51], v[24:27], a[48:55], v2
    ds_write_b128 v0, v[28:31] offset:5120
    v_smfmac_f32_16x16x64_bf16 v[56:59], v[24:27], a[192:199], v2
    ds_write_b32 v11, v8 offset:8704
    v_smfmac_f32_16x16x64_bf16 v[52:55], v[24:27], a[56:63], v2
    s_cbranch_vccnz L_retry2_f2
L_back2_f2_go:
    buffer_load_dwordx4 v[12:15], v0, s[8:11], s61 offen offset:2048 sc1
    v_smfmac_f32_16x16x64_bf16 v[60:63], v[24:27], a[200:207], v2
    s_waitcnt lgkmcnt(0)
    s_barrier
    ds_read_b128 v[32:35], v0 offset:7168
    v_smfmac_f32_16x16x64_bf16 v[48:51], v[28:31], a[64:71], v2
    ds_read_b128 v[36:39], v0 offset:1024
    v_smfmac_f32_16x16x64_bf16 v[56:59], v[28:31], a[208:215], v2
    ds_read_b128 v[40:43], v0 offset:3072
    v_smfmac_f32_16x16x64_bf16 v[52:55], v[28:31], a[72:79], v2
    ds_read_b128 v[44:47], v0 offset:8192
    buffer_load_dwordx4 v[16:19], v0, s[8:11], s61 offen offset:3072 sc1
    v_smfmac_f32_16x16x64_bf16 v[60:63], v[28:31], a[216:223], v2
    s_waitcnt lgkmcnt(3)
    v_smfmac_f32_16x16x64_bf16 v[48:51], v[32:35], a[80:87], v2
    v_smfmac_f32_16x16x64_bf16 v[56:59], v[32:35], a[224:231], v2
    v_smfmac_f32_16x16x64_bf16 v[52:55], v[32:35], a[88:95], v2
    v_smfmac_f32_16x16x64_bf16 v[60:63], v[32:35], a[232:239], v2
    s_waitcnt lgkmcnt(2)
    v_smfmac_f32_16x16x64_bf16 v[48:51], v[36:39], a[96:103], v2
    buffer_load_dword v7, v7, s[8:11], s82 offen sc1
    v_smfmac_f32_16x16x64_bf16 v[56:59], v[36:39], a[240:247], v2
    s_waitcnt vmcnt(3)
    v_smfmac_f32_16x16x64_bf16 v[52:55], v[36:39], a[104:111], v2
    v_smfmac_f32_16x16x64_bf16 v[60:63], v[36:39], a[248:255], v2
    s_waitcnt lgkmcnt(1)
    v_smfmac_f32_16x16x64_bf16 v[48:51], v[40:43], a[112:119], v2
    v_smfmac_f32_16x16x64_bf16 v[56:59], v[40:43], v[80:87], v2
    v_smfmac_f32_16x16x64_bf16 v[52:55], v[40:43], a[120:127], v2
    v_smfmac_f32_16x16x64_bf16 v[60:63], v[40:43], v[88:95], v2
    s_waitcnt lgkmcnt(0)
    v_smfmac_f32_16x16x64_bf16 v[48:51], v[44:47], a[128:135], v2
    v_smfmac_f32_16x16x64_bf16 v[56:59], v[44:47], v[96:103], v2
    v_smfmac_f32_16x16x64_bf16 v[52:55], v[44:47], a[136:143], v2
    s_waitcnt vmcnt(3)
    v_smfmac_f32_16x16x64_bf16 v[60:63], v[44:47], v[104:111], v2
    v_add_f32 v48, v48, v50
    v_add_f32 v49, v49, v51
    v_add_f32 v56, v56, v58
    v_add_f32_e64 v57, v57, v59
    v_cvt_pk_bf16_f32 v50, v48, v49
    v_cvt_pk_bf16_f32 v51, v56, v57
    v_add_f32 v52, v52, v54
    v_add_f32 v53, v53, v55
    v_mfma_f32_16x16x16_bf16 v[56:59], v[50:51], v[4:5], 0
    v_add_f32 v60, v60, v62
    v_add_f32 v61, v61, v63
    v_cvt_pk_bf16_f32 v54, v52, v53
    v_cvt_pk_bf16_f32 v55, v60, v61
    v_smfmac_f32_16x16x64_bf16 v[72:75], v[24:27], v[112:119], v2
    v_mfma_f32_16x16x16_bf16 v[60:63], v[54:55], v[4:5], 0
    v_cvt_pk_bf16_f32 v48, v56, v57
    v_cvt_pk_bf16_f32 v49, v58, v59
    v_add_u32 v8, 73728, v0
    v_smfmac_f32_16x16x64_bf16 v[76:79], v[24:27], v[120:127], v2
    v_mov_b32 v9, 0
    v_mov_b32 v9, 0
    v_cvt_pk_bf16_f32 v50, v60, v61
    v_cvt_pk_bf16_f32 v51, v62, v63
    v_mov_b32 v9, 0
    v_mov_b32 v9, 0
    v_mfma_f32_16x16x32_bf16 v[60:63], v[68:71], v[48:51], 0
    v_mfma_f32_16x16x32_bf16 v[56:59], v[64:67], v[48:51], 0
    v_mfma_f32_16x16x32_bf16 v[52:55], v[48:51], v[48:51], 0
    s_cmp_ge_u32 s7, 63
    s_cbranch_scc1 L_chain_last2
    v_smfmac_f32_16x16x64_bf16 v[72:75], v[28:31], v[128:135], v2
    v_mov_b32_dpp v56, v60 row_ror:8 row_mask:0xf bank_mask:0xc
    v_mov_b32_dpp v57, v61 row_ror:8 row_mask:0xf bank_mask:0xc
    v_mov_b32_dpp v58, v62 row_ror:8 row_mask:0xf bank_mask:0xc
    v_mov_b32_dpp v59, v63 row_ror:8 row_mask:0xf bank_mask:0xc
    ds_write_b128 v0, v[56:59] offset:11264
    ds_write_b128 v10, v[52:55]
    v_smfmac_f32_16x16x64_bf16 v[76:79], v[28:31], v[136:143], v2
    v_smfmac_f32_16x16x64_bf16 v[72:75], v[32:35], v[144:151], v2
    buffer_store_dwordx4 v[48:51], v0, s[8:11], s63 offen sc1
    v_smfmac_f32_16x16x64_bf16 v[76:79], v[32:35], v[152:159], v2
    v_smfmac_f32_16x16x64_bf16 v[72:75], v[36:39], v[160:167], v2
    s_waitcnt lgkmcnt(0)
    s_barrier
    ds_read_b128 v[48:51], v0 offset:12288
    ds_read_b128 v[52:55], v0 offset:9216
    v_smfmac_f32_16x16x64_bf16 v[76:79], v[36:39], v[168:175], v2
    ds_read_b128 v[60:63], v0 offset:10240
    ds_read2_b32 v[64:65], v3 offset0:0 offset1:32
    v_smfmac_f32_16x16x64_bf16 v[72:75], v[40:43], v[176:183], v2
    ds_read2_b32 v[66:67], v3 offset0:128 offset1:160
    v_smfmac_f32_16x16x64_bf16 v[76:79], v[40:43], v[184:191], v2
    v_smfmac_f32_16x16x64_bf16 v[72:75], v[44:47], v[192:199], v2
    v_smfmac_f32_16x16x64_bf16 v[76:79], v[44:47], v[200:207], v2
    s_waitcnt lgkmcnt(4)
    v_add_f32 v56, v56, v48
    v_add_f32 v57, v57, v49
    v_add_f32 v58, v58, v50
    v_add_f32 v59, v59, v51
    s_waitcnt lgkmcnt(2)
    v_pk_add_f32 v[52:53], v[52:53], v[60:61]
    v_pk_add_f32 v[54:55], v[54:55], v[62:63]
    s_waitcnt lgkmcnt(0)
    v_pk_add_f32 v[64:65], v[64:65], v[66:67]
    v_pk_add_f32 v[56:57], v[56:57], v[52:53]
    v_pk_add_f32 v[58:59], v[58:59], v[54:55]
    v_add_f32 v64, v64, v65
    v_max3_f32 v68, v56, v57, v58
    v_max3_f32 v68, v68, v59, v64
    v_pk_add_f32 v[72:73], v[72:73], v[74:75]
    v_pk_add_f32 v[76:77], v[76:77], v[78:79]
    v_max_f32_dpp v69, v68, v68 row_ror:8 row_mask:0xf bank_mask:0xf
    v_max_f32_dpp v68, v68, v68 row_ror:8 row_mask:0xf bank_mask:0xf
    v_cvt_pk_bf16_f32 v74, v72, v73
    v_cvt_pk_bf16_f32 v75, v76, v77
    v_permlane16_swap_b32 v68, v69
    v_max_f32 v65, v68, v69
    v_max_f32 v69, v68, v69
    v_mov_b32 v49, 0
    v_mov_b32 v50, 0
    v_permlane32_swap_b32 v65, v69
    v_max_f32 v68, v65, v69
    v_mul_f32 v68, s75, v68
    v_fma_f32 v56, v56, s74, v68
    v_fma_f32 v57, v57, s74, v68
    v_fma_f32 v58, v58, s74, v68
    v_fma_f32 v59, v59, s74, v68
    v_fma_f32 v64, v64, s74, v68
    v_exp_f32 v56, v56
    v_exp_f32 v57, v57
    v_exp_f32 v58, v58
    v_exp_f32 v59, v59
    v_exp_f32_e64 v64, v64
    v_cvt_pk_bf16_f32 v60, v56, v57
    v_cvt_pk_bf16_f32 v61, v58, v59
    v_cndmask_b32 v52, 0, v60, s[70:71]
    v_cndmask_b32 v53, 0, v61, s[70:71]
    v_cndmask_b32 v54, v60, 0, s[70:71]
    v_cndmask_b32 v55, v61, 0, s[70:71]
    v_pk_add_f32 v[66:67], v[56:57], v[58:59]
    s_waitcnt vmcnt(2)
    v_mfma_f32_16x16x32_bf16 v[60:63], v[12:15], v[52:55], 0
    v_cvt_pk_bf16_f32 v72, v64, 0
    v_cvt_pk_bf16_f32 v73, 0, v64
    v_mfma_f32_16x16x32_bf16 v[68:71], v[16:19], v[52:55], 0
    v_cndmask_b32 v48, v73, v72, s[70:71]
    v_cndmask_b32 v51, v73, v72, s[70:71]
    v_add_f32 v65, v66, v67
    v_mfma_f32_16x16x16_bf16 v[60:63], v[74:75], v[48:49], v[60:63]
    v_add_f32_e64 v65, v65, v64
    ds_read_b128 v[20:23], v8 offset:0
    ds_read_b128 v[24:27], v8 offset:1024
    v_mfma_f32_16x16x16_bf16 v[68:71], v[74:75], v[50:51], v[68:71]
    v_add_f32_dpp v66, v65, v65 row_ror:8 row_mask:0xf bank_mask:0xf
    v_add_f32_dpp v65, v65, v65 row_ror:8 row_mask:0xf bank_mask:0xf
    ds_read_b128 v[28:31], v8 offset:2048
    ds_read_b128 v[32:35], v8 offset:3072
    v_permlane16_swap_b32 v65, v66
    v_add_f32 v64, v65, v66
    v_add_f32_e64 v65, v65, v66
    v_add_f32_dpp v56, v60, v60 row_ror:8 row_mask:0xf bank_mask:0x3
    v_add_f32_dpp v57, v61, v61 row_ror:8 row_mask:0xf bank_mask:0x3
    v_permlane32_swap_b32_e64 v64, v65
    v_add_f32_dpp v58, v62, v62 row_ror:8 row_mask:0xf bank_mask:0x3
    v_add_f32_dpp v59, v63, v63 row_ror:8 row_mask:0xf bank_mask:0x3
    v_add_f32 v64, v65, v64
    v_rcp_f32 v64, v64
    v_add_f32_dpp v56, v68, v68 row_ror:8 row_mask:0xf bank_mask:0xc
    v_add_f32_dpp v57, v69, v69 row_ror:8 row_mask:0xf bank_mask:0xc
    v_add_f32_dpp v58, v70, v70 row_ror:8 row_mask:0xf bank_mask:0xc
    v_add_f32_dpp v59, v71, v71 row_ror:8 row_mask:0xf bank_mask:0xc
    v_pk_mul_f32 v[56:57], v[56:57], v[64:65] op_sel_hi:[1,0]
    v_pk_mul_f32 v[58:59], v[58:59], v[64:65] op_sel_hi:[1,0]
    v_cvt_pk_bf16_f32 v78, v56, v57
    v_cvt_pk_bf16_f32 v79, v58, v59
    ds_write_b64 v6, v[78:79] offset:0
    v_mov_b64 v[48:49], 0
    v_mov_b64 v[50:51], 0
    ds_read_b128 v[36:39], v8 offset:16384
    v_mov_b64 v[52:53], 0
    v_mov_b64 v[54:55], 0
    v_lshlrev_b32 v76, 1, v11
    v_mov_b64 v[56:57], 0
    v_mov_b64 v[58:59], 0
    v_mov_b64 v[60:61], 0
    v_mov_b64 v[62:63], 0
    v_mov_b64 v[44:45], 0
    v_mov_b64 v[46:47], 0
    v_mov_b32 v9, 0
    v_mov_b32_e64 v9, 0
    s_waitcnt lgkmcnt(1)
    s_barrier
    ds_read_b128 v[12:15], v0 offset:0
    v_mov_b64_e64 v[64:65], 0
    ds_read_b128 v[16:19], v0 offset:1024
    v_mov_b64 v[66:67], 0
    v_mov_b64 v[68:69], 0
    v_mov_b64 v[70:71], 0
    v_mov_b64 v[72:73], 0
    ds_read_b128 v[40:43], v8 offset:17408
    v_mov_b64 v[78:79], 0
    v_mov_b32_e64 v9, 0
    s_waitcnt lgkmcnt(1)
    v_smfmac_f32_16x16x64_bf16 v[48:51], v[12:15], v[20:27], v2
    s_add_u32 s7, s7, 1
    ds_read_b128 v[20:23], v8 offset:18432
    v_smfmac_f32_16x16x64_bf16 v[48:51], v[16:19], v[28:35], v2
    s_add_u32 s92, s53, s93
    ds_read_b128 v[24:27], v8 offset:19456
    ds_read_b128 v[28:31], v8 offset:32768
    ds_write_b64 v76, v[74:75] offset:15360
    v_mov_b64 v[74:75], 0
    v_mov_b64_e64 v[76:77], 0
    s_waitcnt lgkmcnt(4)
    v_smfmac_f32_16x16x64_bf16 v[52:55], v[12:15], v[36:43], v2
    s_add_u32 s67, s54, s93
    ds_read_b128 v[32:35], v8 offset:33792
    ds_read_b128 v[36:39], v8 offset:34816
    s_waitcnt lgkmcnt(4)
    v_smfmac_f32_16x16x64_bf16 v[52:55], v[16:19], v[20:27], v2
    s_mov_b32 s68, s60
    ds_read_b128 v[40:43], v8 offset:35840
    ds_read_b128 v[20:23], v8 offset:49152
    v_add_f32 v48, v48, v50
    v_add_f32_e64 v49, v49, v51
    v_smfmac_f32_16x16x64_bf16 v[56:59], v[12:15], v[208:215], v2
    s_mov_b32 s54, s53
    ds_read_b128 v[24:27], v8 offset:50176
    v_cvt_pk_bf16_f32 v48, v48, v49
    v_and_or_b32 v48, v48, -2, s60
    v_smfmac_f32_16x16x64_bf16 v[56:59], v[16:19], v[216:223], v2
    buffer_store_dword v48, v11, s[8:11], s83 offen offset:0
    s_add_u32 s52, s53, 4096
    v_add_f32 v52, v52, v54
    v_add_f32 v53, v53, v55
    s_waitcnt lgkmcnt(4)
    v_smfmac_f32_16x16x64_bf16 v[60:63], v[12:15], v[28:35], v2
    s_add_u32 s80, s53, 8192
    ds_read_b128 v[28:31], v8 offset:51200
    v_cvt_pk_bf16_f32 v52, v52, v53
    v_and_or_b32 v52, v52, -2, s60
    s_waitcnt lgkmcnt(3)
    v_smfmac_f32_16x16x64_bf16 v[60:63], v[16:19], v[36:43], v2
    buffer_store_dword v52, v11, s[8:11], s83 offen offset:1024
    s_add_u32 s53, s53, 9216
    ds_read_b128 v[32:35], v8 offset:52224
    v_add_u32 v8, 65536, v8
    ds_read_b128 v[36:39], v8 offset:0
    v_add_f32 v56, v56, v58
    v_add_f32 v57, v57, v59
    s_waitcnt lgkmcnt(3)
    v_smfmac_f32_16x16x64_bf16 v[64:67], v[12:15], v[20:27], v2
    s_cmp_eq_u32 s53, 420864
    s_cselect_b32 s53, 393216, s53
    ds_read_b128 v[40:43], v8 offset:1024
    ds_read_b128 v[20:23], v8 offset:2048
    v_cvt_pk_bf16_f32 v56, v56, v57
    v_and_or_b32 v56, v56, -2, s60
    s_waitcnt lgkmcnt(3)
    v_smfmac_f32_16x16x64_bf16 v[64:67], v[16:19], v[28:35], v2
    buffer_store_dword v56, v11, s[8:11], s83 offen offset:2048
    s_add_u32 s61, s61, 524288
    ds_read_b128 v[24:27], v8 offset:3072
    ds_read_b128 v[28:31], v8 offset:16384
    v_add_f32 v60, v60, v62
    v_add_f32_e64 v61, v61, v63
    v_smfmac_f32_16x16x64_bf16 v[68:71], v[12:15], v[224:231], v2
    s_add_u32 s63, s63, 131072
    ds_read_b128 v[32:35], v8 offset:17408
    v_cvt_pk_bf16_f32 v60, v60, v61
    v_and_or_b32 v60, v60, -2, s60
    v_smfmac_f32_16x16x64_bf16 v[68:71], v[16:19], v[232:239], v2
    buffer_store_dword v60, v11, s[8:11], s83 offen offset:3072
    s_sub_u32 s62, s64, 1024
    v_add_f32 v64, v64, v66
    v_add_f32_e64 v65, v65, v67
    s_waitcnt lgkmcnt(4)
    v_smfmac_f32_16x16x64_bf16 v[72:75], v[12:15], v[36:43], v2
    s_add_u32 s64, s64, 65536
    ds_read_b128 v[36:39], v8 offset:18432
    v_cvt_pk_bf16_f32 v64, v64, v65
    v_and_or_b32 v64, v64, -2, s60
    s_waitcnt lgkmcnt(3)
    v_smfmac_f32_16x16x64_bf16 v[72:75], v[16:19], v[20:27], v2
    buffer_store_dword v64, v11, s[8:11], s77 offen offset:0
    s_add_u32 s69, s7, 3
    s_min_u32 s69, s69, 64
    ds_read_b128 v[40:43], v8 offset:19456
    v_add_f32 v68, v68, v70
    v_add_f32_e64 v69, v69, v71
    v_smfmac_f32_16x16x64_bf16 v[76:79], v[12:15], v[240:247], v2
    s_mov_b32 s79, 524288
    v_cvt_pk_bf16_f32 v68, v68, v69
    v_and_or_b32 v68, v68, -2, s60
    v_smfmac_f32_16x16x64_bf16 v[76:79], v[16:19], v[248:255], v2
    buffer_store_dword v68, v11, s[8:11], s77 offen offset:1024
    v_add_f32 v72, v72, v74
    v_add_f32_e64 v73, v73, v75
    s_waitcnt lgkmcnt(2)
    v_smfmac_f32_16x16x64_bf16 v[44:47], v[12:15], v[28:35], v2
    v_cvt_pk_bf16_f32 v72, v72, v73
    v_and_or_b32 v72, v72, -2, s60
    s_waitcnt lgkmcnt(0)
    v_smfmac_f32_16x16x64_bf16 v[44:47], v[16:19], v[36:43], v2
    buffer_store_dword v72, v11, s[8:11], s77 offen offset:2048
    v_add_f32 v76, v76, v78
    v_add_f32_e64 v77, v77, v79
    v_cvt_pk_bf16_f32 v76, v76, v77
    v_and_or_b32 v76, v76, -2, s60
    buffer_store_dword v76, v11, s[8:11], s77 offen offset:3072
    v_mov_b32 v9, 0
    v_mov_b32 v9, 0
    v_add_f32 v44, v44, v46
    v_add_f32 v45, v45, v47
    v_cvt_pk_bf16_f32 v44, v44, v45
    v_and_or_b32 v44, v44, -2, s60
    buffer_store_dword v44, v11, s[8:11], s91 offen offset:0
    s_xor_b32 s60, s60, 1
    v_and_b32 v34, 16, v0
    v_mov_b32 v35, 0x3f80
    v_lshlrev_b32_e64 v35, v34, v35
    v_cndmask_b32 v64, 0, v35, s[40:41]
    v_cndmask_b32 v65, 0, v35, s[42:43]
    v_cndmask_b32 v66, 0, v35, s[44:45]
    v_cndmask_b32 v67, 0, v35, s[46:47]
    v_bfe_u32 v33, v0, 5, 2
    v_lshl_add_u32 v33, v33, 2, v34
    v_mov_b32 v36, -1
    v_mov_b64 v[72:73], 0
    v_mov_b64 v[74:75], 0
    v_mov_b64 v[76:77], 0
    v_mov_b64 v[78:79], 0
    s_waitcnt vmcnt(10)
    v_min_u32_dpp v7, v7, v7 quad_perm:[1,0,3,2] row_mask:0xf bank_mask:0xf
    s_nop 1
    v_min_u32_dpp v7, v7, v7 quad_perm:[2,3,0,1] row_mask:0xf bank_mask:0xf
    s_nop 1
    v_min_u32_dpp v7, v7, v7 row_half_mirror row_mask:0xf bank_mask:0xf
    s_nop 1
    v_readfirstlane_b32 s66, v7
    v_bfe_u32 v7, v0, 6, 1
    v_mul_u32_u24 v7, 4080, v7
    v_and_or_b32 v9, v11, 28, 0
    v_add_u32_e64 v7, v7, v9
    s_nop 3
    s_nop 3
    s_nop 3
    s_nop 3
    s_nop 3
    s_nop 3
    s_nop 3
    s_nop 3
    s_nop 3
    s_nop 3
    s_nop 3
    s_nop 3
    buffer_load_dwordx4 v[16:19], v1, s[8:11], s56 offen sc1
    s_nop 3
    s_nop 3
    s_nop 3
    s_nop 3
    s_nop 3
    s_nop 3
    s_nop 3
    s_nop 3
    buffer_load_dwordx4 v[20:23], v1, s[8:11], s56 offen sc1
    s_barrier
L_r9p_103:
    s_waitcnt vmcnt(1)
    v_bitop3_b32 v34, v16, s68, 1 bitop3:0x28
    v_cmp_ne_u32_e64 vcc, 0, v34
    v_mfma_f32_16x16x32_bf16 v[68:71], v[16:19], v[64:67], 0
    v_mov_b32 v9, 0
    v_mov_b32 v9, 0
    v_mov_b32 v9, 0
    s_cbranch_vccnz L_r9r_104
L_r9f_105:
    v_mov_b32 v9, 0
    v_mov_b32 v9, 0
    v_mov_b32 v9, 0
    v_mov_b32 v9, 0
    v_pk_add_f32 v[68:69], v[68:69], v[70:71]
    v_add_f32 v70, v68, v69
    v_add_f32 v68, v68, v69
    v_mov_b32 v9, 0
    v_mov_b32 v9, 0
    v_permlane16_swap_b32 v68, v70
    v_add_f32 v69, v68, v70
    v_add_f32 v68, v68, v70
    v_mov_b32 v9, 0
    v_mov_b32 v9, 0
    v_permlane32_swap_b32 v68, v69
    v_cvt_pk_bf16_f32 v68, v68, v69
    v_min_u32_e64 v68, -2, v68
    buffer_store_dword v68, v33, s[8:11], s92 offen
    buffer_store_dword v36, v33, s[8:11], s67 offen
L_red_done_102:
    s_cmp_ge_u32 s66, s69
    s_cbranch_scc1 L_poll_f2
    s_cmp_ge_u32 s66, s69
    s_cbranch_scc1 L_kvd_107
    s_mov_b32 s79, 524288
L_kv_106:
    v_mov_b32 v76, 4096
    buffer_load_dwordx4 v[72:75], off, s[8:11], s82 sc1
    buffer_load_dwordx4 v[76:79], v76, s[8:11], s82 offen sc1
    s_waitcnt vmcnt(0)
    v_min3_u32 v72, v72, v73, v74
    v_min3_u32 v72, v72, v75, v76
    v_min3_u32 v72, v72, v77, v78
    v_min_u32 v72, v72, v79
    s_nop 0
    v_readfirstlane_b32 s66, v72
    v_mov_b64 v[72:73], 0
    v_mov_b64 v[74:75], 0
    v_mov_b64 v[76:77], 0
    v_mov_b64_e64 v[78:79], 0
    s_cmp_ge_u32 s66, s69
    s_cbranch_scc1 L_kvd_107
    s_sub_u32 s79, s79, 1
    s_cbranch_scc1 L_fail
    s_branch L_kv_106
L_kvd_107:
    s_mov_b32 s79, 524288
    s_waitcnt vmcnt(0)
    s_branch L_poll_f2
L_r9r_104:
    buffer_load_dwordx4 v[16:19], v1, s[8:11], s56 offen sc1
    s_waitcnt vmcnt(1)
    v_bitop3_b32 v34, v20, s68, 1 bitop3:0x28
    v_cmp_ne_u32 vcc, 0, v34
    v_mfma_f32_16x16x32_bf16 v[68:71], v[20:23], v[64:67], 0
    v_mov_b32 v9, 0
    v_mov_b32 v9, 0
    v_mov_b32 v9, 0
    s_cbranch_vccz L_r9f_105
    buffer_load_dwordx4 v[20:23], v1, s[8:11], s56 offen sc1
    s_sub_u32 s79, s79, 1
    s_cbranch_scc1 L_fail
    s_branch L_r9p_103
L_retry2_f2:
    s_waitcnt vmcnt(2)
    v_max3_u32 v9, v28, v29, v30
    v_max3_u32 v9, v9, v31, v8
    v_cmp_eq_u32_e64 vcc, -1, v9
    ds_write_b128 v0, v[28:31] offset:5120
    ds_write_b32 v11, v8 offset:8704
    s_cbranch_vccz L_retry2_f2_ok
    buffer_load_dwordx4 v[28:31], v0, s[8:11], s52 offen offset:1024 sc1
    buffer_load_dword v8, v11, s[8:11], s80 offen offset:512 sc1
L_retry2_f2_l:
    buffer_load_dwordx4 v[28:31], v0, s[8:11], s52 offen offset:1024 sc1
    buffer_load_dword v8, v11, s[8:11], s80 offen offset:512 sc1
    s_waitcnt vmcnt(2)
    v_max3_u32 v9, v28, v29, v30
    v_max3_u32 v9, v9, v31, v8
    v_cmp_eq_u32_e64 vcc, -1, v9
    ds_write_b128 v0, v[28:31] offset:5120
    ds_write_b32 v11, v8 offset:8704
    s_sub_u32 s79, s79, 1
    s_cbranch_scc1 L_fail
    s_cbranch_vccnz L_retry2_f2_l
L_retry2_f2_ok:
    s_branch L_back2_f2_go
L_wave3:
    v_lshrrev_b32 v11, 2, v0
    v_lshlrev_b32 v1, 3, v0
    s_mov_b32 s40, 0x3030303
    s_mov_b32 s41, 0x3030303
    s_mov_b32 s42, 0xc0c0c0c
    s_mov_b32 s43, 0xc0c0c0c
    s_mov_b32 s44, 0x30303030
    s_mov_b32 s45, 0x30303030
    s_mov_b32 s46, 0xc0c0c0c0
    s_mov_b32 s47, 0xc0c0c0c0
    v_mov_b64 v[72:73], 0
    v_mov_b64 v[74:75], 0
    v_mov_b64 v[76:77], 0
    v_mov_b64 v[78:79], 0
    v_bfe_u32 v7, v0, 6, 1
    v_mul_u32_u24 v7, 4080, v7
    v_and_or_b32 v9, v11, 28, 0
    v_add_u32 v7, v7, v9
    v_mov_b32 v24, -1
    v_mov_b32 v27, -1
    s_mov_b32 s67, 0
    s_cmp_eq_u32 s6, 0
    s_cbranch_scc1 L_poll_s3
L_poll_f3:
    buffer_load_dwordx4 v[12:15], v0, s[8:11], s52 offen sc1
L_poll_f3_2:
    s_waitcnt vmcnt(3)
    ds_read_b128 v[32:35], v0 offset:28672
    ds_read_b128 v[36:39], v0 offset:29696
    ds_read_b128 v[40:43], v0 offset:30720
    ds_read_b128 v[44:47], v0 offset:31744
    ds_read_b128 v[64:67], v0 offset:45056
    ds_read_b128 v[68:71], v0 offset:46080
    v_mov_b64 v[48:49], 0
    v_mov_b64 v[50:51], 0
    v_mov_b64 v[52:53], 0
    v_mov_b64 v[54:55], 0
    v_mov_b64 v[56:57], 0
    v_mov_b64 v[58:59], 0
    v_mov_b64 v[60:61], 0
    v_mov_b64_e64 v[62:63], 0
L_retry_f3:
    buffer_load_dwordx4 v[12:15], v0, s[8:11], s52 offen sc1
    s_waitcnt vmcnt(1)
L_step_f3:
    v_max3_u32 v9, v12, v13, v14
    v_max_u32 v9, v9, v15
    v_cmp_eq_u32_e64 vcc, -1, v9
    ds_write_b128 v0, v[12:15] offset:6144
    s_sub_u32 s79, s79, 1
    s_cbranch_scc1 L_fail
    s_cbranch_vccnz L_retry_f3
    v_smfmac_f32_16x16x64_bf16 v[48:51], v[12:15], a[0:7], v2
    v_smfmac_f32_16x16x64_bf16 v[56:59], v[12:15], a[144:151], v2
    buffer_load_dwordx4 v[28:31], v0, s[8:11], s52 offen offset:1024 sc1
    v_smfmac_f32_16x16x64_bf16 v[52:55], v[12:15], a[8:15], v2
    s_waitcnt lgkmcnt(0)
    s_barrier
    ds_read_b128 v[16:19], v0 offset:4096
    ds_read_b128 v[20:23], v0 offset:2048
    v_smfmac_f32_16x16x64_bf16 v[60:63], v[12:15], a[152:159], v2
    ds_read_b128 v[24:27], v0 offset:0
    buffer_load_dword v8, v11, s[8:11], s80 offen offset:768 sc1
    v_smfmac_f32_16x16x64_bf16 v[72:75], v[12:15], v[32:39], v2
    v_smfmac_f32_16x16x64_bf16 v[76:79], v[12:15], v[40:47], v2
    s_waitcnt lgkmcnt(2)
    v_smfmac_f32_16x16x64_bf16 v[48:51], v[16:19], a[16:23], v2
    ds_read_b128 v[32:35], v0 offset:47104
    v_smfmac_f32_16x16x64_bf16 v[56:59], v[16:19], a[160:167], v2
    ds_read_b128 v[36:39], v0 offset:48128
    v_smfmac_f32_16x16x64_bf16 v[52:55], v[16:19], a[24:31], v2
    ds_read_b128 v[40:43], v0 offset:61440
    v_smfmac_f32_16x16x64_bf16 v[60:63], v[16:19], a[168:175], v2
    ds_read_b128 v[44:47], v0 offset:62464
    buffer_load_dwordx4 v[28:31], v0, s[8:11], s52 offen offset:1024 sc1
    v_smfmac_f32_16x16x64_bf16 v[72:75], v[16:19], v[64:71], v2
    s_waitcnt lgkmcnt(2)
    v_smfmac_f32_16x16x64_bf16 v[76:79], v[16:19], v[32:39], v2
    ds_read_b128 v[32:35], v0 offset:63488
    buffer_load_dword v8, v11, s[8:11], s80 offen offset:768 sc1
    s_waitcnt lgkmcnt(6)
    v_smfmac_f32_16x16x64_bf16 v[48:51], v[20:23], a[32:39], v2
    ds_read_b128 v[36:39], v0 offset:64512
    v_smfmac_f32_16x16x64_bf16 v[56:59], v[20:23], a[176:183], v2
    buffer_load_dwordx4 v[64:67], v0, s[8:11], s61 offen sc1
    v_smfmac_f32_16x16x64_bf16 v[52:55], v[20:23], a[40:47], v2
    v_smfmac_f32_16x16x64_bf16 v[60:63], v[20:23], a[184:191], v2
    s_waitcnt vmcnt(3)
    v_max3_u32 v9, v28, v29, v30
    s_waitcnt lgkmcnt(2)
    v_smfmac_f32_16x16x64_bf16 v[72:75], v[20:23], v[40:47], v2
    v_max3_u32 v9, v9, v31, v8
    s_waitcnt lgkmcnt(0)
    v_smfmac_f32_16x16x64_bf16 v[76:79], v[20:23], v[32:39], v2
    buffer_load_dwordx4 v[68:71], v0, s[8:11], s61 offen offset:1024 sc1
    v_cmp_eq_u32_e64 vcc, -1, v9
    s_waitcnt lgkmcnt(6)
    v_smfmac_f32_16x16x64_bf16 v[48:51], v[24:27], a[48:55], v2
    ds_write_b128 v0, v[28:31] offset:7168
    v_smfmac_f32_16x16x64_bf16 v[56:59], v[24:27], a[192:199], v2
    ds_write_b32 v11, v8 offset:8960
    v_smfmac_f32_16x16x64_bf16 v[52:55], v[24:27], a[56:63], v2
    s_cbranch_vccnz L_retry2_f3
L_back2_f3_go:
    v_smfmac_f32_16x16x64_bf16 v[60:63], v[24:27], a[200:207], v2
    s_waitcnt lgkmcnt(0)
    s_barrier
    ds_read_b128 v[32:35], v0 offset:5120
    buffer_load_dwordx4 v[12:15], v0, s[8:11], s61 offen offset:2048 sc1
    v_smfmac_f32_16x16x64_bf16 v[48:51], v[28:31], a[64:71], v2
    ds_read_b128 v[36:39], v0 offset:3072
    v_smfmac_f32_16x16x64_bf16 v[56:59], v[28:31], a[208:215], v2
    ds_read_b128 v[40:43], v0 offset:1024
    v_smfmac_f32_16x16x64_bf16 v[52:55], v[28:31], a[72:79], v2
    ds_read_b128 v[44:47], v0 offset:8192
    v_smfmac_f32_16x16x64_bf16 v[60:63], v[28:31], a[216:223], v2
    buffer_load_dwordx4 v[16:19], v0, s[8:11], s61 offen offset:3072 sc1
    s_waitcnt lgkmcnt(3)
    v_smfmac_f32_16x16x64_bf16 v[48:51], v[32:35], a[80:87], v2
    buffer_load_dword v9, v1, s[8:11], s81 offen sc1
    v_smfmac_f32_16x16x64_bf16 v[56:59], v[32:35], a[224:231], v2
    ds_read_b128 v[20:23], v0 offset:14336
    buffer_load_dword v9, v1, s[8:11], s73 offen sc1
    v_smfmac_f32_16x16x64_bf16 v[52:55], v[32:35], a[88:95], v2
    v_smfmac_f32_16x16x64_bf16 v[60:63], v[32:35], a[232:239], v2
    s_waitcnt lgkmcnt(3)
    v_smfmac_f32_16x16x64_bf16 v[48:51], v[36:39], a[96:103], v2
    v_smfmac_f32_16x16x64_bf16 v[56:59], v[36:39], a[240:247], v2
    s_waitcnt vmcnt(4)
    buffer_load_dword v7, v7, s[8:11], s82 offen sc1
    v_smfmac_f32_16x16x64_bf16 v[52:55], v[36:39], a[104:111], v2
    s_waitcnt lgkmcnt(0)
    buffer_store_dwordx4 v[20:23], v0, s[8:11], s62 offen offset:0 sc1
    v_smfmac_f32_16x16x64_bf16 v[60:63], v[36:39], a[248:255], v2
    ds_read_b128 v[20:23], v0 offset:15360
    s_waitcnt lgkmcnt(3)
    v_smfmac_f32_16x16x64_bf16 v[48:51], v[40:43], a[112:119], v2
    v_smfmac_f32_16x16x64_bf16 v[56:59], v[40:43], v[80:87], v2
    v_smfmac_f32_16x16x64_bf16 v[52:55], v[40:43], a[120:127], v2
    v_smfmac_f32_16x16x64_bf16 v[60:63], v[40:43], v[88:95], v2
    s_waitcnt lgkmcnt(2)
    v_smfmac_f32_16x16x64_bf16 v[48:51], v[44:47], a[128:135], v2
    s_waitcnt lgkmcnt(0)
    buffer_store_dwordx4 v[20:23], v0, s[8:11], s62 offen offset:1024 sc1
    v_smfmac_f32_16x16x64_bf16 v[56:59], v[44:47], v[96:103], v2
    v_mov_b32_e64 v8, s72
    v_smfmac_f32_16x16x64_bf16 v[52:55], v[44:47], a[136:143], v2
    s_mov_b64 exec, 1
    buffer_store_dword v8, off, s[8:11], s65 sc1
    s_mov_b64 exec, -1
    s_waitcnt vmcnt(8)
    v_smfmac_f32_16x16x64_bf16 v[60:63], v[44:47], v[104:111], v2
    v_add_f32 v48, v48, v50
    v_add_f32 v49, v49, v51
    v_add_f32 v56, v56, v58
    v_add_f32_e64 v57, v57, v59
    v_cvt_pk_bf16_f32 v50, v48, v49
    v_cvt_pk_bf16_f32 v51, v56, v57
    v_add_f32 v52, v52, v54
    v_add_f32 v53, v53, v55
    v_mfma_f32_16x16x16_bf16 v[56:59], v[50:51], v[4:5], 0
    v_add_f32 v60, v60, v62
    v_add_f32 v61, v61, v63
    v_cvt_pk_bf16_f32 v54, v52, v53
    v_cvt_pk_bf16_f32 v55, v60, v61
    v_smfmac_f32_16x16x64_bf16 v[72:75], v[24:27], v[112:119], v2
    v_mfma_f32_16x16x16_bf16 v[60:63], v[54:55], v[4:5], 0
    v_cvt_pk_bf16_f32 v48, v56, v57
    v_cvt_pk_bf16_f32 v49, v58, v59
    v_add_u32 v8, 77824, v0
    v_smfmac_f32_16x16x64_bf16 v[76:79], v[24:27], v[120:127], v2
    v_mov_b32 v9, 0
    v_mov_b32 v9, 0
    v_cvt_pk_bf16_f32 v50, v60, v61
    v_cvt_pk_bf16_f32 v51, v62, v63
    v_mov_b32 v9, 0
    v_mov_b32 v9, 0
    v_mfma_f32_16x16x32_bf16 v[60:63], v[68:71], v[48:51], 0
    v_mfma_f32_16x16x32_bf16 v[56:59], v[64:67], v[48:51], 0
    v_mfma_f32_16x16x32_bf16 v[52:55], v[48:51], v[48:51], 0
    s_cmp_ge_u32 s7, 63
    s_cbranch_scc1 L_chain_last3
    v_smfmac_f32_16x16x64_bf16 v[72:75], v[28:31], v[128:135], v2
    v_mov_b32_dpp v56, v60 row_ror:8 row_mask:0xf bank_mask:0xc
    v_mov_b32_dpp v57, v61 row_ror:8 row_mask:0xf bank_mask:0xc
    v_mov_b32_dpp v58, v62 row_ror:8 row_mask:0xf bank_mask:0xc
    v_mov_b32_dpp v59, v63 row_ror:8 row_mask:0xf bank_mask:0xc
    ds_write_b128 v0, v[56:59] offset:12288
    ds_write_b128 v10, v[52:55]
    v_smfmac_f32_16x16x64_bf16 v[76:79], v[28:31], v[136:143], v2
    v_smfmac_f32_16x16x64_bf16 v[72:75], v[32:35], v[144:151], v2
    buffer_store_dwordx4 v[48:51], v0, s[8:11], s63 offen sc1
    v_smfmac_f32_16x16x64_bf16 v[76:79], v[32:35], v[152:159], v2
    v_smfmac_f32_16x16x64_bf16 v[72:75], v[36:39], v[160:167], v2
    s_waitcnt lgkmcnt(0)
    s_barrier
    ds_read_b128 v[48:51], v0 offset:11264
    ds_read_b128 v[52:55], v0 offset:10240
    v_smfmac_f32_16x16x64_bf16 v[76:79], v[36:39], v[168:175], v2
    ds_read_b128 v[60:63], v0 offset:9216
    ds_read2_b32 v[64:65], v3 offset0:0 offset1:32
    v_smfmac_f32_16x16x64_bf16 v[72:75], v[40:43], v[176:183], v2
    ds_read2_b32 v[66:67], v3 offset0:128 offset1:160
    v_smfmac_f32_16x16x64_bf16 v[76:79], v[40:43], v[184:191], v2
    v_smfmac_f32_16x16x64_bf16 v[72:75], v[44:47], v[192:199], v2
    v_smfmac_f32_16x16x64_bf16 v[76:79], v[44:47], v[200:207], v2
    s_waitcnt lgkmcnt(4)
    v_add_f32 v56, v56, v48
    v_add_f32 v57, v57, v49
    v_add_f32 v58, v58, v50
    v_add_f32 v59, v59, v51
    s_waitcnt lgkmcnt(2)
    v_pk_add_f32 v[52:53], v[52:53], v[60:61]
    v_pk_add_f32 v[54:55], v[54:55], v[62:63]
    s_waitcnt lgkmcnt(0)
    v_pk_add_f32 v[64:65], v[64:65], v[66:67]
    v_pk_add_f32 v[56:57], v[56:57], v[52:53]
    v_pk_add_f32 v[58:59], v[58:59], v[54:55]
    v_add_f32 v64, v64, v65
    v_max3_f32 v68, v56, v57, v58
    v_max3_f32 v68, v68, v59, v64
    v_pk_add_f32 v[72:73], v[72:73], v[74:75]
    v_pk_add_f32 v[76:77], v[76:77], v[78:79]
    v_max_f32_dpp v69, v68, v68 row_ror:8 row_mask:0xf bank_mask:0xf
    v_max_f32_dpp v68, v68, v68 row_ror:8 row_mask:0xf bank_mask:0xf
    v_cvt_pk_bf16_f32 v74, v72, v73
    v_cvt_pk_bf16_f32 v75, v76, v77
    v_permlane16_swap_b32 v68, v69
    v_max_f32 v65, v68, v69
    v_max_f32 v69, v68, v69
    v_mov_b32 v49, 0
    v_mov_b32 v50, 0
    v_permlane32_swap_b32 v65, v69
    v_max_f32 v68, v65, v69
    v_mul_f32 v68, s75, v68
    v_fma_f32 v56, v56, s74, v68
    v_fma_f32 v57, v57, s74, v68
    v_fma_f32 v58, v58, s74, v68
    v_fma_f32 v59, v59, s74, v68
    v_fma_f32 v64, v64, s74, v68
    v_exp_f32 v56, v56
    v_exp_f32 v57, v57
    v_exp_f32 v58, v58
    v_exp_f32 v59, v59
    v_exp_f32_e64 v64, v64
    v_cvt_pk_bf16_f32 v60, v56, v57
    v_cvt_pk_bf16_f32 v61, v58, v59
    v_cndmask_b32 v52, 0, v60, s[70:71]
    v_cndmask_b32 v53, 0, v61, s[70:71]
    v_cndmask_b32 v54, v60, 0, s[70:71]
    v_cndmask_b32 v55, v61, 0, s[70:71]
    v_pk_add_f32 v[66:67], v[56:57], v[58:59]
    s_waitcnt vmcnt(7)
    v_mfma_f32_16x16x32_bf16 v[60:63], v[12:15], v[52:55], 0
    v_cvt_pk_bf16_f32 v72, v64, 0
    v_cvt_pk_bf16_f32 v73, 0, v64
    v_mfma_f32_16x16x32_bf16 v[68:71], v[16:19], v[52:55], 0
    v_cndmask_b32 v48, v73, v72, s[70:71]
    v_cndmask_b32 v51, v73, v72, s[70:71]
    v_add_f32 v65, v66, v67
    v_mfma_f32_16x16x16_bf16 v[60:63], v[74:75], v[48:49], v[60:63]
    v_add_f32_e64 v65, v65, v64
    ds_read_b128 v[20:23], v8 offset:0
    ds_read_b128 v[24:27], v8 offset:1024
    v_mfma_f32_16x16x16_bf16 v[68:71], v[74:75], v[50:51], v[68:71]
    v_add_f32_dpp v66, v65, v65 row_ror:8 row_mask:0xf bank_mask:0xf
    v_add_f32_dpp v65, v65, v65 row_ror:8 row_mask:0xf bank_mask:0xf
    ds_read_b128 v[28:31], v8 offset:2048
    ds_read_b128 v[32:35], v8 offset:3072
    v_permlane16_swap_b32 v65, v66
    v_add_f32 v64, v65, v66
    v_add_f32_e64 v65, v65, v66
    v_add_f32_dpp v56, v60, v60 row_ror:8 row_mask:0xf bank_mask:0x3
    v_add_f32_dpp v57, v61, v61 row_ror:8 row_mask:0xf bank_mask:0x3
    v_permlane32_swap_b32_e64 v64, v65
    v_add_f32_dpp v58, v62, v62 row_ror:8 row_mask:0xf bank_mask:0x3
    v_add_f32_dpp v59, v63, v63 row_ror:8 row_mask:0xf bank_mask:0x3
    v_add_f32 v64, v65, v64
    v_rcp_f32 v64, v64
    v_add_f32_dpp v56, v68, v68 row_ror:8 row_mask:0xf bank_mask:0xc
    v_add_f32_dpp v57, v69, v69 row_ror:8 row_mask:0xf bank_mask:0xc
    v_add_f32_dpp v58, v70, v70 row_ror:8 row_mask:0xf bank_mask:0xc
    v_add_f32_dpp v59, v71, v71 row_ror:8 row_mask:0xf bank_mask:0xc
    v_pk_mul_f32 v[56:57], v[56:57], v[64:65] op_sel_hi:[1,0]
    v_pk_mul_f32 v[58:59], v[58:59], v[64:65] op_sel_hi:[1,0]
    v_cvt_pk_bf16_f32 v78, v56, v57
    v_cvt_pk_bf16_f32 v79, v58, v59
    ds_write_b64 v6, v[78:79] offset:0
    v_mov_b64 v[48:49], 0
    v_mov_b64 v[50:51], 0
    ds_read_b128 v[36:39], v8 offset:16384
    v_mov_b64 v[52:53], 0
    v_mov_b64 v[54:55], 0
    v_lshlrev_b32 v76, 1, v11
    v_mov_b64 v[56:57], 0
    v_mov_b64 v[58:59], 0
    v_mov_b64 v[60:61], 0
    v_mov_b64 v[62:63], 0
    v_mov_b64 v[44:45], 0
    v_mov_b64 v[46:47], 0
    v_mov_b32 v9, 0
    v_mov_b32_e64 v9, 0
    s_waitcnt lgkmcnt(1)
    s_barrier
    ds_read_b128 v[12:15], v0 offset:0
    v_mov_b64_e64 v[64:65], 0
    ds_read_b128 v[16:19], v0 offset:1024
    v_mov_b64 v[66:67], 0
    v_mov_b64 v[68:69], 0
    v_mov_b64 v[70:71], 0
    v_mov_b64 v[72:73], 0
    ds_read_b128 v[40:43], v8 offset:17408
    v_mov_b64 v[78:79], 0
    v_mov_b32_e64 v9, 0
    s_waitcnt lgkmcnt(1)
    v_smfmac_f32_16x16x64_bf16 v[48:51], v[12:15], v[20:27], v2
    s_add_u32 s7, s7, 1
    ds_read_b128 v[20:23], v8 offset:18432
    v_smfmac_f32_16x16x64_bf16 v[48:51], v[16:19], v[28:35], v2
    s_add_u32 s92, s53, s93
    ds_read_b128 v[24:27], v8 offset:19456
    ds_read_b128 v[28:31], v8 offset:32768
    ds_write_b64 v76, v[74:75] offset:15872
    v_mov_b64 v[74:75], 0
    v_mov_b64_e64 v[76:77], 0
    s_waitcnt lgkmcnt(4)
    v_smfmac_f32_16x16x64_bf16 v[52:55], v[12:15], v[36:43], v2
    s_add_u32 s67, s54, s93
    ds_read_b128 v[32:35], v8 offset:33792
    ds_read_b128 v[36:39], v8 offset:34816
    s_waitcnt lgkmcnt(4)
    v_smfmac_f32_16x16x64_bf16 v[52:55], v[16:19], v[20:27], v2
    s_mov_b32 s68, s60
    ds_read_b128 v[40:43], v8 offset:35840
    ds_read_b128 v[20:23], v8 offset:49152
    v_add_f32 v48, v48, v50
    v_add_f32_e64 v49, v49, v51
    v_smfmac_f32_16x16x64_bf16 v[56:59], v[12:15], v[208:215], v2
    s_mov_b32 s54, s53
    ds_read_b128 v[24:27], v8 offset:50176
    v_cvt_pk_bf16_f32 v48, v48, v49
    v_and_or_b32 v48, v48, -2, s60
    v_smfmac_f32_16x16x64_bf16 v[56:59], v[16:19], v[216:223], v2
    buffer_store_dword v48, v11, s[8:11], s83 offen offset:0
    s_add_u32 s52, s53, 6144
    v_add_f32 v52, v52, v54
    v_add_f32 v53, v53, v55
    s_waitcnt lgkmcnt(4)
    v_smfmac_f32_16x16x64_bf16 v[60:63], v[12:15], v[28:35], v2
    s_add_u32 s80, s53, 8192
    ds_read_b128 v[28:31], v8 offset:51200
    v_cvt_pk_bf16_f32 v52, v52, v53
    v_and_or_b32 v52, v52, -2, s60
    s_waitcnt lgkmcnt(3)
    v_smfmac_f32_16x16x64_bf16 v[60:63], v[16:19], v[36:43], v2
    buffer_store_dword v52, v11, s[8:11], s83 offen offset:1024
    s_add_u32 s53, s53, 9216
    ds_read_b128 v[32:35], v8 offset:52224
    v_add_u32 v8, 65536, v8
    ds_read_b128 v[36:39], v8 offset:0
    v_add_f32 v56, v56, v58
    v_add_f32 v57, v57, v59
    s_waitcnt lgkmcnt(3)
    v_smfmac_f32_16x16x64_bf16 v[64:67], v[12:15], v[20:27], v2
    s_cmp_eq_u32 s53, 420864
    s_cselect_b32 s53, 393216, s53
    ds_read_b128 v[40:43], v8 offset:1024
    ds_read_b128 v[20:23], v8 offset:2048
    v_cvt_pk_bf16_f32 v56, v56, v57
    v_and_or_b32 v56, v56, -2, s60
    s_waitcnt lgkmcnt(3)
    v_smfmac_f32_16x16x64_bf16 v[64:67], v[16:19], v[28:35], v2
    buffer_store_dword v56, v11, s[8:11], s83 offen offset:2048
    s_add_u32 s61, s61, 524288
    ds_read_b128 v[24:27], v8 offset:3072
    ds_read_b128 v[28:31], v8 offset:16384
    v_add_f32 v60, v60, v62
    v_add_f32_e64 v61, v61, v63
    v_smfmac_f32_16x16x64_bf16 v[68:71], v[12:15], v[224:231], v2
    s_add_u32 s63, s63, 131072
    ds_read_b128 v[32:35], v8 offset:17408
    v_cvt_pk_bf16_f32 v60, v60, v61
    v_and_or_b32 v60, v60, -2, s60
    v_smfmac_f32_16x16x64_bf16 v[68:71], v[16:19], v[232:239], v2
    buffer_store_dword v60, v11, s[8:11], s83 offen offset:3072
    s_sub_u32 s62, s64, 1536
    v_add_f32 v64, v64, v66
    v_add_f32_e64 v65, v65, v67
    s_waitcnt lgkmcnt(4)
    v_smfmac_f32_16x16x64_bf16 v[72:75], v[12:15], v[36:43], v2
    s_add_u32 s64, s64, 65536
    ds_read_b128 v[36:39], v8 offset:18432
    v_cvt_pk_bf16_f32 v64, v64, v65
    v_and_or_b32 v64, v64, -2, s60
    s_waitcnt lgkmcnt(3)
    v_smfmac_f32_16x16x64_bf16 v[72:75], v[16:19], v[20:27], v2
    buffer_store_dword v64, v11, s[8:11], s77 offen offset:0
    s_add_u32 s69, s7, 3
    s_min_u32 s69, s69, 64
    ds_read_b128 v[40:43], v8 offset:19456
    v_add_f32 v68, v68, v70
    v_add_f32_e64 v69, v69, v71
    v_smfmac_f32_16x16x64_bf16 v[76:79], v[12:15], v[240:247], v2
    s_mov_b32 s79, 524288
    v_cvt_pk_bf16_f32 v68, v68, v69
    v_and_or_b32 v68, v68, -2, s60
    v_smfmac_f32_16x16x64_bf16 v[76:79], v[16:19], v[248:255], v2
    buffer_store_dword v68, v11, s[8:11], s77 offen offset:1024
    s_cmp_lt_u32 s7, 62
    s_cselect_b32 s3, 1048576, 0
    s_add_u32 s81, s61, s3
    v_add_f32 v72, v72, v74
    v_add_f32_e64 v73, v73, v75
    s_waitcnt lgkmcnt(2)
    v_smfmac_f32_16x16x64_bf16 v[44:47], v[12:15], v[28:35], v2
    s_sub_u32 s73, s81, 4096
    s_sub_u32 s81, s81, 12288
    v_cvt_pk_bf16_f32 v72, v72, v73
    v_and_or_b32 v72, v72, -2, s60
    s_waitcnt lgkmcnt(0)
    v_smfmac_f32_16x16x64_bf16 v[44:47], v[16:19], v[36:43], v2
    buffer_store_dword v72, v11, s[8:11], s77 offen offset:2048
    s_sub_u32 s72, s7, 1
    v_add_f32 v76, v76, v78
    v_add_f32 v77, v77, v79
    v_cvt_pk_bf16_f32 v76, v76, v77
    v_and_or_b32 v76, v76, -2, s60
    buffer_store_dword v76, v11, s[8:11], s77 offen offset:3072
    v_mov_b32 v9, 0
    v_mov_b32 v9, 0
    v_add_f32 v44, v44, v46
    v_add_f32 v45, v45, v47
    v_cvt_pk_bf16_f32 v44, v44, v45
    v_and_or_b32 v44, v44, -2, s60
    buffer_store_dword v44, v11, s[8:11], s91 offen offset:0
    s_xor_b32 s60, s60, 1
    s_cmp_lt_u32 s7, 62
    s_cbranch_scc1 L_noflag_109
    v_mov_b32 v8, s72
    s_waitcnt vmcnt(11)
    s_mov_b64 exec, 1
    buffer_store_dword v8, off, s[8:11], s65 sc1
    s_mov_b64 exec, -1
L_noflag_109:
    v_mov_b64 v[72:73], 0
    v_mov_b64 v[74:75], 0
    v_mov_b64 v[76:77], 0
    v_mov_b64 v[78:79], 0
    s_waitcnt vmcnt(13)
    v_min_u32_dpp v7, v7, v7 quad_perm:[1,0,3,2] row_mask:0xf bank_mask:0xf
    s_nop 1
    v_min_u32_dpp v7, v7, v7 quad_perm:[2,3,0,1] row_mask:0xf bank_mask:0xf
    s_nop 1
    v_min_u32_dpp v7, v7, v7 row_half_mirror row_mask:0xf bank_mask:0xf
    s_nop 1
    v_readfirstlane_b32 s66, v7
    v_bfe_u32 v7, v0, 6, 1
    v_mul_u32_u24 v7, 4080, v7
    v_and_or_b32 v9, v11, 28, 0
    v_add_u32_e64 v7, v7, v9
L_red_done_108:
    s_barrier
    s_nop 3
    s_nop 3
    s_nop 3
    s_nop 3
    s_nop 3
    s_nop 3
    s_nop 3
    s_nop 3
    s_nop 3
    s_nop 3
    s_nop 3
    s_nop 3
    s_nop 3
    s_nop 3
    s_nop 3
    s_nop 3
    s_nop 3
    s_cmp_ge_u32 s66, s69
    s_cbranch_scc1 L_poll_f3
    s_cmp_ge_u32 s66, s69
    s_cbranch_scc1 L_kvd_111
    s_mov_b32 s79, 524288
L_kv_110:
    v_mov_b32 v76, 4096
    buffer_load_dwordx4 v[72:75], off, s[8:11], s82 sc1
    buffer_load_dwordx4 v[76:79], v76, s[8:11], s82 offen sc1
    s_waitcnt vmcnt(0)
    v_min3_u32 v72, v72, v73, v74
    v_min3_u32 v72, v72, v75, v76
    v_min3_u32 v72, v72, v77, v78
    v_min_u32 v72, v72, v79
    s_nop 0
    v_readfirstlane_b32 s66, v72
    v_mov_b64 v[72:73], 0
    v_mov_b64 v[74:75], 0
    v_mov_b64 v[76:77], 0
    v_mov_b64_e64 v[78:79], 0
    s_cmp_ge_u32 s66, s69
    s_cbranch_scc1 L_kvd_111
    s_sub_u32 s79, s79, 1
    s_cbranch_scc1 L_fail
    s_branch L_kv_110
L_kvd_111:
    s_mov_b32 s79, 524288
    s_waitcnt vmcnt(0)
    s_branch L_poll_f3
L_retry2_f3:
    s_waitcnt vmcnt(2)
    v_max3_u32 v9, v28, v29, v30
    v_max3_u32 v9, v9, v31, v8
    v_cmp_eq_u32 vcc, -1, v9
    ds_write_b128 v0, v[28:31] offset:7168
    ds_write_b32 v11, v8 offset:8960
    s_cbranch_vccz L_retry2_f3_ok
    buffer_load_dwordx4 v[28:31], v0, s[8:11], s52 offen offset:1024 sc1
    buffer_load_dword v8, v11, s[8:11], s80 offen offset:768 sc1
L_retry2_f3_l:
    buffer_load_dwordx4 v[28:31], v0, s[8:11], s52 offen offset:1024 sc1
    buffer_load_dword v8, v11, s[8:11], s80 offen offset:768 sc1
    s_waitcnt vmcnt(2)
    v_max3_u32 v9, v28, v29, v30
    v_max3_u32 v9, v9, v31, v8
    v_cmp_eq_u32_e64 vcc, -1, v9
    ds_write_b128 v0, v[28:31] offset:7168
    ds_write_b32 v11, v8 offset:8960
    s_sub_u32 s79, s79, 1
    s_cbranch_scc1 L_fail
    s_cbranch_vccnz L_retry2_f3_l
L_retry2_f3_ok:
    s_branch L_back2_f3_go
L_chain_last0:
    buffer_store_dwordx4 v[48:51], v0, s[8:11], s63 offen sc1
    v_smfmac_f32_16x16x64_bf16 v[72:75], v[28:31], v[128:135], v2
    v_smfmac_f32_16x16x64_bf16 v[76:79], v[28:31], v[136:143], v2
    v_smfmac_f32_16x16x64_bf16 v[72:75], v[32:35], v[144:151], v2
    v_smfmac_f32_16x16x64_bf16 v[76:79], v[32:35], v[152:159], v2
    v_smfmac_f32_16x16x64_bf16 v[72:75], v[36:39], v[160:167], v2
    v_smfmac_f32_16x16x64_bf16 v[76:79], v[36:39], v[168:175], v2
    v_smfmac_f32_16x16x64_bf16 v[72:75], v[40:43], v[176:183], v2
    v_smfmac_f32_16x16x64_bf16 v[76:79], v[40:43], v[184:191], v2
    v_smfmac_f32_16x16x64_bf16 v[72:75], v[44:47], v[192:199], v2
    v_smfmac_f32_16x16x64_bf16 v[76:79], v[44:47], v[200:207], v2
    s_nop 7
    s_nop 0
    v_pk_add_f32 v[72:73], v[72:73], v[74:75]
    v_pk_add_f32 v[76:77], v[76:77], v[78:79]
    v_cvt_pk_bf16_f32 v74, v72, v73
    v_cvt_pk_bf16_f32 v75, v76, v77
    v_lshlrev_b32_e64 v76, 1, v11
    ds_write_b64 v76, v[74:75] offset:14336
    s_branch L_chain_last
L_chain_last1:
    buffer_store_dwordx4 v[48:51], v0, s[8:11], s63 offen sc1
    v_smfmac_f32_16x16x64_bf16 v[72:75], v[28:31], v[128:135], v2
    v_smfmac_f32_16x16x64_bf16 v[76:79], v[28:31], v[136:143], v2
    v_smfmac_f32_16x16x64_bf16 v[72:75], v[32:35], v[144:151], v2
    v_smfmac_f32_16x16x64_bf16 v[76:79], v[32:35], v[152:159], v2
    v_smfmac_f32_16x16x64_bf16 v[72:75], v[36:39], v[160:167], v2
    v_smfmac_f32_16x16x64_bf16 v[76:79], v[36:39], v[168:175], v2
    v_smfmac_f32_16x16x64_bf16 v[72:75], v[40:43], v[176:183], v2
    v_smfmac_f32_16x16x64_bf16 v[76:79], v[40:43], v[184:191], v2
    v_smfmac_f32_16x16x64_bf16 v[72:75], v[44:47], v[192:199], v2
    v_smfmac_f32_16x16x64_bf16 v[76:79], v[44:47], v[200:207], v2
    s_nop 7
    v_pk_add_f32 v[72:73], v[72:73], v[74:75]
    v_pk_add_f32 v[76:77], v[76:77], v[78:79]
    v_cvt_pk_bf16_f32 v74, v72, v73
    v_cvt_pk_bf16_f32 v75, v76, v77
    v_lshlrev_b32_e64 v76, 1, v11
    ds_write_b64 v76, v[74:75] offset:14848
    s_branch L_chain_last
L_chain_last2:
    buffer_store_dwordx4 v[48:51], v0, s[8:11], s63 offen sc1
    v_smfmac_f32_16x16x64_bf16 v[72:75], v[28:31], v[128:135], v2
    v_smfmac_f32_16x16x64_bf16 v[76:79], v[28:31], v[136:143], v2
    v_smfmac_f32_16x16x64_bf16 v[72:75], v[32:35], v[144:151], v2
    v_smfmac_f32_16x16x64_bf16 v[76:79], v[32:35], v[152:159], v2
    v_smfmac_f32_16x16x64_bf16 v[72:75], v[36:39], v[160:167], v2
    v_smfmac_f32_16x16x64_bf16 v[76:79], v[36:39], v[168:175], v2
    v_smfmac_f32_16x16x64_bf16 v[72:75], v[40:43], v[176:183], v2
    v_smfmac_f32_16x16x64_bf16 v[76:79], v[40:43], v[184:191], v2
    v_smfmac_f32_16x16x64_bf16 v[72:75], v[44:47], v[192:199], v2
    v_smfmac_f32_16x16x64_bf16 v[76:79], v[44:47], v[200:207], v2
    s_nop 7
    v_pk_add_f32 v[72:73], v[72:73], v[74:75]
    v_pk_add_f32 v[76:77], v[76:77], v[78:79]
    v_cvt_pk_bf16_f32 v74, v72, v73
    v_cvt_pk_bf16_f32 v75, v76, v77
    v_lshlrev_b32_e64 v76, 1, v11
    ds_write_b64 v76, v[74:75] offset:15360
    s_branch L_chain_last
L_chain_last3:
    buffer_store_dwordx4 v[48:51], v0, s[8:11], s63 offen sc1
    v_smfmac_f32_16x16x64_bf16 v[72:75], v[28:31], v[128:135], v2
    v_smfmac_f32_16x16x64_bf16 v[76:79], v[28:31], v[136:143], v2
    v_smfmac_f32_16x16x64_bf16 v[72:75], v[32:35], v[144:151], v2
    v_smfmac_f32_16x16x64_bf16 v[76:79], v[32:35], v[152:159], v2
    v_smfmac_f32_16x16x64_bf16 v[72:75], v[36:39], v[160:167], v2
    v_smfmac_f32_16x16x64_bf16 v[76:79], v[36:39], v[168:175], v2
    v_smfmac_f32_16x16x64_bf16 v[72:75], v[40:43], v[176:183], v2
    v_smfmac_f32_16x16x64_bf16 v[76:79], v[40:43], v[184:191], v2
    v_smfmac_f32_16x16x64_bf16 v[72:75], v[44:47], v[192:199], v2
    v_smfmac_f32_16x16x64_bf16 v[76:79], v[44:47], v[200:207], v2
    s_nop 7
    v_pk_add_f32 v[72:73], v[72:73], v[74:75]
    v_pk_add_f32 v[76:77], v[76:77], v[78:79]
    v_cvt_pk_bf16_f32 v74, v72, v73
    v_cvt_pk_bf16_f32 v75, v76, v77
    v_lshlrev_b32_e64 v76, 1, v11
    ds_write_b64 v76, v[74:75] offset:15872
L_chain_last:
    s_lshr_b32 s69, s76, 1
    v_add_u32 v76, s69, v0
    ds_read_b128 v[44:47], v76 offset:14336
    s_mov_b32 exec_hi, 0
    s_waitcnt lgkmcnt(0)
    buffer_store_dwordx4 v[44:47], v0, s[8:11], s64 offen sc1
    s_mov_b64 exec, 1
    s_cmp_eq_u32 s4, 3
    s_cbranch_scc1 L_chain_w3
    s_waitcnt vmcnt(0)
    s_barrier
    s_branch L_chain_end
L_chain_w3:
    v_mov_b32 v8, 63
    s_waitcnt vmcnt(2)
    buffer_store_dword v8, off, s[8:11], s65 sc1
    v_mov_b32_e64 v9, 64
    s_waitcnt vmcnt(1)
    s_barrier
    buffer_store_dword v9, off, s[8:11], s65 sc1
L_chain_end:
    s_endpgm
L_poll_s0:
    buffer_load_dwordx4 v[12:15], v0, s[8:11], s52 offen sc1
L_poll_s0_2:
    s_waitcnt vmcnt(3)
    ds_read_b128 v[32:35], v0 offset:16384
    ds_read_b128 v[36:39], v0 offset:17408
    ds_read_b128 v[40:43], v0 offset:18432
    ds_read_b128 v[44:47], v0 offset:19456
    ds_read_b128 v[64:67], v0 offset:32768
    ds_read_b128 v[68:71], v0 offset:33792
    v_mov_b64 v[48:49], 0
    v_mov_b64 v[50:51], 0
    v_mov_b64 v[52:53], 0
    v_mov_b64 v[54:55], 0
    v_mov_b64 v[56:57], 0
    v_mov_b64 v[58:59], 0
    v_mov_b64 v[60:61], 0
    v_mov_b64 v[62:63], 0
L_retry_s0:
    buffer_load_dwordx4 v[12:15], v0, s[8:11], s52 offen sc1
    s_waitcnt vmcnt(1)
L_step_s0:
    v_max3_u32 v9, v12, v13, v14
    v_max_u32 v9, v9, v15
    v_cmp_eq_u32_e64 vcc, -1, v9
    ds_write_b128 v0, v[12:15] offset:0
    s_sub_u32 s79, s79, 1
    s_cbranch_scc1 L_fail
    s_cbranch_vccnz L_retry_s0
    v_smfmac_f32_16x16x64_bf16 v[48:51], v[12:15], a[0:7], v2
    buffer_load_dwordx4 v[28:31], v0, s[8:11], s52 offen offset:1024 sc1
    v_smfmac_f32_16x16x64_bf16 v[56:59], v[12:15], a[144:151], v2
    v_smfmac_f32_16x16x64_bf16 v[52:55], v[12:15], a[8:15], v2
    s_waitcnt lgkmcnt(0)
    s_barrier
    ds_read_b128 v[16:19], v0 offset:2048
    ds_read_b128 v[20:23], v0 offset:4096
    buffer_load_dword v8, v11, s[8:11], s80 offen offset:0 sc1
    v_smfmac_f32_16x16x64_bf16 v[60:63], v[12:15], a[152:159], v2
    ds_read_b128 v[24:27], v0 offset:6144
    v_smfmac_f32_16x16x64_bf16 v[72:75], v[12:15], v[32:39], v2
    v_smfmac_f32_16x16x64_bf16 v[76:79], v[12:15], v[40:47], v2
    s_waitcnt lgkmcnt(2)
    v_smfmac_f32_16x16x64_bf16 v[48:51], v[16:19], a[16:23], v2
    ds_read_b128 v[32:35], v0 offset:34816
    v_smfmac_f32_16x16x64_bf16 v[56:59], v[16:19], a[160:167], v2
    ds_read_b128 v[36:39], v0 offset:35840
    v_smfmac_f32_16x16x64_bf16 v[52:55], v[16:19], a[24:31], v2
    ds_read_b128 v[40:43], v0 offset:49152
    buffer_load_dwordx4 v[28:31], v0, s[8:11], s52 offen offset:1024 sc1
    v_smfmac_f32_16x16x64_bf16 v[60:63], v[16:19], a[168:175], v2
    ds_read_b128 v[44:47], v0 offset:50176
    v_smfmac_f32_16x16x64_bf16 v[72:75], v[16:19], v[64:71], v2
    buffer_load_dword v8, v11, s[8:11], s80 offen offset:0 sc1
    buffer_load_dwordx4 v[64:67], v0, s[8:11], s61 offen sc1
    s_waitcnt lgkmcnt(2)
    v_smfmac_f32_16x16x64_bf16 v[76:79], v[16:19], v[32:39], v2
    ds_read_b128 v[32:35], v0 offset:51200
    s_waitcnt lgkmcnt(6)
    v_smfmac_f32_16x16x64_bf16 v[48:51], v[20:23], a[32:39], v2
    ds_read_b128 v[36:39], v0 offset:52224
    v_smfmac_f32_16x16x64_bf16 v[56:59], v[20:23], a[176:183], v2
    v_smfmac_f32_16x16x64_bf16 v[52:55], v[20:23], a[40:47], v2
    buffer_load_dwordx4 v[68:71], v0, s[8:11], s61 offen offset:1024 sc1
    v_smfmac_f32_16x16x64_bf16 v[60:63], v[20:23], a[184:191], v2
    s_waitcnt vmcnt(4)
    v_max3_u32 v9, v28, v29, v30
    s_waitcnt lgkmcnt(2)
    v_smfmac_f32_16x16x64_bf16 v[72:75], v[20:23], v[40:47], v2
    v_max3_u32 v9, v9, v31, v8
    s_waitcnt lgkmcnt(0)
    v_smfmac_f32_16x16x64_bf16 v[76:79], v[20:23], v[32:39], v2
    v_cmp_eq_u32 vcc, -1, v9
    ds_write_b128 v0, v[28:31] offset:1024
    s_waitcnt lgkmcnt(7)
    v_smfmac_f32_16x16x64_bf16 v[48:51], v[24:27], a[48:55], v2
    ds_write_b32 v11, v8 offset:8192
    buffer_load_dwordx4 v[12:15], v0, s[8:11], s61 offen offset:2048 sc1
    v_smfmac_f32_16x16x64_bf16 v[56:59], v[24:27], a[192:199], v2
    v_smfmac_f32_16x16x64_bf16 v[52:55], v[24:27], a[56:63], v2
    s_cbranch_vccnz L_retry2_s0
L_back2_s0_go:
    v_smfmac_f32_16x16x64_bf16 v[60:63], v[24:27], a[200:207], v2
    s_waitcnt lgkmcnt(0)
    s_barrier
    ds_read_b128 v[32:35], v0 offset:3072
    v_smfmac_f32_16x16x64_bf16 v[48:51], v[28:31], a[64:71], v2
    ds_read_b128 v[36:39], v0 offset:5120
    buffer_load_dwordx4 v[16:19], v0, s[8:11], s61 offen offset:3072 sc1
    v_smfmac_f32_16x16x64_bf16 v[56:59], v[28:31], a[208:215], v2
    ds_read_b128 v[40:43], v0 offset:7168
    v_smfmac_f32_16x16x64_bf16 v[52:55], v[28:31], a[72:79], v2
    ds_read_b128 v[44:47], v0 offset:8192
    v_smfmac_f32_16x16x64_bf16 v[60:63], v[28:31], a[216:223], v2
    s_waitcnt lgkmcnt(3)
    v_smfmac_f32_16x16x64_bf16 v[48:51], v[32:35], a[80:87], v2
    v_smfmac_f32_16x16x64_bf16 v[56:59], v[32:35], a[224:231], v2
    v_smfmac_f32_16x16x64_bf16 v[52:55], v[32:35], a[88:95], v2
    buffer_load_dword v7, v7, s[8:11], s82 offen sc1
    v_smfmac_f32_16x16x64_bf16 v[60:63], v[32:35], a[232:239], v2
    s_waitcnt lgkmcnt(2)
    v_smfmac_f32_16x16x64_bf16 v[48:51], v[36:39], a[96:103], v2
    v_smfmac_f32_16x16x64_bf16 v[56:59], v[36:39], a[240:247], v2
    s_waitcnt vmcnt(2)
    v_smfmac_f32_16x16x64_bf16 v[52:55], v[36:39], a[104:111], v2
    v_smfmac_f32_16x16x64_bf16 v[60:63], v[36:39], a[248:255], v2
    s_waitcnt lgkmcnt(1)
    v_smfmac_f32_16x16x64_bf16 v[48:51], v[40:43], a[112:119], v2
    v_smfmac_f32_16x16x64_bf16 v[56:59], v[40:43], v[80:87], v2
    v_smfmac_f32_16x16x64_bf16 v[52:55], v[40:43], a[120:127], v2
    v_smfmac_f32_16x16x64_bf16 v[60:63], v[40:43], v[88:95], v2
    s_waitcnt lgkmcnt(0)
    v_smfmac_f32_16x16x64_bf16 v[48:51], v[44:47], a[128:135], v2
    v_smfmac_f32_16x16x64_bf16 v[56:59], v[44:47], v[96:103], v2
    v_smfmac_f32_16x16x64_bf16 v[52:55], v[44:47], a[136:143], v2
    s_waitcnt vmcnt(3)
    v_smfmac_f32_16x16x64_bf16 v[60:63], v[44:47], v[104:111], v2
    v_add_f32 v48, v48, v50
    v_add_f32 v49, v49, v51
    v_add_f32 v56, v56, v58
    v_add_f32 v57, v57, v59
    v_cvt_pk_bf16_f32 v50, v48, v49
    v_cvt_pk_bf16_f32 v51, v56, v57
    v_add_f32 v52, v52, v54
    v_add_f32 v53, v53, v55
    v_mfma_f32_16x16x16_bf16 v[56:59], v[50:51], v[4:5], 0
    v_add_f32 v60, v60, v62
    v_add_f32 v61, v61, v63
    v_cvt_pk_bf16_f32 v54, v52, v53
    v_cvt_pk_bf16_f32 v55, v60, v61
    v_smfmac_f32_16x16x64_bf16 v[72:75], v[24:27], v[112:119], v2
    v_mfma_f32_16x16x16_bf16 v[60:63], v[54:55], v[4:5], 0
    v_cvt_pk_bf16_f32 v48, v56, v57
    v_cvt_pk_bf16_f32 v49, v58, v59
    v_add_u32 v8, 65536, v0
    v_smfmac_f32_16x16x64_bf16 v[76:79], v[24:27], v[120:127], v2
    v_mov_b32 v9, 0
    v_mov_b32 v9, 0
    v_cvt_pk_bf16_f32 v50, v60, v61
    v_cvt_pk_bf16_f32 v51, v62, v63
    v_mov_b32 v9, 0
    v_mov_b32 v9, 0
    v_mfma_f32_16x16x32_bf16 v[60:63], v[68:71], v[48:51], 0
    v_mfma_f32_16x16x32_bf16 v[56:59], v[64:67], v[48:51], 0
    v_mfma_f32_16x16x32_bf16 v[52:55], v[48:51], v[48:51], 0
    s_cmp_ge_u32 s7, 63
    s_cbranch_scc1 L_chain_last0
    v_smfmac_f32_16x16x64_bf16 v[72:75], v[28:31], v[128:135], v2
    v_mov_b32_dpp v56, v60 row_ror:8 row_mask:0xf bank_mask:0xc
    v_mov_b32_dpp v57, v61 row_ror:8 row_mask:0xf bank_mask:0xc
    v_mov_b32_dpp v58, v62 row_ror:8 row_mask:0xf bank_mask:0xc
    v_mov_b32_dpp v59, v63 row_ror:8 row_mask:0xf bank_mask:0xc
    ds_write_b128 v0, v[56:59] offset:9216
    ds_write_b128 v10, v[52:55]
    v_smfmac_f32_16x16x64_bf16 v[76:79], v[28:31], v[136:143], v2
    buffer_store_dwordx4 v[48:51], v0, s[8:11], s63 offen sc1
    v_smfmac_f32_16x16x64_bf16 v[72:75], v[32:35], v[144:151], v2
    v_smfmac_f32_16x16x64_bf16 v[76:79], v[32:35], v[152:159], v2
    v_smfmac_f32_16x16x64_bf16 v[72:75], v[36:39], v[160:167], v2
    s_waitcnt lgkmcnt(0)
    s_barrier
    ds_read_b128 v[48:51], v0 offset:10240
    ds_read_b128 v[52:55], v0 offset:11264
    v_smfmac_f32_16x16x64_bf16 v[76:79], v[36:39], v[168:175], v2
    ds_read_b128 v[60:63], v0 offset:12288
    ds_read2_b32 v[64:65], v3 offset0:0 offset1:32
    v_smfmac_f32_16x16x64_bf16 v[72:75], v[40:43], v[176:183], v2
    ds_read2_b32 v[66:67], v3 offset0:128 offset1:160
    v_smfmac_f32_16x16x64_bf16 v[76:79], v[40:43], v[184:191], v2
    v_smfmac_f32_16x16x64_bf16 v[72:75], v[44:47], v[192:199], v2
    v_smfmac_f32_16x16x64_bf16 v[76:79], v[44:47], v[200:207], v2
    s_waitcnt lgkmcnt(4)
    v_add_f32 v56, v56, v48
    v_add_f32 v57, v57, v49
    v_add_f32 v58, v58, v50
    v_add_f32 v59, v59, v51
    s_waitcnt lgkmcnt(2)
    v_pk_add_f32 v[52:53], v[52:53], v[60:61]
    v_pk_add_f32 v[54:55], v[54:55], v[62:63]
    s_waitcnt lgkmcnt(0)
    v_pk_add_f32 v[64:65], v[64:65], v[66:67]
    v_pk_add_f32 v[56:57], v[56:57], v[52:53]
    v_pk_add_f32 v[58:59], v[58:59], v[54:55]
    v_add_f32 v64, v64, v65
    v_max3_f32 v68, v56, v57, v58
    v_max3_f32 v68, v68, v59, v64
    v_pk_add_f32 v[72:73], v[72:73], v[74:75]
    v_pk_add_f32 v[76:77], v[76:77], v[78:79]
    v_max_f32_dpp v69, v68, v68 row_ror:8 row_mask:0xf bank_mask:0xf
    v_max_f32_dpp v68, v68, v68 row_ror:8 row_mask:0xf bank_mask:0xf
    v_cvt_pk_bf16_f32 v74, v72, v73
    v_cvt_pk_bf16_f32 v75, v76, v77
    v_permlane16_swap_b32 v68, v69
    v_max_f32 v65, v68, v69
    v_max_f32 v69, v68, v69
    v_mov_b32 v49, 0
    v_mov_b32 v50, 0
    v_permlane32_swap_b32 v65, v69
    v_max_f32 v68, v65, v69
    v_mul_f32 v68, s75, v68
    v_fma_f32 v56, v56, s74, v68
    v_fma_f32 v57, v57, s74, v68
    v_fma_f32 v58, v58, s74, v68
    v_fma_f32 v59, v59, s74, v68
    v_fma_f32 v64, v64, s74, v68
    v_exp_f32 v56, v56
    v_exp_f32 v57, v57
    v_exp_f32 v58, v58
    v_exp_f32 v59, v59
    v_exp_f32_e64 v64, v64
    v_cvt_pk_bf16_f32 v60, v56, v57
    v_cvt_pk_bf16_f32 v61, v58, v59
    v_cndmask_b32 v52, 0, v60, s[70:71]
    v_cndmask_b32 v53, 0, v61, s[70:71]
    v_cndmask_b32 v54, v60, 0, s[70:71]
    v_cndmask_b32 v55, v61, 0, s[70:71]
    v_pk_add_f32 v[66:67], v[56:57], v[58:59]
    s_waitcnt vmcnt(2)
    v_mfma_f32_16x16x32_bf16 v[60:63], v[12:15], v[52:55], 0
    v_cvt_pk_bf16_f32 v72, v64, 0
    v_cvt_pk_bf16_f32 v73, 0, v64
    v_mfma_f32_16x16x32_bf16 v[68:71], v[16:19], v[52:55], 0
    v_cndmask_b32 v48, v73, v72, s[70:71]
    v_cndmask_b32 v51, v73, v72, s[70:71]
    v_add_f32 v65, v66, v67
    v_mfma_f32_16x16x16_bf16 v[60:63], v[74:75], v[48:49], v[60:63]
    v_add_f32_e64 v65, v65, v64
    ds_read_b128 v[20:23], v8 offset:0
    ds_read_b128 v[24:27], v8 offset:1024
    v_mfma_f32_16x16x16_bf16 v[68:71], v[74:75], v[50:51], v[68:71]
    v_add_f32_dpp v66, v65, v65 row_ror:8 row_mask:0xf bank_mask:0xf
    v_add_f32_dpp v65, v65, v65 row_ror:8 row_mask:0xf bank_mask:0xf
    ds_read_b128 v[28:31], v8 offset:2048
    ds_read_b128 v[32:35], v8 offset:3072
    v_permlane16_swap_b32 v65, v66
    v_add_f32 v64, v65, v66
    v_add_f32_e64 v65, v65, v66
    v_add_f32_dpp v56, v60, v60 row_ror:8 row_mask:0xf bank_mask:0x3
    v_add_f32_dpp v57, v61, v61 row_ror:8 row_mask:0xf bank_mask:0x3
    v_permlane32_swap_b32_e64 v64, v65
    v_add_f32_dpp v58, v62, v62 row_ror:8 row_mask:0xf bank_mask:0x3
    v_add_f32_dpp v59, v63, v63 row_ror:8 row_mask:0xf bank_mask:0x3
    v_add_f32 v64, v65, v64
    v_rcp_f32 v64, v64
    v_add_f32_dpp v56, v68, v68 row_ror:8 row_mask:0xf bank_mask:0xc
    v_add_f32_dpp v57, v69, v69 row_ror:8 row_mask:0xf bank_mask:0xc
    v_add_f32_dpp v58, v70, v70 row_ror:8 row_mask:0xf bank_mask:0xc
    v_add_f32_dpp v59, v71, v71 row_ror:8 row_mask:0xf bank_mask:0xc
    v_pk_mul_f32 v[56:57], v[56:57], v[64:65] op_sel_hi:[1,0]
    v_pk_mul_f32 v[58:59], v[58:59], v[64:65] op_sel_hi:[1,0]
    v_cvt_pk_bf16_f32 v78, v56, v57
    v_cvt_pk_bf16_f32 v79, v58, v59
    ds_write_b64 v6, v[78:79] offset:0
    v_mov_b64 v[48:49], 0
    v_mov_b64 v[50:51], 0
    ds_read_b128 v[36:39], v8 offset:16384
    v_mov_b64 v[52:53], 0
    v_mov_b64 v[54:55], 0
    v_lshlrev_b32 v76, 1, v11
    v_mov_b64 v[56:57], 0
    v_mov_b64 v[58:59], 0
    v_mov_b64 v[60:61], 0
    v_mov_b64 v[62:63], 0
    v_mov_b64 v[44:45], 0
    v_mov_b64 v[46:47], 0
    v_mov_b32 v9, 0
    v_mov_b32_e64 v9, 0
    s_waitcnt lgkmcnt(1)
    s_barrier
    ds_read_b128 v[12:15], v0 offset:0
    v_mov_b64_e64 v[64:65], 0
    ds_read_b128 v[16:19], v0 offset:1024
    v_mov_b64 v[66:67], 0
    v_mov_b64 v[68:69], 0
    v_mov_b64 v[70:71], 0
    v_mov_b64 v[72:73], 0
    ds_read_b128 v[40:43], v8 offset:17408
    v_mov_b64 v[78:79], 0
    v_mov_b32_e64 v9, 0
    s_waitcnt lgkmcnt(1)
    v_smfmac_f32_16x16x64_bf16 v[48:51], v[12:15], v[20:27], v2
    s_add_u32 s7, s7, 1
    ds_read_b128 v[20:23], v8 offset:18432
    v_smfmac_f32_16x16x64_bf16 v[48:51], v[16:19], v[28:35], v2
    s_add_u32 s92, s53, s93
    ds_read_b128 v[24:27], v8 offset:19456
    ds_read_b128 v[28:31], v8 offset:32768
    ds_write_b64 v76, v[74:75] offset:14336
    v_mov_b64 v[74:75], 0
    v_mov_b64_e64 v[76:77], 0
    s_waitcnt lgkmcnt(4)
    v_smfmac_f32_16x16x64_bf16 v[52:55], v[12:15], v[36:43], v2
    s_add_u32 s67, s54, s93
    ds_read_b128 v[32:35], v8 offset:33792
    ds_read_b128 v[36:39], v8 offset:34816
    s_waitcnt lgkmcnt(4)
    v_smfmac_f32_16x16x64_bf16 v[52:55], v[16:19], v[20:27], v2
    s_mov_b32 s68, s60
    ds_read_b128 v[40:43], v8 offset:35840
    ds_read_b128 v[20:23], v8 offset:49152
    v_add_f32 v48, v48, v50
    v_add_f32_e64 v49, v49, v51
    v_smfmac_f32_16x16x64_bf16 v[56:59], v[12:15], v[208:215], v2
    s_mov_b32 s54, s53
    ds_read_b128 v[24:27], v8 offset:50176
    v_cvt_pk_bf16_f32 v48, v48, v49
    v_and_or_b32 v48, v48, -2, s60
    v_smfmac_f32_16x16x64_bf16 v[56:59], v[16:19], v[216:223], v2
    buffer_store_dword v48, v11, s[8:11], s83 offen offset:0 sc1
    s_add_u32 s52, s53, 0
    v_add_f32 v52, v52, v54
    v_add_f32_e64 v53, v53, v55
    s_waitcnt lgkmcnt(4)
    v_smfmac_f32_16x16x64_bf16 v[60:63], v[12:15], v[28:35], v2
    s_add_u32 s80, s53, 8192
    ds_read_b128 v[28:31], v8 offset:51200
    v_cvt_pk_bf16_f32 v52, v52, v53
    v_and_or_b32 v52, v52, -2, s60
    s_waitcnt lgkmcnt(3)
    v_smfmac_f32_16x16x64_bf16 v[60:63], v[16:19], v[36:43], v2
    buffer_store_dword v52, v11, s[8:11], s83 offen offset:1024 sc1
    s_add_u32 s53, s53, 9216
    ds_read_b128 v[32:35], v8 offset:52224
    v_add_u32 v8, 65536, v8
    ds_read_b128 v[36:39], v8 offset:0
    v_add_f32 v56, v56, v58
    v_add_f32 v57, v57, v59
    s_waitcnt lgkmcnt(3)
    v_smfmac_f32_16x16x64_bf16 v[64:67], v[12:15], v[20:27], v2
    s_cmp_eq_u32 s53, 420864
    s_cselect_b32 s53, 393216, s53
    ds_read_b128 v[40:43], v8 offset:1024
    ds_read_b128 v[20:23], v8 offset:2048
    v_cvt_pk_bf16_f32 v56, v56, v57
    v_and_or_b32 v56, v56, -2, s60
    s_waitcnt lgkmcnt(3)
    v_smfmac_f32_16x16x64_bf16 v[64:67], v[16:19], v[28:35], v2
    buffer_store_dword v56, v11, s[8:11], s83 offen offset:2048 sc1
    s_add_u32 s61, s61, 524288
    ds_read_b128 v[24:27], v8 offset:3072
    ds_read_b128 v[28:31], v8 offset:16384
    v_add_f32 v60, v60, v62
    v_add_f32_e64 v61, v61, v63
    v_smfmac_f32_16x16x64_bf16 v[68:71], v[12:15], v[224:231], v2
    s_add_u32 s63, s63, 131072
    ds_read_b128 v[32:35], v8 offset:17408
    v_cvt_pk_bf16_f32 v60, v60, v61
    v_and_or_b32 v60, v60, -2, s60
    v_smfmac_f32_16x16x64_bf16 v[68:71], v[16:19], v[232:239], v2
    buffer_store_dword v60, v11, s[8:11], s83 offen offset:3072 sc1
    s_sub_u32 s62, s64, 0
    v_add_f32 v64, v64, v66
    v_add_f32 v65, v65, v67
    s_waitcnt lgkmcnt(4)
    v_smfmac_f32_16x16x64_bf16 v[72:75], v[12:15], v[36:43], v2
    s_add_u32 s64, s64, 65536
    ds_read_b128 v[36:39], v8 offset:18432
    v_cvt_pk_bf16_f32 v64, v64, v65
    v_and_or_b32 v64, v64, -2, s60
    s_waitcnt lgkmcnt(3)
    v_smfmac_f32_16x16x64_bf16 v[72:75], v[16:19], v[20:27], v2
    buffer_store_dword v64, v11, s[8:11], s77 offen offset:0 sc1
    s_add_u32 s69, s7, 3
    s_min_u32 s69, s69, 64
    ds_read_b128 v[40:43], v8 offset:19456
    v_add_f32 v68, v68, v70
    v_add_f32_e64 v69, v69, v71
    v_smfmac_f32_16x16x64_bf16 v[76:79], v[12:15], v[240:247], v2
    s_mov_b32 s79, 524288
    v_cvt_pk_bf16_f32 v68, v68, v69
    v_and_or_b32 v68, v68, -2, s60
    v_smfmac_f32_16x16x64_bf16 v[76:79], v[16:19], v[248:255], v2
    buffer_store_dword v68, v11, s[8:11], s77 offen offset:1024 sc1
    v_add_f32 v72, v72, v74
    v_add_f32_e64 v73, v73, v75
    s_waitcnt lgkmcnt(2)
    v_smfmac_f32_16x16x64_bf16 v[44:47], v[12:15], v[28:35], v2
    v_cvt_pk_bf16_f32 v72, v72, v73
    v_and_or_b32 v72, v72, -2, s60
    s_waitcnt lgkmcnt(0)
    v_smfmac_f32_16x16x64_bf16 v[44:47], v[16:19], v[36:43], v2
    buffer_store_dword v72, v11, s[8:11], s77 offen offset:2048 sc1
    v_add_f32 v76, v76, v78
    v_add_f32_e64 v77, v77, v79
    v_cvt_pk_bf16_f32 v76, v76, v77
    v_and_or_b32 v76, v76, -2, s60
    buffer_store_dword v76, v11, s[8:11], s77 offen offset:3072 sc1
    v_mov_b32 v9, 0
    v_mov_b32 v9, 0
    v_add_f32 v44, v44, v46
    v_add_f32 v45, v45, v47
    v_cvt_pk_bf16_f32 v44, v44, v45
    v_and_or_b32 v44, v44, -2, s60
    buffer_store_dword v44, v11, s[8:11], s91 offen offset:0 sc1
    s_xor_b32 s60, s60, 1
    s_nop 3
    s_nop 3
    buffer_load_dwordx4 v[48:51], v1, s[8:11], s56 offen sc1
    buffer_load_dwordx4 v[52:55], v1, s[8:11], s57 offen sc1
    buffer_load_dwordx4 v[56:59], v1, s[8:11], s58 offen sc1
    buffer_load_dwordx4 v[60:63], v1, s[8:11], s59 offen sc1
    v_and_b32 v34, 16, v0
    v_mov_b32 v35, 0x3f80
    v_lshlrev_b32_e64 v35, v34, v35
    v_cndmask_b32 v64, 0, v35, s[40:41]
    v_cndmask_b32 v65, 0, v35, s[42:43]
    v_cndmask_b32 v66, 0, v35, s[44:45]
    v_cndmask_b32 v67, 0, v35, s[46:47]
    v_bfe_u32 v33, v0, 5, 2
    v_lshl_add_u32 v33, v33, 2, v34
    v_bfe_u32 v34, v0, 8, 1
    v_lshl_add_u32 v33, v34, 6, v33
    v_lshrrev_b32_e64 v34, 9, v0
    v_lshl_add_u32 v33, v34, 5, v33
    v_mov_b32 v36, -1
    v_mov_b64 v[72:73], 0
    v_mov_b64 v[74:75], 0
    v_mov_b64 v[76:77], 0
    v_mov_b64 v[78:79], 0
    s_waitcnt vmcnt(14)
    v_min_u32_dpp v7, v7, v7 quad_perm:[1,0,3,2] row_mask:0xf bank_mask:0xf
    s_nop 1
    v_min_u32_dpp v7, v7, v7 quad_perm:[2,3,0,1] row_mask:0xf bank_mask:0xf
    s_nop 1
    v_min_u32_dpp v7, v7, v7 row_half_mirror row_mask:0xf bank_mask:0xf
    s_nop 1
    v_readfirstlane_b32 s66, v7
    v_bfe_u32 v7, v0, 6, 1
    v_mul_u32_u24 v7, 4080, v7
    v_and_or_b32 v9, v11, 28, 0
    v_add_u32_e64 v7, v7, v9
    buffer_load_dwordx4 v[16:19], v1, s[8:11], s56 offen sc1
    buffer_load_dwordx4 v[20:23], v1, s[8:11], s57 offen sc1
    buffer_load_dwordx4 v[24:27], v1, s[8:11], s58 offen sc1
    buffer_load_dwordx4 v[28:31], v1, s[8:11], s59 offen sc1
L_redp_113:
    s_waitcnt vmcnt(6)
    v_bitop3_b32 v34, v48, v52, s68 bitop3:0x7e
    v_mfma_f32_16x16x32_bf16 v[68:71], v[48:51], v[64:67], 0
    v_mfma_f32_16x16x32_bf16 v[68:71], v[52:55], v[64:67], v[68:71]
    s_waitcnt vmcnt(4)
    v_bitop3_b32 v35, v56, v60, s68 bitop3:0x7e
    v_bitop3_b32 v34, v34, v35, 1 bitop3:0xa8
    v_cmp_ne_u32_e64 vcc, 0, v34
    v_mfma_f32_16x16x32_bf16 v[68:71], v[56:59], v[64:67], v[68:71]
    v_mfma_f32_16x16x32_bf16 v[68:71], v[60:63], v[64:67], v[68:71]
    s_cbranch_vccnz L_redr_115
    v_mov_b32 v9, 0
    v_mov_b32 v9, 0
    v_mov_b32 v9, 0
    v_mov_b32 v9, 0
    v_mov_b32 v9, 0
    v_mov_b32 v9, 0
    v_mov_b32 v9, 0
    v_permlane32_swap_b32 v68, v70
    v_permlane32_swap_b32 v69, v71
    v_pk_add_f32 v[68:69], v[68:69], v[70:71]
    v_cvt_pk_bf16_f32 v68, v68, v69
    v_min_u32_e64 v68, -2, v68
    buffer_store_dword v68, v33, s[8:11], s92 offen sc1
    buffer_store_dword v36, v33, s[8:11], s67 offen sc1
L_red_done_112:
    s_barrier
    s_nop 3
    s_nop 3
    s_nop 3
    s_nop 3
    s_nop 3
    s_nop 3
    s_nop 3
    s_nop 3
    s_nop 3
    s_nop 3
    s_nop 3
    s_nop 3
    s_nop 3
    s_nop 3
    s_nop 3
    s_nop 3
    s_nop 3
    s_cmp_ge_u32 s66, s69
    s_cbranch_scc1 L_poll_s0
    s_cmp_ge_u32 s66, s69
    s_cbranch_scc1 L_kvd_118
    s_mov_b32 s79, 524288
L_kv_117:
    v_mov_b32 v76, 4096
    buffer_load_dwordx4 v[72:75], off, s[8:11], s82 sc1
    buffer_load_dwordx4 v[76:79], v76, s[8:11], s82 offen sc1
    s_waitcnt vmcnt(0)
    v_min3_u32 v72, v72, v73, v74
    v_min3_u32 v72, v72, v75, v76
    v_min3_u32 v72, v72, v77, v78
    v_min_u32 v72, v72, v79
    s_nop 0
    v_readfirstlane_b32 s66, v72
    v_mov_b64 v[72:73], 0
    v_mov_b64 v[74:75], 0
    v_mov_b64 v[76:77], 0
    v_mov_b64_e64 v[78:79], 0
    s_cmp_ge_u32 s66, s69
    s_cbranch_scc1 L_kvd_118
    s_sub_u32 s79, s79, 1
    s_cbranch_scc1 L_fail
    s_branch L_kv_117
L_kvd_118:
    s_mov_b32 s79, 524288
    s_waitcnt vmcnt(0)
    s_branch L_poll_s0
L_redr_115:
    buffer_load_dwordx4 v[48:51], v1, s[8:11], s56 offen sc1
    buffer_load_dwordx4 v[52:55], v1, s[8:11], s57 offen sc1
    buffer_load_dwordx4 v[56:59], v1, s[8:11], s58 offen sc1
    buffer_load_dwordx4 v[60:63], v1, s[8:11], s59 offen sc1
L_redp_114:
    s_waitcnt vmcnt(6)
    v_bitop3_b32 v34, v16, v20, s68 bitop3:0x7e
    v_mfma_f32_16x16x32_bf16 v[68:71], v[16:19], v[64:67], 0
    v_mfma_f32_16x16x32_bf16 v[68:71], v[20:23], v[64:67], v[68:71]
    s_waitcnt vmcnt(4)
    v_bitop3_b32 v35, v24, v28, s68 bitop3:0x7e
    v_bitop3_b32 v34, v34, v35, 1 bitop3:0xa8
    v_cmp_ne_u32_e64 vcc, 0, v34
    v_mfma_f32_16x16x32_bf16 v[68:71], v[24:27], v[64:67], v[68:71]
    v_mfma_f32_16x16x32_bf16 v[68:71], v[28:31], v[64:67], v[68:71]
    s_cbranch_vccnz L_redr_116
    v_mov_b32 v9, 0
    v_mov_b32 v9, 0
    v_mov_b32 v9, 0
    v_mov_b32 v9, 0
    v_mov_b32 v9, 0
    v_mov_b32 v9, 0
    v_mov_b32 v9, 0
    v_permlane32_swap_b32 v68, v70
    v_permlane32_swap_b32 v69, v71
    v_pk_add_f32 v[68:69], v[68:69], v[70:71]
    v_cvt_pk_bf16_f32 v68, v68, v69
    v_min_u32_e64 v68, -2, v68
    buffer_store_dword v68, v33, s[8:11], s92 offen sc1
    buffer_store_dword v36, v33, s[8:11], s67 offen sc1
    s_branch L_red_done_112
L_redr_116:
    buffer_load_dwordx4 v[16:19], v1, s[8:11], s56 offen sc1
    buffer_load_dwordx4 v[20:23], v1, s[8:11], s57 offen sc1
    buffer_load_dwordx4 v[24:27], v1, s[8:11], s58 offen sc1
    buffer_load_dwordx4 v[28:31], v1, s[8:11], s59 offen sc1
    s_sub_u32 s79, s79, 1
    s_cbranch_scc1 L_fail
    s_branch L_redp_113
L_retry2_s0:
    s_waitcnt vmcnt(3)
    v_max3_u32 v9, v28, v29, v30
    v_max3_u32 v9, v9, v31, v8
    v_cmp_eq_u32 vcc, -1, v9
    ds_write_b128 v0, v[28:31] offset:1024
    ds_write_b32 v11, v8 offset:8192
    s_cbranch_vccz L_retry2_s0_ok
    buffer_load_dwordx4 v[28:31], v0, s[8:11], s52 offen offset:1024 sc1
    buffer_load_dword v8, v11, s[8:11], s80 offen offset:0 sc1
L_retry2_s0_l:
    buffer_load_dwordx4 v[28:31], v0, s[8:11], s52 offen offset:1024 sc1
    buffer_load_dword v8, v11, s[8:11], s80 offen offset:0 sc1
    s_waitcnt vmcnt(2)
    v_max3_u32 v9, v28, v29, v30
    v_max3_u32 v9, v9, v31, v8
    v_cmp_eq_u32_e64 vcc, -1, v9
    ds_write_b128 v0, v[28:31] offset:1024
    ds_write_b32 v11, v8 offset:8192
    s_sub_u32 s79, s79, 1
    s_cbranch_scc1 L_fail
    s_cbranch_vccnz L_retry2_s0_l
L_retry2_s0_ok:
    s_branch L_back2_s0_go
L_poll_s1:
    buffer_load_dwordx4 v[12:15], v0, s[8:11], s52 offen sc1
L_poll_s1_2:
    s_waitcnt vmcnt(3)
    ds_read_b128 v[32:35], v0 offset:20480
    ds_read_b128 v[36:39], v0 offset:21504
    ds_read_b128 v[40:43], v0 offset:22528
    ds_read_b128 v[44:47], v0 offset:23552
    ds_read_b128 v[64:67], v0 offset:36864
    ds_read_b128 v[68:71], v0 offset:37888
    v_mov_b64 v[48:49], 0
    v_mov_b64 v[50:51], 0
    v_mov_b64 v[52:53], 0
    v_mov_b64 v[54:55], 0
    v_mov_b64 v[56:57], 0
    v_mov_b64 v[58:59], 0
    v_mov_b64 v[60:61], 0
    v_mov_b64_e64 v[62:63], 0
L_retry_s1:
    buffer_load_dwordx4 v[12:15], v0, s[8:11], s52 offen sc1
    s_waitcnt vmcnt(1)
L_step_s1:
    v_max3_u32 v9, v12, v13, v14
    v_max_u32 v9, v9, v15
    v_cmp_eq_u32_e64 vcc, -1, v9
    ds_write_b128 v0, v[12:15] offset:2048
    s_sub_u32 s79, s79, 1
    s_cbranch_scc1 L_fail
    s_cbranch_vccnz L_retry_s1
    v_smfmac_f32_16x16x64_bf16 v[48:51], v[12:15], a[0:7], v2
    buffer_load_dwordx4 v[28:31], v0, s[8:11], s52 offen offset:1024 sc1
    v_smfmac_f32_16x16x64_bf16 v[56:59], v[12:15], a[144:151], v2
    v_smfmac_f32_16x16x64_bf16 v[52:55], v[12:15], a[8:15], v2
    s_waitcnt lgkmcnt(0)
    s_barrier
    ds_read_b128 v[16:19], v0 offset:0
    ds_read_b128 v[20:23], v0 offset:6144
    buffer_load_dword v8, v11, s[8:11], s80 offen offset:256 sc1
    v_smfmac_f32_16x16x64_bf16 v[60:63], v[12:15], a[152:159], v2
    ds_read_b128 v[24:27], v0 offset:4096
    v_smfmac_f32_16x16x64_bf16 v[72:75], v[12:15], v[32:39], v2
    v_smfmac_f32_16x16x64_bf16 v[76:79], v[12:15], v[40:47], v2
    s_waitcnt lgkmcnt(2)
    v_smfmac_f32_16x16x64_bf16 v[48:51], v[16:19], a[16:23], v2
    ds_read_b128 v[32:35], v0 offset:38912
    v_smfmac_f32_16x16x64_bf16 v[56:59], v[16:19], a[160:167], v2
    ds_read_b128 v[36:39], v0 offset:39936
    v_smfmac_f32_16x16x64_bf16 v[52:55], v[16:19], a[24:31], v2
    ds_read_b128 v[40:43], v0 offset:53248
    buffer_load_dwordx4 v[28:31], v0, s[8:11], s52 offen offset:1024 sc1
    v_smfmac_f32_16x16x64_bf16 v[60:63], v[16:19], a[168:175], v2
    ds_read_b128 v[44:47], v0 offset:54272
    v_smfmac_f32_16x16x64_bf16 v[72:75], v[16:19], v[64:71], v2
    buffer_load_dword v8, v11, s[8:11], s80 offen offset:256 sc1
    s_waitcnt lgkmcnt(2)
    v_smfmac_f32_16x16x64_bf16 v[76:79], v[16:19], v[32:39], v2
    ds_read_b128 v[32:35], v0 offset:55296
    buffer_load_dwordx4 v[64:67], v0, s[8:11], s61 offen sc1
    s_waitcnt lgkmcnt(6)
    v_smfmac_f32_16x16x64_bf16 v[48:51], v[20:23], a[32:39], v2
    ds_read_b128 v[36:39], v0 offset:56320
    v_smfmac_f32_16x16x64_bf16 v[56:59], v[20:23], a[176:183], v2
    v_smfmac_f32_16x16x64_bf16 v[52:55], v[20:23], a[40:47], v2
    v_smfmac_f32_16x16x64_bf16 v[60:63], v[20:23], a[184:191], v2
    buffer_load_dwordx4 v[68:71], v0, s[8:11], s61 offen offset:1024 sc1
    s_waitcnt vmcnt(4)
    v_max3_u32 v9, v28, v29, v30
    s_waitcnt lgkmcnt(2)
    v_smfmac_f32_16x16x64_bf16 v[72:75], v[20:23], v[40:47], v2
    v_max3_u32 v9, v9, v31, v8
    s_waitcnt lgkmcnt(0)
    v_smfmac_f32_16x16x64_bf16 v[76:79], v[20:23], v[32:39], v2
    v_cmp_eq_u32 vcc, -1, v9
    ds_write_b128 v0, v[28:31] offset:3072
    s_waitcnt lgkmcnt(7)
    v_smfmac_f32_16x16x64_bf16 v[48:51], v[24:27], a[48:55], v2
    ds_write_b32 v11, v8 offset:8448
    v_smfmac_f32_16x16x64_bf16 v[56:59], v[24:27], a[192:199], v2
    buffer_load_dwordx4 v[12:15], v0, s[8:11], s61 offen offset:2048 sc1
    v_smfmac_f32_16x16x64_bf16 v[52:55], v[24:27], a[56:63], v2
    s_cbranch_vccnz L_retry2_s1
L_back2_s1_go:
    v_smfmac_f32_16x16x64_bf16 v[60:63], v[24:27], a[200:207], v2
    s_waitcnt lgkmcnt(0)
    s_barrier
    ds_read_b128 v[32:35], v0 offset:1024
    v_smfmac_f32_16x16x64_bf16 v[48:51], v[28:31], a[64:71], v2
    ds_read_b128 v[36:39], v0 offset:7168
    v_smfmac_f32_16x16x64_bf16 v[56:59], v[28:31], a[208:215], v2
    ds_read_b128 v[40:43], v0 offset:5120
    buffer_load_dwordx4 v[16:19], v0, s[8:11], s61 offen offset:3072 sc1
    v_smfmac_f32_16x16x64_bf16 v[52:55], v[28:31], a[72:79], v2
    ds_read_b128 v[44:47], v0 offset:8192
    v_smfmac_f32_16x16x64_bf16 v[60:63], v[28:31], a[216:223], v2
    s_waitcnt lgkmcnt(3)
    v_smfmac_f32_16x16x64_bf16 v[48:51], v[32:35], a[80:87], v2
    v_smfmac_f32_16x16x64_bf16 v[56:59], v[32:35], a[224:231], v2
    v_smfmac_f32_16x16x64_bf16 v[52:55], v[32:35], a[88:95], v2
    v_smfmac_f32_16x16x64_bf16 v[60:63], v[32:35], a[232:239], v2
    buffer_load_dword v7, v7, s[8:11], s82 offen sc1
    s_waitcnt lgkmcnt(2)
    v_smfmac_f32_16x16x64_bf16 v[48:51], v[36:39], a[96:103], v2
    v_smfmac_f32_16x16x64_bf16 v[56:59], v[36:39], a[240:247], v2
    s_waitcnt vmcnt(2)
    v_smfmac_f32_16x16x64_bf16 v[52:55], v[36:39], a[104:111], v2
    v_smfmac_f32_16x16x64_bf16 v[60:63], v[36:39], a[248:255], v2
    s_waitcnt lgkmcnt(1)
    v_smfmac_f32_16x16x64_bf16 v[48:51], v[40:43], a[112:119], v2
    v_smfmac_f32_16x16x64_bf16 v[56:59], v[40:43], v[80:87], v2
    v_smfmac_f32_16x16x64_bf16 v[52:55], v[40:43], a[120:127], v2
    v_smfmac_f32_16x16x64_bf16 v[60:63], v[40:43], v[88:95], v2
    s_waitcnt lgkmcnt(0)
    v_smfmac_f32_16x16x64_bf16 v[48:51], v[44:47], a[128:135], v2
    v_smfmac_f32_16x16x64_bf16 v[56:59], v[44:47], v[96:103], v2
    v_smfmac_f32_16x16x64_bf16 v[52:55], v[44:47], a[136:143], v2
    s_waitcnt vmcnt(3)
    v_smfmac_f32_16x16x64_bf16 v[60:63], v[44:47], v[104:111], v2
    v_add_f32 v48, v48, v50
    v_add_f32 v49, v49, v51
    v_add_f32 v56, v56, v58
    v_add_f32 v57, v57, v59
    v_cvt_pk_bf16_f32 v50, v48, v49
    v_cvt_pk_bf16_f32 v51, v56, v57
    v_add_f32 v52, v52, v54
    v_add_f32 v53, v53, v55
    v_mfma_f32_16x16x16_bf16 v[56:59], v[50:51], v[4:5], 0
    v_add_f32 v60, v60, v62
    v_add_f32 v61, v61, v63
    v_cvt_pk_bf16_f32 v54, v52, v53
    v_cvt_pk_bf16_f32 v55, v60, v61
    v_smfmac_f32_16x16x64_bf16 v[72:75], v[24:27], v[112:119], v2
    v_mfma_f32_16x16x16_bf16 v[60:63], v[54:55], v[4:5], 0
    v_cvt_pk_bf16_f32 v48, v56, v57
    v_cvt_pk_bf16_f32 v49, v58, v59
    v_add_u32 v8, 69632, v0
    v_smfmac_f32_16x16x64_bf16 v[76:79], v[24:27], v[120:127], v2
    v_mov_b32 v9, 0
    v_mov_b32 v9, 0
    v_cvt_pk_bf16_f32 v50, v60, v61
    v_cvt_pk_bf16_f32 v51, v62, v63
    v_mov_b32 v9, 0
    v_mov_b32 v9, 0
    v_mfma_f32_16x16x32_bf16 v[60:63], v[68:71], v[48:51], 0
    v_mfma_f32_16x16x32_bf16 v[56:59], v[64:67], v[48:51], 0
    v_mfma_f32_16x16x32_bf16 v[52:55], v[48:51], v[48:51], 0
    s_cmp_ge_u32 s7, 63
    s_cbranch_scc1 L_chain_last1
    v_smfmac_f32_16x16x64_bf16 v[72:75], v[28:31], v[128:135], v2
    v_mov_b32_dpp v56, v60 row_ror:8 row_mask:0xf bank_mask:0xc
    v_mov_b32_dpp v57, v61 row_ror:8 row_mask:0xf bank_mask:0xc
    v_mov_b32_dpp v58, v62 row_ror:8 row_mask:0xf bank_mask:0xc
    v_mov_b32_dpp v59, v63 row_ror:8 row_mask:0xf bank_mask:0xc
    ds_write_b128 v0, v[56:59] offset:10240
    ds_write_b128 v10, v[52:55]
    v_smfmac_f32_16x16x64_bf16 v[76:79], v[28:31], v[136:143], v2
    buffer_store_dwordx4 v[48:51], v0, s[8:11], s63 offen sc1
    v_smfmac_f32_16x16x64_bf16 v[72:75], v[32:35], v[144:151], v2
    v_smfmac_f32_16x16x64_bf16 v[76:79], v[32:35], v[152:159], v2
    v_smfmac_f32_16x16x64_bf16 v[72:75], v[36:39], v[160:167], v2
    s_waitcnt lgkmcnt(0)
    s_barrier
    ds_read_b128 v[48:51], v0 offset:9216
    ds_read_b128 v[52:55], v0 offset:12288
    v_smfmac_f32_16x16x64_bf16 v[76:79], v[36:39], v[168:175], v2
    ds_read_b128 v[60:63], v0 offset:11264
    ds_read2_b32 v[64:65], v3 offset0:0 offset1:32
    v_smfmac_f32_16x16x64_bf16 v[72:75], v[40:43], v[176:183], v2
    ds_read2_b32 v[66:67], v3 offset0:128 offset1:160
    v_smfmac_f32_16x16x64_bf16 v[76:79], v[40:43], v[184:191], v2
    v_smfmac_f32_16x16x64_bf16 v[72:75], v[44:47], v[192:199], v2
    v_smfmac_f32_16x16x64_bf16 v[76:79], v[44:47], v[200:207], v2
    s_waitcnt lgkmcnt(4)
    v_add_f32 v56, v56, v48
    v_add_f32 v57, v57, v49
    v_add_f32 v58, v58, v50
    v_add_f32 v59, v59, v51
    s_waitcnt lgkmcnt(2)
    v_pk_add_f32 v[52:53], v[52:53], v[60:61]
    v_pk_add_f32 v[54:55], v[54:55], v[62:63]
    s_waitcnt lgkmcnt(0)
    v_pk_add_f32 v[64:65], v[64:65], v[66:67]
    v_pk_add_f32 v[56:57], v[56:57], v[52:53]
    v_pk_add_f32 v[58:59], v[58:59], v[54:55]
    v_add_f32 v64, v64, v65
    v_max3_f32 v68, v56, v57, v58
    v_max3_f32 v68, v68, v59, v64
    v_pk_add_f32 v[72:73], v[72:73], v[74:75]
    v_pk_add_f32 v[76:77], v[76:77], v[78:79]
    v_max_f32_dpp v69, v68, v68 row_ror:8 row_mask:0xf bank_mask:0xf
    v_max_f32_dpp v68, v68, v68 row_ror:8 row_mask:0xf bank_mask:0xf
    v_cvt_pk_bf16_f32 v74, v72, v73
    v_cvt_pk_bf16_f32 v75, v76, v77
    v_permlane16_swap_b32 v68, v69
    v_max_f32 v65, v68, v69
    v_max_f32 v69, v68, v69
    v_mov_b32 v49, 0
    v_mov_b32 v50, 0
    v_permlane32_swap_b32 v65, v69
    v_max_f32 v68, v65, v69
    v_mul_f32 v68, s75, v68
    v_fma_f32 v56, v56, s74, v68
    v_fma_f32 v57, v57, s74, v68
    v_fma_f32 v58, v58, s74, v68
    v_fma_f32 v59, v59, s74, v68
    v_fma_f32 v64, v64, s74, v68
    v_exp_f32 v56, v56
    v_exp_f32 v57, v57
    v_exp_f32 v58, v58
    v_exp_f32 v59, v59
    v_exp_f32_e64 v64, v64
    v_cvt_pk_bf16_f32 v60, v56, v57
    v_cvt_pk_bf16_f32 v61, v58, v59
    v_cndmask_b32 v52, 0, v60, s[70:71]
    v_cndmask_b32 v53, 0, v61, s[70:71]
    v_cndmask_b32 v54, v60, 0, s[70:71]
    v_cndmask_b32 v55, v61, 0, s[70:71]
    v_pk_add_f32 v[66:67], v[56:57], v[58:59]
    s_waitcnt vmcnt(2)
    v_mfma_f32_16x16x32_bf16 v[60:63], v[12:15], v[52:55], 0
    v_cvt_pk_bf16_f32 v72, v64, 0
    v_cvt_pk_bf16_f32 v73, 0, v64
    v_mfma_f32_16x16x32_bf16 v[68:71], v[16:19], v[52:55], 0
    v_cndmask_b32 v48, v73, v72, s[70:71]
    v_cndmask_b32 v51, v73, v72, s[70:71]
    v_add_f32 v65, v66, v67
    v_mfma_f32_16x16x16_bf16 v[60:63], v[74:75], v[48:49], v[60:63]
    v_add_f32_e64 v65, v65, v64
    ds_read_b128 v[20:23], v8 offset:0
    ds_read_b128 v[24:27], v8 offset:1024
    v_mfma_f32_16x16x16_bf16 v[68:71], v[74:75], v[50:51], v[68:71]
    v_add_f32_dpp v66, v65, v65 row_ror:8 row_mask:0xf bank_mask:0xf
    v_add_f32_dpp v65, v65, v65 row_ror:8 row_mask:0xf bank_mask:0xf
    ds_read_b128 v[28:31], v8 offset:2048
    ds_read_b128 v[32:35], v8 offset:3072
    v_permlane16_swap_b32 v65, v66
    v_add_f32 v64, v65, v66
    v_add_f32_e64 v65, v65, v66
    v_add_f32_dpp v56, v60, v60 row_ror:8 row_mask:0xf bank_mask:0x3
    v_add_f32_dpp v57, v61, v61 row_ror:8 row_mask:0xf bank_mask:0x3
    v_permlane32_swap_b32_e64 v64, v65
    v_add_f32_dpp v58, v62, v62 row_ror:8 row_mask:0xf bank_mask:0x3
    v_add_f32_dpp v59, v63, v63 row_ror:8 row_mask:0xf bank_mask:0x3
    v_add_f32 v64, v65, v64
    v_rcp_f32 v64, v64
    v_add_f32_dpp v56, v68, v68 row_ror:8 row_mask:0xf bank_mask:0xc
    v_add_f32_dpp v57, v69, v69 row_ror:8 row_mask:0xf bank_mask:0xc
    v_add_f32_dpp v58, v70, v70 row_ror:8 row_mask:0xf bank_mask:0xc
    v_add_f32_dpp v59, v71, v71 row_ror:8 row_mask:0xf bank_mask:0xc
    v_pk_mul_f32 v[56:57], v[56:57], v[64:65] op_sel_hi:[1,0]
    v_pk_mul_f32 v[58:59], v[58:59], v[64:65] op_sel_hi:[1,0]
    v_cvt_pk_bf16_f32 v78, v56, v57
    v_cvt_pk_bf16_f32 v79, v58, v59
    ds_write_b64 v6, v[78:79] offset:0
    v_mov_b64 v[48:49], 0
    v_mov_b64 v[50:51], 0
    ds_read_b128 v[36:39], v8 offset:16384
    v_mov_b64 v[52:53], 0
    v_mov_b64 v[54:55], 0
    v_lshlrev_b32 v76, 1, v11
    v_mov_b64 v[56:57], 0
    v_mov_b64 v[58:59], 0
    v_mov_b64 v[60:61], 0
    v_mov_b64 v[62:63], 0
    v_mov_b64 v[44:45], 0
    v_mov_b64 v[46:47], 0
    v_mov_b32 v9, 0
    v_mov_b32_e64 v9, 0
    s_waitcnt lgkmcnt(1)
    s_barrier
    ds_read_b128 v[12:15], v0 offset:0
    v_mov_b64_e64 v[64:65], 0
    ds_read_b128 v[16:19], v0 offset:1024
    v_mov_b64 v[66:67], 0
    v_mov_b64 v[68:69], 0
    v_mov_b64 v[70:71], 0
    v_mov_b64 v[72:73], 0
    ds_read_b128 v[40:43], v8 offset:17408
    v_mov_b64 v[78:79], 0
    v_mov_b32_e64 v9, 0
    s_waitcnt lgkmcnt(1)
    v_smfmac_f32_16x16x64_bf16 v[48:51], v[12:15], v[20:27], v2
    s_add_u32 s7, s7, 1
    ds_read_b128 v[20:23], v8 offset:18432
    v_smfmac_f32_16x16x64_bf16 v[48:51], v[16:19], v[28:35], v2
    s_add_u32 s92, s53, s93
    ds_read_b128 v[24:27], v8 offset:19456
    ds_read_b128 v[28:31], v8 offset:32768
    ds_write_b64 v76, v[74:75] offset:14848
    v_mov_b64 v[74:75], 0
    v_mov_b64_e64 v[76:77], 0
    s_waitcnt lgkmcnt(4)
    v_smfmac_f32_16x16x64_bf16 v[52:55], v[12:15], v[36:43], v2
    s_add_u32 s67, s54, s93
    ds_read_b128 v[32:35], v8 offset:33792
    ds_read_b128 v[36:39], v8 offset:34816
    s_waitcnt lgkmcnt(4)
    v_smfmac_f32_16x16x64_bf16 v[52:55], v[16:19], v[20:27], v2
    s_mov_b32 s68, s60
    ds_read_b128 v[40:43], v8 offset:35840
    ds_read_b128 v[20:23], v8 offset:49152
    v_add_f32 v48, v48, v50
    v_add_f32_e64 v49, v49, v51
    v_smfmac_f32_16x16x64_bf16 v[56:59], v[12:15], v[208:215], v2
    s_mov_b32 s54, s53
    ds_read_b128 v[24:27], v8 offset:50176
    v_cvt_pk_bf16_f32 v48, v48, v49
    v_and_or_b32 v48, v48, -2, s60
    v_smfmac_f32_16x16x64_bf16 v[56:59], v[16:19], v[216:223], v2
    buffer_store_dword v48, v11, s[8:11], s83 offen offset:0 sc1
    s_add_u32 s52, s53, 2048
    v_add_f32 v52, v52, v54
    v_add_f32 v53, v53, v55
    s_waitcnt lgkmcnt(4)
    v_smfmac_f32_16x16x64_bf16 v[60:63], v[12:15], v[28:35], v2
    s_add_u32 s80, s53, 8192
    ds_read_b128 v[28:31], v8 offset:51200
    v_cvt_pk_bf16_f32 v52, v52, v53
    v_and_or_b32 v52, v52, -2, s60
    s_waitcnt lgkmcnt(3)
    v_smfmac_f32_16x16x64_bf16 v[60:63], v[16:19], v[36:43], v2
    buffer_store_dword v52, v11, s[8:11], s83 offen offset:1024 sc1
    s_add_u32 s53, s53, 9216
    ds_read_b128 v[32:35], v8 offset:52224
    v_add_u32 v8, 65536, v8
    ds_read_b128 v[36:39], v8 offset:0
    v_add_f32 v56, v56, v58
    v_add_f32 v57, v57, v59
    s_waitcnt lgkmcnt(3)
    v_smfmac_f32_16x16x64_bf16 v[64:67], v[12:15], v[20:27], v2
    s_cmp_eq_u32 s53, 420864
    s_cselect_b32 s53, 393216, s53
    ds_read_b128 v[40:43], v8 offset:1024
    ds_read_b128 v[20:23], v8 offset:2048
    v_cvt_pk_bf16_f32 v56, v56, v57
    v_and_or_b32 v56, v56, -2, s60
    s_waitcnt lgkmcnt(3)
    v_smfmac_f32_16x16x64_bf16 v[64:67], v[16:19], v[28:35], v2
    buffer_store_dword v56, v11, s[8:11], s83 offen offset:2048 sc1
    s_add_u32 s61, s61, 524288
    ds_read_b128 v[24:27], v8 offset:3072
    ds_read_b128 v[28:31], v8 offset:16384
    v_add_f32 v60, v60, v62
    v_add_f32_e64 v61, v61, v63
    v_smfmac_f32_16x16x64_bf16 v[68:71], v[12:15], v[224:231], v2
    s_add_u32 s63, s63, 131072
    ds_read_b128 v[32:35], v8 offset:17408
    v_cvt_pk_bf16_f32 v60, v60, v61
    v_and_or_b32 v60, v60, -2, s60
    v_smfmac_f32_16x16x64_bf16 v[68:71], v[16:19], v[232:239], v2
    buffer_store_dword v60, v11, s[8:11], s83 offen offset:3072 sc1
    s_sub_u32 s62, s64, 512
    v_add_f32 v64, v64, v66
    v_add_f32_e64 v65, v65, v67
    s_waitcnt lgkmcnt(4)
    v_smfmac_f32_16x16x64_bf16 v[72:75], v[12:15], v[36:43], v2
    s_add_u32 s64, s64, 65536
    ds_read_b128 v[36:39], v8 offset:18432
    v_cvt_pk_bf16_f32 v64, v64, v65
    v_and_or_b32 v64, v64, -2, s60
    s_waitcnt lgkmcnt(3)
    v_smfmac_f32_16x16x64_bf16 v[72:75], v[16:19], v[20:27], v2
    buffer_store_dword v64, v11, s[8:11], s77 offen offset:0 sc1
    s_add_u32 s69, s7, 3
    s_min_u32 s69, s69, 64
    ds_read_b128 v[40:43], v8 offset:19456
    v_add_f32 v68, v68, v70
    v_add_f32_e64 v69, v69, v71
    v_smfmac_f32_16x16x64_bf16 v[76:79], v[12:15], v[240:247], v2
    s_mov_b32 s79, 524288
    v_cvt_pk_bf16_f32 v68, v68, v69
    v_and_or_b32 v68, v68, -2, s60
    v_smfmac_f32_16x16x64_bf16 v[76:79], v[16:19], v[248:255], v2
    buffer_store_dword v68, v11, s[8:11], s77 offen offset:1024 sc1
    v_add_f32 v72, v72, v74
    v_add_f32_e64 v73, v73, v75
    s_waitcnt lgkmcnt(2)
    v_smfmac_f32_16x16x64_bf16 v[44:47], v[12:15], v[28:35], v2
    v_cvt_pk_bf16_f32 v72, v72, v73
    v_and_or_b32 v72, v72, -2, s60
    s_waitcnt lgkmcnt(0)
    v_smfmac_f32_16x16x64_bf16 v[44:47], v[16:19], v[36:43], v2
    buffer_store_dword v72, v11, s[8:11], s77 offen offset:2048 sc1
    v_add_f32 v76, v76, v78
    v_add_f32_e64 v77, v77, v79
    v_cvt_pk_bf16_f32 v76, v76, v77
    v_and_or_b32 v76, v76, -2, s60
    buffer_store_dword v76, v11, s[8:11], s77 offen offset:3072 sc1
    v_mov_b32 v9, 0
    v_mov_b32 v9, 0
    v_add_f32 v44, v44, v46
    v_add_f32 v45, v45, v47
    v_cvt_pk_bf16_f32 v44, v44, v45
    v_and_or_b32 v44, v44, -2, s60
    buffer_store_dword v44, v11, s[8:11], s91 offen offset:0 sc1
    s_xor_b32 s60, s60, 1
    v_and_b32 v34, 16, v0
    v_mov_b32 v35, 0x3f80
    v_lshlrev_b32_e64 v35, v34, v35
    v_cndmask_b32 v64, 0, v35, s[40:41]
    v_cndmask_b32 v65, 0, v35, s[42:43]
    v_cndmask_b32 v66, 0, v35, s[44:45]
    v_cndmask_b32 v67, 0, v35, s[46:47]
    v_bfe_u32 v33, v0, 5, 2
    v_lshl_add_u32 v33, v33, 2, v34
    v_bfe_u32 v34, v0, 8, 1
    v_lshl_add_u32 v33, v34, 6, v33
    v_lshrrev_b32_e64 v34, 9, v0
    v_lshl_add_u32 v33, v34, 5, v33
    v_mov_b32 v36, -1
    v_mov_b64 v[72:73], 0
    v_mov_b64 v[74:75], 0
    v_mov_b64 v[76:77], 0
    v_mov_b64 v[78:79], 0
    s_waitcnt vmcnt(10)
    v_min_u32_dpp v7, v7, v7 quad_perm:[1,0,3,2] row_mask:0xf bank_mask:0xf
    s_nop 1
    v_min_u32_dpp v7, v7, v7 quad_perm:[2,3,0,1] row_mask:0xf bank_mask:0xf
    s_nop 1
    v_min_u32_dpp v7, v7, v7 row_half_mirror row_mask:0xf bank_mask:0xf
    s_nop 1
    v_readfirstlane_b32 s66, v7
    v_bfe_u32 v7, v0, 6, 1
    v_mul_u32_u24 v7, 4080, v7
    v_and_or_b32 v9, v11, 28, 0
    v_add_u32_e64 v7, v7, v9
    s_nop 3
    s_nop 3
    s_nop 3
    s_nop 3
    s_nop 3
    s_nop 3
    s_nop 3
    s_nop 3
    s_nop 3
    s_nop 3
    buffer_load_dwordx4 v[48:51], v1, s[8:11], s56 offen sc1
    buffer_load_dwordx4 v[52:55], v1, s[8:11], s57 offen sc1
    buffer_load_dwordx4 v[56:59], v1, s[8:11], s58 offen sc1
    buffer_load_dwordx4 v[60:63], v1, s[8:11], s59 offen sc1
    s_barrier
L_redp_120:
    s_waitcnt vmcnt(2)
    v_bitop3_b32 v34, v48, v52, s68 bitop3:0x7e
    v_mfma_f32_16x16x32_bf16 v[68:71], v[48:51], v[64:67], 0
    v_mfma_f32_16x16x32_bf16 v[68:71], v[52:55], v[64:67], v[68:71]
    s_waitcnt vmcnt(0)
    v_bitop3_b32 v35, v56, v60, s68 bitop3:0x7e
    v_bitop3_b32 v34, v34, v35, 1 bitop3:0xa8
    v_cmp_ne_u32 vcc, 0, v34
    v_mfma_f32_16x16x32_bf16 v[68:71], v[56:59], v[64:67], v[68:71]
    v_mfma_f32_16x16x32_bf16 v[68:71], v[60:63], v[64:67], v[68:71]
    s_cbranch_vccnz L_redr_121
    v_mov_b32 v9, 0
    v_mov_b32 v9, 0
    v_mov_b32 v9, 0
    v_mov_b32 v9, 0
    v_mov_b32 v9, 0
    v_mov_b32 v9, 0
    v_mov_b32 v9, 0
    v_permlane32_swap_b32 v68, v70
    v_permlane32_swap_b32 v69, v71
    v_pk_add_f32 v[68:69], v[68:69], v[70:71]
    v_cvt_pk_bf16_f32 v68, v68, v69
    v_min_u32_e64 v68, -2, v68
    buffer_store_dword v68, v33, s[8:11], s92 offen sc1
    buffer_store_dword v36, v33, s[8:11], s67 offen sc1
L_red_done_119:
    s_cmp_ge_u32 s66, s69
    s_cbranch_scc1 L_poll_s1
    s_cmp_ge_u32 s66, s69
    s_cbranch_scc1 L_kvd_123
    s_mov_b32 s79, 524288
L_kv_122:
    v_mov_b32 v76, 4096
    buffer_load_dwordx4 v[72:75], off, s[8:11], s82 sc1
    buffer_load_dwordx4 v[76:79], v76, s[8:11], s82 offen sc1
    s_waitcnt vmcnt(0)
    v_min3_u32 v72, v72, v73, v74
    v_min3_u32 v72, v72, v75, v76
    v_min3_u32 v72, v72, v77, v78
    v_min_u32 v72, v72, v79
    s_nop 0
    v_readfirstlane_b32 s66, v72
    v_mov_b64 v[72:73], 0
    v_mov_b64 v[74:75], 0
    v_mov_b64 v[76:77], 0
    v_mov_b64_e64 v[78:79], 0
    s_cmp_ge_u32 s66, s69
    s_cbranch_scc1 L_kvd_123
    s_sub_u32 s79, s79, 1
    s_cbranch_scc1 L_fail
    s_branch L_kv_122
L_kvd_123:
    s_mov_b32 s79, 524288
    s_waitcnt vmcnt(0)
    s_branch L_poll_s1
L_redr_121:
    buffer_load_dwordx4 v[48:51], v1, s[8:11], s56 offen sc1
    buffer_load_dwordx4 v[52:55], v1, s[8:11], s57 offen sc1
    buffer_load_dwordx4 v[56:59], v1, s[8:11], s58 offen sc1
    buffer_load_dwordx4 v[60:63], v1, s[8:11], s59 offen sc1
    s_sub_u32 s79, s79, 1
    s_cbranch_scc1 L_fail
    s_branch L_redp_120
L_retry2_s1:
    s_waitcnt vmcnt(3)
    v_max3_u32 v9, v28, v29, v30
    v_max3_u32 v9, v9, v31, v8
    v_cmp_eq_u32_e64 vcc, -1, v9
    ds_write_b128 v0, v[28:31] offset:3072
    ds_write_b32 v11, v8 offset:8448
    s_cbranch_vccz L_retry2_s1_ok
    buffer_load_dwordx4 v[28:31], v0, s[8:11], s52 offen offset:1024 sc1
    buffer_load_dword v8, v11, s[8:11], s80 offen offset:256 sc1
L_retry2_s1_l:
    buffer_load_dwordx4 v[28:31], v0, s[8:11], s52 offen offset:1024 sc1
    buffer_load_dword v8, v11, s[8:11], s80 offen offset:256 sc1
    s_waitcnt vmcnt(2)
    v_max3_u32 v9, v28, v29, v30
    v_max3_u32 v9, v9, v31, v8
    v_cmp_eq_u32_e64 vcc, -1, v9
    ds_write_b128 v0, v[28:31] offset:3072
    ds_write_b32 v11, v8 offset:8448
    s_sub_u32 s79, s79, 1
    s_cbranch_scc1 L_fail
    s_cbranch_vccnz L_retry2_s1_l
L_retry2_s1_ok:
    s_branch L_back2_s1_go
L_poll_s2:
    buffer_load_dwordx4 v[12:15], v0, s[8:11], s52 offen sc1
L_poll_s2_2:
    s_waitcnt vmcnt(3)
    ds_read_b128 v[32:35], v0 offset:24576
    ds_read_b128 v[36:39], v0 offset:25600
    ds_read_b128 v[40:43], v0 offset:26624
    ds_read_b128 v[44:47], v0 offset:27648
    ds_read_b128 v[64:67], v0 offset:40960
    ds_read_b128 v[68:71], v0 offset:41984
    v_mov_b64 v[48:49], 0
    v_mov_b64 v[50:51], 0
    v_mov_b64 v[52:53], 0
    v_mov_b64 v[54:55], 0
    v_mov_b64 v[56:57], 0
    v_mov_b64 v[58:59], 0
    v_mov_b64 v[60:61], 0
    v_mov_b64_e64 v[62:63], 0
L_retry_s2:
    buffer_load_dwordx4 v[12:15], v0, s[8:11], s52 offen sc1
    s_waitcnt vmcnt(1)
L_step_s2:
    v_max3_u32 v9, v12, v13, v14
    v_max_u32 v9, v9, v15
    v_cmp_eq_u32_e64 vcc, -1, v9
    ds_write_b128 v0, v[12:15] offset:4096
    s_sub_u32 s79, s79, 1
    s_cbranch_scc1 L_fail
    s_cbranch_vccnz L_retry_s2
    v_smfmac_f32_16x16x64_bf16 v[48:51], v[12:15], a[0:7], v2
    v_smfmac_f32_16x16x64_bf16 v[56:59], v[12:15], a[144:151], v2
    buffer_load_dwordx4 v[28:31], v0, s[8:11], s52 offen offset:1024 sc1
    v_smfmac_f32_16x16x64_bf16 v[52:55], v[12:15], a[8:15], v2
    s_waitcnt lgkmcnt(0)
    s_barrier
    ds_read_b128 v[16:19], v0 offset:6144
    ds_read_b128 v[20:23], v0 offset:0
    v_smfmac_f32_16x16x64_bf16 v[60:63], v[12:15], a[152:159], v2
    ds_read_b128 v[24:27], v0 offset:2048
    buffer_load_dword v8, v11, s[8:11], s80 offen offset:512 sc1
    v_smfmac_f32_16x16x64_bf16 v[72:75], v[12:15], v[32:39], v2
    v_smfmac_f32_16x16x64_bf16 v[76:79], v[12:15], v[40:47], v2
    s_waitcnt lgkmcnt(2)
    v_smfmac_f32_16x16x64_bf16 v[48:51], v[16:19], a[16:23], v2
    ds_read_b128 v[32:35], v0 offset:43008
    v_smfmac_f32_16x16x64_bf16 v[56:59], v[16:19], a[160:167], v2
    ds_read_b128 v[36:39], v0 offset:44032
    v_smfmac_f32_16x16x64_bf16 v[52:55], v[16:19], a[24:31], v2
    ds_read_b128 v[40:43], v0 offset:57344
    v_smfmac_f32_16x16x64_bf16 v[60:63], v[16:19], a[168:175], v2
    ds_read_b128 v[44:47], v0 offset:58368
    buffer_load_dwordx4 v[28:31], v0, s[8:11], s52 offen offset:1024 sc1
    v_smfmac_f32_16x16x64_bf16 v[72:75], v[16:19], v[64:71], v2
    s_waitcnt lgkmcnt(2)
    v_smfmac_f32_16x16x64_bf16 v[76:79], v[16:19], v[32:39], v2
    ds_read_b128 v[32:35], v0 offset:59392
    buffer_load_dword v8, v11, s[8:11], s80 offen offset:512 sc1
    s_waitcnt lgkmcnt(6)
    v_smfmac_f32_16x16x64_bf16 v[48:51], v[20:23], a[32:39], v2
    ds_read_b128 v[36:39], v0 offset:60416
    buffer_load_dwordx4 v[64:67], v0, s[8:11], s61 offen sc1
    v_smfmac_f32_16x16x64_bf16 v[56:59], v[20:23], a[176:183], v2
    v_smfmac_f32_16x16x64_bf16 v[52:55], v[20:23], a[40:47], v2
    v_smfmac_f32_16x16x64_bf16 v[60:63], v[20:23], a[184:191], v2
    s_waitcnt vmcnt(3)
    v_max3_u32 v9, v28, v29, v30
    s_waitcnt lgkmcnt(2)
    v_smfmac_f32_16x16x64_bf16 v[72:75], v[20:23], v[40:47], v2
    buffer_load_dwordx4 v[68:71], v0, s[8:11], s61 offen offset:1024 sc1
    v_max3_u32 v9, v9, v31, v8
    s_waitcnt lgkmcnt(0)
    v_smfmac_f32_16x16x64_bf16 v[76:79], v[20:23], v[32:39], v2
    v_cmp_eq_u32_e64 vcc, -1, v9
    s_waitcnt lgkmcnt(6)
    v_smfmac_f32_16x16x64_bf16 v[48:51], v[24:27], a[48:55], v2
    ds_write_b128 v0, v[28:31] offset:5120
    v_smfmac_f32_16x16x64_bf16 v[56:59], v[24:27], a[192:199], v2
    ds_write_b32 v11, v8 offset:8704
    v_smfmac_f32_16x16x64_bf16 v[52:55], v[24:27], a[56:63], v2
    s_cbranch_vccnz L_retry2_s2
L_back2_s2_go:
    buffer_load_dwordx4 v[12:15], v0, s[8:11], s61 offen offset:2048 sc1
    v_smfmac_f32_16x16x64_bf16 v[60:63], v[24:27], a[200:207], v2
    s_waitcnt lgkmcnt(0)
    s_barrier
    ds_read_b128 v[32:35], v0 offset:7168
    v_smfmac_f32_16x16x64_bf16 v[48:51], v[28:31], a[64:71], v2
    ds_read_b128 v[36:39], v0 offset:1024
    v_smfmac_f32_16x16x64_bf16 v[56:59], v[28:31], a[208:215], v2
    ds_read_b128 v[40:43], v0 offset:3072
    v_smfmac_f32_16x16x64_bf16 v[52:55], v[28:31], a[72:79], v2
    ds_read_b128 v[44:47], v0 offset:8192
    buffer_load_dwordx4 v[16:19], v0, s[8:11], s61 offen offset:3072 sc1
    v_smfmac_f32_16x16x64_bf16 v[60:63], v[28:31], a[216:223], v2
    s_waitcnt lgkmcnt(3)
    v_smfmac_f32_16x16x64_bf16 v[48:51], v[32:35], a[80:87], v2
    v_smfmac_f32_16x16x64_bf16 v[56:59], v[32:35], a[224:231], v2
    v_smfmac_f32_16x16x64_bf16 v[52:55], v[32:35], a[88:95], v2
    v_smfmac_f32_16x16x64_bf16 v[60:63], v[32:35], a[232:239], v2
    s_waitcnt lgkmcnt(2)
    v_smfmac_f32_16x16x64_bf16 v[48:51], v[36:39], a[96:103], v2
    buffer_load_dword v7, v7, s[8:11], s82 offen sc1
    v_smfmac_f32_16x16x64_bf16 v[56:59], v[36:39], a[240:247], v2
    s_waitcnt vmcnt(3)
    v_smfmac_f32_16x16x64_bf16 v[52:55], v[36:39], a[104:111], v2
    v_smfmac_f32_16x16x64_bf16 v[60:63], v[36:39], a[248:255], v2
    s_waitcnt lgkmcnt(1)
    v_smfmac_f32_16x16x64_bf16 v[48:51], v[40:43], a[112:119], v2
    v_smfmac_f32_16x16x64_bf16 v[56:59], v[40:43], v[80:87], v2
    v_smfmac_f32_16x16x64_bf16 v[52:55], v[40:43], a[120:127], v2
    v_smfmac_f32_16x16x64_bf16 v[60:63], v[40:43], v[88:95], v2
    s_waitcnt lgkmcnt(0)
    v_smfmac_f32_16x16x64_bf16 v[48:51], v[44:47], a[128:135], v2
    v_smfmac_f32_16x16x64_bf16 v[56:59], v[44:47], v[96:103], v2
    v_smfmac_f32_16x16x64_bf16 v[52:55], v[44:47], a[136:143], v2
    s_waitcnt vmcnt(3)
    v_smfmac_f32_16x16x64_bf16 v[60:63], v[44:47], v[104:111], v2
    v_add_f32 v48, v48, v50
    v_add_f32 v49, v49, v51
    v_add_f32 v56, v56, v58
    v_add_f32_e64 v57, v57, v59
    v_cvt_pk_bf16_f32 v50, v48, v49
    v_cvt_pk_bf16_f32 v51, v56, v57
    v_add_f32 v52, v52, v54
    v_add_f32 v53, v53, v55
    v_mfma_f32_16x16x16_bf16 v[56:59], v[50:51], v[4:5], 0
    v_add_f32 v60, v60, v62
    v_add_f32 v61, v61, v63
    v_cvt_pk_bf16_f32 v54, v52, v53
    v_cvt_pk_bf16_f32 v55, v60, v61
    v_smfmac_f32_16x16x64_bf16 v[72:75], v[24:27], v[112:119], v2
    v_mfma_f32_16x16x16_bf16 v[60:63], v[54:55], v[4:5], 0
    v_cvt_pk_bf16_f32 v48, v56, v57
    v_cvt_pk_bf16_f32 v49, v58, v59
    v_add_u32 v8, 73728, v0
    v_smfmac_f32_16x16x64_bf16 v[76:79], v[24:27], v[120:127], v2
    v_mov_b32 v9, 0
    v_mov_b32 v9, 0
    v_cvt_pk_bf16_f32 v50, v60, v61
    v_cvt_pk_bf16_f32 v51, v62, v63
    v_mov_b32 v9, 0
    v_mov_b32 v9, 0
    v_mfma_f32_16x16x32_bf16 v[60:63], v[68:71], v[48:51], 0
    v_mfma_f32_16x16x32_bf16 v[56:59], v[64:67], v[48:51], 0
    v_mfma_f32_16x16x32_bf16 v[52:55], v[48:51], v[48:51], 0
    s_cmp_ge_u32 s7, 63
    s_cbranch_scc1 L_chain_last2
    v_smfmac_f32_16x16x64_bf16 v[72:75], v[28:31], v[128:135], v2
    v_mov_b32_dpp v56, v60 row_ror:8 row_mask:0xf bank_mask:0xc
    v_mov_b32_dpp v57, v61 row_ror:8 row_mask:0xf bank_mask:0xc
    v_mov_b32_dpp v58, v62 row_ror:8 row_mask:0xf bank_mask:0xc
    v_mov_b32_dpp v59, v63 row_ror:8 row_mask:0xf bank_mask:0xc
    ds_write_b128 v0, v[56:59] offset:11264
    ds_write_b128 v10, v[52:55]
    v_smfmac_f32_16x16x64_bf16 v[76:79], v[28:31], v[136:143], v2
    v_smfmac_f32_16x16x64_bf16 v[72:75], v[32:35], v[144:151], v2
    buffer_store_dwordx4 v[48:51], v0, s[8:11], s63 offen sc1
    v_smfmac_f32_16x16x64_bf16 v[76:79], v[32:35], v[152:159], v2
    v_smfmac_f32_16x16x64_bf16 v[72:75], v[36:39], v[160:167], v2
    s_waitcnt lgkmcnt(0)
    s_barrier
    ds_read_b128 v[48:51], v0 offset:12288
    ds_read_b128 v[52:55], v0 offset:9216
    v_smfmac_f32_16x16x64_bf16 v[76:79], v[36:39], v[168:175], v2
    ds_read_b128 v[60:63], v0 offset:10240
    ds_read2_b32 v[64:65], v3 offset0:0 offset1:32
    v_smfmac_f32_16x16x64_bf16 v[72:75], v[40:43], v[176:183], v2
    ds_read2_b32 v[66:67], v3 offset0:128 offset1:160
    v_smfmac_f32_16x16x64_bf16 v[76:79], v[40:43], v[184:191], v2
    v_smfmac_f32_16x16x64_bf16 v[72:75], v[44:47], v[192:199], v2
    v_smfmac_f32_16x16x64_bf16 v[76:79], v[44:47], v[200:207], v2
    s_waitcnt lgkmcnt(4)
    v_add_f32 v56, v56, v48
    v_add_f32 v57, v57, v49
    v_add_f32 v58, v58, v50
    v_add_f32 v59, v59, v51
    s_waitcnt lgkmcnt(2)
    v_pk_add_f32 v[52:53], v[52:53], v[60:61]
    v_pk_add_f32 v[54:55], v[54:55], v[62:63]
    s_waitcnt lgkmcnt(0)
    v_pk_add_f32 v[64:65], v[64:65], v[66:67]
    v_pk_add_f32 v[56:57], v[56:57], v[52:53]
    v_pk_add_f32 v[58:59], v[58:59], v[54:55]
    v_add_f32 v64, v64, v65
    v_max3_f32 v68, v56, v57, v58
    v_max3_f32 v68, v68, v59, v64
    v_pk_add_f32 v[72:73], v[72:73], v[74:75]
    v_pk_add_f32 v[76:77], v[76:77], v[78:79]
    v_max_f32_dpp v69, v68, v68 row_ror:8 row_mask:0xf bank_mask:0xf
    v_max_f32_dpp v68, v68, v68 row_ror:8 row_mask:0xf bank_mask:0xf
    v_cvt_pk_bf16_f32 v74, v72, v73
    v_cvt_pk_bf16_f32 v75, v76, v77
    v_permlane16_swap_b32 v68, v69
    v_max_f32 v65, v68, v69
    v_max_f32 v69, v68, v69
    v_mov_b32 v49, 0
    v_mov_b32 v50, 0
    v_permlane32_swap_b32 v65, v69
    v_max_f32 v68, v65, v69
    v_mul_f32 v68, s75, v68
    v_fma_f32 v56, v56, s74, v68
    v_fma_f32 v57, v57, s74, v68
    v_fma_f32 v58, v58, s74, v68
    v_fma_f32 v59, v59, s74, v68
    v_fma_f32 v64, v64, s74, v68
    v_exp_f32 v56, v56
    v_exp_f32 v57, v57
    v_exp_f32 v58, v58
    v_exp_f32 v59, v59
    v_exp_f32_e64 v64, v64
    v_cvt_pk_bf16_f32 v60, v56, v57
    v_cvt_pk_bf16_f32 v61, v58, v59
    v_cndmask_b32 v52, 0, v60, s[70:71]
    v_cndmask_b32 v53, 0, v61, s[70:71]
    v_cndmask_b32 v54, v60, 0, s[70:71]
    v_cndmask_b32 v55, v61, 0, s[70:71]
    v_pk_add_f32 v[66:67], v[56:57], v[58:59]
    s_waitcnt vmcnt(2)
    v_mfma_f32_16x16x32_bf16 v[60:63], v[12:15], v[52:55], 0
    v_cvt_pk_bf16_f32 v72, v64, 0
    v_cvt_pk_bf16_f32 v73, 0, v64
    v_mfma_f32_16x16x32_bf16 v[68:71], v[16:19], v[52:55], 0
    v_cndmask_b32 v48, v73, v72, s[70:71]
    v_cndmask_b32 v51, v73, v72, s[70:71]
    v_add_f32 v65, v66, v67
    v_mfma_f32_16x16x16_bf16 v[60:63], v[74:75], v[48:49], v[60:63]
    v_add_f32_e64 v65, v65, v64
    ds_read_b128 v[20:23], v8 offset:0
    ds_read_b128 v[24:27], v8 offset:1024
    v_mfma_f32_16x16x16_bf16 v[68:71], v[74:75], v[50:51], v[68:71]
    v_add_f32_dpp v66, v65, v65 row_ror:8 row_mask:0xf bank_mask:0xf
    v_add_f32_dpp v65, v65, v65 row_ror:8 row_mask:0xf bank_mask:0xf
    ds_read_b128 v[28:31], v8 offset:2048
    ds_read_b128 v[32:35], v8 offset:3072
    v_permlane16_swap_b32 v65, v66
    v_add_f32 v64, v65, v66
    v_add_f32_e64 v65, v65, v66
    v_add_f32_dpp v56, v60, v60 row_ror:8 row_mask:0xf bank_mask:0x3
    v_add_f32_dpp v57, v61, v61 row_ror:8 row_mask:0xf bank_mask:0x3
    v_permlane32_swap_b32_e64 v64, v65
    v_add_f32_dpp v58, v62, v62 row_ror:8 row_mask:0xf bank_mask:0x3
    v_add_f32_dpp v59, v63, v63 row_ror:8 row_mask:0xf bank_mask:0x3
    v_add_f32 v64, v65, v64
    v_rcp_f32 v64, v64
    v_add_f32_dpp v56, v68, v68 row_ror:8 row_mask:0xf bank_mask:0xc
    v_add_f32_dpp v57, v69, v69 row_ror:8 row_mask:0xf bank_mask:0xc
    v_add_f32_dpp v58, v70, v70 row_ror:8 row_mask:0xf bank_mask:0xc
    v_add_f32_dpp v59, v71, v71 row_ror:8 row_mask:0xf bank_mask:0xc
    v_pk_mul_f32 v[56:57], v[56:57], v[64:65] op_sel_hi:[1,0]
    v_pk_mul_f32 v[58:59], v[58:59], v[64:65] op_sel_hi:[1,0]
    v_cvt_pk_bf16_f32 v78, v56, v57
    v_cvt_pk_bf16_f32 v79, v58, v59
    ds_write_b64 v6, v[78:79] offset:0
    v_mov_b64 v[48:49], 0
    v_mov_b64 v[50:51], 0
    ds_read_b128 v[36:39], v8 offset:16384
    v_mov_b64 v[52:53], 0
    v_mov_b64 v[54:55], 0
    v_lshlrev_b32 v76, 1, v11
    v_mov_b64 v[56:57], 0
    v_mov_b64 v[58:59], 0
    v_mov_b64 v[60:61], 0
    v_mov_b64 v[62:63], 0
    v_mov_b64 v[44:45], 0
    v_mov_b64 v[46:47], 0
    v_mov_b32 v9, 0
    v_mov_b32_e64 v9, 0
    s_waitcnt lgkmcnt(1)
    s_barrier
    ds_read_b128 v[12:15], v0 offset:0
    v_mov_b64_e64 v[64:65], 0
    ds_read_b128 v[16:19], v0 offset:1024
    v_mov_b64 v[66:67], 0
    v_mov_b64 v[68:69], 0
    v_mov_b64 v[70:71], 0
    v_mov_b64 v[72:73], 0
    ds_read_b128 v[40:43], v8 offset:17408
    v_mov_b64 v[78:79], 0
    v_mov_b32_e64 v9, 0
    s_waitcnt lgkmcnt(1)
    v_smfmac_f32_16x16x64_bf16 v[48:51], v[12:15], v[20:27], v2
    s_add_u32 s7, s7, 1
    ds_read_b128 v[20:23], v8 offset:18432
    v_smfmac_f32_16x16x64_bf16 v[48:51], v[16:19], v[28:35], v2
    s_add_u32 s92, s53, s93
    ds_read_b128 v[24:27], v8 offset:19456
    ds_read_b128 v[28:31], v8 offset:32768
    ds_write_b64 v76, v[74:75] offset:15360
    v_mov_b64 v[74:75], 0
    v_mov_b64_e64 v[76:77], 0
    s_waitcnt lgkmcnt(4)
    v_smfmac_f32_16x16x64_bf16 v[52:55], v[12:15], v[36:43], v2
    s_add_u32 s67, s54, s93
    ds_read_b128 v[32:35], v8 offset:33792
    ds_read_b128 v[36:39], v8 offset:34816
    s_waitcnt lgkmcnt(4)
    v_smfmac_f32_16x16x64_bf16 v[52:55], v[16:19], v[20:27], v2
    s_mov_b32 s68, s60
    ds_read_b128 v[40:43], v8 offset:35840
    ds_read_b128 v[20:23], v8 offset:49152
    v_add_f32 v48, v48, v50
    v_add_f32_e64 v49, v49, v51
    v_smfmac_f32_16x16x64_bf16 v[56:59], v[12:15], v[208:215], v2
    s_mov_b32 s54, s53
    ds_read_b128 v[24:27], v8 offset:50176
    v_cvt_pk_bf16_f32 v48, v48, v49
    v_and_or_b32 v48, v48, -2, s60
    v_smfmac_f32_16x16x64_bf16 v[56:59], v[16:19], v[216:223], v2
    buffer_store_dword v48, v11, s[8:11], s83 offen offset:0 sc1
    s_add_u32 s52, s53, 4096
    v_add_f32 v52, v52, v54
    v_add_f32 v53, v53, v55
    s_waitcnt lgkmcnt(4)
    v_smfmac_f32_16x16x64_bf16 v[60:63], v[12:15], v[28:35], v2
    s_add_u32 s80, s53, 8192
    ds_read_b128 v[28:31], v8 offset:51200
    v_cvt_pk_bf16_f32 v52, v52, v53
    v_and_or_b32 v52, v52, -2, s60
    s_waitcnt lgkmcnt(3)
    v_smfmac_f32_16x16x64_bf16 v[60:63], v[16:19], v[36:43], v2
    buffer_store_dword v52, v11, s[8:11], s83 offen offset:1024 sc1
    s_add_u32 s53, s53, 9216
    ds_read_b128 v[32:35], v8 offset:52224
    v_add_u32 v8, 65536, v8
    ds_read_b128 v[36:39], v8 offset:0
    v_add_f32 v56, v56, v58
    v_add_f32 v57, v57, v59
    s_waitcnt lgkmcnt(3)
    v_smfmac_f32_16x16x64_bf16 v[64:67], v[12:15], v[20:27], v2
    s_cmp_eq_u32 s53, 420864
    s_cselect_b32 s53, 393216, s53
    ds_read_b128 v[40:43], v8 offset:1024
    ds_read_b128 v[20:23], v8 offset:2048
    v_cvt_pk_bf16_f32 v56, v56, v57
    v_and_or_b32 v56, v56, -2, s60
    s_waitcnt lgkmcnt(3)
    v_smfmac_f32_16x16x64_bf16 v[64:67], v[16:19], v[28:35], v2
    buffer_store_dword v56, v11, s[8:11], s83 offen offset:2048 sc1
    s_add_u32 s61, s61, 524288
    ds_read_b128 v[24:27], v8 offset:3072
    ds_read_b128 v[28:31], v8 offset:16384
    v_add_f32 v60, v60, v62
    v_add_f32_e64 v61, v61, v63
    v_smfmac_f32_16x16x64_bf16 v[68:71], v[12:15], v[224:231], v2
    s_add_u32 s63, s63, 131072
    ds_read_b128 v[32:35], v8 offset:17408
    v_cvt_pk_bf16_f32 v60, v60, v61
    v_and_or_b32 v60, v60, -2, s60
    v_smfmac_f32_16x16x64_bf16 v[68:71], v[16:19], v[232:239], v2
    buffer_store_dword v60, v11, s[8:11], s83 offen offset:3072 sc1
    s_sub_u32 s62, s64, 1024
    v_add_f32 v64, v64, v66
    v_add_f32_e64 v65, v65, v67
    s_waitcnt lgkmcnt(4)
    v_smfmac_f32_16x16x64_bf16 v[72:75], v[12:15], v[36:43], v2
    s_add_u32 s64, s64, 65536
    ds_read_b128 v[36:39], v8 offset:18432
    v_cvt_pk_bf16_f32 v64, v64, v65
    v_and_or_b32 v64, v64, -2, s60
    s_waitcnt lgkmcnt(3)
    v_smfmac_f32_16x16x64_bf16 v[72:75], v[16:19], v[20:27], v2
    buffer_store_dword v64, v11, s[8:11], s77 offen offset:0 sc1
    s_add_u32 s69, s7, 3
    s_min_u32 s69, s69, 64
    ds_read_b128 v[40:43], v8 offset:19456
    v_add_f32 v68, v68, v70
    v_add_f32_e64 v69, v69, v71
    v_smfmac_f32_16x16x64_bf16 v[76:79], v[12:15], v[240:247], v2
    s_mov_b32 s79, 524288
    v_cvt_pk_bf16_f32 v68, v68, v69
    v_and_or_b32 v68, v68, -2, s60
    v_smfmac_f32_16x16x64_bf16 v[76:79], v[16:19], v[248:255], v2
    buffer_store_dword v68, v11, s[8:11], s77 offen offset:1024 sc1
    v_add_f32 v72, v72, v74
    v_add_f32_e64 v73, v73, v75
    s_waitcnt lgkmcnt(2)
    v_smfmac_f32_16x16x64_bf16 v[44:47], v[12:15], v[28:35], v2
    v_cvt_pk_bf16_f32 v72, v72, v73
    v_and_or_b32 v72, v72, -2, s60
    s_waitcnt lgkmcnt(0)
    v_smfmac_f32_16x16x64_bf16 v[44:47], v[16:19], v[36:43], v2
    buffer_store_dword v72, v11, s[8:11], s77 offen offset:2048 sc1
    v_add_f32 v76, v76, v78
    v_add_f32_e64 v77, v77, v79
    v_cvt_pk_bf16_f32 v76, v76, v77
    v_and_or_b32 v76, v76, -2, s60
    buffer_store_dword v76, v11, s[8:11], s77 offen offset:3072 sc1
    v_mov_b32 v9, 0
    v_mov_b32 v9, 0
    v_add_f32 v44, v44, v46
    v_add_f32 v45, v45, v47
    v_cvt_pk_bf16_f32 v44, v44, v45
    v_and_or_b32 v44, v44, -2, s60
    buffer_store_dword v44, v11, s[8:11], s91 offen offset:0 sc1
    s_xor_b32 s60, s60, 1
    v_and_b32 v34, 16, v0
    v_mov_b32 v35, 0x3f80
    v_lshlrev_b32_e64 v35, v34, v35
    v_cndmask_b32 v64, 0, v35, s[40:41]
    v_cndmask_b32 v65, 0, v35, s[42:43]
    v_cndmask_b32 v66, 0, v35, s[44:45]
    v_cndmask_b32 v67, 0, v35, s[46:47]
    v_bfe_u32 v33, v0, 5, 2
    v_lshl_add_u32 v33, v33, 2, v34
    v_mov_b32 v36, -1
    v_mov_b64 v[72:73], 0
    v_mov_b64 v[74:75], 0
    v_mov_b64 v[76:77], 0
    v_mov_b64 v[78:79], 0
    s_waitcnt vmcnt(10)
    v_min_u32_dpp v7, v7, v7 quad_perm:[1,0,3,2] row_mask:0xf bank_mask:0xf
    s_nop 1
    v_min_u32_dpp v7, v7, v7 quad_perm:[2,3,0,1] row_mask:0xf bank_mask:0xf
    s_nop 1
    v_min_u32_dpp v7, v7, v7 row_half_mirror row_mask:0xf bank_mask:0xf
    s_nop 1
    v_readfirstlane_b32 s66, v7
    v_bfe_u32 v7, v0, 6, 1
    v_mul_u32_u24 v7, 4080, v7
    v_and_or_b32 v9, v11, 28, 0
    v_add_u32_e64 v7, v7, v9
    s_nop 3
    s_nop 3
    s_nop 3
    s_nop 3
    s_nop 3
    s_nop 3
    s_nop 3
    s_nop 3
    s_nop 3
    s_nop 3
    s_nop 3
    s_nop 3
    buffer_load_dwordx4 v[16:19], v1, s[8:11], s56 offen sc1
    s_nop 3
    s_nop 3
    s_nop 3
    s_nop 3
    s_nop 3
    s_nop 3
    s_nop 3
    s_nop 3
    buffer_load_dwordx4 v[20:23], v1, s[8:11], s56 offen sc1
    s_barrier
L_r9p_125:
    s_waitcnt vmcnt(1)
    v_bitop3_b32 v34, v16, s68, 1 bitop3:0x28
    v_cmp_ne_u32_e64 vcc, 0, v34
    v_mfma_f32_16x16x32_bf16 v[68:71], v[16:19], v[64:67], 0
    v_mov_b32 v9, 0
    v_mov_b32 v9, 0
    v_mov_b32 v9, 0
    s_cbranch_vccnz L_r9r_126
L_r9f_127:
    v_mov_b32 v9, 0
    v_mov_b32 v9, 0
    v_mov_b32 v9, 0
    v_mov_b32 v9, 0
    v_pk_add_f32 v[68:69], v[68:69], v[70:71]
    v_add_f32 v70, v68, v69
    v_add_f32 v68, v68, v69
    v_mov_b32 v9, 0
    v_mov_b32 v9, 0
    v_permlane16_swap_b32 v68, v70
    v_add_f32 v69, v68, v70
    v_add_f32 v68, v68, v70
    v_mov_b32 v9, 0
    v_mov_b32 v9, 0
    v_permlane32_swap_b32 v68, v69
    v_cvt_pk_bf16_f32 v68, v68, v69
    v_min_u32_e64 v68, -2, v68
    buffer_store_dword v68, v33, s[8:11], s92 offen sc1
    buffer_store_dword v36, v33, s[8:11], s67 offen sc1
L_red_done_124:
    s_cmp_ge_u32 s66, s69
    s_cbranch_scc1 L_poll_s2
    s_cmp_ge_u32 s66, s69
    s_cbranch_scc1 L_kvd_129
    s_mov_b32 s79, 524288
L_kv_128:
    v_mov_b32 v76, 4096
    buffer_load_dwordx4 v[72:75], off, s[8:11], s82 sc1
    buffer_load_dwordx4 v[76:79], v76, s[8:11], s82 offen sc1
    s_waitcnt vmcnt(0)
    v_min3_u32 v72, v72, v73, v74
    v_min3_u32 v72, v72, v75, v76
    v_min3_u32 v72, v72, v77, v78
    v_min_u32 v72, v72, v79
    s_nop 0
    v_readfirstlane_b32 s66, v72
    v_mov_b64 v[72:73], 0
    v_mov_b64 v[74:75], 0
    v_mov_b64 v[76:77], 0
    v_mov_b64_e64 v[78:79], 0
    s_cmp_ge_u32 s66, s69
    s_cbranch_scc1 L_kvd_129
    s_sub_u32 s79, s79, 1
    s_cbranch_scc1 L_fail
    s_branch L_kv_128
L_kvd_129:
    s_mov_b32 s79, 524288
    s_waitcnt vmcnt(0)
    s_branch L_poll_s2
L_r9r_126:
    buffer_load_dwordx4 v[16:19], v1, s[8:11], s56 offen sc1
    s_waitcnt vmcnt(1)
    v_bitop3_b32 v34, v20, s68, 1 bitop3:0x28
    v_cmp_ne_u32 vcc, 0, v34
    v_mfma_f32_16x16x32_bf16 v[68:71], v[20:23], v[64:67], 0
    v_mov_b32 v9, 0
    v_mov_b32 v9, 0
    v_mov_b32 v9, 0
    s_cbranch_vccz L_r9f_127
    buffer_load_dwordx4 v[20:23], v1, s[8:11], s56 offen sc1
    s_sub_u32 s79, s79, 1
    s_cbranch_scc1 L_fail
    s_branch L_r9p_125
L_retry2_s2:
    s_waitcnt vmcnt(2)
    v_max3_u32 v9, v28, v29, v30
    v_max3_u32 v9, v9, v31, v8
    v_cmp_eq_u32_e64 vcc, -1, v9
    ds_write_b128 v0, v[28:31] offset:5120
    ds_write_b32 v11, v8 offset:8704
    s_cbranch_vccz L_retry2_s2_ok
    buffer_load_dwordx4 v[28:31], v0, s[8:11], s52 offen offset:1024 sc1
    buffer_load_dword v8, v11, s[8:11], s80 offen offset:512 sc1
L_retry2_s2_l:
    buffer_load_dwordx4 v[28:31], v0, s[8:11], s52 offen offset:1024 sc1
    buffer_load_dword v8, v11, s[8:11], s80 offen offset:512 sc1
    s_waitcnt vmcnt(2)
    v_max3_u32 v9, v28, v29, v30
    v_max3_u32 v9, v9, v31, v8
    v_cmp_eq_u32_e64 vcc, -1, v9
    ds_write_b128 v0, v[28:31] offset:5120
    ds_write_b32 v11, v8 offset:8704
    s_sub_u32 s79, s79, 1
    s_cbranch_scc1 L_fail
    s_cbranch_vccnz L_retry2_s2_l
L_retry2_s2_ok:
    s_branch L_back2_s2_go
L_poll_s3:
    buffer_load_dwordx4 v[12:15], v0, s[8:11], s52 offen sc1
L_poll_s3_2:
    s_waitcnt vmcnt(3)
    ds_read_b128 v[32:35], v0 offset:28672
    ds_read_b128 v[36:39], v0 offset:29696
    ds_read_b128 v[40:43], v0 offset:30720
    ds_read_b128 v[44:47], v0 offset:31744
    ds_read_b128 v[64:67], v0 offset:45056
    ds_read_b128 v[68:71], v0 offset:46080
    v_mov_b64 v[48:49], 0
    v_mov_b64 v[50:51], 0
    v_mov_b64 v[52:53], 0
    v_mov_b64 v[54:55], 0
    v_mov_b64 v[56:57], 0
    v_mov_b64 v[58:59], 0
    v_mov_b64 v[60:61], 0
    v_mov_b64_e64 v[62:63], 0
L_retry_s3:
    buffer_load_dwordx4 v[12:15], v0, s[8:11], s52 offen sc1
    s_waitcnt vmcnt(1)
L_step_s3:
    v_max3_u32 v9, v12, v13, v14
    v_max_u32 v9, v9, v15
    v_cmp_eq_u32_e64 vcc, -1, v9
    ds_write_b128 v0, v[12:15] offset:6144
    s_sub_u32 s79, s79, 1
    s_cbranch_scc1 L_fail
    s_cbranch_vccnz L_retry_s3
    v_smfmac_f32_16x16x64_bf16 v[48:51], v[12:15], a[0:7], v2
    v_smfmac_f32_16x16x64_bf16 v[56:59], v[12:15], a[144:151], v2
    buffer_load_dwordx4 v[28:31], v0, s[8:11], s52 offen offset:1024 sc1
    v_smfmac_f32_16x16x64_bf16 v[52:55], v[12:15], a[8:15], v2
    s_waitcnt lgkmcnt(0)
    s_barrier
    ds_read_b128 v[16:19], v0 offset:4096
    ds_read_b128 v[20:23], v0 offset:2048
    v_smfmac_f32_16x16x64_bf16 v[60:63], v[12:15], a[152:159], v2
    ds_read_b128 v[24:27], v0 offset:0
    buffer_load_dword v8, v11, s[8:11], s80 offen offset:768 sc1
    v_smfmac_f32_16x16x64_bf16 v[72:75], v[12:15], v[32:39], v2
    v_smfmac_f32_16x16x64_bf16 v[76:79], v[12:15], v[40:47], v2
    s_waitcnt lgkmcnt(2)
    v_smfmac_f32_16x16x64_bf16 v[48:51], v[16:19], a[16:23], v2
    ds_read_b128 v[32:35], v0 offset:47104
    v_smfmac_f32_16x16x64_bf16 v[56:59], v[16:19], a[160:167], v2
    ds_read_b128 v[36:39], v0 offset:48128
    v_smfmac_f32_16x16x64_bf16 v[52:55], v[16:19], a[24:31], v2
    ds_read_b128 v[40:43], v0 offset:61440
    v_smfmac_f32_16x16x64_bf16 v[60:63], v[16:19], a[168:175], v2
    ds_read_b128 v[44:47], v0 offset:62464
    buffer_load_dwordx4 v[28:31], v0, s[8:11], s52 offen offset:1024 sc1
    v_smfmac_f32_16x16x64_bf16 v[72:75], v[16:19], v[64:71], v2
    s_waitcnt lgkmcnt(2)
    v_smfmac_f32_16x16x64_bf16 v[76:79], v[16:19], v[32:39], v2
    ds_read_b128 v[32:35], v0 offset:63488
    buffer_load_dword v8, v11, s[8:11], s80 offen offset:768 sc1
    s_waitcnt lgkmcnt(6)
    v_smfmac_f32_16x16x64_bf16 v[48:51], v[20:23], a[32:39], v2
    ds_read_b128 v[36:39], v0 offset:64512
    v_smfmac_f32_16x16x64_bf16 v[56:59], v[20:23], a[176:183], v2
    buffer_load_dwordx4 v[64:67], v0, s[8:11], s61 offen sc1
    v_smfmac_f32_16x16x64_bf16 v[52:55], v[20:23], a[40:47], v2
    v_smfmac_f32_16x16x64_bf16 v[60:63], v[20:23], a[184:191], v2
    s_waitcnt vmcnt(3)
    v_max3_u32 v9, v28, v29, v30
    s_waitcnt lgkmcnt(2)
    v_smfmac_f32_16x16x64_bf16 v[72:75], v[20:23], v[40:47], v2
    v_max3_u32 v9, v9, v31, v8
    s_waitcnt lgkmcnt(0)
    v_smfmac_f32_16x16x64_bf16 v[76:79], v[20:23], v[32:39], v2
    buffer_load_dwordx4 v[68:71], v0, s[8:11], s61 offen offset:1024 sc1
    v_cmp_eq_u32_e64 vcc, -1, v9
    s_waitcnt lgkmcnt(6)
    v_smfmac_f32_16x16x64_bf16 v[48:51], v[24:27], a[48:55], v2
    ds_write_b128 v0, v[28:31] offset:7168
    v_smfmac_f32_16x16x64_bf16 v[56:59], v[24:27], a[192:199], v2
    ds_write_b32 v11, v8 offset:8960
    v_smfmac_f32_16x16x64_bf16 v[52:55], v[24:27], a[56:63], v2
    s_cbranch_vccnz L_retry2_s3
L_back2_s3_go:
    v_smfmac_f32_16x16x64_bf16 v[60:63], v[24:27], a[200:207], v2
    s_waitcnt lgkmcnt(0)
    s_barrier
    ds_read_b128 v[32:35], v0 offset:5120
    buffer_load_dwordx4 v[12:15], v0, s[8:11], s61 offen offset:2048 sc1
    v_smfmac_f32_16x16x64_bf16 v[48:51], v[28:31], a[64:71], v2
    ds_read_b128 v[36:39], v0 offset:3072
    v_smfmac_f32_16x16x64_bf16 v[56:59], v[28:31], a[208:215], v2
    ds_read_b128 v[40:43], v0 offset:1024
    v_smfmac_f32_16x16x64_bf16 v[52:55], v[28:31], a[72:79], v2
    ds_read_b128 v[44:47], v0 offset:8192
    v_smfmac_f32_16x16x64_bf16 v[60:63], v[28:31], a[216:223], v2
    buffer_load_dwordx4 v[16:19], v0, s[8:11], s61 offen offset:3072 sc1
    s_waitcnt lgkmcnt(3)
    v_smfmac_f32_16x16x64_bf16 v[48:51], v[32:35], a[80:87], v2
    buffer_load_dword v9, v1, s[8:11], s81 offen sc1
    v_smfmac_f32_16x16x64_bf16 v[56:59], v[32:35], a[224:231], v2
    ds_read_b128 v[20:23], v0 offset:14336
    buffer_load_dword v9, v1, s[8:11], s73 offen sc1
    v_smfmac_f32_16x16x64_bf16 v[52:55], v[32:35], a[88:95], v2
    v_smfmac_f32_16x16x64_bf16 v[60:63], v[32:35], a[232:239], v2
    s_waitcnt lgkmcnt(3)
    v_smfmac_f32_16x16x64_bf16 v[48:51], v[36:39], a[96:103], v2
    v_smfmac_f32_16x16x64_bf16 v[56:59], v[36:39], a[240:247], v2
    s_waitcnt vmcnt(4)
    buffer_load_dword v7, v7, s[8:11], s82 offen sc1
    v_smfmac_f32_16x16x64_bf16 v[52:55], v[36:39], a[104:111], v2
    s_waitcnt lgkmcnt(0)
    buffer_store_dwordx4 v[20:23], v0, s[8:11], s62 offen offset:0 sc1
    v_smfmac_f32_16x16x64_bf16 v[60:63], v[36:39], a[248:255], v2
    ds_read_b128 v[20:23], v0 offset:15360
    s_waitcnt lgkmcnt(3)
    v_smfmac_f32_16x16x64_bf16 v[48:51], v[40:43], a[112:119], v2
    v_smfmac_f32_16x16x64_bf16 v[56:59], v[40:43], v[80:87], v2
    v_smfmac_f32_16x16x64_bf16 v[52:55], v[40:43], a[120:127], v2
    v_smfmac_f32_16x16x64_bf16 v[60:63], v[40:43], v[88:95], v2
    s_waitcnt lgkmcnt(2)
    v_smfmac_f32_16x16x64_bf16 v[48:51], v[44:47], a[128:135], v2
    s_waitcnt lgkmcnt(0)
    buffer_store_dwordx4 v[20:23], v0, s[8:11], s62 offen offset:1024 sc1
    v_smfmac_f32_16x16x64_bf16 v[56:59], v[44:47], v[96:103], v2
    v_mov_b32_e64 v8, s72
    v_smfmac_f32_16x16x64_bf16 v[52:55], v[44:47], a[136:143], v2
    s_mov_b64 exec, 1
    buffer_store_dword v8, off, s[8:11], s65 sc1
    s_mov_b64 exec, -1
    s_waitcnt vmcnt(8)
    v_smfmac_f32_16x16x64_bf16 v[60:63], v[44:47], v[104:111], v2
    v_add_f32 v48, v48, v50
    v_add_f32 v49, v49, v51
    v_add_f32 v56, v56, v58
    v_add_f32_e64 v57, v57, v59
    v_cvt_pk_bf16_f32 v50, v48, v49
    v_cvt_pk_bf16_f32 v51, v56, v57
    v_add_f32 v52, v52, v54
    v_add_f32 v53, v53, v55
    v_mfma_f32_16x16x16_bf16 v[56:59], v[50:51], v[4:5], 0
    v_add_f32 v60, v60, v62
    v_add_f32 v61, v61, v63
    v_cvt_pk_bf16_f32 v54, v52, v53
    v_cvt_pk_bf16_f32 v55, v60, v61
    v_smfmac_f32_16x16x64_bf16 v[72:75], v[24:27], v[112:119], v2
    v_mfma_f32_16x16x16_bf16 v[60:63], v[54:55], v[4:5], 0
    v_cvt_pk_bf16_f32 v48, v56, v57
    v_cvt_pk_bf16_f32 v49, v58, v59
    v_add_u32 v8, 77824, v0
    v_smfmac_f32_16x16x64_bf16 v[76:79], v[24:27], v[120:127], v2
    v_mov_b32 v9, 0
    v_mov_b32 v9, 0
    v_cvt_pk_bf16_f32 v50, v60, v61
    v_cvt_pk_bf16_f32 v51, v62, v63
    v_mov_b32 v9, 0
    v_mov_b32 v9, 0
    v_mfma_f32_16x16x32_bf16 v[60:63], v[68:71], v[48:51], 0
    v_mfma_f32_16x16x32_bf16 v[56:59], v[64:67], v[48:51], 0
    v_mfma_f32_16x16x32_bf16 v[52:55], v[48:51], v[48:51], 0
    s_cmp_ge_u32 s7, 63
    s_cbranch_scc1 L_chain_last3
    v_smfmac_f32_16x16x64_bf16 v[72:75], v[28:31], v[128:135], v2
    v_mov_b32_dpp v56, v60 row_ror:8 row_mask:0xf bank_mask:0xc
    v_mov_b32_dpp v57, v61 row_ror:8 row_mask:0xf bank_mask:0xc
    v_mov_b32_dpp v58, v62 row_ror:8 row_mask:0xf bank_mask:0xc
    v_mov_b32_dpp v59, v63 row_ror:8 row_mask:0xf bank_mask:0xc
    ds_write_b128 v0, v[56:59] offset:12288
    ds_write_b128 v10, v[52:55]
    v_smfmac_f32_16x16x64_bf16 v[76:79], v[28:31], v[136:143], v2
    v_smfmac_f32_16x16x64_bf16 v[72:75], v[32:35], v[144:151], v2
    buffer_store_dwordx4 v[48:51], v0, s[8:11], s63 offen sc1
    v_smfmac_f32_16x16x64_bf16 v[76:79], v[32:35], v[152:159], v2
    v_smfmac_f32_16x16x64_bf16 v[72:75], v[36:39], v[160:167], v2
    s_waitcnt lgkmcnt(0)
    s_barrier
    ds_read_b128 v[48:51], v0 offset:11264
    ds_read_b128 v[52:55], v0 offset:10240
    v_smfmac_f32_16x16x64_bf16 v[76:79], v[36:39], v[168:175], v2
    ds_read_b128 v[60:63], v0 offset:9216
    ds_read2_b32 v[64:65], v3 offset0:0 offset1:32
    v_smfmac_f32_16x16x64_bf16 v[72:75], v[40:43], v[176:183], v2
    ds_read2_b32 v[66:67], v3 offset0:128 offset1:160
    v_smfmac_f32_16x16x64_bf16 v[76:79], v[40:43], v[184:191], v2
    v_smfmac_f32_16x16x64_bf16 v[72:75], v[44:47], v[192:199], v2
    v_smfmac_f32_16x16x64_bf16 v[76:79], v[44:47], v[200:207], v2
    s_waitcnt lgkmcnt(4)
    v_add_f32 v56, v56, v48
    v_add_f32 v57, v57, v49
    v_add_f32 v58, v58, v50
    v_add_f32 v59, v59, v51
    s_waitcnt lgkmcnt(2)
    v_pk_add_f32 v[52:53], v[52:53], v[60:61]
    v_pk_add_f32 v[54:55], v[54:55], v[62:63]
    s_waitcnt lgkmcnt(0)
    v_pk_add_f32 v[64:65], v[64:65], v[66:67]
    v_pk_add_f32 v[56:57], v[56:57], v[52:53]
    v_pk_add_f32 v[58:59], v[58:59], v[54:55]
    v_add_f32 v64, v64, v65
    v_max3_f32 v68, v56, v57, v58
    v_max3_f32 v68, v68, v59, v64
    v_pk_add_f32 v[72:73], v[72:73], v[74:75]
    v_pk_add_f32 v[76:77], v[76:77], v[78:79]
    v_max_f32_dpp v69, v68, v68 row_ror:8 row_mask:0xf bank_mask:0xf
    v_max_f32_dpp v68, v68, v68 row_ror:8 row_mask:0xf bank_mask:0xf
    v_cvt_pk_bf16_f32 v74, v72, v73
    v_cvt_pk_bf16_f32 v75, v76, v77
    v_permlane16_swap_b32 v68, v69
    v_max_f32 v65, v68, v69
    v_max_f32 v69, v68, v69
    v_mov_b32 v49, 0
    v_mov_b32 v50, 0
    v_permlane32_swap_b32 v65, v69
    v_max_f32 v68, v65, v69
    v_mul_f32 v68, s75, v68
    v_fma_f32 v56, v56, s74, v68
    v_fma_f32 v57, v57, s74, v68
    v_fma_f32 v58, v58, s74, v68
    v_fma_f32 v59, v59, s74, v68
    v_fma_f32 v64, v64, s74, v68
    v_exp_f32 v56, v56
    v_exp_f32 v57, v57
    v_exp_f32 v58, v58
    v_exp_f32 v59, v59
    v_exp_f32_e64 v64, v64
    v_cvt_pk_bf16_f32 v60, v56, v57
    v_cvt_pk_bf16_f32 v61, v58, v59
    v_cndmask_b32 v52, 0, v60, s[70:71]
    v_cndmask_b32 v53, 0, v61, s[70:71]
    v_cndmask_b32 v54, v60, 0, s[70:71]
    v_cndmask_b32 v55, v61, 0, s[70:71]
    v_pk_add_f32 v[66:67], v[56:57], v[58:59]
    s_waitcnt vmcnt(7)
    v_mfma_f32_16x16x32_bf16 v[60:63], v[12:15], v[52:55], 0
    v_cvt_pk_bf16_f32 v72, v64, 0
    v_cvt_pk_bf16_f32 v73, 0, v64
    v_mfma_f32_16x16x32_bf16 v[68:71], v[16:19], v[52:55], 0
    v_cndmask_b32 v48, v73, v72, s[70:71]
    v_cndmask_b32 v51, v73, v72, s[70:71]
    v_add_f32 v65, v66, v67
    v_mfma_f32_16x16x16_bf16 v[60:63], v[74:75], v[48:49], v[60:63]
    v_add_f32_e64 v65, v65, v64
    ds_read_b128 v[20:23], v8 offset:0
    ds_read_b128 v[24:27], v8 offset:1024
    v_mfma_f32_16x16x16_bf16 v[68:71], v[74:75], v[50:51], v[68:71]
    v_add_f32_dpp v66, v65, v65 row_ror:8 row_mask:0xf bank_mask:0xf
    v_add_f32_dpp v65, v65, v65 row_ror:8 row_mask:0xf bank_mask:0xf
    ds_read_b128 v[28:31], v8 offset:2048
    ds_read_b128 v[32:35], v8 offset:3072
    v_permlane16_swap_b32 v65, v66
    v_add_f32 v64, v65, v66
    v_add_f32_e64 v65, v65, v66
    v_add_f32_dpp v56, v60, v60 row_ror:8 row_mask:0xf bank_mask:0x3
    v_add_f32_dpp v57, v61, v61 row_ror:8 row_mask:0xf bank_mask:0x3
    v_permlane32_swap_b32_e64 v64, v65
    v_add_f32_dpp v58, v62, v62 row_ror:8 row_mask:0xf bank_mask:0x3
    v_add_f32_dpp v59, v63, v63 row_ror:8 row_mask:0xf bank_mask:0x3
    v_add_f32 v64, v65, v64
    v_rcp_f32 v64, v64
    v_add_f32_dpp v56, v68, v68 row_ror:8 row_mask:0xf bank_mask:0xc
    v_add_f32_dpp v57, v69, v69 row_ror:8 row_mask:0xf bank_mask:0xc
    v_add_f32_dpp v58, v70, v70 row_ror:8 row_mask:0xf bank_mask:0xc
    v_add_f32_dpp v59, v71, v71 row_ror:8 row_mask:0xf bank_mask:0xc
    v_pk_mul_f32 v[56:57], v[56:57], v[64:65] op_sel_hi:[1,0]
    v_pk_mul_f32 v[58:59], v[58:59], v[64:65] op_sel_hi:[1,0]
    v_cvt_pk_bf16_f32 v78, v56, v57
    v_cvt_pk_bf16_f32 v79, v58, v59
    ds_write_b64 v6, v[78:79] offset:0
    v_mov_b64 v[48:49], 0
    v_mov_b64 v[50:51], 0
    ds_read_b128 v[36:39], v8 offset:16384
    v_mov_b64 v[52:53], 0
    v_mov_b64 v[54:55], 0
    v_lshlrev_b32 v76, 1, v11
    v_mov_b64 v[56:57], 0
    v_mov_b64 v[58:59], 0
    v_mov_b64 v[60:61], 0
    v_mov_b64 v[62:63], 0
    v_mov_b64 v[44:45], 0
    v_mov_b64 v[46:47], 0
    v_mov_b32 v9, 0
    v_mov_b32_e64 v9, 0
    s_waitcnt lgkmcnt(1)
    s_barrier
    ds_read_b128 v[12:15], v0 offset:0
    v_mov_b64_e64 v[64:65], 0
    ds_read_b128 v[16:19], v0 offset:1024
    v_mov_b64 v[66:67], 0
    v_mov_b64 v[68:69], 0
    v_mov_b64 v[70:71], 0
    v_mov_b64 v[72:73], 0
    ds_read_b128 v[40:43], v8 offset:17408
    v_mov_b64 v[78:79], 0
    v_mov_b32_e64 v9, 0
    s_waitcnt lgkmcnt(1)
    v_smfmac_f32_16x16x64_bf16 v[48:51], v[12:15], v[20:27], v2
    s_add_u32 s7, s7, 1
    ds_read_b128 v[20:23], v8 offset:18432
    v_smfmac_f32_16x16x64_bf16 v[48:51], v[16:19], v[28:35], v2
    s_add_u32 s92, s53, s93
    ds_read_b128 v[24:27], v8 offset:19456
    ds_read_b128 v[28:31], v8 offset:32768
    ds_write_b64 v76, v[74:75] offset:15872
    v_mov_b64 v[74:75], 0
    v_mov_b64_e64 v[76:77], 0
    s_waitcnt lgkmcnt(4)
    v_smfmac_f32_16x16x64_bf16 v[52:55], v[12:15], v[36:43], v2
    s_add_u32 s67, s54, s93
    ds_read_b128 v[32:35], v8 offset:33792
    ds_read_b128 v[36:39], v8 offset:34816
    s_waitcnt lgkmcnt(4)
    v_smfmac_f32_16x16x64_bf16 v[52:55], v[16:19], v[20:27], v2
    s_mov_b32 s68, s60
    ds_read_b128 v[40:43], v8 offset:35840
    ds_read_b128 v[20:23], v8 offset:49152
    v_add_f32 v48, v48, v50
    v_add_f32_e64 v49, v49, v51
    v_smfmac_f32_16x16x64_bf16 v[56:59], v[12:15], v[208:215], v2
    s_mov_b32 s54, s53
    ds_read_b128 v[24:27], v8 offset:50176
    v_cvt_pk_bf16_f32 v48, v48, v49
    v_and_or_b32 v48, v48, -2, s60
    v_smfmac_f32_16x16x64_bf16 v[56:59], v[16:19], v[216:223], v2
    buffer_store_dword v48, v11, s[8:11], s83 offen offset:0 sc1
    s_add_u32 s52, s53, 6144
    v_add_f32 v52, v52, v54
    v_add_f32 v53, v53, v55
    s_waitcnt lgkmcnt(4)
    v_smfmac_f32_16x16x64_bf16 v[60:63], v[12:15], v[28:35], v2
    s_add_u32 s80, s53, 8192
    ds_read_b128 v[28:31], v8 offset:51200
    v_cvt_pk_bf16_f32 v52, v52, v53
    v_and_or_b32 v52, v52, -2, s60
    s_waitcnt lgkmcnt(3)
    v_smfmac_f32_16x16x64_bf16 v[60:63], v[16:19], v[36:43], v2
    buffer_store_dword v52, v11, s[8:11], s83 offen offset:1024 sc1
    s_add_u32 s53, s53, 9216
    ds_read_b128 v[32:35], v8 offset:52224
    v_add_u32 v8, 65536, v8
    ds_read_b128 v[36:39], v8 offset:0
    v_add_f32 v56, v56, v58
    v_add_f32 v57, v57, v59
    s_waitcnt lgkmcnt(3)
    v_smfmac_f32_16x16x64_bf16 v[64:67], v[12:15], v[20:27], v2
    s_cmp_eq_u32 s53, 420864
    s_cselect_b32 s53, 393216, s53
    ds_read_b128 v[40:43], v8 offset:1024
    ds_read_b128 v[20:23], v8 offset:2048
    v_cvt_pk_bf16_f32 v56, v56, v57
    v_and_or_b32 v56, v56, -2, s60
    s_waitcnt lgkmcnt(3)
    v_smfmac_f32_16x16x64_bf16 v[64:67], v[16:19], v[28:35], v2
    buffer_store_dword v56, v11, s[8:11], s83 offen offset:2048 sc1
    s_add_u32 s61, s61, 524288
    ds_read_b128 v[24:27], v8 offset:3072
    ds_read_b128 v[28:31], v8 offset:16384
    v_add_f32 v60, v60, v62
    v_add_f32_e64 v61, v61, v63
    v_smfmac_f32_16x16x64_bf16 v[68:71], v[12:15], v[224:231], v2
    s_add_u32 s63, s63, 131072
    ds_read_b128 v[32:35], v8 offset:17408
    v_cvt_pk_bf16_f32 v60, v60, v61
    v_and_or_b32 v60, v60, -2, s60
    v_smfmac_f32_16x16x64_bf16 v[68:71], v[16:19], v[232:239], v2
    buffer_store_dword v60, v11, s[8:11], s83 offen offset:3072 sc1
    s_sub_u32 s62, s64, 1536
    v_add_f32 v64, v64, v66
    v_add_f32_e64 v65, v65, v67
    s_waitcnt lgkmcnt(4)
    v_smfmac_f32_16x16x64_bf16 v[72:75], v[12:15], v[36:43], v2
    s_add_u32 s64, s64, 65536
    ds_read_b128 v[36:39], v8 offset:18432
    v_cvt_pk_bf16_f32 v64, v64, v65
    v_and_or_b32 v64, v64, -2, s60
    s_waitcnt lgkmcnt(3)
    v_smfmac_f32_16x16x64_bf16 v[72:75], v[16:19], v[20:27], v2
    buffer_store_dword v64, v11, s[8:11], s77 offen offset:0 sc1
    s_add_u32 s69, s7, 3
    s_min_u32 s69, s69, 64
    ds_read_b128 v[40:43], v8 offset:19456
    v_add_f32 v68, v68, v70
    v_add_f32_e64 v69, v69, v71
    v_smfmac_f32_16x16x64_bf16 v[76:79], v[12:15], v[240:247], v2
    s_mov_b32 s79, 524288
    v_cvt_pk_bf16_f32 v68, v68, v69
    v_and_or_b32 v68, v68, -2, s60
    v_smfmac_f32_16x16x64_bf16 v[76:79], v[16:19], v[248:255], v2
    buffer_store_dword v68, v11, s[8:11], s77 offen offset:1024 sc1
    s_cmp_lt_u32 s7, 62
    s_cselect_b32 s3, 1048576, 0
    s_add_u32 s81, s61, s3
    v_add_f32 v72, v72, v74
    v_add_f32_e64 v73, v73, v75
    s_waitcnt lgkmcnt(2)
    v_smfmac_f32_16x16x64_bf16 v[44:47], v[12:15], v[28:35], v2
    s_sub_u32 s73, s81, 4096
    s_sub_u32 s81, s81, 12288
    v_cvt_pk_bf16_f32 v72, v72, v73
    v_and_or_b32 v72, v72, -2, s60
    s_waitcnt lgkmcnt(0)
    v_smfmac_f32_16x16x64_bf16 v[44:47], v[16:19], v[36:43], v2
    buffer_store_dword v72, v11, s[8:11], s77 offen offset:2048 sc1
    s_sub_u32 s72, s7, 1
    v_add_f32 v76, v76, v78
    v_add_f32 v77, v77, v79
    v_cvt_pk_bf16_f32 v76, v76, v77
    v_and_or_b32 v76, v76, -2, s60
    buffer_store_dword v76, v11, s[8:11], s77 offen offset:3072 sc1
    v_mov_b32 v9, 0
    v_mov_b32 v9, 0
    v_add_f32 v44, v44, v46
    v_add_f32 v45, v45, v47
    v_cvt_pk_bf16_f32 v44, v44, v45
    v_and_or_b32 v44, v44, -2, s60
    buffer_store_dword v44, v11, s[8:11], s91 offen offset:0 sc1
    s_xor_b32 s60, s60, 1
    s_cmp_lt_u32 s7, 62
    s_cbranch_scc1 L_noflag_131
    v_mov_b32 v8, s72
    s_waitcnt vmcnt(11)
    s_mov_b64 exec, 1
    buffer_store_dword v8, off, s[8:11], s65 sc1
    s_mov_b64 exec, -1
L_noflag_131:
    v_mov_b64 v[72:73], 0
    v_mov_b64 v[74:75], 0
    v_mov_b64 v[76:77], 0
    v_mov_b64 v[78:79], 0
    s_waitcnt vmcnt(13)
    v_min_u32_dpp v7, v7, v7 quad_perm:[1,0,3,2] row_mask:0xf bank_mask:0xf
    s_nop 1
    v_min_u32_dpp v7, v7, v7 quad_perm:[2,3,0,1] row_mask:0xf bank_mask:0xf
    s_nop 1
    v_min_u32_dpp v7, v7, v7 row_half_mirror row_mask:0xf bank_mask:0xf
    s_nop 1
    v_readfirstlane_b32 s66, v7
    v_bfe_u32 v7, v0, 6, 1
    v_mul_u32_u24 v7, 4080, v7
    v_and_or_b32 v9, v11, 28, 0
    v_add_u32_e64 v7, v7, v9
L_red_done_130:
    s_barrier
    s_nop 3
    s_nop 3
    s_nop 3
    s_nop 3
    s_nop 3
    s_nop 3
    s_nop 3
    s_nop 3
    s_nop 3
    s_nop 3
    s_nop 3
    s_nop 3
    s_nop 3
    s_nop 3
    s_nop 3
    s_nop 3
    s_nop 3
    s_cmp_ge_u32 s66, s69
    s_cbranch_scc1 L_poll_s3
    s_cmp_ge_u32 s66, s69
    s_cbranch_scc1 L_kvd_133
    s_mov_b32 s79, 524288
L_kv_132:
    v_mov_b32 v76, 4096
    buffer_load_dwordx4 v[72:75], off, s[8:11], s82 sc1
    buffer_load_dwordx4 v[76:79], v76, s[8:11], s82 offen sc1
    s_waitcnt vmcnt(0)
    v_min3_u32 v72, v72, v73, v74
    v_min3_u32 v72, v72, v75, v76
    v_min3_u32 v72, v72, v77, v78
    v_min_u32 v72, v72, v79
    s_nop 0
    v_readfirstlane_b32 s66, v72
    v_mov_b64 v[72:73], 0
    v_mov_b64 v[74:75], 0
    v_mov_b64 v[76:77], 0
    v_mov_b64_e64 v[78:79], 0
    s_cmp_ge_u32 s66, s69
    s_cbranch_scc1 L_kvd_133
    s_sub_u32 s79, s79, 1
    s_cbranch_scc1 L_fail
    s_branch L_kv_132
L_kvd_133:
    s_mov_b32 s79, 524288
    s_waitcnt vmcnt(0)
    s_branch L_poll_s3
L_retry2_s3:
    s_waitcnt vmcnt(2)
    v_max3_u32 v9, v28, v29, v30
    v_max3_u32 v9, v9, v31, v8
    v_cmp_eq_u32 vcc, -1, v9
    ds_write_b128 v0, v[28:31] offset:7168
    ds_write_b32 v11, v8 offset:8960
    s_cbranch_vccz L_retry2_s3_ok
    buffer_load_dwordx4 v[28:31], v0, s[8:11], s52 offen offset:1024 sc1
    buffer_load_dword v8, v11, s[8:11], s80 offen offset:768 sc1
L_retry2_s3_l:
    buffer_load_dwordx4 v[28:31], v0, s[8:11], s52 offen offset:1024 sc1
    buffer_load_dword v8, v11, s[8:11], s80 offen offset:768 sc1
    s_waitcnt vmcnt(2)
    v_max3_u32 v9, v28, v29, v30
    v_max3_u32 v9, v9, v31, v8
    v_cmp_eq_u32_e64 vcc, -1, v9
    ds_write_b128 v0, v[28:31] offset:7168
    ds_write_b32 v11, v8 offset:8960
    s_sub_u32 s79, s79, 1
    s_cbranch_scc1 L_fail
    s_cbranch_vccnz L_retry2_s3_l
L_retry2_s3_ok:
    s_branch L_back2_s3_go
L_code_end:
.section .rodata,"a"
.p2align 6
.amdhsa_kernel parallel_sum__memory_aug_recurrent_mem_tr__dense_activation_silu__prompt_kernel
  .amdhsa_next_free_vgpr 512
  .amdhsa_next_free_sgpr 102
  .amdhsa_accum_offset 256
  .amdhsa_group_segment_fixed_size 0
  .amdhsa_kernarg_size 104
  .amdhsa_user_sgpr_count 2
  .amdhsa_user_sgpr_kernarg_segment_ptr 1
  .amdhsa_system_sgpr_workgroup_id_x 1
.end_amdhsa_kernel
```
